```python
import torch

def _softmax(x, axis=-1):
    return torch.softmax(x, dim=axis)
def _gelu(x):
    return torch.nn.functional.gelu(x, approximate="tanh")
def _silu(x):
    return torch.nn.functional.silu(x)
def _sigmoid(x):
    return torch.sigmoid(x)
def _layernorm(x, axis=-1, eps=1e-5):
    m = x.mean(dim=axis, keepdim=True)
    v = x.var(dim=axis, keepdim=True, unbiased=False)
    return (x - m) / torch.sqrt(v + eps)
def _scatter_add(tgt, idx, src, axis=0):
    return tgt.clone().index_add_(axis, idx, src)
def _segment_sum(src, seg, n):
    out = torch.zeros((n,) + src.shape[1:], dtype=src.dtype)
    return out.index_add_(0, seg, src)
def _pad(x, pw):
    flat = tuple(v for pair in reversed(pw) for v in pair)
    return torch.nn.functional.pad(x, flat)

kernel_name = 'standalone__gqa_block_cached__near_ridge'

def setup_inputs():

    _w = (lambda a: (lambda t: t.to(torch.bfloat16) if t.is_floating_point() else t)(torch.as_tensor(a)))
    B, Sq, D = 32, 144, 640
    Hq, Hkv, Sk, Dh = 32, 32, 512, 128
    assert Hq % Hkv == 0, (Hq, Hkv)
    return {
        "x": _w((lambda *s: torch.randn(*s, dtype=torch.bfloat16) * 0.8)(B, Sq, D)),
        "k_cache": _w((lambda *s: torch.randn(*s, dtype=torch.bfloat16) * 0.8)(B, Hkv, Sk, Dh)),
        "v_cache": _w((lambda *s: torch.randn(*s, dtype=torch.bfloat16) * 0.05)(B, Hkv, Sk, Dh)),
        "wq": _w((lambda *s: torch.randn(*s, dtype=torch.bfloat16) * 0.8)(D, Hq * Dh) * (D ** -0.5)),
        "wo": _w((lambda *s: torch.randn(*s, dtype=torch.bfloat16) * 0.05)(Hq * Dh, D) * ((Hq * Dh) ** -0.5)),
    }

def reference(x, k_cache, v_cache, wq, wo):
    B, Sq, D = x.shape
    Hq, Dh = 32, 128
    Hkv = k_cache.shape[1]
    rep = Hq // Hkv
    q = (lambda x, *d: x.permute(*d))((x @ wq).reshape(B, Sq, Hq, Dh), 0, 2, 1, 3)
    k = (lambda x, n, axis: torch.repeat_interleave(x, n, dim=axis))(k_cache, rep, axis=1)
    v = (lambda x, n, axis: torch.repeat_interleave(x, n, dim=axis))(v_cache, rep, axis=1)
    scores = torch.einsum("bhqd,bhkd->bhqk", q, k) * (Dh ** -0.5)
    p = _softmax(scores, axis=-1)
    o = torch.einsum("bhqk,bhkd->bhqd", p, v)
    return (lambda x, *d: x.permute(*d))(o, 0, 2, 1, 3).reshape(B, Sq, Hq * Dh) @ wo
```

```asm
; @launch grid=(256,1,1) block=(256,1,1) lds=163840
.amdgcn_target "amdgcn-amd-amdhsa--gfx950"
.text
.globl standalone__gqa_block_cached__near_ridge_kernel
.p2align 8
.type standalone__gqa_block_cached__near_ridge_kernel,@function
standalone__gqa_block_cached__near_ridge_kernel:
    s_cmp_ge_u32 s2, 256
    s_cbranch_scc1 gqa_kernel_end
    s_load_dwordx8 s[84:91], s[0:1], 0
    s_load_dwordx8 s[92:99], s[0:1], 32
    v_lshrrev_b32 v84, 6, v0
    v_and_b32 v85, 63, v0
    v_readfirstlane_b32 s3, v84
    v_and_b32 v90, 1, v84
    v_lshrrev_b32 v91, 1, v84
    v_lshrrev_b32 v92, 5, v85
    v_bfe_u32 v93, v85, 2, 3
    v_and_b32 v94, 3, v85
    s_movk_i32 s40, 1280
    v_mul_lo_u32 v86, v93, s40
    v_lshl_add_u32 v86, v92, 6, v86
    v_xor_b32 v88, 3, v94
    v_lshl_add_u32 v13, v94, 4, v86
    v_lshl_add_u32 v87, v88, 4, v86
    v_add_u32 v14, 9216, v87
    v_add_u32 v15, 18432, v13
    v_add_u32 v16, 27648, v87
    v_lshrrev_b32 v89, 2, v93
    v_lshlrev_b32 v97, 1, v89
    v_xor_b32 v97, v97, v94
    v_and_b32 v87, 3, v93
    v_lshl_add_u32 v87, v89, 3, v87
    v_lshl_add_u32 v87, v90, 5, v87
    v_lshlrev_b32 v89, 6, v92
    v_lshl_add_u32 v87, v87, 13, v89
    v_lshl_add_u32 v89, v90, 7, v89
    v_lshl_add_u32 v9, v97, 4, v87
    v_add_u32 v10, 130048, v9
    v_add_u32 v11, 30720, v9
    v_add_u32 v12, 160768, v9
    v_mul_u32_u24 v87, 3, v91
    v_xor_b32 v87, v87, v94
    v_lshl_add_u32 v87, v87, 4, v86
    v_lshlrev_b32 v86, 2, v84
    v_sub_u32 v86, v91, v86
    v_add_u32 v86, 16, v86
    s_movk_i32 s41, 10240
    v_mul_lo_u32 v86, v86, s41
    v_add_u32 v86, v86, v87
    v_lshl_add_u32 v17, v90, 30, v86
    s_bfe_u32 s40, s2, 0x3
    s_lshr_b32 s45, s2, 3
    s_and_b32 s43, s2, 7
    s_lshl_b32 s43, s43, 0
    s_or_b32 s43, s43, s40
    s_bfe_u32 s42, s2, 0x3
    s_lshl_b32 s42, s42, 5
    s_or_b32 s42, s42, s45
    s_mul_i32 s40, s40, 32
    s_lshl_b32 s45, s45, 0
    s_add_u32 s45, s45, s40
    s_and_b32 s45, s45, 31
    s_lshr_b32 s44, s3, 1
    s_lshl_b32 s60, s3, 12
    s_add_u32 s75, s60, 65536
    s_lshl_b32 s72, s44, 10
    s_add_u32 s72, s72, 16384
    s_bitcmp1_b32 s3, 0
    s_cselect_b32 s72, 0x1d000, s72
    s_lshl_b32 s40, s43, 2
    s_add_u32 s40, s40, s44
    s_lshl_b32 s63, s40, 8
    s_add_u32 s63, s63, 512
    s_xor_b32 s64, s63, 128
    s_lshl_b32 s41, s42, 5
    s_add_u32 s40, s40, s41
    s_lshl_b32 s59, s40, 17
    s_mul_i32 s40, s45, 5
    s_lshr_b32 s40, s40, 4
    s_lshl_b32 s65, s40, 7
    s_lshl_b32 s62, s40, 19
    s_mul_i32 s66, s42, 184320
    s_mul_i32 s40, s3, 40960
    s_add_u32 s66, s66, s40
    v_lshl_add_u32 v87, v85, 2, v84
    s_lshl3_add_u32 s40, s42, s43
    s_mul_i32 s40, s40, 23040
    v_mul_u32_u24 v1, 1280, v87
    v_cmp_gt_u32 vcc, 18, v87
    v_add_u32 v1, s40, v1
    v_mov_b32 v86, 0x40000000
    v_cndmask_b32 v1, v86, v1, vcc
    s_mov_b32 s10, 0x5a0000
    s_mov_b32 s11, 0x20000
    s_mov_b32 s22, 0x500000
    s_mov_b32 s23, 0x20000
    s_mov_b32 s14, 0x8000000
    s_mov_b32 s15, 0x20000
    s_mov_b32 s18, 0x8000000
    s_mov_b32 s19, 0x20000
    s_mov_b32 s30, 0x500000
    s_mov_b32 s31, 0x20000
    s_mov_b32 s34, 0x5a0000
    s_mov_b32 s35, 0x20000
    s_mov_b32 s38, 0x100
    s_mov_b32 s39, 0x20000
    s_mov_b32 s26, 0x3212000
    s_mov_b32 s27, 0x20000
    s_waitcnt lgkmcnt(0)
    s_mov_b32 s8, s84
    s_and_b32 s9, s85, 0xffff
    s_mov_b32 s20, s90
    s_and_b32 s21, s91, 0xffff
    s_add_u32 m0, s60, 47104
    s_add_u32 s53, s66, s65
    buffer_load_dwordx4 v13, s[8:11], s53 offen offset:0 lds
    buffer_load_dwordx4 v14, s[8:11], s53 offen offset:1024 lds
    s_add_u32 s65, s65, 128
    buffer_load_dwordx4 v15, s[8:11], s53 offen offset:2048 lds
    s_cmp_ge_u32 s65, 1280
    s_cselect_b32 s65, 0, s65
    buffer_load_dwordx4 v16, s[8:11], s53 offen offset:3072 lds
    s_add_u32 m0, s72, 47104
    s_nop 0
    buffer_load_dwordx4 v17, s[8:11], s53 offen offset:0 lds
    s_add_u32 m0, s75, 0
    s_add_u32 s53, s63, s62
    buffer_load_dwordx4 v9, s[20:23], s53 offen offset:0 lds
    buffer_load_dwordx4 v10, s[20:23], s53 offen offset:1024 lds
    buffer_load_dwordx4 v11, s[20:23], s53 offen offset:2048 lds
    buffer_load_dwordx4 v12, s[20:23], s53 offen offset:3072 lds
    s_add_u32 m0, s75, 16384
    s_add_u32 s53, s64, s62
    buffer_load_dwordx4 v9, s[20:23], s53 offen offset:0 lds
    buffer_load_dwordx4 v10, s[20:23], s53 offen offset:1024 lds
    s_sub_u32 s62, s62, 512
    buffer_load_dwordx4 v11, s[20:23], s53 offen offset:2048 lds
    buffer_load_dwordx4 v12, s[20:23], s53 offen offset:3072 lds
    s_mov_b32 s12, s86
    s_and_b32 s13, s87, 0xffff
    s_mov_b32 s16, s88
    s_and_b32 s17, s89, 0xffff
    s_mov_b32 s28, s92
    s_and_b32 s29, s93, 0xffff
    s_mov_b32 s32, s94
    s_and_b32 s33, s95, 0xffff
    s_mov_b32 s36, s96
    s_and_b32 s37, s97, 0xffff
    s_mov_b32 s24, s98
    s_and_b32 s25, s99, 0xffff
    v_lshlrev_b32 v24, 4, v85
    s_getpc_b64 s[84:85]
gqa_kernel_pc:
    s_lshr_b32 s40, s2, 1
    s_and_b32 s40, s40, 0x7c
    s_add_u32 s40, s40, s3
    s_lshl_b32 s40, s40, 9
    s_add_u32 s40, s40, 3072
    s_add_u32 s84, s84, s40
    s_addc_u32 s85, s85, 0
    v_lshrrev_b32 v2, 4, v85
    v_lshlrev_b32 v2, 7, v2
    v_mov_b32 v3, s85
    v_add_co_u32 v2, vcc, s84, v2
    s_nop 1
    v_addc_co_u32 v3, vcc, 0, v3, vcc
    global_load_dword v254, v[2:3], off
    v_lshl_add_u32 v87, v93, 8, v89
    v_lshl_add_u32 v5, v97, 4, v87
    v_add_u32 v6, 1024, v5
    v_add_u32 v7, 2048, v5
    v_add_u32 v8, 3072, v5
    s_lshl_b32 s40, s2, 1
    s_add_u32 s40, s40, s44
    s_mul_i32 s40, s40, 5
    s_lshr_b32 s41, s2, 3
    s_add_u32 s40, s40, s41
    s_and_b32 s40, s40, 15
    s_lshl_b32 s56, s40, 13
    s_mov_b32 s89, s60
    s_mov_b32 s90, s75
    s_mov_b32 s91, s59
    s_add_u32 s74, s56, 16384
    s_and_b32 s74, s74, 0x1ffff
    s_add_u32 s74, s74, s59
    s_add_u32 s74, s74, 262144
    s_add_u32 s83, s56, 32768
    s_and_b32 s83, s83, 0x1ffff
    s_add_u32 s83, s83, s59
    s_add_u32 s83, s83, 262144
    s_add_u32 s94, s56, 24576
    s_and_b32 s94, s94, 0x1ffff
    s_add_u32 s94, s94, s59
    s_add_u32 s94, s94, 262144
    s_mov_b32 s67, 0
    s_movk_i32 s68, 2048
    s_mov_b32 s69, 0x83210549
    s_mov_b32 s6, 0x8000000
    s_mov_b32 s7, 0x20000
    s_and_b32 s95, s3, 1
    s_lshl_b32 s40, s42, 2
    s_lshr_b32 s41, s43, 1
    s_add_u32 s40, s40, s41
    s_and_b32 s41, s43, 1
    s_lshl_b32 s61, s44, 7
    s_add_u32 s61, s61, s40
    s_lshl1_add_u32 s61, s61, s41
    s_lshl1_add_u32 s61, s61, s95
    s_lshl3_add_u32 s61, s61, 52428800
    s_mul_i32 s40, s40, 40960
    s_mul_i32 s77, s41, 20480
    s_add_u32 s77, s77, s40
    s_lshl_b32 s73, s3, 10
    s_add_u32 s77, s77, s73
    s_add_u32 s73, s73, 155648
    s_mul_i32 s41, s41, 640
    s_add_u32 s76, s41, s40
    s_mul_i32 s41, s3, 10240
    s_add_u32 s76, s76, s41
    s_mov_b32 s71, 0xfff007c
    s_sub_u32 s76, s76, 256
    s_lshl2_add_u32 s40, s42, s3
    s_mul_i32 s40, s40, 512
    s_lshl_b32 s41, s43, 3
    s_add_u32 s40, s40, s41
    s_add_u32 s45, s40, 52436992
    v_mul_u32_u24 v4, 128, v94
    s_or_b32 s40, s2, s3
    s_cmp_lg_u32 s40, 0
    s_cbranch_scc1 gqa_kernel_nononce
    s_memrealtime s[48:49]
    s_waitcnt lgkmcnt(0)
    s_or_b32 s49, s49, 0x80000000
    v_mov_b32 v244, s48
    v_mov_b32 v245, s49
    s_mov_b64 exec, 1
    buffer_store_dwordx2 v[244:245], v24, s[36:39], 0 offen sc1
    s_mov_b64 exec, -1
gqa_kernel_nononce:
    s_mov_b32 s50, 0x40000
    s_mov_b32 s51, 0
    s_mul_i32 s40, s42, 1
    s_lshr_b32 s40, s40, 5
    s_add_u32 s40, s40, 1
    s_lshl_b32 s96, 1, s40
    s_mov_b64 s[54:55], 0
    s_mov_b32 s46, 0x3e0293ee
    s_mov_b32 s47, s46
    s_mov_b32 s81, 0x33800000
    s_mov_b32 s82, 0x47800000
    v_and_b32 v95, 15, v85
    v_lshrrev_b32 v96, 4, v85
    v_lshrrev_b32 v86, 3, v95
    v_mul_u32_u24 v88, 3, v86
    v_xor_b32 v88, v88, v96
    v_and_b32 v87, 7, v95
    v_lshlrev_b32 v87, 6, v87
    v_lshl_add_u32 v87, v88, 4, v87
    v_lshl_add_u32 v87, v86, 10, v87
    v_add_u32 v22, 131072, v87
    v_lshl_add_u32 v21, v90, 13, v22
    v_add_u32 v73, 47104, v87
    v_lshl_add_u32 v72, v90, 13, v73
    v_and_b32 v88, 0x1ff, v24
    v_lshl_add_u32 v88, v92, 10, v88
    v_lshl_add_u32 v88, v91, 9, v88
    v_lshl_add_u32 v88, v90, 3, v88
    v_add_u32 v228, 159744, v88
    v_and_b32 v87, 0xffffffcf, v87
    v_bfe_u32 v86, v95, 2, 1
    v_lshlrev_b32 v86, 1, v86
    v_xor_b32 v86, v86, v96
    v_lshl_add_u32 v87, v86, 4, v87
    v_lshl_add_u32 v18, v91, 13, v87
    v_lshrrev_b32 v86, 1, v96
    v_lshlrev_b32 v87, 10, v86
    v_lshl_add_u32 v87, v93, 6, v87
    v_and_b32 v88, 1, v85
    v_lshl_add_u32 v87, v88, 3, v87
    v_bfe_u32 v88, v85, 1, 1
    v_lshl_add_u32 v87, v88, 4, v87
    v_and_b32 v88, 1, v96
    v_lshl_add_u32 v87, v88, 5, v87
    v_lshl_add_u32 v19, v91, 13, v87
    v_xor_b32 v20, 32, v19
    v_lshl_add_u32 v86, v90, 9, v19
    v_xor_b32 v87, 32, v86
    v_xor_b32 v88, 512, v86
    v_xor_b32 v89, 512, v87
    v_add_u32 v68, 65536, v86
    v_add_u32 v69, 65536, v87
    v_add_u32 v70, 65536, v88
    v_add_u32 v71, 65536, v89
    v_mov_b32 v112, 0
    v_mov_b32 v113, 0
    v_mov_b32 v114, 0
    v_mov_b32 v115, 0
    v_mov_b32 v144, 0
    v_mov_b32 v145, 0
    v_mov_b32 v146, 0
    v_mov_b32 v147, 0
    v_mov_b32 v176, 0
    v_mov_b32 v177, 0
    v_mov_b32 v178, 0
    v_mov_b32 v179, 0
    v_mov_b32 v208, 0
    v_mov_b32 v209, 0
    v_mov_b32 v210, 0
    v_mov_b32 v211, 0
    s_add_u32 m0, s75, 32768
    s_add_u32 s53, s63, s62
    buffer_load_dwordx4 v9, s[20:23], s53 offen offset:0 lds
    buffer_load_dwordx4 v10, s[20:23], s53 offen offset:1024 lds
    buffer_load_dwordx4 v11, s[20:23], s53 offen offset:2048 lds
    buffer_load_dwordx4 v12, s[20:23], s53 offen offset:3072 lds
    s_waitcnt vmcnt(9) lgkmcnt(0)
    s_barrier
    ds_read_b64_tr_b16 a[20:21], v68 offset:0
    ds_read_b64_tr_b16 a[22:23], v68 offset:2048
    ds_read_b128 v[44:47], v73 offset:16384
    ds_read_b128 v[64:67], v73 offset:16896
    ds_read_b128 v[40:43], v72 offset:6144
    ds_read_b128 v[60:63], v72 offset:6656
    ds_read_b128 v[36:39], v72 offset:4096
    ds_read_b128 v[56:59], v72 offset:4608
    s_waitcnt lgkmcnt(5)
    v_mfma_f32_16x16x32_bf16 a[144:147], a[20:23], v[44:47], 0
    s_add_u32 m0, s60, 131072
    s_add_u32 s53, s66, s65
    ds_read_b64_tr_b16 a[24:25], v68 offset:4096
    ds_read_b64_tr_b16 a[26:27], v68 offset:6144
    ds_read_b128 v[32:35], v72 offset:2048
    s_waitcnt lgkmcnt(1)
    v_mfma_f32_16x16x32_bf16 a[144:147], a[24:27], v[64:67], a[144:147]
    buffer_load_dwordx4 v13, s[8:11], s53 offen offset:0 lds
    ds_read_b128 v[52:55], v72 offset:2560
    v_mfma_f32_16x16x32_bf16 a[128:131], a[24:27], v[60:63], 0
    ds_read_b64_tr_b16 a[28:29], v69 offset:0
    ds_read_b64_tr_b16 a[30:31], v69 offset:2048
    ds_read_b128 v[28:31], v72 offset:0
    v_mfma_f32_16x16x32_bf16 a[128:131], a[20:23], v[40:43], a[128:131]
    ds_read_b64_tr_b16 a[36:37], v69 offset:4096
    ds_read_b64_tr_b16 a[38:39], v69 offset:6144
    ds_read_b128 v[48:51], v72 offset:512
    v_mfma_f32_16x16x32_bf16 a[112:115], a[20:23], v[36:39], 0
    ds_read_b64_tr_b16 v[76:77], v70 offset:0
    v_mfma_f32_16x16x32_bf16 a[112:115], a[24:27], v[56:59], a[112:115]
    buffer_load_dwordx4 v14, s[8:11], s53 offen offset:1024 lds
    s_waitcnt lgkmcnt(7)
    v_mfma_f32_16x16x32_bf16 a[96:99], a[24:27], v[52:55], 0
    s_add_u32 s65, s65, 128
    ds_read_b64_tr_b16 v[78:79], v70 offset:2048
    v_mfma_f32_16x16x32_bf16 a[96:99], a[20:23], v[32:35], a[96:99]
    s_waitcnt lgkmcnt(5)
    ds_read_b64_tr_b16 v[80:81], v70 offset:4096
    v_mfma_f32_16x16x32_bf16 a[80:83], a[20:23], v[28:31], 0
    s_waitcnt lgkmcnt(3)
    ds_read_b64_tr_b16 v[82:83], v70 offset:6144
    v_mfma_f32_16x16x32_bf16 a[80:83], a[24:27], v[48:51], a[80:83]
    buffer_load_dwordx4 v15, s[8:11], s53 offen offset:2048 lds
    v_mfma_f32_16x16x32_bf16 a[160:163], a[28:31], v[28:31], 0
    s_cmp_ge_u32 s65, 1280
    s_cselect_b32 s65, 0, s65
    v_mfma_f32_16x16x32_bf16 a[160:163], a[36:39], v[48:51], a[160:163]
    ds_read_b64_tr_b16 v[232:233], v71 offset:0
    v_mfma_f32_16x16x32_bf16 a[176:179], a[36:39], v[52:55], 0
    ds_read_b64_tr_b16 v[234:235], v71 offset:2048
    v_mfma_f32_16x16x32_bf16 a[176:179], a[28:31], v[32:35], a[176:179]
    buffer_load_dwordx4 v16, s[8:11], s53 offen offset:3072 lds
    v_mfma_f32_16x16x32_bf16 a[192:195], a[28:31], v[36:39], 0
    s_add_u32 m0, s72, 131072
    ds_read_b64_tr_b16 v[236:237], v71 offset:4096
    v_mfma_f32_16x16x32_bf16 a[192:195], a[36:39], v[56:59], a[192:195]
    ds_read_b64_tr_b16 v[238:239], v71 offset:6144
    v_mfma_f32_16x16x32_bf16 a[208:211], a[36:39], v[60:63], 0
    v_mfma_f32_16x16x32_bf16 a[208:211], a[28:31], v[40:43], a[208:211]
    buffer_load_dwordx4 v17, s[8:11], s53 offen offset:0 lds
    v_mfma_f32_16x16x32_bf16 a[148:151], a[28:31], v[44:47], 0
    s_add_u32 m0, s75, 49152
    s_add_u32 s53, s64, s62
    v_mfma_f32_16x16x32_bf16 a[148:151], a[36:39], v[64:67], a[148:151]
    s_waitcnt lgkmcnt(2)
    v_mfma_f32_16x16x32_bf16 a[132:135], v[76:79], v[40:43], 0
    v_mfma_f32_16x16x32_bf16 a[132:135], v[80:83], v[60:63], a[132:135]
    buffer_load_dwordx4 v9, s[20:23], s53 offen offset:0 lds
    v_mfma_f32_16x16x32_bf16 a[116:119], v[80:83], v[56:59], 0
    v_mfma_f32_16x16x32_bf16 a[116:119], v[76:79], v[36:39], a[116:119]
    v_mfma_f32_16x16x32_bf16 a[100:103], v[76:79], v[32:35], 0
    v_mfma_f32_16x16x32_bf16 a[100:103], v[80:83], v[52:55], a[100:103]
    buffer_load_dwordx4 v10, s[20:23], s53 offen offset:1024 lds
    v_mfma_f32_16x16x32_bf16 a[84:87], v[80:83], v[48:51], 0
    s_add_u32 s62, s62, 524800
    buffer_load_dwordx4 v11, s[20:23], s53 offen offset:2048 lds
    s_cmp_ge_u32 s62, 5242880
    s_cselect_b32 s62, 0, s62
    buffer_load_dwordx4 v12, s[20:23], s53 offen offset:3072 lds
    v_mfma_f32_16x16x32_bf16 a[84:87], v[76:79], v[28:31], a[84:87]
    s_waitcnt vmcnt(14) lgkmcnt(0)
    s_barrier
    s_add_u32 m0, s75, 0
    s_add_u32 s53, s63, s62
    v_mfma_f32_16x16x32_bf16 a[164:167], v[232:235], v[28:31], 0
    ds_read_b64_tr_b16 a[20:21], v68 offset:16384
    ds_read_b64_tr_b16 a[22:23], v68 offset:18432
    v_mfma_f32_16x16x32_bf16 a[164:167], v[236:239], v[48:51], a[164:167]
    ds_read_b64_tr_b16 a[24:25], v68 offset:20480
    ds_read_b64_tr_b16 a[26:27], v68 offset:22528
    v_mfma_f32_16x16x32_bf16 a[180:183], v[236:239], v[52:55], 0
    buffer_load_dwordx4 v9, s[20:23], s53 offen offset:0 lds
    v_mfma_f32_16x16x32_bf16 a[180:183], v[232:235], v[32:35], a[180:183]
    ds_read_b64_tr_b16 a[28:29], v69 offset:16384
    v_mfma_f32_16x16x32_bf16 a[196:199], v[232:235], v[36:39], 0
    ds_read_b64_tr_b16 a[30:31], v69 offset:18432
    v_mfma_f32_16x16x32_bf16 a[196:199], v[236:239], v[56:59], a[196:199]
    ds_read_b64_tr_b16 a[36:37], v69 offset:20480
    v_mfma_f32_16x16x32_bf16 a[212:215], v[236:239], v[60:63], 0
    buffer_load_dwordx4 v10, s[20:23], s53 offen offset:1024 lds
    v_mfma_f32_16x16x32_bf16 a[212:215], v[232:235], v[40:43], a[212:215]
    s_waitcnt lgkmcnt(4)
    ds_read_b64_tr_b16 a[38:39], v69 offset:22528
    v_mfma_f32_16x16x32_bf16 a[152:155], a[20:23], v[44:47], 0
    s_waitcnt lgkmcnt(4)
    ds_read_b64_tr_b16 v[76:77], v70 offset:16384
    v_mfma_f32_16x16x32_bf16 a[152:155], a[24:27], v[64:67], a[152:155]
    ds_read_b64_tr_b16 v[78:79], v70 offset:18432
    v_mfma_f32_16x16x32_bf16 a[136:139], a[24:27], v[60:63], 0
    buffer_load_dwordx4 v11, s[20:23], s53 offen offset:2048 lds
    v_mfma_f32_16x16x32_bf16 a[136:139], a[20:23], v[40:43], a[136:139]
    ds_read_b64_tr_b16 v[80:81], v70 offset:20480
    v_mfma_f32_16x16x32_bf16 a[120:123], a[20:23], v[36:39], 0
    ds_read_b64_tr_b16 v[82:83], v70 offset:22528
    v_mfma_f32_16x16x32_bf16 a[120:123], a[24:27], v[56:59], a[120:123]
    ds_read_b64_tr_b16 v[232:233], v71 offset:16384
    v_mfma_f32_16x16x32_bf16 a[104:107], a[24:27], v[52:55], 0
    buffer_load_dwordx4 v12, s[20:23], s53 offen offset:3072 lds
    v_mfma_f32_16x16x32_bf16 a[104:107], a[20:23], v[32:35], a[104:107]
    ds_read_b64_tr_b16 v[234:235], v71 offset:18432
    v_mfma_f32_16x16x32_bf16 a[88:91], a[20:23], v[28:31], 0
    ds_read_b64_tr_b16 v[236:237], v71 offset:20480
    v_mfma_f32_16x16x32_bf16 a[88:91], a[24:27], v[48:51], a[88:91]
    s_waitcnt lgkmcnt(5)
    ds_read_b64_tr_b16 v[238:239], v71 offset:22528
    v_mfma_f32_16x16x32_bf16 a[168:171], a[28:31], v[28:31], 0
    buffer_load_dword v254, v4, s[24:27], s45 offen sc1
    v_mfma_f32_16x16x32_bf16 a[168:171], a[36:39], v[48:51], a[168:171]
    v_mfma_f32_16x16x32_bf16 a[184:187], a[36:39], v[52:55], 0
    v_mfma_f32_16x16x32_bf16 a[184:187], a[28:31], v[32:35], a[184:187]
    v_mfma_f32_16x16x32_bf16 a[200:203], a[28:31], v[36:39], 0
    buffer_load_dword v254, off, s[24:27], s61 sc1
    v_mfma_f32_16x16x32_bf16 a[200:203], a[36:39], v[56:59], a[200:203]
    v_mfma_f32_16x16x32_bf16 a[216:219], a[36:39], v[60:63], 0
    v_mfma_f32_16x16x32_bf16 a[216:219], a[28:31], v[40:43], a[216:219]
    v_mfma_f32_16x16x32_bf16 a[156:159], a[28:31], v[44:47], 0
    buffer_load_dword v254, off, s[36:39], 0 offset:256
    v_mfma_f32_16x16x32_bf16 a[156:159], a[36:39], v[64:67], a[156:159]
    v_mfma_f32_16x16x32_bf16 a[140:143], v[76:79], v[40:43], 0
    s_waitcnt lgkmcnt(0)
    v_mfma_f32_16x16x32_bf16 a[140:143], v[80:83], v[60:63], a[140:143]
    v_mfma_f32_16x16x32_bf16 a[124:127], v[80:83], v[56:59], 0
    buffer_load_dword v254, off, s[36:39], 0 offset:256
    v_mfma_f32_16x16x32_bf16 a[124:127], v[76:79], v[36:39], a[124:127]
    v_mfma_f32_16x16x32_bf16 a[108:111], v[76:79], v[32:35], 0
    v_mfma_f32_16x16x32_bf16 a[108:111], v[80:83], v[52:55], a[108:111]
    v_mfma_f32_16x16x32_bf16 a[92:95], v[80:83], v[48:51], 0
    buffer_load_dword v254, off, s[36:39], 0 offset:256
    buffer_load_dword v254, off, s[36:39], 0 offset:256
    v_mfma_f32_16x16x32_bf16 a[92:95], v[76:79], v[28:31], a[92:95]
    s_waitcnt vmcnt(19) lgkmcnt(0)
    s_barrier
    ds_read_b64_tr_b16 a[20:21], v68 offset:32768
    ds_read_b64_tr_b16 a[22:23], v68 offset:34816
    v_mfma_f32_16x16x32_bf16 a[172:175], v[232:235], v[28:31], 0
    ds_read_b64_tr_b16 a[24:25], v68 offset:36864
    ds_read_b64_tr_b16 a[26:27], v68 offset:38912
    v_mfma_f32_16x16x32_bf16 a[172:175], v[236:239], v[48:51], a[172:175]
    ds_read_b64_tr_b16 a[28:29], v69 offset:32768
    v_mfma_f32_16x16x32_bf16 a[188:191], v[236:239], v[52:55], 0
    ds_read_b64_tr_b16 a[30:31], v69 offset:34816
    v_mfma_f32_16x16x32_bf16 a[188:191], v[232:235], v[32:35], a[188:191]
    ds_read_b64_tr_b16 a[36:37], v69 offset:36864
    v_mfma_f32_16x16x32_bf16 a[204:207], v[232:235], v[36:39], 0
    ds_read_b64_tr_b16 a[38:39], v69 offset:38912
    v_mfma_f32_16x16x32_bf16 a[204:207], v[236:239], v[56:59], a[204:207]
    ds_read_b64_tr_b16 v[76:77], v70 offset:32768
    v_mfma_f32_16x16x32_bf16 a[220:223], v[236:239], v[60:63], 0
    ds_read_b64_tr_b16 v[78:79], v70 offset:34816
    v_mfma_f32_16x16x32_bf16 a[220:223], v[232:235], v[40:43], a[220:223]
    s_waitcnt lgkmcnt(6)
    ds_read_b64_tr_b16 v[80:81], v70 offset:36864
    v_mfma_f32_16x16x32_bf16 v[212:215], a[20:23], v[44:47], 0
    ds_read_b64_tr_b16 v[82:83], v70 offset:38912
    v_mfma_f32_16x16x32_bf16 v[212:215], a[24:27], v[64:67], v[212:215]
    s_add_u32 m0, s75, 16384
    s_add_u32 s53, s64, s62
    v_mfma_f32_16x16x32_bf16 v[180:183], a[24:27], v[60:63], 0
    buffer_load_dwordx4 v9, s[20:23], s53 offen offset:0 lds
    v_mfma_f32_16x16x32_bf16 v[180:183], a[20:23], v[40:43], v[180:183]
    ds_read_b64_tr_b16 v[232:233], v71 offset:32768
    v_mfma_f32_16x16x32_bf16 v[148:151], a[20:23], v[36:39], 0
    ds_read_b64_tr_b16 v[234:235], v71 offset:34816
    v_mfma_f32_16x16x32_bf16 v[148:151], a[24:27], v[56:59], v[148:151]
    ds_read_b64_tr_b16 v[236:237], v71 offset:36864
    v_mfma_f32_16x16x32_bf16 v[116:119], a[24:27], v[52:55], 0
    buffer_load_dwordx4 v10, s[20:23], s53 offen offset:1024 lds
    v_mfma_f32_16x16x32_bf16 v[116:119], a[20:23], v[32:35], v[116:119]
    s_sub_u32 s62, s62, 512
    ds_read_b64_tr_b16 v[238:239], v71 offset:38912
    v_mfma_f32_16x16x32_bf16 v[84:87], a[20:23], v[28:31], 0
    v_mfma_f32_16x16x32_bf16 v[84:87], a[24:27], v[48:51], v[84:87]
    s_waitcnt lgkmcnt(4)
    v_mfma_f32_16x16x32_bf16 v[88:91], a[28:31], v[28:31], 0
    buffer_load_dwordx4 v11, s[20:23], s53 offen offset:2048 lds
    v_mfma_f32_16x16x32_bf16 v[88:91], a[36:39], v[48:51], v[88:91]
    v_mfma_f32_16x16x32_bf16 v[120:123], a[36:39], v[52:55], 0
    v_mfma_f32_16x16x32_bf16 v[120:123], a[28:31], v[32:35], v[120:123]
    v_mfma_f32_16x16x32_bf16 v[152:155], a[28:31], v[36:39], 0
    buffer_load_dwordx4 v12, s[20:23], s53 offen offset:3072 lds
    v_mfma_f32_16x16x32_bf16 v[152:155], a[36:39], v[56:59], v[152:155]
    v_mfma_f32_16x16x32_bf16 v[184:187], a[36:39], v[60:63], 0
    v_mfma_f32_16x16x32_bf16 v[184:187], a[28:31], v[40:43], v[184:187]
    v_mfma_f32_16x16x32_bf16 v[216:219], a[28:31], v[44:47], 0
    global_load_dword v254, v[2:3], off
    v_mfma_f32_16x16x32_bf16 v[216:219], a[36:39], v[64:67], v[216:219]
    v_mfma_f32_16x16x32_bf16 v[188:191], v[76:79], v[40:43], 0
    v_mfma_f32_16x16x32_bf16 v[188:191], v[80:83], v[60:63], v[188:191]
    v_mfma_f32_16x16x32_bf16 v[156:159], v[80:83], v[56:59], 0
    v_mfma_f32_16x16x32_bf16 v[156:159], v[76:79], v[36:39], v[156:159]
    v_mfma_f32_16x16x32_bf16 v[124:127], v[76:79], v[32:35], 0
    v_mfma_f32_16x16x32_bf16 v[124:127], v[80:83], v[52:55], v[124:127]
    v_mfma_f32_16x16x32_bf16 v[92:95], v[80:83], v[48:51], 0
    v_mfma_f32_16x16x32_bf16 v[92:95], v[76:79], v[28:31], v[92:95]
    s_lshr_b32 s96, s96, 1
    s_cbranch_scc0 1
    s_waitcnt vmcnt(0)
    s_waitcnt vmcnt(15) lgkmcnt(0)
    s_barrier
    ds_read_b64_tr_b16 a[20:21], v68 offset:49152
    ds_read_b64_tr_b16 a[22:23], v68 offset:51200
    v_mfma_f32_16x16x32_bf16 v[96:99], v[232:235], v[28:31], 0
    ds_read_b64_tr_b16 a[24:25], v68 offset:53248
    ds_read_b64_tr_b16 a[26:27], v68 offset:55296
    v_mfma_f32_16x16x32_bf16 v[96:99], v[236:239], v[48:51], v[96:99]
    ds_read_b64_tr_b16 a[28:29], v69 offset:49152
    v_mfma_f32_16x16x32_bf16 v[128:131], v[236:239], v[52:55], 0
    ds_read_b64_tr_b16 a[30:31], v69 offset:51200
    v_mfma_f32_16x16x32_bf16 v[128:131], v[232:235], v[32:35], v[128:131]
    ds_read_b64_tr_b16 a[36:37], v69 offset:53248
    v_mfma_f32_16x16x32_bf16 v[160:163], v[232:235], v[36:39], 0
    ds_read_b64_tr_b16 a[38:39], v69 offset:55296
    v_mfma_f32_16x16x32_bf16 v[160:163], v[236:239], v[56:59], v[160:163]
    ds_read_b128 a[56:59], v22 offset:16384
    v_mfma_f32_16x16x32_bf16 v[192:195], v[236:239], v[60:63], 0
    ds_read_b128 a[76:79], v22 offset:16896
    v_mfma_f32_16x16x32_bf16 v[192:195], v[232:235], v[40:43], v[192:195]
    s_waitcnt lgkmcnt(6)
    ds_read_b128 a[52:55], v21 offset:6144
    v_mfma_f32_16x16x32_bf16 v[220:223], a[20:23], v[44:47], 0
    ds_read_b128 a[72:75], v21 offset:6656
    v_mfma_f32_16x16x32_bf16 v[220:223], a[24:27], v[64:67], v[220:223]
    s_add_u32 m0, s75, 32768
    s_add_u32 s53, s63, s62
    v_mfma_f32_16x16x32_bf16 v[196:199], a[24:27], v[60:63], 0
    buffer_load_dwordx4 v9, s[20:23], s53 offen offset:0 lds
    v_mfma_f32_16x16x32_bf16 v[196:199], a[20:23], v[40:43], v[196:199]
    ds_read_b64_tr_b16 v[76:77], v70 offset:49152
    v_mfma_f32_16x16x32_bf16 v[164:167], a[20:23], v[36:39], 0
    ds_read_b64_tr_b16 v[78:79], v70 offset:51200
    v_mfma_f32_16x16x32_bf16 v[164:167], a[24:27], v[56:59], v[164:167]
    ds_read_b64_tr_b16 v[80:81], v70 offset:53248
    v_mfma_f32_16x16x32_bf16 v[132:135], a[24:27], v[52:55], 0
    buffer_load_dwordx4 v10, s[20:23], s53 offen offset:1024 lds
    v_mfma_f32_16x16x32_bf16 v[132:135], a[20:23], v[32:35], v[132:135]
    ds_read_b64_tr_b16 v[82:83], v70 offset:55296
    v_mfma_f32_16x16x32_bf16 v[100:103], a[20:23], v[28:31], 0
    ds_read_b128 a[48:51], v21 offset:4096
    v_mfma_f32_16x16x32_bf16 v[100:103], a[24:27], v[48:51], v[100:103]
    s_waitcnt lgkmcnt(5)
    ds_read_b128 a[68:71], v21 offset:4608
    v_mfma_f32_16x16x32_bf16 v[104:107], a[28:31], v[28:31], 0
    buffer_load_dwordx4 v11, s[20:23], s53 offen offset:2048 lds
    v_mfma_f32_16x16x32_bf16 v[104:107], a[36:39], v[48:51], v[104:107]
    ds_read_b128 a[44:47], v21 offset:2048
    v_mfma_f32_16x16x32_bf16 v[136:139], a[36:39], v[52:55], 0
    ds_read_b128 a[64:67], v21 offset:2560
    v_mfma_f32_16x16x32_bf16 v[136:139], a[28:31], v[32:35], v[136:139]
    ds_read_b128 a[40:43], v21 offset:0
    v_mfma_f32_16x16x32_bf16 v[168:171], a[28:31], v[36:39], 0
    buffer_load_dwordx4 v12, s[20:23], s53 offen offset:3072 lds
    v_mfma_f32_16x16x32_bf16 v[168:171], a[36:39], v[56:59], v[168:171]
    s_and_b32 s70, s69, 0x7000
    s_add_u32 s70, s70, s56
    s_and_b32 s70, s70, 0x1ffff
    s_add_u32 s70, s70, s91
    v_mfma_f32_16x16x32_bf16 v[200:203], a[36:39], v[60:63], 0
    s_bitcmp1_b32 s69, 15
    s_cselect_b64 s[4:5], s[16:17], s[12:13]
    s_lshr_b32 s40, s69, 4
    s_lshl_b32 s69, s69, 28
    v_mfma_f32_16x16x32_bf16 v[200:203], a[28:31], v[40:43], v[200:203]
    s_or_b32 s69, s69, s40
    ds_read_b128 a[60:63], v21 offset:512
    v_mfma_f32_16x16x32_bf16 v[224:227], a[28:31], v[44:47], 0
    ds_read_b64_tr_b16 v[232:233], v71 offset:49152
    v_mfma_f32_16x16x32_bf16 v[224:227], a[36:39], v[64:67], v[224:227]
    s_waitcnt lgkmcnt(2)
    ds_read_b64_tr_b16 v[234:235], v71 offset:51200
    v_mfma_f32_16x16x32_bf16 v[204:207], v[76:79], v[40:43], 0
    ds_read_b64_tr_b16 v[236:237], v71 offset:53248
    v_mfma_f32_16x16x32_bf16 v[204:207], v[80:83], v[60:63], v[204:207]
    ds_read_b64_tr_b16 v[238:239], v71 offset:55296
    v_mfma_f32_16x16x32_bf16 v[172:175], v[80:83], v[56:59], 0
    v_mfma_f32_16x16x32_bf16 v[172:175], v[76:79], v[36:39], v[172:175]
    v_mfma_f32_16x16x32_bf16 v[140:143], v[76:79], v[32:35], 0
    v_mfma_f32_16x16x32_bf16 v[140:143], v[80:83], v[52:55], v[140:143]
    v_mfma_f32_16x16x32_bf16 v[108:111], v[80:83], v[48:51], 0
    v_mfma_f32_16x16x32_bf16 v[108:111], v[76:79], v[28:31], v[108:111]
    s_mov_b32 s92, 3
gqa_kernel_qloop_0:
    s_waitcnt vmcnt(15) lgkmcnt(0)
    s_barrier
    s_add_u32 m0, s75, 49152
    s_add_u32 s53, s64, s62
    v_mfma_f32_16x16x32_bf16 v[112:115], v[232:235], v[28:31], v[112:115]
    buffer_load_dwordx4 v9, s[20:23], s53 offen offset:0 lds
    v_mfma_f32_16x16x32_bf16 v[112:115], v[236:239], v[48:51], v[112:115]
    ds_read_b64_tr_b16 a[20:21], v68 offset:0
    ds_read_b64_tr_b16 a[22:23], v68 offset:2048
    v_mfma_f32_16x16x32_bf16 v[144:147], v[236:239], v[52:55], v[144:147]
    ds_read_b64_tr_b16 a[24:25], v68 offset:4096
    ds_read_b64_tr_b16 a[26:27], v68 offset:6144
    v_mfma_f32_16x16x32_bf16 v[144:147], v[232:235], v[32:35], v[144:147]
    ds_read_b64_tr_b16 a[28:29], v69 offset:0
    v_mfma_f32_16x16x32_bf16 v[176:179], v[232:235], v[36:39], v[176:179]
    buffer_load_dwordx4 v10, s[20:23], s53 offen offset:1024 lds
    v_mfma_f32_16x16x32_bf16 v[176:179], v[236:239], v[56:59], v[176:179]
    s_add_u32 s62, s62, 524800
    ds_read_b64_tr_b16 a[30:31], v69 offset:2048
    v_mfma_f32_16x16x32_bf16 v[208:211], v[236:239], v[60:63], v[208:211]
    ds_read_b64_tr_b16 a[36:37], v69 offset:4096
    v_mfma_f32_16x16x32_bf16 v[208:211], v[232:235], v[40:43], v[208:211]
    s_waitcnt lgkmcnt(5)
    ds_read_b64_tr_b16 a[38:39], v69 offset:6144
    v_mfma_f32_16x16x32_bf16 a[144:147], a[20:23], a[56:59], a[144:147]
    buffer_load_dwordx4 v11, s[20:23], s53 offen offset:2048 lds
    s_waitcnt lgkmcnt(4)
    v_mfma_f32_16x16x32_bf16 a[144:147], a[24:27], a[76:79], a[144:147]
    s_cmp_ge_u32 s62, 5242880
    s_cselect_b32 s62, 0, s62
    v_mfma_f32_16x16x32_bf16 a[128:131], a[24:27], a[72:75], a[128:131]
    ds_read_b64_tr_b16 v[76:77], v70 offset:0
    v_mfma_f32_16x16x32_bf16 a[128:131], a[20:23], a[52:55], a[128:131]
    ds_read_b64_tr_b16 v[78:79], v70 offset:2048
    v_mfma_f32_16x16x32_bf16 a[112:115], a[20:23], a[48:51], a[112:115]
    buffer_load_dwordx4 v12, s[20:23], s53 offen offset:3072 lds
    v_mfma_f32_16x16x32_bf16 a[112:115], a[24:27], a[68:71], a[112:115]
    s_add_u32 m0, s60, 131072
    s_add_u32 s53, s66, s65
    v_mfma_f32_16x16x32_bf16 a[96:99], a[24:27], a[64:67], a[96:99]
    ds_read_b64_tr_b16 v[80:81], v70 offset:4096
    v_mfma_f32_16x16x32_bf16 a[96:99], a[20:23], a[44:47], a[96:99]
    ds_read_b64_tr_b16 v[82:83], v70 offset:6144
    v_mfma_f32_16x16x32_bf16 a[80:83], a[20:23], a[40:43], a[80:83]
    buffer_load_dwordx4 v13, s[8:11], s53 offen offset:0 lds
    v_mfma_f32_16x16x32_bf16 a[80:83], a[24:27], a[60:63], a[80:83]
    s_waitcnt lgkmcnt(2)
    ds_read_b64_tr_b16 v[232:233], v71 offset:0
    v_accvgpr_mov_b32 a224, a228
    v_mfma_f32_16x16x32_bf16 a[160:163], a[28:31], a[40:43], a[160:163]
    ds_read_b64_tr_b16 v[234:235], v71 offset:2048
    v_accvgpr_mov_b32 a225, a229
    v_mfma_f32_16x16x32_bf16 a[160:163], a[36:39], a[60:63], a[160:163]
    ds_read_b64_tr_b16 v[236:237], v71 offset:4096
    v_accvgpr_mov_b32 a226, a230
    v_mfma_f32_16x16x32_bf16 a[176:179], a[36:39], a[64:67], a[176:179]
    buffer_load_dwordx4 v14, s[8:11], s53 offen offset:1024 lds
    v_mfma_f32_16x16x32_bf16 a[176:179], a[28:31], a[44:47], a[176:179]
    s_add_u32 s65, s65, 128
    ds_read_b64_tr_b16 v[238:239], v71 offset:6144
    v_mfma_f32_16x16x32_bf16 a[192:195], a[28:31], a[48:51], a[192:195]
    v_accvgpr_mov_b32 a227, a231
    v_accvgpr_mov_b32 a228, a232
    v_mfma_f32_16x16x32_bf16 a[192:195], a[36:39], a[68:71], a[192:195]
    v_accvgpr_mov_b32 a229, a233
    v_accvgpr_mov_b32 a230, a234
    v_mfma_f32_16x16x32_bf16 a[208:211], a[36:39], a[72:75], a[208:211]
    buffer_load_dwordx4 v15, s[8:11], s53 offen offset:2048 lds
    v_mfma_f32_16x16x32_bf16 a[208:211], a[28:31], a[52:55], a[208:211]
    s_cmp_ge_u32 s65, 1280
    s_cselect_b32 s65, 0, s65
    v_mfma_f32_16x16x32_bf16 a[148:151], a[28:31], a[56:59], a[148:151]
    v_accvgpr_mov_b32 a231, a235
    v_accvgpr_mov_b32 a232, a236
    v_mfma_f32_16x16x32_bf16 a[148:151], a[36:39], a[76:79], a[148:151]
    v_accvgpr_mov_b32 a233, a237
    v_accvgpr_mov_b32 a234, a238
    v_mfma_f32_16x16x32_bf16 a[132:135], v[76:79], a[52:55], a[132:135]
    buffer_load_dwordx4 v16, s[8:11], s53 offen offset:3072 lds
    s_waitcnt lgkmcnt(0)
    v_mfma_f32_16x16x32_bf16 a[132:135], v[80:83], a[72:75], a[132:135]
    s_add_u32 m0, s72, 131072
    v_accvgpr_mov_b32 a235, a239
    v_mfma_f32_16x16x32_bf16 a[116:119], v[80:83], a[68:71], a[116:119]
    v_mfma_f32_16x16x32_bf16 a[116:119], v[76:79], a[48:51], a[116:119]
    v_mfma_f32_16x16x32_bf16 a[100:103], v[76:79], a[44:47], a[100:103]
    buffer_load_dwordx4 v17, s[8:11], s53 offen offset:0 lds
    v_mfma_f32_16x16x32_bf16 a[100:103], v[80:83], a[64:67], a[100:103]
    v_mfma_f32_16x16x32_bf16 a[84:87], v[80:83], a[60:63], a[84:87]
    v_mfma_f32_16x16x32_bf16 a[84:87], v[76:79], a[40:43], a[84:87]
    s_waitcnt vmcnt(14) lgkmcnt(0)
    s_barrier
    s_add_u32 m0, s75, 0
    s_add_u32 s53, s63, s62
    v_mfma_f32_16x16x32_bf16 a[164:167], v[232:235], a[40:43], a[164:167]
    buffer_load_dwordx4 v9, s[20:23], s53 offen offset:0 lds
    v_mfma_f32_16x16x32_bf16 a[164:167], v[236:239], a[60:63], a[164:167]
    ds_read_b64_tr_b16 a[20:21], v68 offset:16384
    ds_read_b64_tr_b16 a[22:23], v68 offset:18432
    v_mfma_f32_16x16x32_bf16 a[180:183], v[236:239], a[64:67], a[180:183]
    ds_read_b64_tr_b16 a[24:25], v68 offset:20480
    ds_read_b64_tr_b16 a[26:27], v68 offset:22528
    v_mfma_f32_16x16x32_bf16 a[180:183], v[232:235], a[44:47], a[180:183]
    ds_read_b64_tr_b16 a[28:29], v69 offset:16384
    v_mfma_f32_16x16x32_bf16 a[196:199], v[232:235], a[48:51], a[196:199]
    buffer_load_dwordx4 v10, s[20:23], s53 offen offset:1024 lds
    v_mfma_f32_16x16x32_bf16 a[196:199], v[236:239], a[68:71], a[196:199]
    ds_read_b64_tr_b16 a[30:31], v69 offset:18432
    v_mfma_f32_16x16x32_bf16 a[212:215], v[236:239], a[72:75], a[212:215]
    ds_read_b64_tr_b16 a[36:37], v69 offset:20480
    v_mfma_f32_16x16x32_bf16 a[212:215], v[232:235], a[52:55], a[212:215]
    s_waitcnt lgkmcnt(5)
    ds_read_b64_tr_b16 a[38:39], v69 offset:22528
    v_mfma_f32_16x16x32_bf16 a[152:155], a[20:23], a[56:59], a[152:155]
    buffer_load_dwordx4 v11, s[20:23], s53 offen offset:2048 lds
    s_waitcnt lgkmcnt(4)
    v_mfma_f32_16x16x32_bf16 a[152:155], a[24:27], a[76:79], a[152:155]
    ds_read_b64_tr_b16 v[76:77], v70 offset:16384
    v_mfma_f32_16x16x32_bf16 a[136:139], a[24:27], a[72:75], a[136:139]
    ds_read_b64_tr_b16 v[78:79], v70 offset:18432
    v_mfma_f32_16x16x32_bf16 a[136:139], a[20:23], a[52:55], a[136:139]
    ds_read_b64_tr_b16 v[80:81], v70 offset:20480
    v_mfma_f32_16x16x32_bf16 a[120:123], a[20:23], a[48:51], a[120:123]
    buffer_load_dwordx4 v12, s[20:23], s53 offen offset:3072 lds
    v_mfma_f32_16x16x32_bf16 a[120:123], a[24:27], a[68:71], a[120:123]
    s_add_u32 m0, s60, s67
    ds_read_b64_tr_b16 v[82:83], v70 offset:22528
    v_mfma_f32_16x16x32_bf16 a[104:107], a[24:27], a[64:67], a[104:107]
    ds_read_b64_tr_b16 v[232:233], v71 offset:16384
    v_mfma_f32_16x16x32_bf16 a[104:107], a[20:23], a[44:47], a[104:107]
    ds_read_b64_tr_b16 v[234:235], v71 offset:18432
    v_mfma_f32_16x16x32_bf16 a[88:91], a[20:23], a[40:43], a[88:91]
    buffer_load_dwordx4 v5, s[4:7], s70 offen offset:0 nt lds
    v_mfma_f32_16x16x32_bf16 a[88:91], a[24:27], a[60:63], a[88:91]
    s_add_u32 m0, s60, s67
    s_add_u32 s67, s67, s68
    s_waitcnt lgkmcnt(3)
    v_mfma_f32_16x16x32_bf16 a[168:171], a[28:31], a[40:43], a[168:171]
    ds_read_b64_tr_b16 v[236:237], v71 offset:20480
    v_mfma_f32_16x16x32_bf16 a[168:171], a[36:39], a[60:63], a[168:171]
    ds_read_b64_tr_b16 v[238:239], v71 offset:22528
    v_mfma_f32_16x16x32_bf16 a[184:187], a[36:39], a[64:67], a[184:187]
    buffer_load_dwordx4 v6, s[4:7], s70 offen offset:1024 nt lds
    v_mfma_f32_16x16x32_bf16 a[184:187], a[28:31], a[44:47], a[184:187]
    s_xor_b32 s68, s68, 12288
    s_mov_b32 m0, s73
    s_bitcmp1_b32 s71, 0
    s_cselect_b32 s40, s76, 0x40000000
    v_mfma_f32_16x16x32_bf16 a[200:203], a[28:31], a[48:51], a[200:203]
    v_mfma_f32_16x16x32_bf16 a[200:203], a[36:39], a[68:71], a[200:203]
    v_mfma_f32_16x16x32_bf16 a[216:219], a[36:39], a[72:75], a[216:219]
    buffer_load_dwordx4 v13, s[28:31], s40 offen offset:0 nt lds
    v_mfma_f32_16x16x32_bf16 a[216:219], a[28:31], a[52:55], a[216:219]
    s_xor_b32 s73, s73, 4096
    s_lshr_b32 s71, s71, 1
    s_add_u32 s76, s76, 128
    v_mfma_f32_16x16x32_bf16 a[156:159], a[28:31], a[56:59], a[156:159]
    v_mfma_f32_16x16x32_bf16 a[156:159], a[36:39], a[76:79], a[156:159]
    v_mfma_f32_16x16x32_bf16 a[140:143], v[76:79], a[52:55], a[140:143]
    buffer_load_dwordx4 a[236:239], v5, s[16:19], s74 offen offset:0 nt
    s_waitcnt lgkmcnt(0)
    v_mfma_f32_16x16x32_bf16 a[140:143], v[80:83], a[72:75], a[140:143]
    s_add_u32 s74, s74, 2048
    s_add_u32 s40, s65, 128
    s_cmp_ge_u32 s40, 1280
    s_cselect_b32 s40, 0, s40
    v_mfma_f32_16x16x32_bf16 a[124:127], v[80:83], a[68:71], a[124:127]
    v_mfma_f32_16x16x32_bf16 a[124:127], v[76:79], a[48:51], a[124:127]
    v_mfma_f32_16x16x32_bf16 a[108:111], v[76:79], a[44:47], a[108:111]
    buffer_load_dword v254, v1, s[8:11], s40 offen
    v_mfma_f32_16x16x32_bf16 a[108:111], v[80:83], a[64:67], a[108:111]
    v_mfma_f32_16x16x32_bf16 a[92:95], v[80:83], a[60:63], a[92:95]
    v_mfma_f32_16x16x32_bf16 a[92:95], v[76:79], a[40:43], a[92:95]
    s_waitcnt vmcnt(18) lgkmcnt(0)
    s_barrier
    ds_read_b64_tr_b16 a[20:21], v68 offset:32768
    ds_read_b64_tr_b16 a[22:23], v68 offset:34816
    v_mfma_f32_16x16x32_bf16 a[172:175], v[232:235], a[40:43], a[172:175]
    ds_read_b64_tr_b16 a[24:25], v68 offset:36864
    ds_read_b64_tr_b16 a[26:27], v68 offset:38912
    v_mfma_f32_16x16x32_bf16 a[172:175], v[236:239], a[60:63], a[172:175]
    ds_read_b64_tr_b16 a[28:29], v69 offset:32768
    v_mfma_f32_16x16x32_bf16 a[188:191], v[236:239], a[64:67], a[188:191]
    ds_read_b64_tr_b16 a[30:31], v69 offset:34816
    v_mfma_f32_16x16x32_bf16 a[188:191], v[232:235], a[44:47], a[188:191]
    ds_read_b64_tr_b16 a[36:37], v69 offset:36864
    v_mfma_f32_16x16x32_bf16 a[204:207], v[232:235], a[48:51], a[204:207]
    ds_read_b64_tr_b16 a[38:39], v69 offset:38912
    v_mfma_f32_16x16x32_bf16 a[204:207], v[236:239], a[68:71], a[204:207]
    ds_read_b64_tr_b16 v[76:77], v70 offset:32768
    v_mfma_f32_16x16x32_bf16 a[220:223], v[236:239], a[72:75], a[220:223]
    ds_read_b64_tr_b16 v[78:79], v70 offset:34816
    v_mfma_f32_16x16x32_bf16 a[220:223], v[232:235], a[52:55], a[220:223]
    s_waitcnt lgkmcnt(6)
    ds_read_b64_tr_b16 v[80:81], v70 offset:36864
    v_mfma_f32_16x16x32_bf16 v[212:215], a[20:23], a[56:59], v[212:215]
    ds_read_b64_tr_b16 v[82:83], v70 offset:38912
    v_mfma_f32_16x16x32_bf16 v[212:215], a[24:27], a[76:79], v[212:215]
    s_add_u32 m0, s75, 16384
    s_add_u32 s53, s64, s62
    v_mfma_f32_16x16x32_bf16 v[180:183], a[24:27], a[72:75], v[180:183]
    buffer_load_dwordx4 v9, s[20:23], s53 offen offset:0 lds
    v_mfma_f32_16x16x32_bf16 v[180:183], a[20:23], a[52:55], v[180:183]
    ds_read_b64_tr_b16 v[232:233], v71 offset:32768
    v_mfma_f32_16x16x32_bf16 v[148:151], a[20:23], a[48:51], v[148:151]
    ds_read_b64_tr_b16 v[234:235], v71 offset:34816
    v_mfma_f32_16x16x32_bf16 v[148:151], a[24:27], a[68:71], v[148:151]
    v_accvgpr_mov_b32 a19, a15
    v_accvgpr_mov_b32 a18, a14
    v_mfma_f32_16x16x32_bf16 v[116:119], a[24:27], a[64:67], v[116:119]
    buffer_load_dwordx4 v10, s[20:23], s53 offen offset:1024 lds
    v_mfma_f32_16x16x32_bf16 v[116:119], a[20:23], a[44:47], v[116:119]
    s_sub_u32 s62, s62, 512
    v_accvgpr_mov_b32 a17, a13
    v_mfma_f32_16x16x32_bf16 v[84:87], a[20:23], a[40:43], v[84:87]
    v_accvgpr_mov_b32 a16, a12
    v_accvgpr_mov_b32 a15, a11
    v_mfma_f32_16x16x32_bf16 v[84:87], a[24:27], a[60:63], v[84:87]
    s_waitcnt lgkmcnt(0)
    v_accvgpr_mov_b32 a14, a10
    v_accvgpr_mov_b32 a13, a9
    v_mfma_f32_16x16x32_bf16 v[88:91], a[28:31], a[40:43], v[88:91]
    buffer_load_dwordx4 v11, s[20:23], s53 offen offset:2048 lds
    v_mfma_f32_16x16x32_bf16 v[88:91], a[36:39], a[60:63], v[88:91]
    v_accvgpr_mov_b32 a12, a8
    v_accvgpr_mov_b32 a11, a7
    v_mfma_f32_16x16x32_bf16 v[120:123], a[36:39], a[64:67], v[120:123]
    v_accvgpr_mov_b32 a10, a6
    v_accvgpr_mov_b32 a9, a5
    v_mfma_f32_16x16x32_bf16 v[120:123], a[28:31], a[44:47], v[120:123]
    v_accvgpr_mov_b32 a8, a4
    v_accvgpr_mov_b32 a7, a3
    v_mfma_f32_16x16x32_bf16 v[152:155], a[28:31], a[48:51], v[152:155]
    buffer_load_dwordx4 v12, s[20:23], s53 offen offset:3072 lds
    v_mfma_f32_16x16x32_bf16 v[152:155], a[36:39], a[68:71], v[152:155]
    v_accvgpr_mov_b32 a6, a2
    v_accvgpr_mov_b32 a5, a1
    v_mfma_f32_16x16x32_bf16 v[184:187], a[36:39], a[72:75], v[184:187]
    v_accvgpr_mov_b32 a4, a0
    ds_read_b64_tr_b16 a[0:1], v228 offset:0
    v_mfma_f32_16x16x32_bf16 v[184:187], a[28:31], a[52:55], v[184:187]
    ds_read_b64_tr_b16 a[2:3], v228 offset:2048
    v_xor_b32 v228, 4096, v228
    v_mfma_f32_16x16x32_bf16 v[216:219], a[28:31], a[56:59], v[216:219]
    global_load_dword v254, v[2:3], off
    v_mfma_f32_16x16x32_bf16 v[216:219], a[36:39], a[76:79], v[216:219]
    ds_read_b64_tr_b16 v[236:237], v71 offset:36864
    v_mfma_f32_16x16x32_bf16 v[188:191], v[76:79], a[52:55], v[188:191]
    ds_read_b64_tr_b16 v[238:239], v71 offset:38912
    v_mfma_f32_16x16x32_bf16 v[188:191], v[80:83], a[72:75], v[188:191]
    v_mfma_f32_16x16x32_bf16 v[156:159], v[80:83], a[68:71], v[156:159]
    v_mfma_f32_16x16x32_bf16 v[156:159], v[76:79], a[48:51], v[156:159]
    v_mfma_f32_16x16x32_bf16 v[124:127], v[76:79], a[44:47], v[124:127]
    v_mfma_f32_16x16x32_bf16 v[124:127], v[80:83], a[64:67], v[124:127]
    v_mfma_f32_16x16x32_bf16 v[92:95], v[80:83], a[60:63], v[92:95]
    v_mfma_f32_16x16x32_bf16 v[92:95], v[76:79], a[40:43], v[92:95]
    s_lshr_b32 s96, s96, 1
    s_cbranch_scc0 1
    s_waitcnt vmcnt(0)
    s_waitcnt vmcnt(14) lgkmcnt(0)
    s_barrier
    ds_read_b64_tr_b16 a[20:21], v68 offset:49152
    ds_read_b64_tr_b16 a[22:23], v68 offset:51200
    v_mfma_f32_16x16x32_bf16 v[96:99], v[232:235], a[40:43], v[96:99]
    ds_read_b64_tr_b16 a[24:25], v68 offset:53248
    ds_read_b64_tr_b16 a[26:27], v68 offset:55296
    v_mfma_f32_16x16x32_bf16 v[96:99], v[236:239], a[60:63], v[96:99]
    ds_read_b64_tr_b16 a[28:29], v69 offset:49152
    v_mfma_f32_16x16x32_bf16 v[128:131], v[236:239], a[64:67], v[128:131]
    ds_read_b64_tr_b16 a[30:31], v69 offset:51200
    v_mfma_f32_16x16x32_bf16 v[128:131], v[232:235], a[44:47], v[128:131]
    ds_read_b64_tr_b16 a[36:37], v69 offset:53248
    v_mfma_f32_16x16x32_bf16 v[160:163], v[232:235], a[48:51], v[160:163]
    ds_read_b64_tr_b16 a[38:39], v69 offset:55296
    v_mfma_f32_16x16x32_bf16 v[160:163], v[236:239], a[68:71], v[160:163]
    ds_read_b128 v[44:47], v22 offset:16384
    v_mfma_f32_16x16x32_bf16 v[192:195], v[236:239], a[72:75], v[192:195]
    ds_read_b128 v[64:67], v22 offset:16896
    v_mfma_f32_16x16x32_bf16 v[192:195], v[232:235], a[52:55], v[192:195]
    s_waitcnt lgkmcnt(6)
    ds_read_b128 v[40:43], v21 offset:6144
    v_mfma_f32_16x16x32_bf16 v[220:223], a[20:23], a[56:59], v[220:223]
    ds_read_b128 v[60:63], v21 offset:6656
    v_mfma_f32_16x16x32_bf16 v[220:223], a[24:27], a[76:79], v[220:223]
    s_add_u32 m0, s75, 32768
    s_add_u32 s53, s63, s62
    v_mfma_f32_16x16x32_bf16 v[196:199], a[24:27], a[72:75], v[196:199]
    buffer_load_dwordx4 v9, s[20:23], s53 offen offset:0 lds
    v_mfma_f32_16x16x32_bf16 v[196:199], a[20:23], a[52:55], v[196:199]
    ds_read_b64_tr_b16 v[76:77], v70 offset:49152
    v_mfma_f32_16x16x32_bf16 v[164:167], a[20:23], a[48:51], v[164:167]
    ds_read_b64_tr_b16 v[78:79], v70 offset:51200
    v_mfma_f32_16x16x32_bf16 v[164:167], a[24:27], a[68:71], v[164:167]
    ds_read_b64_tr_b16 v[80:81], v70 offset:53248
    v_mfma_f32_16x16x32_bf16 v[132:135], a[24:27], a[64:67], v[132:135]
    buffer_load_dwordx4 v10, s[20:23], s53 offen offset:1024 lds
    v_mfma_f32_16x16x32_bf16 v[132:135], a[20:23], a[44:47], v[132:135]
    ds_read_b64_tr_b16 v[82:83], v70 offset:55296
    v_mfma_f32_16x16x32_bf16 v[100:103], a[20:23], a[40:43], v[100:103]
    ds_read_b128 v[36:39], v21 offset:4096
    v_mfma_f32_16x16x32_bf16 v[100:103], a[24:27], a[60:63], v[100:103]
    s_waitcnt lgkmcnt(5)
    ds_read_b128 v[56:59], v21 offset:4608
    v_mfma_f32_16x16x32_bf16 v[104:107], a[28:31], a[40:43], v[104:107]
    buffer_load_dwordx4 v11, s[20:23], s53 offen offset:2048 lds
    v_mfma_f32_16x16x32_bf16 v[104:107], a[36:39], a[60:63], v[104:107]
    ds_read_b128 v[32:35], v21 offset:2048
    v_mfma_f32_16x16x32_bf16 v[136:139], a[36:39], a[64:67], v[136:139]
    ds_read_b128 v[52:55], v21 offset:2560
    v_mfma_f32_16x16x32_bf16 v[136:139], a[28:31], a[44:47], v[136:139]
    ds_read_b128 v[28:31], v21 offset:0
    v_accvgpr_write_b32 a32, v240
    v_mfma_f32_16x16x32_bf16 v[168:171], a[28:31], a[48:51], v[168:171]
    buffer_load_dwordx4 v12, s[20:23], s53 offen offset:3072 lds
    v_mfma_f32_16x16x32_bf16 v[168:171], a[36:39], a[68:71], v[168:171]
    s_and_b32 s70, s69, 0x7000
    s_add_u32 s70, s70, s56
    s_and_b32 s70, s70, 0x1ffff
    s_add_u32 s70, s70, s91
    v_mfma_f32_16x16x32_bf16 v[200:203], a[36:39], a[72:75], v[200:203]
    s_bitcmp1_b32 s69, 15
    s_cselect_b64 s[4:5], s[16:17], s[12:13]
    s_lshr_b32 s40, s69, 4
    s_lshl_b32 s69, s69, 28
    v_mfma_f32_16x16x32_bf16 v[200:203], a[28:31], a[52:55], v[200:203]
    s_or_b32 s69, s69, s40
    ds_read_b128 v[48:51], v21 offset:512
    v_mfma_f32_16x16x32_bf16 v[224:227], a[28:31], a[56:59], v[224:227]
    ds_read_b64_tr_b16 v[232:233], v71 offset:49152
    v_accvgpr_write_b32 a33, v241
    v_mfma_f32_16x16x32_bf16 v[224:227], a[36:39], a[76:79], v[224:227]
    s_waitcnt lgkmcnt(2)
    ds_read_b64_tr_b16 v[234:235], v71 offset:51200
    v_accvgpr_write_b32 a34, v242
    v_mfma_f32_16x16x32_bf16 v[204:207], v[76:79], a[52:55], v[204:207]
    ds_read_b64_tr_b16 v[236:237], v71 offset:53248
    v_accvgpr_write_b32 a35, v243
    v_mfma_f32_16x16x32_bf16 v[204:207], v[80:83], a[72:75], v[204:207]
    ds_read_b64_tr_b16 v[238:239], v71 offset:55296
    v_mov_b32 v240, v244
    v_mfma_f32_16x16x32_bf16 v[172:175], v[80:83], a[68:71], v[172:175]
    v_mov_b32 v241, v245
    v_mov_b32 v242, v246
    v_mfma_f32_16x16x32_bf16 v[172:175], v[76:79], a[48:51], v[172:175]
    v_mov_b32 v243, v247
    v_mov_b32 v244, v248
    v_mfma_f32_16x16x32_bf16 v[140:143], v[76:79], a[44:47], v[140:143]
    v_mov_b32 v245, v249
    v_mov_b32 v246, v250
    v_mfma_f32_16x16x32_bf16 v[140:143], v[80:83], a[64:67], v[140:143]
    v_mov_b32 v247, v251
    v_mfma_f32_16x16x32_bf16 v[108:111], v[80:83], a[60:63], v[108:111]
    v_mfma_f32_16x16x32_bf16 v[108:111], v[76:79], a[40:43], v[108:111]
    s_waitcnt vmcnt(14) lgkmcnt(0)
    s_barrier
    s_add_u32 m0, s75, 49152
    s_add_u32 s53, s64, s62
    v_mfma_f32_16x16x32_bf16 v[112:115], v[232:235], a[40:43], v[112:115]
    buffer_load_dwordx4 v9, s[20:23], s53 offen offset:0 lds
    v_mfma_f32_16x16x32_bf16 v[112:115], v[236:239], a[60:63], v[112:115]
    ds_read_b64_tr_b16 a[20:21], v68 offset:0
    ds_read_b64_tr_b16 a[22:23], v68 offset:2048
    v_mfma_f32_16x16x32_bf16 v[144:147], v[236:239], a[64:67], v[144:147]
    ds_read_b64_tr_b16 a[24:25], v68 offset:4096
    ds_read_b64_tr_b16 a[26:27], v68 offset:6144
    v_mfma_f32_16x16x32_bf16 v[144:147], v[232:235], a[44:47], v[144:147]
    ds_read_b64_tr_b16 a[28:29], v69 offset:0
    v_mfma_f32_16x16x32_bf16 v[176:179], v[232:235], a[48:51], v[176:179]
    buffer_load_dwordx4 v10, s[20:23], s53 offen offset:1024 lds
    v_mfma_f32_16x16x32_bf16 v[176:179], v[236:239], a[68:71], v[176:179]
    s_add_u32 s62, s62, 524800
    ds_read_b64_tr_b16 a[30:31], v69 offset:2048
    v_mfma_f32_16x16x32_bf16 v[208:211], v[236:239], a[72:75], v[208:211]
    ds_read_b64_tr_b16 a[36:37], v69 offset:4096
    v_mfma_f32_16x16x32_bf16 v[208:211], v[232:235], a[52:55], v[208:211]
    s_waitcnt lgkmcnt(5)
    ds_read_b64_tr_b16 a[38:39], v69 offset:6144
    v_mfma_f32_16x16x32_bf16 a[144:147], a[20:23], v[44:47], a[144:147]
    buffer_load_dwordx4 v11, s[20:23], s53 offen offset:2048 lds
    s_waitcnt lgkmcnt(4)
    v_mfma_f32_16x16x32_bf16 a[144:147], a[24:27], v[64:67], a[144:147]
    s_cmp_ge_u32 s62, 5242880
    s_cselect_b32 s62, 0, s62
    v_mfma_f32_16x16x32_bf16 a[128:131], a[24:27], v[60:63], a[128:131]
    ds_read_b64_tr_b16 v[76:77], v70 offset:0
    v_mfma_f32_16x16x32_bf16 a[128:131], a[20:23], v[40:43], a[128:131]
    ds_read_b64_tr_b16 v[78:79], v70 offset:2048
    v_mfma_f32_16x16x32_bf16 a[112:115], a[20:23], v[36:39], a[112:115]
    buffer_load_dwordx4 v12, s[20:23], s53 offen offset:3072 lds
    v_mfma_f32_16x16x32_bf16 a[112:115], a[24:27], v[56:59], a[112:115]
    s_add_u32 m0, s60, 131072
    s_add_u32 s53, s66, s65
    v_mfma_f32_16x16x32_bf16 a[96:99], a[24:27], v[52:55], a[96:99]
    ds_read_b64_tr_b16 v[80:81], v70 offset:4096
    v_mfma_f32_16x16x32_bf16 a[96:99], a[20:23], v[32:35], a[96:99]
    ds_read_b64_tr_b16 v[82:83], v70 offset:6144
    v_mfma_f32_16x16x32_bf16 a[80:83], a[20:23], v[28:31], a[80:83]
    buffer_load_dwordx4 v13, s[8:11], s53 offen offset:0 lds
    v_mfma_f32_16x16x32_bf16 a[80:83], a[24:27], v[48:51], a[80:83]
    s_waitcnt lgkmcnt(2)
    ds_read_b64_tr_b16 v[232:233], v71 offset:0
    v_accvgpr_mov_b32 a240, a244
    v_mfma_f32_16x16x32_bf16 a[160:163], a[28:31], v[28:31], a[160:163]
    ds_read_b64_tr_b16 v[234:235], v71 offset:2048
    v_accvgpr_mov_b32 a241, a245
    v_mfma_f32_16x16x32_bf16 a[160:163], a[36:39], v[48:51], a[160:163]
    ds_read_b64_tr_b16 v[236:237], v71 offset:4096
    v_accvgpr_mov_b32 a242, a246
    v_mfma_f32_16x16x32_bf16 a[176:179], a[36:39], v[52:55], a[176:179]
    buffer_load_dwordx4 v14, s[8:11], s53 offen offset:1024 lds
    v_mfma_f32_16x16x32_bf16 a[176:179], a[28:31], v[32:35], a[176:179]
    s_add_u32 s65, s65, 128
    ds_read_b64_tr_b16 v[238:239], v71 offset:6144
    v_mfma_f32_16x16x32_bf16 a[192:195], a[28:31], v[36:39], a[192:195]
    v_accvgpr_mov_b32 a243, a247
    v_accvgpr_mov_b32 a244, a248
    v_mfma_f32_16x16x32_bf16 a[192:195], a[36:39], v[56:59], a[192:195]
    v_accvgpr_mov_b32 a245, a249
    v_accvgpr_mov_b32 a246, a250
    v_mfma_f32_16x16x32_bf16 a[208:211], a[36:39], v[60:63], a[208:211]
    buffer_load_dwordx4 v15, s[8:11], s53 offen offset:2048 lds
    v_mfma_f32_16x16x32_bf16 a[208:211], a[28:31], v[40:43], a[208:211]
    s_cmp_ge_u32 s65, 1280
    s_cselect_b32 s65, 0, s65
    v_mfma_f32_16x16x32_bf16 a[148:151], a[28:31], v[44:47], a[148:151]
    v_accvgpr_mov_b32 a247, a251
    v_accvgpr_mov_b32 a248, a252
    v_mfma_f32_16x16x32_bf16 a[148:151], a[36:39], v[64:67], a[148:151]
    v_accvgpr_mov_b32 a249, a253
    v_accvgpr_mov_b32 a250, a254
    v_mfma_f32_16x16x32_bf16 a[132:135], v[76:79], v[40:43], a[132:135]
    buffer_load_dwordx4 v16, s[8:11], s53 offen offset:3072 lds
    s_waitcnt lgkmcnt(0)
    v_mfma_f32_16x16x32_bf16 a[132:135], v[80:83], v[60:63], a[132:135]
    s_add_u32 m0, s72, 131072
    v_accvgpr_mov_b32 a251, a255
    v_mfma_f32_16x16x32_bf16 a[116:119], v[80:83], v[56:59], a[116:119]
    v_mfma_f32_16x16x32_bf16 a[116:119], v[76:79], v[36:39], a[116:119]
    v_mfma_f32_16x16x32_bf16 a[100:103], v[76:79], v[32:35], a[100:103]
    buffer_load_dwordx4 v17, s[8:11], s53 offen offset:0 lds
    v_mfma_f32_16x16x32_bf16 a[100:103], v[80:83], v[52:55], a[100:103]
    v_mfma_f32_16x16x32_bf16 a[84:87], v[80:83], v[48:51], a[84:87]
    v_mfma_f32_16x16x32_bf16 a[84:87], v[76:79], v[28:31], a[84:87]
    s_waitcnt vmcnt(14) lgkmcnt(0)
    s_barrier
    s_add_u32 m0, s75, 0
    s_add_u32 s53, s63, s62
    v_mfma_f32_16x16x32_bf16 a[164:167], v[232:235], v[28:31], a[164:167]
    buffer_load_dwordx4 v9, s[20:23], s53 offen offset:0 lds
    v_mfma_f32_16x16x32_bf16 a[164:167], v[236:239], v[48:51], a[164:167]
    ds_read_b64_tr_b16 a[20:21], v68 offset:16384
    ds_read_b64_tr_b16 a[22:23], v68 offset:18432
    v_mfma_f32_16x16x32_bf16 a[180:183], v[236:239], v[52:55], a[180:183]
    ds_read_b64_tr_b16 a[24:25], v68 offset:20480
    ds_read_b64_tr_b16 a[26:27], v68 offset:22528
    v_mfma_f32_16x16x32_bf16 a[180:183], v[232:235], v[32:35], a[180:183]
    ds_read_b64_tr_b16 a[28:29], v69 offset:16384
    v_mfma_f32_16x16x32_bf16 a[196:199], v[232:235], v[36:39], a[196:199]
    buffer_load_dwordx4 v10, s[20:23], s53 offen offset:1024 lds
    v_mfma_f32_16x16x32_bf16 a[196:199], v[236:239], v[56:59], a[196:199]
    ds_read_b64_tr_b16 a[30:31], v69 offset:18432
    v_mfma_f32_16x16x32_bf16 a[212:215], v[236:239], v[60:63], a[212:215]
    ds_read_b64_tr_b16 a[36:37], v69 offset:20480
    v_mfma_f32_16x16x32_bf16 a[212:215], v[232:235], v[40:43], a[212:215]
    s_waitcnt lgkmcnt(5)
    ds_read_b64_tr_b16 a[38:39], v69 offset:22528
    v_mfma_f32_16x16x32_bf16 a[152:155], a[20:23], v[44:47], a[152:155]
    buffer_load_dwordx4 v11, s[20:23], s53 offen offset:2048 lds
    s_waitcnt lgkmcnt(4)
    v_mfma_f32_16x16x32_bf16 a[152:155], a[24:27], v[64:67], a[152:155]
    ds_read_b64_tr_b16 v[76:77], v70 offset:16384
    v_mfma_f32_16x16x32_bf16 a[136:139], a[24:27], v[60:63], a[136:139]
    ds_read_b64_tr_b16 v[78:79], v70 offset:18432
    v_mfma_f32_16x16x32_bf16 a[136:139], a[20:23], v[40:43], a[136:139]
    ds_read_b64_tr_b16 v[80:81], v70 offset:20480
    v_mfma_f32_16x16x32_bf16 a[120:123], a[20:23], v[36:39], a[120:123]
    buffer_load_dwordx4 v12, s[20:23], s53 offen offset:3072 lds
    v_mfma_f32_16x16x32_bf16 a[120:123], a[24:27], v[56:59], a[120:123]
    s_add_u32 m0, s60, s67
    ds_read_b64_tr_b16 v[82:83], v70 offset:22528
    v_mfma_f32_16x16x32_bf16 a[104:107], a[24:27], v[52:55], a[104:107]
    ds_read_b64_tr_b16 v[232:233], v71 offset:16384
    v_mfma_f32_16x16x32_bf16 a[104:107], a[20:23], v[32:35], a[104:107]
    ds_read_b64_tr_b16 v[234:235], v71 offset:18432
    v_mfma_f32_16x16x32_bf16 a[88:91], a[20:23], v[28:31], a[88:91]
    buffer_load_dwordx4 v5, s[4:7], s70 offen offset:0 nt lds
    v_mfma_f32_16x16x32_bf16 a[88:91], a[24:27], v[48:51], a[88:91]
    s_add_u32 m0, s60, s67
    s_add_u32 s67, s67, s68
    s_waitcnt lgkmcnt(3)
    v_mfma_f32_16x16x32_bf16 a[168:171], a[28:31], v[28:31], a[168:171]
    ds_read_b64_tr_b16 v[236:237], v71 offset:20480
    v_mfma_f32_16x16x32_bf16 a[168:171], a[36:39], v[48:51], a[168:171]
    ds_read_b64_tr_b16 v[238:239], v71 offset:22528
    v_mfma_f32_16x16x32_bf16 a[184:187], a[36:39], v[52:55], a[184:187]
    buffer_load_dwordx4 v6, s[4:7], s70 offen offset:1024 nt lds
    v_mfma_f32_16x16x32_bf16 a[184:187], a[28:31], v[32:35], a[184:187]
    s_xor_b32 s68, s68, 12288
    s_mov_b32 m0, s73
    s_bitcmp1_b32 s71, 0
    s_cselect_b32 s40, s76, 0x40000000
    v_mfma_f32_16x16x32_bf16 a[200:203], a[28:31], v[36:39], a[200:203]
    v_mfma_f32_16x16x32_bf16 a[200:203], a[36:39], v[56:59], a[200:203]
    v_mfma_f32_16x16x32_bf16 a[216:219], a[36:39], v[60:63], a[216:219]
    buffer_load_dwordx4 v13, s[28:31], s40 offen offset:0 nt lds
    v_mfma_f32_16x16x32_bf16 a[216:219], a[28:31], v[40:43], a[216:219]
    s_xor_b32 s73, s73, 4096
    s_lshr_b32 s71, s71, 1
    s_add_u32 s76, s76, 128
    v_mfma_f32_16x16x32_bf16 a[156:159], a[28:31], v[44:47], a[156:159]
    v_mfma_f32_16x16x32_bf16 a[156:159], a[36:39], v[64:67], a[156:159]
    v_mfma_f32_16x16x32_bf16 a[140:143], v[76:79], v[40:43], a[140:143]
    buffer_load_dwordx4 a[252:255], v5, s[12:15], s83 offen offset:0 nt
    s_waitcnt lgkmcnt(0)
    v_mfma_f32_16x16x32_bf16 a[140:143], v[80:83], v[60:63], a[140:143]
    s_add_u32 s83, s83, 2048
    v_mfma_f32_16x16x32_bf16 a[124:127], v[80:83], v[56:59], a[124:127]
    v_mfma_f32_16x16x32_bf16 a[124:127], v[76:79], v[36:39], a[124:127]
    v_mfma_f32_16x16x32_bf16 a[108:111], v[76:79], v[32:35], a[108:111]
    buffer_load_dwordx4 v[248:251], v5, s[12:15], s94 offen offset:0 nt
    v_mfma_f32_16x16x32_bf16 a[108:111], v[80:83], v[52:55], a[108:111]
    s_add_u32 s94, s94, 2048
    s_add_u32 s40, s65, 128
    s_cmp_ge_u32 s40, 1280
    s_cselect_b32 s40, 0, s40
    v_mfma_f32_16x16x32_bf16 a[92:95], v[80:83], v[48:51], a[92:95]
    buffer_load_dword v254, v1, s[8:11], s40 offen
    v_mfma_f32_16x16x32_bf16 a[92:95], v[76:79], v[28:31], a[92:95]
    s_waitcnt vmcnt(19) lgkmcnt(0)
    s_barrier
    ds_read_b64_tr_b16 a[20:21], v68 offset:32768
    ds_read_b64_tr_b16 a[22:23], v68 offset:34816
    v_mfma_f32_16x16x32_bf16 a[172:175], v[232:235], v[28:31], a[172:175]
    ds_read_b64_tr_b16 a[24:25], v68 offset:36864
    ds_read_b64_tr_b16 a[26:27], v68 offset:38912
    v_mfma_f32_16x16x32_bf16 a[172:175], v[236:239], v[48:51], a[172:175]
    ds_read_b64_tr_b16 a[28:29], v69 offset:32768
    v_mfma_f32_16x16x32_bf16 a[188:191], v[236:239], v[52:55], a[188:191]
    ds_read_b64_tr_b16 a[30:31], v69 offset:34816
    v_mfma_f32_16x16x32_bf16 a[188:191], v[232:235], v[32:35], a[188:191]
    ds_read_b64_tr_b16 a[36:37], v69 offset:36864
    v_mfma_f32_16x16x32_bf16 a[204:207], v[232:235], v[36:39], a[204:207]
    ds_read_b64_tr_b16 a[38:39], v69 offset:38912
    v_mfma_f32_16x16x32_bf16 a[204:207], v[236:239], v[56:59], a[204:207]
    ds_read_b64_tr_b16 v[76:77], v70 offset:32768
    v_mfma_f32_16x16x32_bf16 a[220:223], v[236:239], v[60:63], a[220:223]
    ds_read_b64_tr_b16 v[78:79], v70 offset:34816
    v_mfma_f32_16x16x32_bf16 a[220:223], v[232:235], v[40:43], a[220:223]
    s_waitcnt lgkmcnt(6)
    ds_read_b64_tr_b16 v[80:81], v70 offset:36864
    v_mfma_f32_16x16x32_bf16 v[212:215], a[20:23], v[44:47], v[212:215]
    ds_read_b64_tr_b16 v[82:83], v70 offset:38912
    v_mfma_f32_16x16x32_bf16 v[212:215], a[24:27], v[64:67], v[212:215]
    s_add_u32 m0, s75, 16384
    s_add_u32 s53, s64, s62
    v_mfma_f32_16x16x32_bf16 v[180:183], a[24:27], v[60:63], v[180:183]
    buffer_load_dwordx4 v9, s[20:23], s53 offen offset:0 lds
    v_mfma_f32_16x16x32_bf16 v[180:183], a[20:23], v[40:43], v[180:183]
    ds_read_b64_tr_b16 v[232:233], v71 offset:32768
    v_mfma_f32_16x16x32_bf16 v[148:151], a[20:23], v[36:39], v[148:151]
    ds_read_b64_tr_b16 v[234:235], v71 offset:34816
    v_mfma_f32_16x16x32_bf16 v[148:151], a[24:27], v[56:59], v[148:151]
    v_accvgpr_mov_b32 a19, a15
    v_accvgpr_mov_b32 a18, a14
    v_mfma_f32_16x16x32_bf16 v[116:119], a[24:27], v[52:55], v[116:119]
    buffer_load_dwordx4 v10, s[20:23], s53 offen offset:1024 lds
    v_mfma_f32_16x16x32_bf16 v[116:119], a[20:23], v[32:35], v[116:119]
    s_sub_u32 s62, s62, 512
    v_accvgpr_mov_b32 a17, a13
    v_mfma_f32_16x16x32_bf16 v[84:87], a[20:23], v[28:31], v[84:87]
    v_accvgpr_mov_b32 a16, a12
    v_accvgpr_mov_b32 a15, a11
    v_mfma_f32_16x16x32_bf16 v[84:87], a[24:27], v[48:51], v[84:87]
    s_waitcnt lgkmcnt(0)
    v_accvgpr_mov_b32 a14, a10
    v_accvgpr_mov_b32 a13, a9
    v_mfma_f32_16x16x32_bf16 v[88:91], a[28:31], v[28:31], v[88:91]
    buffer_load_dwordx4 v11, s[20:23], s53 offen offset:2048 lds
    v_mfma_f32_16x16x32_bf16 v[88:91], a[36:39], v[48:51], v[88:91]
    v_accvgpr_mov_b32 a12, a8
    v_accvgpr_mov_b32 a11, a7
    v_mfma_f32_16x16x32_bf16 v[120:123], a[36:39], v[52:55], v[120:123]
    v_accvgpr_mov_b32 a10, a6
    v_accvgpr_mov_b32 a9, a5
    v_mfma_f32_16x16x32_bf16 v[120:123], a[28:31], v[32:35], v[120:123]
    v_accvgpr_mov_b32 a8, a4
    v_accvgpr_mov_b32 a7, a3
    v_mfma_f32_16x16x32_bf16 v[152:155], a[28:31], v[36:39], v[152:155]
    buffer_load_dwordx4 v12, s[20:23], s53 offen offset:3072 lds
    v_mfma_f32_16x16x32_bf16 v[152:155], a[36:39], v[56:59], v[152:155]
    v_accvgpr_mov_b32 a6, a2
    v_accvgpr_mov_b32 a5, a1
    v_mfma_f32_16x16x32_bf16 v[184:187], a[36:39], v[60:63], v[184:187]
    v_accvgpr_mov_b32 a4, a0
    ds_read_b64_tr_b16 a[0:1], v228 offset:0
    v_mfma_f32_16x16x32_bf16 v[184:187], a[28:31], v[40:43], v[184:187]
    ds_read_b64_tr_b16 a[2:3], v228 offset:2048
    v_xor_b32 v228, 4096, v228
    v_mfma_f32_16x16x32_bf16 v[216:219], a[28:31], v[44:47], v[216:219]
    global_load_dword v254, v[2:3], off
    v_mfma_f32_16x16x32_bf16 v[216:219], a[36:39], v[64:67], v[216:219]
    ds_read_b64_tr_b16 v[236:237], v71 offset:36864
    v_mfma_f32_16x16x32_bf16 v[188:191], v[76:79], v[40:43], v[188:191]
    ds_read_b64_tr_b16 v[238:239], v71 offset:38912
    v_mfma_f32_16x16x32_bf16 v[188:191], v[80:83], v[60:63], v[188:191]
    v_mfma_f32_16x16x32_bf16 v[156:159], v[80:83], v[56:59], v[156:159]
    v_mfma_f32_16x16x32_bf16 v[156:159], v[76:79], v[36:39], v[156:159]
    v_mfma_f32_16x16x32_bf16 v[124:127], v[76:79], v[32:35], v[124:127]
    v_mfma_f32_16x16x32_bf16 v[124:127], v[80:83], v[52:55], v[124:127]
    v_mfma_f32_16x16x32_bf16 v[92:95], v[80:83], v[48:51], v[92:95]
    v_mfma_f32_16x16x32_bf16 v[92:95], v[76:79], v[28:31], v[92:95]
    s_lshr_b32 s96, s96, 1
    s_cbranch_scc0 1
    s_waitcnt vmcnt(0)
    s_waitcnt vmcnt(15) lgkmcnt(0)
    s_barrier
    ds_read_b64_tr_b16 a[20:21], v68 offset:49152
    ds_read_b64_tr_b16 a[22:23], v68 offset:51200
    v_mfma_f32_16x16x32_bf16 v[96:99], v[232:235], v[28:31], v[96:99]
    ds_read_b64_tr_b16 a[24:25], v68 offset:53248
    ds_read_b64_tr_b16 a[26:27], v68 offset:55296
    v_mfma_f32_16x16x32_bf16 v[96:99], v[236:239], v[48:51], v[96:99]
    ds_read_b64_tr_b16 a[28:29], v69 offset:49152
    v_mfma_f32_16x16x32_bf16 v[128:131], v[236:239], v[52:55], v[128:131]
    ds_read_b64_tr_b16 a[30:31], v69 offset:51200
    v_mfma_f32_16x16x32_bf16 v[128:131], v[232:235], v[32:35], v[128:131]
    ds_read_b64_tr_b16 a[36:37], v69 offset:53248
    v_mfma_f32_16x16x32_bf16 v[160:163], v[232:235], v[36:39], v[160:163]
    ds_read_b64_tr_b16 a[38:39], v69 offset:55296
    v_mfma_f32_16x16x32_bf16 v[160:163], v[236:239], v[56:59], v[160:163]
    ds_read_b128 a[56:59], v22 offset:16384
    v_mfma_f32_16x16x32_bf16 v[192:195], v[236:239], v[60:63], v[192:195]
    ds_read_b128 a[76:79], v22 offset:16896
    v_mfma_f32_16x16x32_bf16 v[192:195], v[232:235], v[40:43], v[192:195]
    s_waitcnt lgkmcnt(6)
    ds_read_b128 a[52:55], v21 offset:6144
    v_mfma_f32_16x16x32_bf16 v[220:223], a[20:23], v[44:47], v[220:223]
    ds_read_b128 a[72:75], v21 offset:6656
    v_mfma_f32_16x16x32_bf16 v[220:223], a[24:27], v[64:67], v[220:223]
    s_add_u32 m0, s75, 32768
    s_add_u32 s53, s63, s62
    v_mfma_f32_16x16x32_bf16 v[196:199], a[24:27], v[60:63], v[196:199]
    buffer_load_dwordx4 v9, s[20:23], s53 offen offset:0 lds
    v_mfma_f32_16x16x32_bf16 v[196:199], a[20:23], v[40:43], v[196:199]
    ds_read_b64_tr_b16 v[76:77], v70 offset:49152
    v_mfma_f32_16x16x32_bf16 v[164:167], a[20:23], v[36:39], v[164:167]
    ds_read_b64_tr_b16 v[78:79], v70 offset:51200
    v_mfma_f32_16x16x32_bf16 v[164:167], a[24:27], v[56:59], v[164:167]
    ds_read_b64_tr_b16 v[80:81], v70 offset:53248
    v_mfma_f32_16x16x32_bf16 v[132:135], a[24:27], v[52:55], v[132:135]
    buffer_load_dwordx4 v10, s[20:23], s53 offen offset:1024 lds
    v_mfma_f32_16x16x32_bf16 v[132:135], a[20:23], v[32:35], v[132:135]
    ds_read_b64_tr_b16 v[82:83], v70 offset:55296
    v_mfma_f32_16x16x32_bf16 v[100:103], a[20:23], v[28:31], v[100:103]
    ds_read_b128 a[48:51], v21 offset:4096
    v_mfma_f32_16x16x32_bf16 v[100:103], a[24:27], v[48:51], v[100:103]
    s_waitcnt lgkmcnt(5)
    ds_read_b128 a[68:71], v21 offset:4608
    v_mfma_f32_16x16x32_bf16 v[104:107], a[28:31], v[28:31], v[104:107]
    buffer_load_dwordx4 v11, s[20:23], s53 offen offset:2048 lds
    v_mfma_f32_16x16x32_bf16 v[104:107], a[36:39], v[48:51], v[104:107]
    ds_read_b128 a[44:47], v21 offset:2048
    v_mfma_f32_16x16x32_bf16 v[136:139], a[36:39], v[52:55], v[136:139]
    ds_read_b128 a[64:67], v21 offset:2560
    v_mfma_f32_16x16x32_bf16 v[136:139], a[28:31], v[32:35], v[136:139]
    ds_read_b128 a[40:43], v21 offset:0
    v_mfma_f32_16x16x32_bf16 v[168:171], a[28:31], v[36:39], v[168:171]
    buffer_load_dwordx4 v12, s[20:23], s53 offen offset:3072 lds
    v_mfma_f32_16x16x32_bf16 v[168:171], a[36:39], v[56:59], v[168:171]
    s_and_b32 s70, s69, 0x7000
    s_add_u32 s70, s70, s56
    s_and_b32 s70, s70, 0x1ffff
    s_add_u32 s70, s70, s91
    v_mfma_f32_16x16x32_bf16 v[200:203], a[36:39], v[60:63], v[200:203]
    s_bitcmp1_b32 s69, 15
    s_cselect_b64 s[4:5], s[16:17], s[12:13]
    s_lshr_b32 s40, s69, 4
    s_lshl_b32 s69, s69, 28
    v_mfma_f32_16x16x32_bf16 v[200:203], a[28:31], v[40:43], v[200:203]
    s_or_b32 s69, s69, s40
    ds_read_b128 a[60:63], v21 offset:512
    v_mfma_f32_16x16x32_bf16 v[224:227], a[28:31], v[44:47], v[224:227]
    ds_read_b64_tr_b16 v[232:233], v71 offset:49152
    v_mfma_f32_16x16x32_bf16 v[224:227], a[36:39], v[64:67], v[224:227]
    s_waitcnt lgkmcnt(2)
    ds_read_b64_tr_b16 v[234:235], v71 offset:51200
    v_mfma_f32_16x16x32_bf16 v[204:207], v[76:79], v[40:43], v[204:207]
    ds_read_b64_tr_b16 v[236:237], v71 offset:53248
    v_mfma_f32_16x16x32_bf16 v[204:207], v[80:83], v[60:63], v[204:207]
    ds_read_b64_tr_b16 v[238:239], v71 offset:55296
    v_mfma_f32_16x16x32_bf16 v[172:175], v[80:83], v[56:59], v[172:175]
    v_mfma_f32_16x16x32_bf16 v[172:175], v[76:79], v[36:39], v[172:175]
    v_mfma_f32_16x16x32_bf16 v[140:143], v[76:79], v[32:35], v[140:143]
    v_mfma_f32_16x16x32_bf16 v[140:143], v[80:83], v[52:55], v[140:143]
    v_mfma_f32_16x16x32_bf16 v[108:111], v[80:83], v[48:51], v[108:111]
    v_mfma_f32_16x16x32_bf16 v[108:111], v[76:79], v[28:31], v[108:111]
    s_sub_u32 s92, s92, 1
    s_cbranch_scc0 gqa_kernel_qloop_0
    s_waitcnt vmcnt(15) lgkmcnt(0)
    s_barrier
    s_add_u32 m0, s75, 65536
    s_add_u32 s53, s64, s62
    v_mfma_f32_16x16x32_bf16 v[112:115], v[232:235], v[28:31], v[112:115]
    buffer_load_dwordx4 v9, s[20:23], s53 offen offset:0 lds
    v_mfma_f32_16x16x32_bf16 v[112:115], v[236:239], v[48:51], v[112:115]
    ds_read_b64_tr_b16 a[20:21], v68 offset:0
    ds_read_b64_tr_b16 a[22:23], v68 offset:2048
    v_mfma_f32_16x16x32_bf16 v[144:147], v[236:239], v[52:55], v[144:147]
    ds_read_b64_tr_b16 a[24:25], v68 offset:4096
    ds_read_b64_tr_b16 a[26:27], v68 offset:6144
    v_mfma_f32_16x16x32_bf16 v[144:147], v[232:235], v[32:35], v[144:147]
    ds_read_b64_tr_b16 a[28:29], v69 offset:0
    v_lshl_add_u32 v25, s3, 12, v24
    v_mfma_f32_16x16x32_bf16 v[176:179], v[232:235], v[36:39], v[176:179]
    buffer_load_dwordx4 v10, s[20:23], s53 offen offset:1024 lds
    v_mfma_f32_16x16x32_bf16 v[176:179], v[236:239], v[56:59], v[176:179]
    s_add_u32 s62, s62, 524800
    ds_read_b64_tr_b16 a[30:31], v69 offset:2048
    v_mfma_f32_16x16x32_bf16 v[208:211], v[236:239], v[60:63], v[208:211]
    ds_read_b64_tr_b16 a[36:37], v69 offset:4096
    v_add_u32 v25, 131072, v25
    v_mfma_f32_16x16x32_bf16 v[208:211], v[232:235], v[40:43], v[208:211]
    s_waitcnt lgkmcnt(3)
    ds_read_b64_tr_b16 a[38:39], v69 offset:6144
    v_xor_b32 v26, 4096, v25
    v_mfma_f32_16x16x32_bf16 a[144:147], a[20:23], a[56:59], a[144:147]
    buffer_load_dwordx4 v11, s[20:23], s53 offen offset:2048 lds
    v_mfma_f32_16x16x32_bf16 a[144:147], a[24:27], a[76:79], a[144:147]
    s_cmp_ge_u32 s62, 5242880
    s_cselect_b32 s62, 0, s62
    v_mfma_f32_16x16x32_bf16 a[128:131], a[24:27], a[72:75], a[128:131]
    ds_read_b64_tr_b16 v[76:77], v70 offset:0
    v_and_b32 v27, 0xfffffcf0, v25
    v_mfma_f32_16x16x32_bf16 a[128:131], a[20:23], a[52:55], a[128:131]
    ds_read_b64_tr_b16 v[78:79], v70 offset:2048
    v_bfe_u32 v74, v24, 9, 1
    v_mfma_f32_16x16x32_bf16 a[112:115], a[20:23], a[48:51], a[112:115]
    buffer_load_dwordx4 v12, s[20:23], s53 offen offset:3072 lds
    v_mfma_f32_16x16x32_bf16 a[112:115], a[24:27], a[68:71], a[112:115]
    s_add_u32 m0, s90, 49152
    s_add_u32 s53, s56, 32768
    s_and_b32 s53, s53, 0x1ffff
    s_add_u32 s53, s53, s91
    v_mfma_f32_16x16x32_bf16 a[96:99], a[24:27], a[64:67], a[96:99]
    ds_read_b64_tr_b16 v[80:81], v70 offset:4096
    v_lshl_add_u32 v27, v74, 8, v27
    v_mfma_f32_16x16x32_bf16 a[96:99], a[20:23], a[44:47], a[96:99]
    ds_read_b64_tr_b16 v[82:83], v70 offset:6144
    v_bfe_u32 v74, v24, 8, 1
    v_mfma_f32_16x16x32_bf16 a[80:83], a[20:23], a[40:43], a[80:83]
    buffer_load_dwordx4 v5, s[12:15], s53 offen offset:0 nt lds
    v_mfma_f32_16x16x32_bf16 a[80:83], a[24:27], a[60:63], a[80:83]
    s_waitcnt lgkmcnt(2)
    ds_read_b64_tr_b16 v[232:233], v71 offset:0
    v_lshl_add_u32 v27, v74, 3, v27
    v_mfma_f32_16x16x32_bf16 a[160:163], a[28:31], a[40:43], a[160:163]
    ds_read_b64_tr_b16 v[234:235], v71 offset:2048
    v_mfma_f32_16x16x32_bf16 a[160:163], a[36:39], a[60:63], a[160:163]
    ds_read_b64_tr_b16 v[236:237], v71 offset:4096
    v_mfma_f32_16x16x32_bf16 a[176:179], a[36:39], a[64:67], a[176:179]
    buffer_load_dwordx4 v6, s[12:15], s53 offen offset:1024 nt lds
    v_mfma_f32_16x16x32_bf16 a[176:179], a[28:31], a[44:47], a[176:179]
    ds_read_b64_tr_b16 v[238:239], v71 offset:6144
    v_mfma_f32_16x16x32_bf16 a[192:195], a[28:31], a[48:51], a[192:195]
    v_mfma_f32_16x16x32_bf16 a[192:195], a[36:39], a[68:71], a[192:195]
    v_mfma_f32_16x16x32_bf16 a[208:211], a[36:39], a[72:75], a[208:211]
    buffer_load_dwordx4 v7, s[12:15], s53 offen offset:2048 nt lds
    v_mfma_f32_16x16x32_bf16 a[208:211], a[28:31], a[52:55], a[208:211]
    v_mfma_f32_16x16x32_bf16 a[148:151], a[28:31], a[56:59], a[148:151]
    v_mfma_f32_16x16x32_bf16 a[148:151], a[36:39], a[76:79], a[148:151]
    v_mfma_f32_16x16x32_bf16 a[132:135], v[76:79], a[52:55], a[132:135]
    buffer_load_dwordx4 v8, s[12:15], s53 offen offset:3072 nt lds
    s_waitcnt lgkmcnt(1)
    v_mfma_f32_16x16x32_bf16 a[132:135], v[80:83], a[72:75], a[132:135]
    v_accvgpr_read_b32 v28, a80
    v_accvgpr_read_b32 v29, a81
    v_mfma_f32_16x16x32_bf16 a[116:119], v[80:83], a[68:71], a[116:119]
    v_accvgpr_read_b32 v30, a82
    v_accvgpr_read_b32 v31, a83
    v_mfma_f32_16x16x32_bf16 a[116:119], v[76:79], a[48:51], a[116:119]
    v_accvgpr_read_b32 v32, a160
    v_accvgpr_read_b32 v33, a161
    v_mfma_f32_16x16x32_bf16 a[100:103], v[76:79], a[44:47], a[100:103]
    v_accvgpr_read_b32 v34, a162
    v_accvgpr_read_b32 v35, a163
    v_mfma_f32_16x16x32_bf16 a[100:103], v[80:83], a[64:67], a[100:103]
    v_pk_mul_f32 v[28:29], v[28:29], s[46:47]
    v_pk_mul_f32 v[30:31], v[30:31], s[46:47]
    v_pk_mul_f32 v[32:33], v[32:33], s[46:47]
    v_pk_mul_f32 v[34:35], v[34:35], s[46:47]
    v_mfma_f32_16x16x32_bf16 a[84:87], v[80:83], a[60:63], a[84:87]
    v_cvt_pk_bf16_f32 v28, v28, v29
    v_cvt_pk_bf16_f32 v29, v30, v31
    v_mfma_f32_16x16x32_bf16 a[84:87], v[76:79], a[40:43], a[84:87]
    s_waitcnt vmcnt(13) lgkmcnt(0)
    s_barrier
    ds_read_b64_tr_b16 a[20:21], v68 offset:16384
    ds_read_b64_tr_b16 a[22:23], v68 offset:18432
    v_mfma_f32_16x16x32_bf16 a[164:167], v[232:235], a[40:43], a[164:167]
    ds_read_b64_tr_b16 a[24:25], v68 offset:20480
    ds_read_b64_tr_b16 a[26:27], v68 offset:22528
    v_mfma_f32_16x16x32_bf16 a[164:167], v[236:239], a[60:63], a[164:167]
    ds_read_b64_tr_b16 a[28:29], v69 offset:16384
    v_accvgpr_read_b32 v10, a32
    v_mfma_f32_16x16x32_bf16 a[180:183], v[236:239], a[64:67], a[180:183]
    ds_read_b64_tr_b16 a[30:31], v69 offset:18432
    v_accvgpr_read_b32 v11, a33
    v_mfma_f32_16x16x32_bf16 a[180:183], v[232:235], a[44:47], a[180:183]
    ds_read_b64_tr_b16 a[36:37], v69 offset:20480
    v_accvgpr_read_b32 v12, a34
    v_mfma_f32_16x16x32_bf16 a[196:199], v[232:235], a[48:51], a[196:199]
    ds_read_b64_tr_b16 a[38:39], v69 offset:22528
    v_accvgpr_read_b32 v13, a35
    v_mfma_f32_16x16x32_bf16 a[196:199], v[236:239], a[68:71], a[196:199]
    ds_read_b64_tr_b16 v[76:77], v70 offset:16384
    v_mov_b32 v14, v240
    v_mfma_f32_16x16x32_bf16 a[212:215], v[236:239], a[72:75], a[212:215]
    ds_read_b64_tr_b16 v[78:79], v70 offset:18432
    v_mov_b32 v15, v241
    v_mfma_f32_16x16x32_bf16 a[212:215], v[232:235], a[52:55], a[212:215]
    s_waitcnt lgkmcnt(3)
    ds_read_b64_tr_b16 v[80:81], v70 offset:20480
    v_mov_b32 v16, v242
    v_mfma_f32_16x16x32_bf16 a[152:155], a[20:23], a[56:59], a[152:155]
    ds_read_b64_tr_b16 v[82:83], v70 offset:22528
    v_mov_b32 v17, v243
    v_mfma_f32_16x16x32_bf16 a[152:155], a[24:27], a[76:79], a[152:155]
    ds_read_b64_tr_b16 v[232:233], v71 offset:16384
    v_cvt_pk_bf16_f32 v30, v32, v33
    v_mfma_f32_16x16x32_bf16 a[136:139], a[24:27], a[72:75], a[136:139]
    ds_read_b64_tr_b16 v[234:235], v71 offset:18432
    v_cvt_pk_bf16_f32 v31, v34, v35
    v_mfma_f32_16x16x32_bf16 a[136:139], a[20:23], a[52:55], a[136:139]
    ds_read_b64_tr_b16 v[236:237], v71 offset:20480
    v_accvgpr_read_b32 v36, a96
    v_mfma_f32_16x16x32_bf16 a[120:123], a[20:23], a[48:51], a[120:123]
    ds_read_b64_tr_b16 v[238:239], v71 offset:22528
    v_accvgpr_read_b32 v37, a97
    v_mfma_f32_16x16x32_bf16 a[120:123], a[24:27], a[68:71], a[120:123]
    s_add_u32 m0, s90, 0
    s_add_u32 s53, s56, 8192
    s_and_b32 s53, s53, 0x1ffff
    s_add_u32 s53, s53, s91
    v_mfma_f32_16x16x32_bf16 a[104:107], a[24:27], a[64:67], a[104:107]
    buffer_load_dwordx4 v5, s[16:19], s53 offen offset:0 nt lds
    v_mfma_f32_16x16x32_bf16 a[104:107], a[20:23], a[44:47], a[104:107]
    v_accvgpr_read_b32 v38, a98
    v_accvgpr_read_b32 v39, a99
    v_mfma_f32_16x16x32_bf16 a[88:91], a[20:23], a[40:43], a[88:91]
    v_accvgpr_read_b32 v40, a176
    v_accvgpr_read_b32 v41, a177
    v_mfma_f32_16x16x32_bf16 a[88:91], a[24:27], a[60:63], a[88:91]
    v_accvgpr_read_b32 v42, a178
    v_accvgpr_read_b32 v43, a179
    v_mfma_f32_16x16x32_bf16 a[168:171], a[28:31], a[40:43], a[168:171]
    s_waitcnt lgkmcnt(0)
    ds_write2st64_b64 v27, v[28:29], v[30:31] offset0:32 offset1:33
    v_pk_mul_f32 v[36:37], v[36:37], s[46:47]
    v_pk_mul_f32 v[38:39], v[38:39], s[46:47]
    v_pk_mul_f32 v[40:41], v[40:41], s[46:47]
    v_pk_mul_f32 v[42:43], v[42:43], s[46:47]
    v_mfma_f32_16x16x32_bf16 a[168:171], a[36:39], a[60:63], a[168:171]
    buffer_load_dwordx4 v6, s[16:19], s53 offen offset:1024 nt lds
    v_mfma_f32_16x16x32_bf16 a[184:187], a[36:39], a[64:67], a[184:187]
    ds_read_b128 a[80:83], v25 offset:16384
    v_cvt_pk_bf16_f32 v36, v36, v37
    v_mfma_f32_16x16x32_bf16 a[184:187], a[28:31], a[44:47], a[184:187]
    v_cvt_pk_bf16_f32 v37, v38, v39
    v_cvt_pk_bf16_f32 v38, v40, v41
    v_mfma_f32_16x16x32_bf16 a[200:203], a[28:31], a[48:51], a[200:203]
    v_cvt_pk_bf16_f32 v39, v42, v43
    v_accvgpr_read_b32 v44, a112
    v_mfma_f32_16x16x32_bf16 a[200:203], a[36:39], a[68:71], a[200:203]
    buffer_load_dwordx4 v7, s[16:19], s53 offen offset:2048 nt lds
    v_mfma_f32_16x16x32_bf16 a[216:219], a[36:39], a[72:75], a[216:219]
    v_accvgpr_read_b32 v45, a113
    v_accvgpr_read_b32 v46, a114
    v_mfma_f32_16x16x32_bf16 a[216:219], a[28:31], a[52:55], a[216:219]
    v_accvgpr_read_b32 v47, a115
    v_accvgpr_read_b32 v48, a192
    v_mfma_f32_16x16x32_bf16 a[156:159], a[28:31], a[56:59], a[156:159]
    v_accvgpr_read_b32 v49, a193
    v_accvgpr_read_b32 v50, a194
    v_mfma_f32_16x16x32_bf16 a[156:159], a[36:39], a[76:79], a[156:159]
    buffer_load_dwordx4 v8, s[16:19], s53 offen offset:3072 nt lds
    v_mfma_f32_16x16x32_bf16 a[140:143], v[76:79], a[52:55], a[140:143]
    v_accvgpr_read_b32 v51, a195
    v_accvgpr_read_b32 v52, a128
    v_mfma_f32_16x16x32_bf16 a[140:143], v[80:83], a[72:75], a[140:143]
    ds_write2st64_b64 v27, v[36:37], v[38:39] offset0:34 offset1:35
    v_pk_mul_f32 v[44:45], v[44:45], s[46:47]
    v_pk_mul_f32 v[46:47], v[46:47], s[46:47]
    v_pk_mul_f32 v[48:49], v[48:49], s[46:47]
    v_pk_mul_f32 v[50:51], v[50:51], s[46:47]
    v_mfma_f32_16x16x32_bf16 a[124:127], v[80:83], a[68:71], a[124:127]
    ds_read_b128 a[96:99], v25 offset:17408
    v_cvt_pk_bf16_f32 v44, v44, v45
    v_mfma_f32_16x16x32_bf16 a[124:127], v[76:79], a[48:51], a[124:127]
    v_cvt_pk_bf16_f32 v45, v46, v47
    v_cvt_pk_bf16_f32 v46, v48, v49
    v_mfma_f32_16x16x32_bf16 a[108:111], v[76:79], a[44:47], a[108:111]
    v_cvt_pk_bf16_f32 v47, v50, v51
    v_accvgpr_read_b32 v53, a129
    v_mfma_f32_16x16x32_bf16 a[108:111], v[80:83], a[64:67], a[108:111]
    v_accvgpr_read_b32 v54, a130
    v_accvgpr_read_b32 v55, a131
    v_mfma_f32_16x16x32_bf16 a[92:95], v[80:83], a[60:63], a[92:95]
    v_accvgpr_read_b32 v56, a208
    v_accvgpr_read_b32 v57, a209
    v_mfma_f32_16x16x32_bf16 a[92:95], v[76:79], a[40:43], a[92:95]
    s_waitcnt vmcnt(12) lgkmcnt(0)
    s_barrier
    ds_read_b64_tr_b16 a[20:21], v68 offset:32768
    ds_read_b64_tr_b16 a[22:23], v68 offset:34816
    v_mfma_f32_16x16x32_bf16 a[172:175], v[232:235], a[40:43], a[172:175]
    ds_read_b64_tr_b16 a[24:25], v68 offset:36864
    ds_read_b64_tr_b16 a[26:27], v68 offset:38912
    v_mfma_f32_16x16x32_bf16 a[172:175], v[236:239], a[60:63], a[172:175]
    ds_read_b64_tr_b16 a[28:29], v69 offset:32768
    v_accvgpr_read_b32 v58, a210
    v_mfma_f32_16x16x32_bf16 a[188:191], v[236:239], a[64:67], a[188:191]
    ds_read_b64_tr_b16 a[30:31], v69 offset:34816
    v_accvgpr_read_b32 v59, a211
    v_mfma_f32_16x16x32_bf16 a[188:191], v[232:235], a[44:47], a[188:191]
    ds_write2st64_b64 v27, v[44:45], v[46:47] offset0:36 offset1:37
    v_pk_mul_f32 v[52:53], v[52:53], s[46:47]
    v_pk_mul_f32 v[54:55], v[54:55], s[46:47]
    v_pk_mul_f32 v[56:57], v[56:57], s[46:47]
    v_pk_mul_f32 v[58:59], v[58:59], s[46:47]
    v_mfma_f32_16x16x32_bf16 a[204:207], v[232:235], a[48:51], a[204:207]
    ds_read_b64_tr_b16 a[36:37], v69 offset:36864
    v_cvt_pk_bf16_f32 v52, v52, v53
    v_mfma_f32_16x16x32_bf16 a[204:207], v[236:239], a[68:71], a[204:207]
    ds_read_b64_tr_b16 a[38:39], v69 offset:38912
    v_cvt_pk_bf16_f32 v53, v54, v55
    v_mfma_f32_16x16x32_bf16 a[220:223], v[236:239], a[72:75], a[220:223]
    ds_read_b64_tr_b16 v[76:77], v70 offset:32768
    v_cvt_pk_bf16_f32 v54, v56, v57
    v_mfma_f32_16x16x32_bf16 a[220:223], v[232:235], a[52:55], a[220:223]
    s_waitcnt lgkmcnt(3)
    ds_read_b64_tr_b16 v[78:79], v70 offset:34816
    v_cvt_pk_bf16_f32 v55, v58, v59
    v_mfma_f32_16x16x32_bf16 v[212:215], a[20:23], a[56:59], v[212:215]
    ds_read_b64_tr_b16 v[80:81], v70 offset:36864
    v_accvgpr_read_b32 v28, a84
    v_mfma_f32_16x16x32_bf16 v[212:215], a[24:27], a[76:79], v[212:215]
    ds_read_b64_tr_b16 v[82:83], v70 offset:38912
    v_accvgpr_read_b32 v29, a85
    v_mfma_f32_16x16x32_bf16 v[180:183], a[24:27], a[72:75], v[180:183]
    ds_read_b64_tr_b16 v[232:233], v71 offset:32768
    v_accvgpr_read_b32 v30, a86
    v_mfma_f32_16x16x32_bf16 v[180:183], a[20:23], a[52:55], v[180:183]
    ds_read_b64_tr_b16 v[234:235], v71 offset:34816
    v_accvgpr_read_b32 v31, a87
    v_mfma_f32_16x16x32_bf16 v[148:151], a[20:23], a[48:51], v[148:151]
    ds_read_b64_tr_b16 v[236:237], v71 offset:36864
    v_accvgpr_read_b32 v32, a164
    v_mfma_f32_16x16x32_bf16 v[148:151], a[24:27], a[68:71], v[148:151]
    buffer_store_dwordx4 a[16:19], v24, s[24:27], s77 offen offset:0 sc1
    v_mfma_f32_16x16x32_bf16 v[116:119], a[24:27], a[64:67], v[116:119]
    s_add_u32 s77, s77, 4096
    ds_read_b64_tr_b16 v[238:239], v71 offset:38912
    v_mfma_f32_16x16x32_bf16 v[116:119], a[20:23], a[44:47], v[116:119]
    ds_read_b128 a[112:115], v25 offset:18432
    v_accvgpr_read_b32 v33, a165
    v_mfma_f32_16x16x32_bf16 v[84:87], a[20:23], a[40:43], v[84:87]
    v_accvgpr_read_b32 v34, a166
    v_accvgpr_read_b32 v35, a167
    v_mfma_f32_16x16x32_bf16 v[84:87], a[24:27], a[60:63], v[84:87]
    ds_write2st64_b64 v27, v[52:53], v[54:55] offset0:38 offset1:39
    v_pk_mul_f32 v[28:29], v[28:29], s[46:47]
    v_pk_mul_f32 v[30:31], v[30:31], s[46:47]
    v_pk_mul_f32 v[32:33], v[32:33], s[46:47]
    v_pk_mul_f32 v[34:35], v[34:35], s[46:47]
    v_mfma_f32_16x16x32_bf16 v[88:91], a[28:31], a[40:43], v[88:91]
    buffer_store_dwordx4 a[12:15], v24, s[24:27], s77 offen offset:0 sc1
    s_waitcnt lgkmcnt(2)
    v_mfma_f32_16x16x32_bf16 v[88:91], a[36:39], a[60:63], v[88:91]
    s_add_u32 s77, s77, 4096
    ds_read_b128 a[128:131], v25 offset:19456
    v_mfma_f32_16x16x32_bf16 v[120:123], a[36:39], a[64:67], v[120:123]
    v_cvt_pk_bf16_f32 v28, v28, v29
    v_cvt_pk_bf16_f32 v29, v30, v31
    v_mfma_f32_16x16x32_bf16 v[120:123], a[28:31], a[44:47], v[120:123]
    v_cvt_pk_bf16_f32 v30, v32, v33
    v_cvt_pk_bf16_f32 v31, v34, v35
    v_mfma_f32_16x16x32_bf16 v[152:155], a[28:31], a[48:51], v[152:155]
    buffer_store_dwordx4 a[8:11], v24, s[24:27], s77 offen offset:0 sc1
    v_mfma_f32_16x16x32_bf16 v[152:155], a[36:39], a[68:71], v[152:155]
    s_add_u32 s77, s77, 4096
    v_accvgpr_read_b32 v36, a100
    v_mfma_f32_16x16x32_bf16 v[184:187], a[36:39], a[72:75], v[184:187]
    v_accvgpr_read_b32 v37, a101
    v_accvgpr_read_b32 v38, a102
    v_mfma_f32_16x16x32_bf16 v[184:187], a[28:31], a[52:55], v[184:187]
    v_accvgpr_read_b32 v39, a103
    v_accvgpr_read_b32 v40, a180
    v_mfma_f32_16x16x32_bf16 v[216:219], a[28:31], a[56:59], v[216:219]
    buffer_store_dwordx4 a[4:7], v24, s[24:27], s77 offen offset:0 sc1
    v_mfma_f32_16x16x32_bf16 v[216:219], a[36:39], a[76:79], v[216:219]
    s_add_u32 s77, s77, 4096
    v_accvgpr_read_b32 v41, a181
    v_mfma_f32_16x16x32_bf16 v[188:191], v[76:79], a[52:55], v[188:191]
    v_accvgpr_read_b32 v42, a182
    v_accvgpr_read_b32 v43, a183
    v_mfma_f32_16x16x32_bf16 v[188:191], v[80:83], a[72:75], v[188:191]
    ds_write2st64_b64 v27, v[28:29], v[30:31] offset0:32 offset1:33
    v_pk_mul_f32 v[36:37], v[36:37], s[46:47]
    v_pk_mul_f32 v[38:39], v[38:39], s[46:47]
    v_pk_mul_f32 v[40:41], v[40:41], s[46:47]
    v_pk_mul_f32 v[42:43], v[42:43], s[46:47]
    v_mfma_f32_16x16x32_bf16 v[156:159], v[80:83], a[68:71], v[156:159]
    buffer_store_dwordx4 a[0:3], v24, s[24:27], s77 offen offset:0 sc1
    v_mfma_f32_16x16x32_bf16 v[156:159], v[76:79], a[48:51], v[156:159]
    ds_read_b128 a[84:87], v25 offset:16384
    v_cvt_pk_bf16_f32 v36, v36, v37
    v_mfma_f32_16x16x32_bf16 v[124:127], v[76:79], a[44:47], v[124:127]
    v_cvt_pk_bf16_f32 v37, v38, v39
    v_cvt_pk_bf16_f32 v38, v40, v41
    v_mfma_f32_16x16x32_bf16 v[124:127], v[80:83], a[64:67], v[124:127]
    v_cvt_pk_bf16_f32 v39, v42, v43
    v_accvgpr_read_b32 v44, a116
    v_mfma_f32_16x16x32_bf16 v[92:95], v[80:83], a[60:63], v[92:95]
    v_accvgpr_read_b32 v45, a117
    v_accvgpr_read_b32 v46, a118
    v_mfma_f32_16x16x32_bf16 v[92:95], v[76:79], a[40:43], v[92:95]
    s_waitcnt vmcnt(13) lgkmcnt(0)
    s_barrier
    v_add_u32 v68, 16384, v68
    v_add_u32 v69, 16384, v69
    v_add_u32 v70, 16384, v70
    v_add_u32 v71, 16384, v71
    ds_read_b64_tr_b16 a[20:21], v68 offset:49152
    ds_read_b64_tr_b16 a[22:23], v68 offset:51200
    v_mfma_f32_16x16x32_bf16 v[96:99], v[232:235], a[40:43], v[96:99]
    ds_read_b64_tr_b16 a[24:25], v68 offset:53248
    ds_read_b64_tr_b16 a[26:27], v68 offset:55296
    v_mfma_f32_16x16x32_bf16 v[96:99], v[236:239], a[60:63], v[96:99]
    ds_read_b64_tr_b16 a[28:29], v69 offset:49152
    v_accvgpr_read_b32 v47, a119
    v_mfma_f32_16x16x32_bf16 v[128:131], v[236:239], a[64:67], v[128:131]
    ds_read_b64_tr_b16 a[30:31], v69 offset:51200
    v_accvgpr_read_b32 v48, a196
    v_mfma_f32_16x16x32_bf16 v[128:131], v[232:235], a[44:47], v[128:131]
    ds_read_b64_tr_b16 a[36:37], v69 offset:53248
    v_accvgpr_read_b32 v49, a197
    v_mfma_f32_16x16x32_bf16 v[160:163], v[232:235], a[48:51], v[160:163]
    ds_read_b64_tr_b16 a[38:39], v69 offset:55296
    v_accvgpr_read_b32 v50, a198
    v_mfma_f32_16x16x32_bf16 v[160:163], v[236:239], a[68:71], v[160:163]
    ds_read_b64_tr_b16 v[76:77], v70 offset:49152
    v_accvgpr_read_b32 v51, a199
    v_mfma_f32_16x16x32_bf16 v[192:195], v[236:239], a[72:75], v[192:195]
    ds_write2st64_b64 v27, v[36:37], v[38:39] offset0:34 offset1:35
    v_pk_mul_f32 v[44:45], v[44:45], s[46:47]
    v_pk_mul_f32 v[46:47], v[46:47], s[46:47]
    v_pk_mul_f32 v[48:49], v[48:49], s[46:47]
    v_pk_mul_f32 v[50:51], v[50:51], s[46:47]
    v_mfma_f32_16x16x32_bf16 v[192:195], v[232:235], a[52:55], v[192:195]
    s_waitcnt lgkmcnt(2)
    ds_read_b64_tr_b16 v[78:79], v70 offset:51200
    v_cvt_pk_bf16_f32 v44, v44, v45
    v_mfma_f32_16x16x32_bf16 v[220:223], a[20:23], a[56:59], v[220:223]
    ds_read_b64_tr_b16 v[80:81], v70 offset:53248
    v_cvt_pk_bf16_f32 v45, v46, v47
    v_mfma_f32_16x16x32_bf16 v[220:223], a[24:27], a[76:79], v[220:223]
    ds_read_b64_tr_b16 v[82:83], v70 offset:55296
    v_cvt_pk_bf16_f32 v46, v48, v49
    v_mfma_f32_16x16x32_bf16 v[196:199], a[24:27], a[72:75], v[196:199]
    ds_read_b64_tr_b16 v[232:233], v71 offset:49152
    v_cvt_pk_bf16_f32 v47, v50, v51
    v_mfma_f32_16x16x32_bf16 v[196:199], a[20:23], a[52:55], v[196:199]
    ds_read_b64_tr_b16 v[234:235], v71 offset:51200
    v_accvgpr_read_b32 v52, a132
    v_mfma_f32_16x16x32_bf16 v[164:167], a[20:23], a[48:51], v[164:167]
    ds_read_b64_tr_b16 v[236:237], v71 offset:53248
    v_accvgpr_read_b32 v53, a133
    v_mfma_f32_16x16x32_bf16 v[164:167], a[24:27], a[68:71], v[164:167]
    ds_read_b64_tr_b16 v[238:239], v71 offset:55296
    v_accvgpr_read_b32 v54, a134
    v_mfma_f32_16x16x32_bf16 v[132:135], a[24:27], a[64:67], v[132:135]
    ds_read_b128 a[100:103], v25 offset:17408
    v_accvgpr_read_b32 v55, a135
    v_mfma_f32_16x16x32_bf16 v[132:135], a[20:23], a[44:47], v[132:135]
    v_accvgpr_read_b32 v56, a212
    v_accvgpr_read_b32 v57, a213
    v_mfma_f32_16x16x32_bf16 v[100:103], a[20:23], a[40:43], v[100:103]
    v_accvgpr_read_b32 v58, a214
    v_accvgpr_read_b32 v59, a215
    v_mfma_f32_16x16x32_bf16 v[100:103], a[24:27], a[60:63], v[100:103]
    ds_write2st64_b64 v27, v[44:45], v[46:47] offset0:36 offset1:37
    v_pk_mul_f32 v[52:53], v[52:53], s[46:47]
    v_pk_mul_f32 v[54:55], v[54:55], s[46:47]
    v_pk_mul_f32 v[56:57], v[56:57], s[46:47]
    v_pk_mul_f32 v[58:59], v[58:59], s[46:47]
    v_mfma_f32_16x16x32_bf16 v[104:107], a[28:31], a[40:43], v[104:107]
    ds_read_b128 a[116:119], v25 offset:18432
    v_cvt_pk_bf16_f32 v52, v52, v53
    v_mfma_f32_16x16x32_bf16 v[104:107], a[36:39], a[60:63], v[104:107]
    v_cvt_pk_bf16_f32 v53, v54, v55
    v_cvt_pk_bf16_f32 v54, v56, v57
    v_mfma_f32_16x16x32_bf16 v[136:139], a[36:39], a[64:67], v[136:139]
    v_cvt_pk_bf16_f32 v55, v58, v59
    v_accvgpr_read_b32 v28, a88
    v_mfma_f32_16x16x32_bf16 v[136:139], a[28:31], a[44:47], v[136:139]
    v_accvgpr_read_b32 v29, a89
    v_accvgpr_read_b32 v30, a90
    v_mfma_f32_16x16x32_bf16 v[168:171], a[28:31], a[48:51], v[168:171]
    v_accvgpr_read_b32 v31, a91
    v_accvgpr_read_b32 v32, a168
    v_mfma_f32_16x16x32_bf16 v[168:171], a[36:39], a[68:71], v[168:171]
    v_accvgpr_read_b32 v33, a169
    v_accvgpr_read_b32 v34, a170
    v_mfma_f32_16x16x32_bf16 v[200:203], a[36:39], a[72:75], v[200:203]
    v_accvgpr_read_b32 v35, a171
    v_accvgpr_read_b32 v36, a104
    v_mfma_f32_16x16x32_bf16 v[200:203], a[28:31], a[52:55], v[200:203]
    ds_write2st64_b64 v27, v[52:53], v[54:55] offset0:38 offset1:39
    v_pk_mul_f32 v[28:29], v[28:29], s[46:47]
    v_pk_mul_f32 v[30:31], v[30:31], s[46:47]
    v_pk_mul_f32 v[32:33], v[32:33], s[46:47]
    v_pk_mul_f32 v[34:35], v[34:35], s[46:47]
    v_mfma_f32_16x16x32_bf16 v[224:227], a[28:31], a[56:59], v[224:227]
    ds_read_b128 a[132:135], v25 offset:19456
    v_cvt_pk_bf16_f32 v28, v28, v29
    v_mfma_f32_16x16x32_bf16 v[224:227], a[36:39], a[76:79], v[224:227]
    s_waitcnt lgkmcnt(2)
    v_cvt_pk_bf16_f32 v29, v30, v31
    v_cvt_pk_bf16_f32 v30, v32, v33
    v_mfma_f32_16x16x32_bf16 v[204:207], v[76:79], a[52:55], v[204:207]
    v_cvt_pk_bf16_f32 v31, v34, v35
    v_accvgpr_read_b32 v37, a105
    v_mfma_f32_16x16x32_bf16 v[204:207], v[80:83], a[72:75], v[204:207]
    v_accvgpr_read_b32 v38, a106
    v_accvgpr_read_b32 v39, a107
    v_mfma_f32_16x16x32_bf16 v[172:175], v[80:83], a[68:71], v[172:175]
    v_accvgpr_read_b32 v40, a184
    v_accvgpr_read_b32 v41, a185
    v_mfma_f32_16x16x32_bf16 v[172:175], v[76:79], a[48:51], v[172:175]
    v_accvgpr_read_b32 v42, a186
    v_accvgpr_read_b32 v43, a187
    v_mfma_f32_16x16x32_bf16 v[140:143], v[76:79], a[44:47], v[140:143]
    ds_write2st64_b64 v27, v[28:29], v[30:31] offset0:32 offset1:33
    v_pk_mul_f32 v[36:37], v[36:37], s[46:47]
    v_pk_mul_f32 v[38:39], v[38:39], s[46:47]
    v_pk_mul_f32 v[40:41], v[40:41], s[46:47]
    v_pk_mul_f32 v[42:43], v[42:43], s[46:47]
    v_mfma_f32_16x16x32_bf16 v[140:143], v[80:83], a[64:67], v[140:143]
    ds_read_b128 a[88:91], v25 offset:16384
    v_cvt_pk_bf16_f32 v36, v36, v37
    v_mfma_f32_16x16x32_bf16 v[108:111], v[80:83], a[60:63], v[108:111]
    v_cvt_pk_bf16_f32 v37, v38, v39
    v_cvt_pk_bf16_f32 v38, v40, v41
    v_mfma_f32_16x16x32_bf16 v[108:111], v[76:79], a[40:43], v[108:111]
    s_waitcnt lgkmcnt(0)
    s_barrier
    buffer_load_dwordx2 v[252:253], off, s[36:39], 0 sc1
    v_mfma_f32_16x16x32_bf16 v[112:115], v[232:235], a[40:43], v[112:115]
    v_cvt_pk_bf16_f32 v39, v42, v43
    v_mfma_f32_16x16x32_bf16 v[112:115], v[236:239], a[60:63], v[112:115]
    ds_write2st64_b64 v27, v[36:37], v[38:39] offset0:34 offset1:35
    v_pk_mul_f32 v[84:85], v[84:85], s[46:47]
    v_pk_mul_f32 v[86:87], v[86:87], s[46:47]
    v_pk_mul_f32 v[88:89], v[88:89], s[46:47]
    v_pk_mul_f32 v[90:91], v[90:91], s[46:47]
    v_mfma_f32_16x16x32_bf16 v[144:147], v[236:239], a[64:67], v[144:147]
    ds_read_b128 a[104:107], v25 offset:17408
    v_cvt_pk_bf16_f32 v84, v84, v85
    v_mfma_f32_16x16x32_bf16 v[144:147], v[232:235], a[44:47], v[144:147]
    v_cvt_pk_bf16_f32 v85, v86, v87
    v_cvt_pk_bf16_f32 v86, v88, v89
    v_mfma_f32_16x16x32_bf16 v[176:179], v[232:235], a[48:51], v[176:179]
    v_cvt_pk_bf16_f32 v87, v90, v91
    v_mfma_f32_16x16x32_bf16 v[176:179], v[236:239], a[68:71], v[176:179]
    ds_write2st64_b64 v27, v[84:85], v[86:87] offset0:36 offset1:37
    v_pk_mul_f32 v[116:117], v[116:117], s[46:47]
    v_pk_mul_f32 v[118:119], v[118:119], s[46:47]
    v_pk_mul_f32 v[120:121], v[120:121], s[46:47]
    v_pk_mul_f32 v[122:123], v[122:123], s[46:47]
    v_mfma_f32_16x16x32_bf16 v[208:211], v[236:239], a[72:75], v[208:211]
    ds_read_b128 a[0:3], v25 offset:18432
    v_cvt_pk_bf16_f32 v116, v116, v117
    v_cvt_pk_bf16_f32 v117, v118, v119
    v_cvt_pk_bf16_f32 v118, v120, v121
    v_cvt_pk_bf16_f32 v119, v122, v123
    ds_write2st64_b64 v27, v[116:117], v[118:119] offset0:38 offset1:39
    v_pk_mul_f32 v[148:149], v[148:149], s[46:47]
    v_pk_mul_f32 v[150:151], v[150:151], s[46:47]
    v_pk_mul_f32 v[152:153], v[152:153], s[46:47]
    v_pk_mul_f32 v[154:155], v[154:155], s[46:47]
    v_cvt_pk_bf16_f32 v148, v148, v149
    v_cvt_pk_bf16_f32 v149, v150, v151
    v_cvt_pk_bf16_f32 v150, v152, v153
    v_cvt_pk_bf16_f32 v151, v154, v155
    ds_write2st64_b64 v27, v[148:149], v[150:151] offset0:32 offset1:33
    ds_read_b128 a[16:19], v25 offset:19456
    ds_read_b128 a[32:35], v25 offset:16384
    v_mfma_f32_16x16x32_bf16 v[208:211], v[232:235], a[52:55], v[208:211]
    v_pk_mul_f32 v[212:213], v[212:213], s[46:47]
    s_add_u32 m0, s90, 16384
    s_add_u32 s53, s56, 24576
    s_and_b32 s53, s53, 0x1ffff
    s_add_u32 s53, s53, s91
    buffer_load_dwordx4 v5, s[12:15], s53 offen offset:0 nt lds
    v_pk_mul_f32 v[214:215], v[214:215], s[46:47]
    v_pk_mul_f32 v[216:217], v[216:217], s[46:47]
    v_pk_mul_f32 v[218:219], v[218:219], s[46:47]
    v_cvt_pk_bf16_f32 v28, v212, v213
    v_cvt_pk_bf16_f32 v29, v214, v215
    v_cvt_pk_bf16_f32 v30, v216, v217
    v_cvt_pk_bf16_f32 v31, v218, v219
    ds_write2st64_b64 v27, v[28:29], v[30:31] offset0:0 offset1:1
    v_pk_mul_f32 v[220:221], v[220:221], s[46:47]
    v_pk_mul_f32 v[222:223], v[222:223], s[46:47]
    v_pk_mul_f32 v[224:225], v[224:225], s[46:47]
    v_pk_mul_f32 v[226:227], v[226:227], s[46:47]
    v_cvt_pk_bf16_f32 v32, v220, v221
    v_cvt_pk_bf16_f32 v33, v222, v223
    v_cvt_pk_bf16_f32 v34, v224, v225
    v_cvt_pk_bf16_f32 v35, v226, v227
    ds_write2st64_b64 v27, v[32:33], v[34:35] offset0:2 offset1:3
    v_accvgpr_read_b32 v228, a144
    v_accvgpr_read_b32 v229, a145
    v_accvgpr_read_b32 v230, a146
    v_accvgpr_read_b32 v231, a147
    v_accvgpr_read_b32 v232, a148
    v_accvgpr_read_b32 v233, a149
    v_accvgpr_read_b32 v234, a150
    v_accvgpr_read_b32 v235, a151
    v_pk_mul_f32 v[228:229], v[228:229], s[46:47]
    v_pk_mul_f32 v[230:231], v[230:231], s[46:47]
    v_pk_mul_f32 v[232:233], v[232:233], s[46:47]
    v_pk_mul_f32 v[234:235], v[234:235], s[46:47]
    v_cvt_pk_bf16_f32 v36, v228, v229
    v_cvt_pk_bf16_f32 v37, v230, v231
    v_cvt_pk_bf16_f32 v38, v232, v233
    v_cvt_pk_bf16_f32 v39, v234, v235
    ds_write2st64_b64 v27, v[36:37], v[38:39] offset0:4 offset1:5
    v_accvgpr_read_b32 v236, a152
    v_accvgpr_read_b32 v237, a153
    v_accvgpr_read_b32 v238, a154
    v_accvgpr_read_b32 v239, a155
    v_accvgpr_read_b32 v240, a156
    v_accvgpr_read_b32 v241, a157
    v_accvgpr_read_b32 v242, a158
    v_accvgpr_read_b32 v243, a159
    v_pk_mul_f32 v[236:237], v[236:237], s[46:47]
    v_pk_mul_f32 v[238:239], v[238:239], s[46:47]
    v_pk_mul_f32 v[240:241], v[240:241], s[46:47]
    buffer_load_dwordx4 v6, s[12:15], s53 offen offset:1024 nt lds
    v_pk_mul_f32 v[242:243], v[242:243], s[46:47]
    v_cvt_pk_bf16_f32 v40, v236, v237
    v_cvt_pk_bf16_f32 v41, v238, v239
    v_cvt_pk_bf16_f32 v42, v240, v241
    v_cvt_pk_bf16_f32 v43, v242, v243
    ds_write2st64_b64 v27, v[40:41], v[42:43] offset0:6 offset1:7
    v_accvgpr_read_b32 v228, a92
    v_accvgpr_read_b32 v229, a93
    v_accvgpr_read_b32 v230, a94
    v_accvgpr_read_b32 v231, a95
    v_accvgpr_read_b32 v232, a172
    v_accvgpr_read_b32 v233, a173
    v_accvgpr_read_b32 v234, a174
    v_accvgpr_read_b32 v235, a175
    v_pk_mul_f32 v[228:229], v[228:229], s[46:47]
    v_pk_mul_f32 v[230:231], v[230:231], s[46:47]
    v_pk_mul_f32 v[232:233], v[232:233], s[46:47]
    v_pk_mul_f32 v[234:235], v[234:235], s[46:47]
    v_cvt_pk_bf16_f32 v44, v228, v229
    v_cvt_pk_bf16_f32 v45, v230, v231
    v_cvt_pk_bf16_f32 v46, v232, v233
    v_cvt_pk_bf16_f32 v47, v234, v235
    ds_write2st64_b64 v27, v[44:45], v[46:47] offset0:32 offset1:33
    v_accvgpr_read_b32 v236, a108
    v_accvgpr_read_b32 v237, a109
    v_accvgpr_read_b32 v238, a110
    v_accvgpr_read_b32 v239, a111
    v_accvgpr_read_b32 v240, a188
    v_accvgpr_read_b32 v241, a189
    v_accvgpr_read_b32 v242, a190
    v_accvgpr_read_b32 v243, a191
    v_pk_mul_f32 v[236:237], v[236:237], s[46:47]
    v_pk_mul_f32 v[238:239], v[238:239], s[46:47]
    v_pk_mul_f32 v[240:241], v[240:241], s[46:47]
    v_pk_mul_f32 v[242:243], v[242:243], s[46:47]
    v_cvt_pk_bf16_f32 v48, v236, v237
    v_cvt_pk_bf16_f32 v49, v238, v239
    v_cvt_pk_bf16_f32 v50, v240, v241
    v_cvt_pk_bf16_f32 v51, v242, v243
    v_accvgpr_read_b32 v228, a120
    v_accvgpr_read_b32 v229, a121
    v_accvgpr_read_b32 v230, a122
    v_accvgpr_read_b32 v231, a123
    buffer_load_dwordx4 v7, s[12:15], s53 offen offset:2048 nt lds
    v_accvgpr_read_b32 v232, a200
    v_accvgpr_read_b32 v233, a201
    v_accvgpr_read_b32 v234, a202
    v_accvgpr_read_b32 v235, a203
    v_pk_mul_f32 v[228:229], v[228:229], s[46:47]
    v_pk_mul_f32 v[230:231], v[230:231], s[46:47]
    v_pk_mul_f32 v[232:233], v[232:233], s[46:47]
    v_pk_mul_f32 v[234:235], v[234:235], s[46:47]
    v_cvt_pk_bf16_f32 v52, v228, v229
    v_cvt_pk_bf16_f32 v53, v230, v231
    v_cvt_pk_bf16_f32 v54, v232, v233
    v_cvt_pk_bf16_f32 v55, v234, v235
    ds_write2st64_b64 v27, v[52:53], v[54:55] offset0:36 offset1:37
    v_accvgpr_read_b32 v236, a124
    v_accvgpr_read_b32 v237, a125
    v_accvgpr_read_b32 v238, a126
    v_accvgpr_read_b32 v239, a127
    v_accvgpr_read_b32 v240, a204
    v_accvgpr_read_b32 v241, a205
    v_accvgpr_read_b32 v242, a206
    v_accvgpr_read_b32 v243, a207
    v_pk_mul_f32 v[236:237], v[236:237], s[46:47]
    v_pk_mul_f32 v[238:239], v[238:239], s[46:47]
    v_pk_mul_f32 v[240:241], v[240:241], s[46:47]
    v_pk_mul_f32 v[242:243], v[242:243], s[46:47]
    v_cvt_pk_bf16_f32 v56, v236, v237
    v_cvt_pk_bf16_f32 v57, v238, v239
    v_cvt_pk_bf16_f32 v58, v240, v241
    v_cvt_pk_bf16_f32 v59, v242, v243
    v_permlane32_swap_b32 v48, v50
    v_permlane32_swap_b32 v49, v51
    v_permlane32_swap_b32 v56, v58
    v_permlane32_swap_b32 v57, v59
    v_permlane16_swap_b32 v48, v50
    v_permlane16_swap_b32 v49, v51
    v_permlane16_swap_b32 v56, v58
    v_permlane16_swap_b32 v57, v59
    ds_read_b128 a[92:95], v25 offset:16384
    ds_read_b128 a[120:123], v25 offset:18432
    v_accvgpr_write_b32 a108, v48
    v_accvgpr_write_b32 a109, v49
    v_accvgpr_write_b32 a110, v50
    v_accvgpr_write_b32 a111, v51
    v_accvgpr_write_b32 a124, v56
    buffer_load_dwordx4 v8, s[12:15], s53 offen offset:3072 nt lds
    v_accvgpr_write_b32 a125, v57
    v_accvgpr_write_b32 a126, v58
    v_accvgpr_write_b32 a127, v59
    v_accvgpr_read_b32 v228, a136
    v_accvgpr_read_b32 v229, a137
    v_accvgpr_read_b32 v230, a138
    v_accvgpr_read_b32 v231, a139
    v_accvgpr_read_b32 v232, a216
    v_accvgpr_read_b32 v233, a217
    v_accvgpr_read_b32 v234, a218
    v_accvgpr_read_b32 v235, a219
    v_pk_mul_f32 v[228:229], v[228:229], s[46:47]
    v_pk_mul_f32 v[230:231], v[230:231], s[46:47]
    v_pk_mul_f32 v[232:233], v[232:233], s[46:47]
    v_pk_mul_f32 v[234:235], v[234:235], s[46:47]
    v_cvt_pk_bf16_f32 v60, v228, v229
    v_cvt_pk_bf16_f32 v61, v230, v231
    v_cvt_pk_bf16_f32 v62, v232, v233
    v_cvt_pk_bf16_f32 v63, v234, v235
    ds_write2st64_b64 v27, v[60:61], v[62:63] offset0:32 offset1:33
    v_accvgpr_read_b32 v236, a140
    v_accvgpr_read_b32 v237, a141
    v_accvgpr_read_b32 v238, a142
    v_accvgpr_read_b32 v239, a143
    v_accvgpr_read_b32 v240, a220
    v_accvgpr_read_b32 v241, a221
    v_accvgpr_read_b32 v242, a222
    v_accvgpr_read_b32 v243, a223
    v_pk_mul_f32 v[236:237], v[236:237], s[46:47]
    v_pk_mul_f32 v[238:239], v[238:239], s[46:47]
    v_pk_mul_f32 v[240:241], v[240:241], s[46:47]
    v_pk_mul_f32 v[242:243], v[242:243], s[46:47]
    v_cvt_pk_bf16_f32 v64, v236, v237
    v_cvt_pk_bf16_f32 v65, v238, v239
    v_cvt_pk_bf16_f32 v66, v240, v241
    v_cvt_pk_bf16_f32 v67, v242, v243
    v_pk_mul_f32 v[92:93], v[92:93], s[46:47]
    v_pk_mul_f32 v[94:95], v[94:95], s[46:47]
    v_pk_mul_f32 v[96:97], v[96:97], s[46:47]
    v_pk_mul_f32 v[98:99], v[98:99], s[46:47]
    v_cvt_pk_bf16_f32 v68, v92, v93
    s_add_u32 m0, s90, 32768
    s_add_u32 s53, s56, 16384
    s_and_b32 s53, s53, 0x1ffff
    s_add_u32 s53, s53, s91
    buffer_load_dwordx4 v5, s[16:19], s53 offen offset:0 nt lds
    v_cvt_pk_bf16_f32 v69, v94, v95
    v_cvt_pk_bf16_f32 v70, v96, v97
    v_cvt_pk_bf16_f32 v71, v98, v99
    ds_write2st64_b64 v27, v[68:69], v[70:71] offset0:36 offset1:37
    v_pk_mul_f32 v[100:101], v[100:101], s[46:47]
    v_pk_mul_f32 v[102:103], v[102:103], s[46:47]
    v_pk_mul_f32 v[104:105], v[104:105], s[46:47]
    v_pk_mul_f32 v[106:107], v[106:107], s[46:47]
    v_cvt_pk_bf16_f32 v72, v100, v101
    v_cvt_pk_bf16_f32 v73, v102, v103
    v_cvt_pk_bf16_f32 v74, v104, v105
    v_cvt_pk_bf16_f32 v75, v106, v107
    v_permlane32_swap_b32 v64, v66
    v_permlane32_swap_b32 v65, v67
    v_permlane32_swap_b32 v72, v74
    v_permlane32_swap_b32 v73, v75
    v_permlane16_swap_b32 v64, v66
    v_permlane16_swap_b32 v65, v67
    v_permlane16_swap_b32 v72, v74
    v_permlane16_swap_b32 v73, v75
    ds_read_b128 a[136:139], v25 offset:16384
    ds_read_b128 a[4:7], v25 offset:18432
    v_accvgpr_write_b32 a140, v64
    v_accvgpr_write_b32 a141, v65
    v_accvgpr_write_b32 a142, v66
    v_accvgpr_write_b32 a143, v67
    v_accvgpr_write_b32 a8, v72
    v_accvgpr_write_b32 a9, v73
    v_accvgpr_write_b32 a10, v74
    v_accvgpr_write_b32 a11, v75
    s_waitcnt lgkmcnt(4)
    s_barrier
    ds_read_b128 a[64:67], v25 offset:0
    ds_read_b128 a[72:75], v25 offset:1024
    ds_read_b128 a[68:71], v26 offset:0
    ds_read_b128 a[76:79], v26 offset:1024
    ds_read_b128 a[144:147], v25 offset:2048
    ds_read_b128 a[152:155], v25 offset:3072
    ds_read_b128 a[148:151], v26 offset:2048
    ds_read_b128 a[156:159], v26 offset:3072
    v_pk_mul_f32 v[108:109], v[108:109], s[46:47]
    v_pk_mul_f32 v[110:111], v[110:111], s[46:47]
    v_pk_mul_f32 v[112:113], v[112:113], s[46:47]
    v_pk_mul_f32 v[114:115], v[114:115], s[46:47]
    v_cvt_pk_bf16_f32 v44, v108, v109
    v_cvt_pk_bf16_f32 v45, v110, v111
    v_cvt_pk_bf16_f32 v46, v112, v113
    v_cvt_pk_bf16_f32 v47, v114, v115
    ds_write2st64_b64 v27, v[44:45], v[46:47] offset0:32 offset1:33
    v_pk_mul_f32 v[124:125], v[124:125], s[46:47]
    v_pk_mul_f32 v[126:127], v[126:127], s[46:47]
    v_pk_mul_f32 v[128:129], v[128:129], s[46:47]
    v_pk_mul_f32 v[130:131], v[130:131], s[46:47]
    v_cvt_pk_bf16_f32 v48, v124, v125
    v_cvt_pk_bf16_f32 v49, v126, v127
    v_cvt_pk_bf16_f32 v50, v128, v129
    v_cvt_pk_bf16_f32 v51, v130, v131
    buffer_load_dwordx4 v6, s[16:19], s53 offen offset:1024 nt lds
    v_pk_mul_f32 v[132:133], v[132:133], s[46:47]
    v_pk_mul_f32 v[134:135], v[134:135], s[46:47]
    v_pk_mul_f32 v[136:137], v[136:137], s[46:47]
    v_pk_mul_f32 v[138:139], v[138:139], s[46:47]
    v_cvt_pk_bf16_f32 v52, v132, v133
    v_cvt_pk_bf16_f32 v53, v134, v135
    v_cvt_pk_bf16_f32 v54, v136, v137
    v_cvt_pk_bf16_f32 v55, v138, v139
    ds_write2st64_b64 v27, v[52:53], v[54:55] offset0:36 offset1:37
    v_pk_mul_f32 v[140:141], v[140:141], s[46:47]
    v_pk_mul_f32 v[142:143], v[142:143], s[46:47]
    v_pk_mul_f32 v[144:145], v[144:145], s[46:47]
    v_pk_mul_f32 v[146:147], v[146:147], s[46:47]
    v_cvt_pk_bf16_f32 v56, v140, v141
    v_cvt_pk_bf16_f32 v57, v142, v143
    v_cvt_pk_bf16_f32 v58, v144, v145
    v_cvt_pk_bf16_f32 v59, v146, v147
    v_permlane32_swap_b32 v48, v50
    v_permlane32_swap_b32 v49, v51
    v_permlane32_swap_b32 v56, v58
    v_permlane32_swap_b32 v57, v59
    v_permlane16_swap_b32 v48, v50
    v_permlane16_swap_b32 v49, v51
    v_permlane16_swap_b32 v56, v58
    v_permlane16_swap_b32 v57, v59
    ds_read_b128 a[12:15], v25 offset:16384
    ds_read_b128 a[24:27], v25 offset:18432
    v_accvgpr_write_b32 a20, v48
    v_accvgpr_write_b32 a21, v49
    v_accvgpr_write_b32 a22, v50
    v_accvgpr_write_b32 a23, v51
    v_accvgpr_write_b32 a28, v56
    v_accvgpr_write_b32 a29, v57
    v_accvgpr_write_b32 a30, v58
    v_accvgpr_write_b32 a31, v59
    v_pk_mul_f32 v[156:157], v[156:157], s[46:47]
    v_pk_mul_f32 v[158:159], v[158:159], s[46:47]
    v_pk_mul_f32 v[160:161], v[160:161], s[46:47]
    v_pk_mul_f32 v[162:163], v[162:163], s[46:47]
    v_cvt_pk_bf16_f32 v60, v156, v157
    v_cvt_pk_bf16_f32 v61, v158, v159
    v_cvt_pk_bf16_f32 v62, v160, v161
    v_cvt_pk_bf16_f32 v63, v162, v163
    ds_write2st64_b64 v27, v[60:61], v[62:63] offset0:32 offset1:33
    v_pk_mul_f32 v[164:165], v[164:165], s[46:47]
    v_pk_mul_f32 v[166:167], v[166:167], s[46:47]
    buffer_load_dwordx4 v7, s[16:19], s53 offen offset:2048 nt lds
    v_pk_mul_f32 v[168:169], v[168:169], s[46:47]
    v_pk_mul_f32 v[170:171], v[170:171], s[46:47]
    v_cvt_pk_bf16_f32 v64, v164, v165
    v_cvt_pk_bf16_f32 v65, v166, v167
    v_cvt_pk_bf16_f32 v66, v168, v169
    v_cvt_pk_bf16_f32 v67, v170, v171
    v_pk_mul_f32 v[172:173], v[172:173], s[46:47]
    v_pk_mul_f32 v[174:175], v[174:175], s[46:47]
    v_pk_mul_f32 v[176:177], v[176:177], s[46:47]
    v_pk_mul_f32 v[178:179], v[178:179], s[46:47]
    v_cvt_pk_bf16_f32 v68, v172, v173
    v_cvt_pk_bf16_f32 v69, v174, v175
    v_cvt_pk_bf16_f32 v70, v176, v177
    v_cvt_pk_bf16_f32 v71, v178, v179
    ds_write2st64_b64 v27, v[68:69], v[70:71] offset0:36 offset1:37
    v_pk_mul_f32 v[180:181], v[180:181], s[46:47]
    v_pk_mul_f32 v[182:183], v[182:183], s[46:47]
    v_pk_mul_f32 v[184:185], v[184:185], s[46:47]
    v_pk_mul_f32 v[186:187], v[186:187], s[46:47]
    v_cvt_pk_bf16_f32 v72, v180, v181
    v_cvt_pk_bf16_f32 v73, v182, v183
    v_cvt_pk_bf16_f32 v74, v184, v185
    v_cvt_pk_bf16_f32 v75, v186, v187
    v_permlane32_swap_b32 v64, v66
    v_permlane32_swap_b32 v65, v67
    v_permlane32_swap_b32 v72, v74
    v_permlane32_swap_b32 v73, v75
    v_permlane16_swap_b32 v64, v66
    v_permlane16_swap_b32 v65, v67
    v_permlane16_swap_b32 v72, v74
    v_permlane16_swap_b32 v73, v75
    ds_read_b128 a[36:39], v25 offset:16384
    ds_read_b128 a[44:47], v25 offset:18432
    v_accvgpr_write_b32 a40, v64
    v_accvgpr_write_b32 a41, v65
    v_accvgpr_write_b32 a42, v66
    v_accvgpr_write_b32 a43, v67
    v_accvgpr_write_b32 a48, v72
    v_accvgpr_write_b32 a49, v73
    v_accvgpr_write_b32 a50, v74
    v_accvgpr_write_b32 a51, v75
    v_pk_mul_f32 v[188:189], v[188:189], s[46:47]
    v_pk_mul_f32 v[190:191], v[190:191], s[46:47]
    v_pk_mul_f32 v[192:193], v[192:193], s[46:47]
    buffer_load_dwordx4 v8, s[16:19], s53 offen offset:3072 nt lds
    v_pk_mul_f32 v[194:195], v[194:195], s[46:47]
    v_cvt_pk_bf16_f32 v44, v188, v189
    v_cvt_pk_bf16_f32 v45, v190, v191
    v_cvt_pk_bf16_f32 v46, v192, v193
    v_cvt_pk_bf16_f32 v47, v194, v195
    ds_write2st64_b64 v27, v[44:45], v[46:47] offset0:32 offset1:33
    v_pk_mul_f32 v[196:197], v[196:197], s[46:47]
    v_pk_mul_f32 v[198:199], v[198:199], s[46:47]
    v_pk_mul_f32 v[200:201], v[200:201], s[46:47]
    v_pk_mul_f32 v[202:203], v[202:203], s[46:47]
    v_cvt_pk_bf16_f32 v48, v196, v197
    v_cvt_pk_bf16_f32 v49, v198, v199
    v_cvt_pk_bf16_f32 v50, v200, v201
    v_cvt_pk_bf16_f32 v51, v202, v203
    v_pk_mul_f32 v[204:205], v[204:205], s[46:47]
    v_pk_mul_f32 v[206:207], v[206:207], s[46:47]
    v_pk_mul_f32 v[208:209], v[208:209], s[46:47]
    v_pk_mul_f32 v[210:211], v[210:211], s[46:47]
    v_cvt_pk_bf16_f32 v52, v204, v205
    v_cvt_pk_bf16_f32 v53, v206, v207
    v_cvt_pk_bf16_f32 v54, v208, v209
    v_cvt_pk_bf16_f32 v55, v210, v211
    ds_write2st64_b64 v27, v[52:53], v[54:55] offset0:36 offset1:37
    v_permlane32_swap_b32 v48, v50
    v_permlane32_swap_b32 v49, v51
    s_nop 0
    v_permlane16_swap_b32 v48, v50
    v_permlane16_swap_b32 v49, v51
    ds_read_b128 a[52:55], v25 offset:16384
    ds_read_b128 a[60:63], v25 offset:18432
    v_accvgpr_write_b32 a56, v48
    v_accvgpr_write_b32 a57, v49
    v_accvgpr_write_b32 a58, v50
    v_accvgpr_write_b32 a59, v51
    v_accvgpr_write_b32 a216, v244
    v_accvgpr_write_b32 a217, v245
    v_accvgpr_write_b32 a218, v246
    v_accvgpr_write_b32 a219, v247
    v_accvgpr_write_b32 a220, v248
    v_accvgpr_write_b32 a221, v249
    v_accvgpr_write_b32 a222, v250
    v_accvgpr_write_b32 a223, v251
    v_mov_b32 v244, 0x3f803f80
    v_accvgpr_write_b32 a180, v244
    v_accvgpr_write_b32 a181, v244
    v_accvgpr_write_b32 a182, v244
    v_accvgpr_write_b32 a183, v244
    s_waitcnt vmcnt(8)
    v_readfirstlane_b32 s48, v252
    v_readfirstlane_b32 s49, v253
    s_cmp_lt_i32 s49, 0
    s_cbranch_scc1 gqa_kernel_n1_x
    v_mov_b32 v246, 0
gqa_kernel_n1:
    buffer_load_dwordx2 v[244:245], v246, s[36:39], 0 offen sc1
    s_waitcnt vmcnt(0)
    v_readfirstlane_b32 s48, v244
    v_readfirstlane_b32 s49, v245
    s_sub_u32 s50, s50, 1
    s_cbranch_scc1 gqa_kernel_n1_x
    s_cmp_lt_i32 s49, 0
    s_cbranch_scc0 gqa_kernel_n1
gqa_kernel_n1_x:
    s_nop 1
    s_nop 0
    v_mov_b32 v244, s48
    v_mov_b32 v245, s49
    s_mov_b64 exec, 1
    buffer_store_dwordx2 v[244:245], v24, s[24:27], s61 offen offset:0 sc1
    s_mov_b64 exec, -1
    s_lshl_b32 s78, s95, 12
    s_lshl_b32 s41, s43, 9
    s_add_u32 s78, s78, s41
    s_add_u32 s78, s78, 52428800
    v_lshrrev_b32 v21, 1, v24
    v_mov_b32 v247, 0x30000
    v_mov_b32 v248, 0x30000
    v_mov_b32 v249, 0x30000
    v_mov_b32 v250, 0x30000
    v_mov_b32 v251, 0x30000
    v_add_u32 v9, s75, v24
    s_mul_i32 s40, s42, 20
    s_lshr_b32 s40, s40, 5
    s_add_u32 s40, s40, 0
    s_lshl_b32 s97, 1, s40
gqa_kernel_A:
    s_mov_b32 s58, s59
    s_mov_b32 s30, 0x8000000
    s_add_u32 s59, s59, 262144
    s_cmp_eq_u32 s51, 0
    s_cselect_b32 s89, s60, 0x30000
    s_cselect_b32 s90, s75, 0x30000
    s_cselect_b32 s91, s59, 0x40000000
    s_cselect_b32 s98, 0x40000000, s76
    s_cselect_b64 vcc, 0, -1
    s_cmp_eq_u32 s95, 1
    s_cbranch_scc1 gqa_kernel_A1
gqa_kernel_A0:
    s_waitcnt vmcnt(3) lgkmcnt(0)
    s_barrier
    ds_read_b128 a[184:187], v18 offset:0
    s_waitcnt lgkmcnt(0)
    v_mfma_f32_16x16x32_bf16 v[28:31], a[184:187], a[0:3], 0
    ds_read_b128 a[188:191], v18 offset:512
    ds_read_b128 a[192:195], v18 offset:4096
    s_waitcnt lgkmcnt(1)
    v_mfma_f32_16x16x32_bf16 v[28:31], a[188:191], a[4:7], v[28:31]
    s_waitcnt lgkmcnt(0)
    ds_read_b128 a[196:199], v18 offset:4608
    v_mfma_f32_16x16x32_bf16 v[28:31], a[192:195], a[8:11], v[28:31]
    s_waitcnt lgkmcnt(0)
    ds_read_b128 a[200:203], v18 offset:2048
    v_mfma_f32_16x16x32_bf16 v[28:31], a[196:199], a[12:15], v[28:31]
    ds_read_b128 a[204:207], v18 offset:2560
    v_mfma_f32_16x16x32_bf16 v[32:35], a[184:187], a[16:19], 0
    s_add_u32 s45, s98, 0
    ds_read_b128 a[208:211], v18 offset:6144
    v_mfma_f32_16x16x32_bf16 v[32:35], a[188:191], a[20:23], v[32:35]
    s_cbranch_vccz 2
    buffer_load_dwordx4 a[216:219], v24, s[24:27], s45 offen offset:0 sc1
    v_mfma_f32_16x16x32_bf16 v[32:35], a[192:195], a[24:27], v[32:35]
    ds_read_b128 a[212:215], v18 offset:6656
    v_mfma_f32_16x16x32_bf16 v[32:35], a[196:199], a[28:31], v[32:35]
    v_exp_f32 v28, v28
    v_mfma_f32_16x16x32_bf16 v[36:39], a[184:187], a[32:35], 0
    v_exp_f32 v29, v29
    v_mfma_f32_16x16x32_bf16 v[36:39], a[188:191], a[36:39], v[36:39]
    v_exp_f32 v30, v30
    v_mfma_f32_16x16x32_bf16 v[36:39], a[192:195], a[40:43], v[36:39]
    v_exp_f32 v31, v31
    v_mfma_f32_16x16x32_bf16 v[36:39], a[196:199], a[44:47], v[36:39]
    v_cvt_pk_bf16_f32 v28, v28, v29
    v_cvt_pk_bf16_f32 v29, v30, v31
    v_mfma_f32_16x16x32_bf16 v[40:43], a[184:187], a[48:51], 0
    v_exp_f32 v32, v32
    v_mfma_f32_16x16x32_bf16 v[40:43], a[188:191], a[52:55], v[40:43]
    s_cbranch_vccz 2
    buffer_load_dwordx4 a[220:223], v24, s[24:27], s45 offen offset:1024 sc1
    v_mfma_f32_16x16x32_bf16 v[40:43], a[192:195], a[56:59], v[40:43]
    v_exp_f32 v33, v33
    v_mfma_f32_16x16x32_bf16 v[40:43], a[196:199], a[60:63], v[40:43]
    v_exp_f32 v34, v34
    v_mfma_f32_16x16x32_bf16 v[76:79], a[184:187], a[64:67], 0
    v_exp_f32 v35, v35
    v_mfma_f32_16x16x32_bf16 v[76:79], a[188:191], a[68:71], v[76:79]
    v_cvt_pk_bf16_f32 v32, v32, v33
    v_cvt_pk_bf16_f32 v33, v34, v35
    v_mfma_f32_16x16x32_bf16 v[76:79], a[192:195], a[72:75], v[76:79]
    v_exp_f32 v36, v36
    v_mfma_f32_16x16x32_bf16 v[76:79], a[196:199], a[76:79], v[76:79]
    s_waitcnt lgkmcnt(0)
    v_exp_f32 v37, v37
    v_mfma_f32_16x16x32_bf16 v[60:63], a[200:203], a[0:3], 0
    v_exp_f32 v38, v38
    v_mfma_f32_16x16x32_bf16 v[60:63], a[204:207], a[4:7], v[60:63]
    v_exp_f32 v39, v39
    v_mfma_f32_16x16x32_bf16 v[60:63], a[208:211], a[8:11], v[60:63]
    s_add_u32 s45, s98, 40960
    v_cvt_pk_bf16_f32 v36, v36, v37
    s_cbranch_vccz 2
    buffer_load_dwordx4 a[224:227], v24, s[24:27], s45 offen offset:0 sc1
    v_mfma_f32_16x16x32_bf16 v[60:63], a[212:215], a[12:15], v[60:63]
    s_lshr_b32 s97, s97, 1
    s_cbranch_scc0 1
    s_waitcnt vmcnt(7)
    s_cbranch_vccnz 1
    s_waitcnt vmcnt(4)
    s_waitcnt vmcnt(8) lgkmcnt(0)
    s_barrier
    s_add_u32 m0, s60, 0
    s_add_u32 s53, s56, 24576
    v_mfma_f32_16x16x32_bf16 v[64:67], a[200:203], a[16:19], 0
    s_and_b32 s53, s53, 0x1ffff
    s_add_u32 s53, s53, s58
    v_mfma_f32_16x16x32_bf16 v[64:67], a[204:207], a[20:23], v[64:67]
    buffer_load_dwordx4 v5, s[16:19], s53 offen offset:0 nt lds
    v_mfma_f32_16x16x32_bf16 v[64:67], a[208:211], a[24:27], v[64:67]
    ds_read_b128 a[184:187], v18 offset:16384
    v_cvt_pk_bf16_f32 v37, v38, v39
    v_mfma_f32_16x16x32_bf16 v[64:67], a[212:215], a[28:31], v[64:67]
    ds_read_b128 a[188:191], v18 offset:16896
    v_mfma_f32_16x16x32_bf16 v[68:71], a[200:203], a[32:35], 0
    ds_read_b128 a[192:195], v18 offset:20480
    v_mfma_f32_16x16x32_bf16 v[68:71], a[204:207], a[36:39], v[68:71]
    ds_read_b128 a[196:199], v18 offset:20992
    v_mfma_f32_16x16x32_bf16 v[68:71], a[208:211], a[40:43], v[68:71]
    s_cbranch_vccz 2
    buffer_load_dwordx4 a[228:231], v24, s[24:27], s45 offen offset:1024 sc1
    v_mfma_f32_16x16x32_bf16 v[68:71], a[212:215], a[44:47], v[68:71]
    v_exp_f32 v40, v40
    v_mfma_f32_16x16x32_bf16 v[72:75], a[200:203], a[48:51], 0
    v_exp_f32 v41, v41
    v_mfma_f32_16x16x32_bf16 v[72:75], a[204:207], a[52:55], v[72:75]
    v_exp_f32 v42, v42
    v_mfma_f32_16x16x32_bf16 v[72:75], a[208:211], a[56:59], v[72:75]
    v_exp_f32 v43, v43
    v_mfma_f32_16x16x32_bf16 v[72:75], a[212:215], a[60:63], v[72:75]
    v_cvt_pk_bf16_f32 v40, v40, v41
    v_cvt_pk_bf16_f32 v41, v42, v43
    v_mfma_f32_16x16x32_bf16 v[80:83], a[200:203], a[64:67], 0
    ds_read_b128 a[200:203], v18 offset:18432
    v_mfma_f32_16x16x32_bf16 v[80:83], a[204:207], a[68:71], v[80:83]
    buffer_load_dwordx4 v6, s[16:19], s53 offen offset:1024 nt lds
    v_mfma_f32_16x16x32_bf16 v[80:83], a[208:211], a[72:75], v[80:83]
    s_add_u32 s45, s98, 81920
    ds_read_b128 a[204:207], v18 offset:18944
    v_mfma_f32_16x16x32_bf16 v[80:83], a[212:215], a[76:79], v[80:83]
    s_cbranch_vccz 2
    buffer_load_dwordx4 a[232:235], v24, s[24:27], s45 offen offset:0 sc1
    s_waitcnt lgkmcnt(2)
    v_mfma_f32_16x16x32_bf16 v[44:47], a[184:187], a[0:3], 0
    ds_read_b128 a[208:211], v18 offset:22528
    v_mfma_f32_16x16x32_bf16 v[44:47], a[188:191], a[4:7], v[44:47]
    ds_read_b128 a[212:215], v18 offset:23040
    v_mfma_f32_16x16x32_bf16 v[44:47], a[192:195], a[8:11], v[44:47]
    v_exp_f32 v76, v76
    v_mfma_f32_16x16x32_bf16 v[44:47], a[196:199], a[12:15], v[44:47]
    v_exp_f32 v77, v77
    v_mfma_f32_16x16x32_bf16 v[48:51], a[184:187], a[16:19], 0
    v_exp_f32 v78, v78
    v_mfma_f32_16x16x32_bf16 v[48:51], a[188:191], a[20:23], v[48:51]
    v_exp_f32 v79, v79
    v_mfma_f32_16x16x32_bf16 v[48:51], a[192:195], a[24:27], v[48:51]
    s_cbranch_vccz 2
    buffer_load_dwordx4 a[236:239], v24, s[24:27], s45 offen offset:1024 sc1
    v_mfma_f32_16x16x32_bf16 v[48:51], a[196:199], a[28:31], v[48:51]
    v_cvt_pk_bf16_f32 v76, v76, v77
    v_cvt_pk_bf16_f32 v77, v78, v79
    v_mfma_f32_16x16x32_bf16 v[52:55], a[184:187], a[32:35], 0
    v_exp_f32 v60, v60
    v_mfma_f32_16x16x32_bf16 v[52:55], a[188:191], a[36:39], v[52:55]
    v_exp_f32 v61, v61
    v_mfma_f32_16x16x32_bf16 v[52:55], a[192:195], a[40:43], v[52:55]
    v_exp_f32 v62, v62
    v_mfma_f32_16x16x32_bf16 v[52:55], a[196:199], a[44:47], v[52:55]
    buffer_load_dwordx4 v7, s[16:19], s53 offen offset:2048 nt lds
    v_mfma_f32_16x16x32_bf16 v[56:59], a[184:187], a[48:51], 0
    v_exp_f32 v63, v63
    v_mfma_f32_16x16x32_bf16 v[56:59], a[188:191], a[52:55], v[56:59]
    v_cvt_pk_bf16_f32 v30, v60, v61
    v_cvt_pk_bf16_f32 v31, v62, v63
    v_mfma_f32_16x16x32_bf16 v[56:59], a[192:195], a[56:59], v[56:59]
    v_exp_f32 v64, v64
    v_mfma_f32_16x16x32_bf16 v[56:59], a[196:199], a[60:63], v[56:59]
    s_waitcnt lgkmcnt(0)
    v_exp_f32 v65, v65
    v_mfma_f32_16x16x32_bf16 v[60:63], a[200:203], a[0:3], 0
    v_exp_f32 v66, v66
    v_mfma_f32_16x16x32_bf16 v[60:63], a[204:207], a[4:7], v[60:63]
    v_exp_f32 v67, v67
    v_cvt_pk_bf16_f32 v34, v64, v65
    v_cvt_pk_bf16_f32 v35, v66, v67
    v_mfma_f32_16x16x32_bf16 v[60:63], a[208:211], a[8:11], v[60:63]
    v_exp_f32 v68, v68
    v_mfma_f32_16x16x32_bf16 v[60:63], a[212:215], a[12:15], v[60:63]
    v_exp_f32 v69, v69
    v_mfma_f32_16x16x32_bf16 v[64:67], a[200:203], a[16:19], 0
    v_exp_f32 v70, v70
    v_mfma_f32_16x16x32_bf16 v[64:67], a[204:207], a[20:23], v[64:67]
    v_exp_f32 v71, v71
    v_cvt_pk_bf16_f32 v38, v68, v69
    v_cvt_pk_bf16_f32 v39, v70, v71
    v_mfma_f32_16x16x32_bf16 v[64:67], a[208:211], a[24:27], v[64:67]
    v_exp_f32 v72, v72
    v_mfma_f32_16x16x32_bf16 v[64:67], a[212:215], a[28:31], v[64:67]
    v_exp_f32 v73, v73
    v_mfma_f32_16x16x32_bf16 v[68:71], a[200:203], a[32:35], 0
    v_exp_f32 v74, v74
    v_mfma_f32_16x16x32_bf16 v[68:71], a[204:207], a[36:39], v[68:71]
    v_exp_f32 v75, v75
    v_cvt_pk_bf16_f32 v42, v72, v73
    v_cvt_pk_bf16_f32 v43, v74, v75
    v_mfma_f32_16x16x32_bf16 v[68:71], a[208:211], a[40:43], v[68:71]
    v_exp_f32 v80, v80
    v_mfma_f32_16x16x32_bf16 v[68:71], a[212:215], a[44:47], v[68:71]
    s_cbranch_vccnz 1
    s_waitcnt vmcnt(4)
    s_waitcnt vmcnt(7) lgkmcnt(0)
    s_barrier
    ds_read_b64_tr_b16 a[184:185], v19 offset:32768
    ds_read_b64_tr_b16 a[186:187], v19 offset:34816
    v_mfma_f32_16x16x32_bf16 v[72:75], a[200:203], a[48:51], 0
    buffer_load_dwordx4 v8, s[16:19], s53 offen offset:3072 nt lds
    v_mfma_f32_16x16x32_bf16 v[72:75], a[204:207], a[52:55], v[72:75]
    ds_read_b64_tr_b16 a[188:189], v20 offset:32768
    v_mfma_f32_16x16x32_bf16 v[72:75], a[208:211], a[56:59], v[72:75]
    ds_read_b64_tr_b16 a[190:191], v20 offset:34816
    v_mfma_f32_16x16x32_bf16 v[72:75], a[212:215], a[60:63], v[72:75]
    v_exp_f32 v81, v81
    v_mfma_f32_16x16x32_bf16 a[160:163], a[180:183], v[28:31], 0
    v_exp_f32 v82, v82
    v_mfma_f32_16x16x32_bf16 a[164:167], a[180:183], v[32:35], 0
    v_exp_f32 v83, v83
    v_cvt_pk_bf16_f32 v78, v80, v81
    v_cvt_pk_bf16_f32 v79, v82, v83
    v_mfma_f32_16x16x32_bf16 a[168:171], a[180:183], v[36:39], 0
    ds_read_b64_tr_b16 a[192:193], v19 offset:33280
    s_add_u32 s45, s98, 122880
    v_mfma_f32_16x16x32_bf16 a[172:175], a[180:183], v[40:43], 0
    ds_read_b64_tr_b16 a[194:195], v19 offset:35328
    v_mfma_f32_16x16x32_bf16 a[176:179], a[180:183], v[76:79], 0
    s_cbranch_vccz 2
    buffer_load_dwordx4 a[240:243], v24, s[24:27], s45 offen offset:0 sc1
    s_waitcnt lgkmcnt(2)
    v_mfma_f32_16x16x32_bf16 v[212:215], a[184:187], v[76:79], 0
    s_add_u32 m0, s60, 16384
    s_add_u32 s53, s56, 40960
    s_and_b32 s53, s53, 0x1ffff
    s_add_u32 s53, s53, s58
    v_mfma_f32_16x16x32_bf16 v[180:183], a[184:187], v[40:43], 0
    buffer_load_dwordx4 v5, s[12:15], s53 offen offset:0 nt lds
    v_mfma_f32_16x16x32_bf16 v[148:151], a[184:187], v[36:39], 0
    ds_read_b64_tr_b16 a[196:197], v20 offset:33280
    v_mfma_f32_16x16x32_bf16 v[116:119], a[184:187], v[32:35], 0
    ds_read_b64_tr_b16 a[198:199], v20 offset:35328
    v_mfma_f32_16x16x32_bf16 v[84:87], a[184:187], v[28:31], 0
    s_cbranch_vccz 2
    buffer_load_dwordx4 a[244:247], v24, s[24:27], s45 offen offset:1024 sc1
    v_mfma_f32_16x16x32_bf16 v[88:91], a[188:191], v[28:31], 0
    ds_read_b64_tr_b16 a[200:201], v19 offset:36864
    v_mfma_f32_16x16x32_bf16 v[120:123], a[188:191], v[32:35], 0
    ds_read_b64_tr_b16 a[202:203], v19 offset:38912
    v_mfma_f32_16x16x32_bf16 v[152:155], a[188:191], v[36:39], 0
    ds_read_b64_tr_b16 a[204:205], v20 offset:36864
    v_mfma_f32_16x16x32_bf16 v[184:187], a[188:191], v[40:43], 0
    ds_read_b64_tr_b16 a[206:207], v20 offset:38912
    v_mfma_f32_16x16x32_bf16 v[216:219], a[188:191], v[76:79], 0
    s_waitcnt lgkmcnt(5)
    ds_read_b64_tr_b16 a[208:209], v19 offset:37376
    v_mfma_f32_16x16x32_bf16 v[220:223], a[192:195], v[76:79], 0
    buffer_load_dwordx4 v6, s[12:15], s53 offen offset:1024 nt lds
    v_mfma_f32_16x16x32_bf16 v[188:191], a[192:195], v[40:43], 0
    ds_read_b64_tr_b16 a[210:211], v19 offset:39424
    v_mfma_f32_16x16x32_bf16 v[156:159], a[192:195], v[36:39], 0
    ds_read_b64_tr_b16 a[212:213], v20 offset:37376
    v_mfma_f32_16x16x32_bf16 v[124:127], a[192:195], v[32:35], 0
    s_add_u32 s45, s98, 163840
    ds_read_b64_tr_b16 a[214:215], v20 offset:39424
    v_mfma_f32_16x16x32_bf16 v[92:95], a[192:195], v[28:31], 0
    s_cbranch_vccz 2
    buffer_load_dwordx4 a[248:251], v24, s[24:27], s45 offen offset:0 sc1
    s_waitcnt lgkmcnt(4)
    v_mfma_f32_16x16x32_bf16 v[96:99], a[196:199], v[28:31], 0
    v_exp_f32 v44, v44
    v_mfma_f32_16x16x32_bf16 v[128:131], a[196:199], v[32:35], 0
    v_exp_f32 v45, v45
    v_mfma_f32_16x16x32_bf16 v[160:163], a[196:199], v[36:39], 0
    v_exp_f32 v46, v46
    v_mfma_f32_16x16x32_bf16 v[192:195], a[196:199], v[40:43], 0
    v_exp_f32 v47, v47
    v_mfma_f32_16x16x32_bf16 v[224:227], a[196:199], v[76:79], 0
    v_cvt_pk_bf16_f32 v44, v44, v45
    v_cvt_pk_bf16_f32 v45, v46, v47
    v_mfma_f32_16x16x32_bf16 v[228:231], a[200:203], v[76:79], 0
    v_exp_f32 v48, v48
    v_mfma_f32_16x16x32_bf16 v[196:199], a[200:203], v[40:43], 0
    v_exp_f32 v49, v49
    v_mfma_f32_16x16x32_bf16 v[164:167], a[200:203], v[36:39], 0
    s_lshr_b32 s97, s97, 1
    s_cbranch_scc0 1
    s_waitcnt vmcnt(7)
    s_cbranch_vccnz 1
    s_waitcnt vmcnt(4)
    s_waitcnt vmcnt(8) lgkmcnt(0)
    s_barrier
    v_mfma_f32_16x16x32_bf16 v[132:135], a[200:203], v[32:35], 0
    buffer_load_dwordx4 v7, s[12:15], s53 offen offset:2048 nt lds
    v_mfma_f32_16x16x32_bf16 v[100:103], a[200:203], v[28:31], 0
    ds_read_b128 a[184:187], v18 offset:49152
    v_mfma_f32_16x16x32_bf16 v[104:107], a[204:207], v[28:31], 0
    ds_read_b128 a[188:191], v18 offset:49664
    v_mfma_f32_16x16x32_bf16 v[136:139], a[204:207], v[32:35], 0
    ds_read_b128 a[192:195], v18 offset:53248
    v_mfma_f32_16x16x32_bf16 v[168:171], a[204:207], v[36:39], 0
    ds_read_b128 a[196:199], v18 offset:53760
    v_mfma_f32_16x16x32_bf16 v[200:203], a[204:207], v[40:43], 0
    s_cbranch_vccz 2
    buffer_load_dwordx4 a[252:255], v24, s[24:27], s45 offen offset:1024 sc1
    v_mfma_f32_16x16x32_bf16 v[232:235], a[204:207], v[76:79], 0
    ds_read_b128 a[200:203], v18 offset:51200
    v_mfma_f32_16x16x32_bf16 v[236:239], a[208:211], v[76:79], 0
    ds_read_b128 a[204:207], v18 offset:51712
    v_mfma_f32_16x16x32_bf16 v[204:207], a[208:211], v[40:43], 0
    v_exp_f32 v50, v50
    v_mfma_f32_16x16x32_bf16 v[172:175], a[208:211], v[36:39], 0
    v_exp_f32 v51, v51
    v_mfma_f32_16x16x32_bf16 v[140:143], a[208:211], v[32:35], 0
    v_cvt_pk_bf16_f32 v48, v48, v49
    v_cvt_pk_bf16_f32 v49, v50, v51
    v_mfma_f32_16x16x32_bf16 v[108:111], a[208:211], v[28:31], 0
    ds_read_b128 a[208:211], v18 offset:55296
    v_mfma_f32_16x16x32_bf16 v[112:115], a[212:215], v[28:31], 0
    v_exp_f32 v52, v52
    v_mfma_f32_16x16x32_bf16 v[144:147], a[212:215], v[32:35], 0
    s_add_u32 s45, s98, 204800
    v_mfma_f32_16x16x32_bf16 v[176:179], a[212:215], v[36:39], 0
    s_cbranch_vccz 2
    buffer_load_dwordx4 v[10:13], v24, s[24:27], s45 offen offset:0 sc1
    v_mfma_f32_16x16x32_bf16 v[208:211], a[212:215], v[40:43], 0
    v_exp_f32 v53, v53
    v_mfma_f32_16x16x32_bf16 v[240:243], a[212:215], v[76:79], 0
    buffer_load_dwordx4 v8, s[12:15], s53 offen offset:3072 nt lds
    s_waitcnt lgkmcnt(1)
    v_mfma_f32_16x16x32_bf16 v[28:31], a[184:187], a[0:3], 0
    ds_read_b128 a[212:215], v18 offset:55808
    v_mfma_f32_16x16x32_bf16 v[28:31], a[188:191], a[4:7], v[28:31]
    v_exp_f32 v54, v54
    v_mfma_f32_16x16x32_bf16 v[28:31], a[192:195], a[8:11], v[28:31]
    v_exp_f32 v55, v55
    v_mfma_f32_16x16x32_bf16 v[28:31], a[196:199], a[12:15], v[28:31]
    v_cvt_pk_bf16_f32 v52, v52, v53
    v_cvt_pk_bf16_f32 v53, v54, v55
    v_mfma_f32_16x16x32_bf16 v[32:35], a[184:187], a[16:19], 0
    v_exp_f32 v56, v56
    v_mfma_f32_16x16x32_bf16 v[32:35], a[188:191], a[20:23], v[32:35]
    s_cbranch_vccz 2
    buffer_load_dwordx4 v[14:17], v24, s[24:27], s45 offen offset:1024 sc1
    v_mfma_f32_16x16x32_bf16 v[32:35], a[192:195], a[24:27], v[32:35]
    v_exp_f32 v57, v57
    v_mfma_f32_16x16x32_bf16 v[32:35], a[196:199], a[28:31], v[32:35]
    v_exp_f32 v58, v58
    v_mfma_f32_16x16x32_bf16 v[36:39], a[184:187], a[32:35], 0
    v_exp_f32 v59, v59
    v_mfma_f32_16x16x32_bf16 v[36:39], a[188:191], a[36:39], v[36:39]
    v_cvt_pk_bf16_f32 v56, v56, v57
    v_cvt_pk_bf16_f32 v57, v58, v59
    v_mfma_f32_16x16x32_bf16 v[36:39], a[192:195], a[40:43], v[36:39]
    v_exp_f32 v60, v60
    v_mfma_f32_16x16x32_bf16 v[36:39], a[196:199], a[44:47], v[36:39]
    v_exp_f32 v61, v61
    v_mfma_f32_16x16x32_bf16 v[40:43], a[184:187], a[48:51], 0
    v_exp_f32 v62, v62
    v_mfma_f32_16x16x32_bf16 v[40:43], a[188:191], a[52:55], v[40:43]
    v_exp_f32 v63, v63
    v_mfma_f32_16x16x32_bf16 v[40:43], a[192:195], a[56:59], v[40:43]
    v_cvt_pk_bf16_f32 v46, v60, v61
    v_cvt_pk_bf16_f32 v47, v62, v63
    v_mfma_f32_16x16x32_bf16 v[40:43], a[196:199], a[60:63], v[40:43]
    v_exp_f32 v64, v64
    v_mfma_f32_16x16x32_bf16 v[76:79], a[184:187], a[64:67], 0
    v_exp_f32 v65, v65
    v_mfma_f32_16x16x32_bf16 v[76:79], a[188:191], a[68:71], v[76:79]
    v_exp_f32 v66, v66
    v_mfma_f32_16x16x32_bf16 v[76:79], a[192:195], a[72:75], v[76:79]
    v_exp_f32 v67, v67
    v_mfma_f32_16x16x32_bf16 v[76:79], a[196:199], a[76:79], v[76:79]
    s_cbranch_vccnz 1
    s_waitcnt vmcnt(4)
    s_waitcnt vmcnt(7) lgkmcnt(0)
    s_barrier
    v_xor_b32 v19, 0x10000, v19
    v_xor_b32 v20, 0x10000, v20
    v_xor_b32 v18, 0x10000, v18
    s_add_u32 s57, s56, 32768
    s_and_b32 s57, s57, 0x1ffff
    v_mfma_f32_16x16x32_bf16 v[60:63], a[200:203], a[0:3], 0
    s_mov_b32 s88, 16384
    s_mov_b32 s94, 32768
    s_cmp_gt_i32 s88, 0
    s_cselect_b64 s[28:29], s[16:17], s[12:13]
    v_mfma_f32_16x16x32_bf16 v[60:63], a[204:207], a[4:7], v[60:63]
    s_add_u32 m0, s60, s94
    s_add_u32 s53, s58, s57
    v_cvt_pk_bf16_f32 v50, v64, v65
    v_cvt_pk_bf16_f32 v51, v66, v67
    v_mfma_f32_16x16x32_bf16 v[60:63], a[208:211], a[8:11], v[60:63]
    buffer_load_dwordx4 v5, s[28:31], s53 offen offset:0 nt lds
    v_mfma_f32_16x16x32_bf16 v[60:63], a[212:215], a[12:15], v[60:63]
    s_add_u32 s57, s57, s88
    ds_read_b64_tr_b16 a[184:185], v19 offset:0
    v_mfma_f32_16x16x32_bf16 v[64:67], a[200:203], a[16:19], 0
    v_exp_f32 v68, v68
    v_mfma_f32_16x16x32_bf16 v[64:67], a[204:207], a[20:23], v[64:67]
    v_exp_f32 v69, v69
    v_exp_f32 v70, v70
    v_mfma_f32_16x16x32_bf16 v[64:67], a[208:211], a[24:27], v[64:67]
    v_exp_f32 v71, v71
    v_cvt_pk_bf16_f32 v54, v68, v69
    v_cvt_pk_bf16_f32 v55, v70, v71
    v_mfma_f32_16x16x32_bf16 v[64:67], a[212:215], a[28:31], v[64:67]
    v_exp_f32 v72, v72
    v_mfma_f32_16x16x32_bf16 v[68:71], a[200:203], a[32:35], 0
    buffer_load_dwordx4 v6, s[28:31], s53 offen offset:1024 nt lds
    v_mfma_f32_16x16x32_bf16 v[68:71], a[204:207], a[36:39], v[68:71]
    s_and_b32 s57, s57, 0x1ffff
    s_sub_u32 s88, 8192, s88
    v_exp_f32 v73, v73
    v_mfma_f32_16x16x32_bf16 v[68:71], a[208:211], a[40:43], v[68:71]
    v_exp_f32 v74, v74
    v_exp_f32 v75, v75
    v_mfma_f32_16x16x32_bf16 v[68:71], a[212:215], a[44:47], v[68:71]
    v_cvt_pk_bf16_f32 v58, v72, v73
    v_cvt_pk_bf16_f32 v59, v74, v75
    v_mfma_f32_16x16x32_bf16 v[72:75], a[200:203], a[48:51], 0
    ds_read_b64_tr_b16 a[186:187], v19 offset:2048
    v_mfma_f32_16x16x32_bf16 v[72:75], a[204:207], a[52:55], v[72:75]
    ds_read_b64_tr_b16 a[188:189], v20 offset:0
    v_mfma_f32_16x16x32_bf16 v[72:75], a[208:211], a[56:59], v[72:75]
    ds_read_b64_tr_b16 a[190:191], v20 offset:2048
    v_mfma_f32_16x16x32_bf16 v[72:75], a[212:215], a[60:63], v[72:75]
    ds_read_b64_tr_b16 a[192:193], v19 offset:512
    v_mfma_f32_16x16x32_bf16 v[80:83], a[200:203], a[64:67], 0
    ds_read_b64_tr_b16 a[194:195], v19 offset:2560
    v_mfma_f32_16x16x32_bf16 v[80:83], a[204:207], a[68:71], v[80:83]
    ds_read_b64_tr_b16 a[196:197], v20 offset:512
    v_mfma_f32_16x16x32_bf16 v[80:83], a[208:211], a[72:75], v[80:83]
    buffer_load_dwordx4 v7, s[28:31], s53 offen offset:2048 nt lds
    v_mfma_f32_16x16x32_bf16 v[80:83], a[212:215], a[76:79], v[80:83]
    s_add_u32 s94, s94, 16384
    s_and_b32 s94, s94, 0x1ffff
    v_mfma_f32_16x16x32_bf16 a[160:163], a[180:183], v[44:47], a[160:163]
    ds_read_b64_tr_b16 a[198:199], v20 offset:2560
    v_mfma_f32_16x16x32_bf16 a[164:167], a[180:183], v[48:51], a[164:167]
    ds_read_b64_tr_b16 a[200:201], v19 offset:4096
    v_mfma_f32_16x16x32_bf16 a[168:171], a[180:183], v[52:55], a[168:171]
    ds_read_b64_tr_b16 a[202:203], v19 offset:6144
    v_mfma_f32_16x16x32_bf16 a[172:175], a[180:183], v[56:59], a[172:175]
    s_waitcnt lgkmcnt(3)
    ds_read_b64_tr_b16 a[204:205], v20 offset:4096
    v_mfma_f32_16x16x32_bf16 v[180:183], a[184:187], v[56:59], v[180:183]
    ds_read_b64_tr_b16 a[206:207], v20 offset:6144
    v_mfma_f32_16x16x32_bf16 v[148:151], a[184:187], v[52:55], v[148:151]
    ds_read_b64_tr_b16 a[208:209], v19 offset:4608
    v_mfma_f32_16x16x32_bf16 v[116:119], a[184:187], v[48:51], v[116:119]
    ds_read_b64_tr_b16 a[210:211], v19 offset:6656
    v_mfma_f32_16x16x32_bf16 v[84:87], a[184:187], v[44:47], v[84:87]
    buffer_load_dwordx4 v8, s[28:31], s53 offen offset:3072 nt lds
    v_mfma_f32_16x16x32_bf16 v[88:91], a[188:191], v[44:47], v[88:91]
    ds_read_b64_tr_b16 a[212:213], v20 offset:4608
    v_mfma_f32_16x16x32_bf16 v[120:123], a[188:191], v[48:51], v[120:123]
    ds_read_b64_tr_b16 a[214:215], v20 offset:6656
    v_mfma_f32_16x16x32_bf16 v[152:155], a[188:191], v[52:55], v[152:155]
    v_exp_f32 v28, v28
    v_mfma_f32_16x16x32_bf16 v[184:187], a[188:191], v[56:59], v[184:187]
    v_exp_f32 v29, v29
    v_mfma_f32_16x16x32_bf16 v[188:191], a[192:195], v[56:59], v[188:191]
    v_exp_f32 v30, v30
    v_mfma_f32_16x16x32_bf16 v[156:159], a[192:195], v[52:55], v[156:159]
    v_exp_f32 v31, v31
    v_mfma_f32_16x16x32_bf16 v[124:127], a[192:195], v[48:51], v[124:127]
    v_cvt_pk_bf16_f32 v28, v28, v29
    v_cvt_pk_bf16_f32 v29, v30, v31
    v_mfma_f32_16x16x32_bf16 v[92:95], a[192:195], v[44:47], v[92:95]
    s_waitcnt lgkmcnt(0)
    v_exp_f32 v32, v32
    v_mfma_f32_16x16x32_bf16 v[96:99], a[196:199], v[44:47], v[96:99]
    v_exp_f32 v33, v33
    v_mfma_f32_16x16x32_bf16 v[128:131], a[196:199], v[48:51], v[128:131]
    v_exp_f32 v34, v34
    v_mfma_f32_16x16x32_bf16 v[160:163], a[196:199], v[52:55], v[160:163]
    v_exp_f32 v35, v35
    v_mfma_f32_16x16x32_bf16 v[192:195], a[196:199], v[56:59], v[192:195]
    s_mov_b32 s92, 1
gqa_kernel_aloop_0:
    s_lshr_b32 s97, s97, 1
    s_cbranch_scc0 1
    s_waitcnt vmcnt(3)
    s_waitcnt vmcnt(4) lgkmcnt(0)
    s_barrier
    s_cmp_gt_i32 s88, 0
    s_cselect_b64 s[28:29], s[16:17], s[12:13]
    v_mfma_f32_16x16x32_bf16 v[196:199], a[200:203], v[56:59], v[196:199]
    s_add_u32 m0, s60, s94
    s_add_u32 s53, s58, s57
    v_mfma_f32_16x16x32_bf16 v[164:167], a[200:203], v[52:55], v[164:167]
    buffer_load_dwordx4 v5, s[28:31], s53 offen offset:0 nt lds
    v_mfma_f32_16x16x32_bf16 v[132:135], a[200:203], v[48:51], v[132:135]
    s_add_u32 s57, s57, s88
    ds_read_b128 a[184:187], v18 offset:16384
    v_mfma_f32_16x16x32_bf16 v[100:103], a[200:203], v[44:47], v[100:103]
    ds_read_b128 a[188:191], v18 offset:16896
    v_cvt_pk_bf16_f32 v32, v32, v33
    v_mfma_f32_16x16x32_bf16 v[104:107], a[204:207], v[44:47], v[104:107]
    ds_read_b128 a[192:195], v18 offset:20480
    v_cvt_pk_bf16_f32 v33, v34, v35
    v_mfma_f32_16x16x32_bf16 v[136:139], a[204:207], v[48:51], v[136:139]
    ds_read_b128 a[196:199], v18 offset:20992
    v_mfma_f32_16x16x32_bf16 v[168:171], a[204:207], v[52:55], v[168:171]
    ds_read_b128 a[200:203], v18 offset:18432
    v_mfma_f32_16x16x32_bf16 v[200:203], a[204:207], v[56:59], v[200:203]
    ds_read_b128 a[204:207], v18 offset:18944
    v_mfma_f32_16x16x32_bf16 v[204:207], a[208:211], v[56:59], v[204:207]
    v_exp_f32 v36, v36
    v_mfma_f32_16x16x32_bf16 v[172:175], a[208:211], v[52:55], v[172:175]
    v_exp_f32 v37, v37
    v_mfma_f32_16x16x32_bf16 v[140:143], a[208:211], v[48:51], v[140:143]
    v_exp_f32 v38, v38
    v_mfma_f32_16x16x32_bf16 v[108:111], a[208:211], v[44:47], v[108:111]
    ds_read_b128 a[208:211], v18 offset:22528
    v_mfma_f32_16x16x32_bf16 v[112:115], a[212:215], v[44:47], v[112:115]
    v_exp_f32 v39, v39
    v_mfma_f32_16x16x32_bf16 v[144:147], a[212:215], v[48:51], v[144:147]
    buffer_load_dwordx4 v6, s[28:31], s53 offen offset:1024 nt lds
    v_mfma_f32_16x16x32_bf16 v[176:179], a[212:215], v[52:55], v[176:179]
    s_and_b32 s57, s57, 0x1ffff
    s_sub_u32 s88, 8192, s88
    v_mfma_f32_16x16x32_bf16 v[208:211], a[212:215], v[56:59], v[208:211]
    s_waitcnt lgkmcnt(1)
    ds_read_b128 a[212:215], v18 offset:23040
    v_cvt_pk_bf16_f32 v36, v36, v37
    v_mfma_f32_16x16x32_bf16 v[44:47], a[184:187], a[0:3], 0
    v_cvt_pk_bf16_f32 v37, v38, v39
    v_mfma_f32_16x16x32_bf16 v[44:47], a[188:191], a[4:7], v[44:47]
    v_exp_f32 v40, v40
    v_mfma_f32_16x16x32_bf16 v[44:47], a[192:195], a[8:11], v[44:47]
    v_exp_f32 v41, v41
    v_mfma_f32_16x16x32_bf16 v[44:47], a[196:199], a[12:15], v[44:47]
    v_exp_f32 v42, v42
    v_mfma_f32_16x16x32_bf16 v[48:51], a[184:187], a[16:19], 0
    v_exp_f32 v43, v43
    v_mfma_f32_16x16x32_bf16 v[48:51], a[188:191], a[20:23], v[48:51]
    v_cvt_pk_bf16_f32 v40, v40, v41
    v_cvt_pk_bf16_f32 v41, v42, v43
    v_mfma_f32_16x16x32_bf16 v[48:51], a[192:195], a[24:27], v[48:51]
    v_exp_f32 v76, v76
    v_mfma_f32_16x16x32_bf16 v[48:51], a[196:199], a[28:31], v[48:51]
    v_exp_f32 v77, v77
    v_mfma_f32_16x16x32_bf16 v[52:55], a[184:187], a[32:35], 0
    v_exp_f32 v78, v78
    v_mfma_f32_16x16x32_bf16 v[52:55], a[188:191], a[36:39], v[52:55]
    v_exp_f32 v79, v79
    v_mfma_f32_16x16x32_bf16 v[52:55], a[192:195], a[40:43], v[52:55]
    v_cvt_pk_bf16_f32 v76, v76, v77
    v_cvt_pk_bf16_f32 v77, v78, v79
    v_mfma_f32_16x16x32_bf16 v[52:55], a[196:199], a[44:47], v[52:55]
    buffer_load_dwordx4 v7, s[28:31], s53 offen offset:2048 nt lds
    v_mfma_f32_16x16x32_bf16 v[56:59], a[184:187], a[48:51], 0
    s_add_u32 s94, s94, 16384
    s_and_b32 s94, s94, 0x1ffff
    v_mfma_f32_16x16x32_bf16 v[56:59], a[188:191], a[52:55], v[56:59]
    v_exp_f32 v60, v60
    v_exp_f32 v61, v61
    v_mfma_f32_16x16x32_bf16 v[56:59], a[192:195], a[56:59], v[56:59]
    v_exp_f32 v62, v62
    v_exp_f32 v63, v63
    v_mfma_f32_16x16x32_bf16 v[56:59], a[196:199], a[60:63], v[56:59]
    v_cvt_pk_bf16_f32 v30, v60, v61
    v_cvt_pk_bf16_f32 v31, v62, v63
    v_mfma_f32_16x16x32_bf16 v[60:63], a[200:203], a[0:3], 0
    v_exp_f32 v64, v64
    v_mfma_f32_16x16x32_bf16 v[60:63], a[204:207], a[4:7], v[60:63]
    s_waitcnt lgkmcnt(0)
    v_exp_f32 v65, v65
    v_exp_f32 v66, v66
    v_mfma_f32_16x16x32_bf16 v[60:63], a[208:211], a[8:11], v[60:63]
    v_exp_f32 v67, v67
    v_cvt_pk_bf16_f32 v34, v64, v65
    v_cvt_pk_bf16_f32 v35, v66, v67
    v_mfma_f32_16x16x32_bf16 v[60:63], a[212:215], a[12:15], v[60:63]
    v_exp_f32 v68, v68
    v_mfma_f32_16x16x32_bf16 v[64:67], a[200:203], a[16:19], 0
    v_exp_f32 v69, v69
    v_mfma_f32_16x16x32_bf16 v[64:67], a[204:207], a[20:23], v[64:67]
    v_exp_f32 v70, v70
    v_exp_f32 v71, v71
    v_mfma_f32_16x16x32_bf16 v[64:67], a[208:211], a[24:27], v[64:67]
    v_cvt_pk_bf16_f32 v38, v68, v69
    v_cvt_pk_bf16_f32 v39, v70, v71
    v_mfma_f32_16x16x32_bf16 v[64:67], a[212:215], a[28:31], v[64:67]
    v_exp_f32 v72, v72
    v_mfma_f32_16x16x32_bf16 v[68:71], a[200:203], a[32:35], 0
    v_exp_f32 v73, v73
    v_mfma_f32_16x16x32_bf16 v[68:71], a[204:207], a[36:39], v[68:71]
    v_exp_f32 v74, v74
    v_exp_f32 v75, v75
    v_mfma_f32_16x16x32_bf16 v[68:71], a[208:211], a[40:43], v[68:71]
    v_cvt_pk_bf16_f32 v42, v72, v73
    v_cvt_pk_bf16_f32 v43, v74, v75
    v_mfma_f32_16x16x32_bf16 v[68:71], a[212:215], a[44:47], v[68:71]
    s_waitcnt vmcnt(3) lgkmcnt(0)
    s_barrier
    ds_read_b64_tr_b16 a[184:185], v19 offset:32768
    ds_read_b64_tr_b16 a[186:187], v19 offset:34816
    v_mfma_f32_16x16x32_bf16 v[72:75], a[200:203], a[48:51], 0
    buffer_load_dwordx4 v8, s[28:31], s53 offen offset:3072 nt lds
    v_mfma_f32_16x16x32_bf16 v[72:75], a[204:207], a[52:55], v[72:75]
    ds_read_b64_tr_b16 a[188:189], v20 offset:32768
    v_mfma_f32_16x16x32_bf16 v[72:75], a[208:211], a[56:59], v[72:75]
    ds_read_b64_tr_b16 a[190:191], v20 offset:34816
    v_mfma_f32_16x16x32_bf16 v[72:75], a[212:215], a[60:63], v[72:75]
    v_exp_f32 v80, v80
    v_mfma_f32_16x16x32_bf16 a[160:163], a[180:183], v[28:31], a[160:163]
    v_exp_f32 v81, v81
    v_mfma_f32_16x16x32_bf16 a[164:167], a[180:183], v[32:35], a[164:167]
    v_exp_f32 v82, v82
    v_exp_f32 v83, v83
    v_mfma_f32_16x16x32_bf16 a[168:171], a[180:183], v[36:39], a[168:171]
    s_cmp_gt_i32 s88, 0
    s_cselect_b64 s[28:29], s[16:17], s[12:13]
    s_add_u32 m0, s60, s94
    s_add_u32 s53, s58, s57
    v_mfma_f32_16x16x32_bf16 a[172:175], a[180:183], v[40:43], a[172:175]
    buffer_load_dwordx4 v5, s[28:31], s53 offen offset:0 nt lds
    v_cvt_pk_bf16_f32 v78, v80, v81
    v_cvt_pk_bf16_f32 v79, v82, v83
    s_nop 1
    v_mfma_f32_16x16x32_bf16 a[176:179], a[180:183], v[76:79], a[176:179]
    s_add_u32 s57, s57, s88
    ds_read_b64_tr_b16 a[192:193], v19 offset:33280
    s_waitcnt lgkmcnt(1)
    v_mfma_f32_16x16x32_bf16 v[212:215], a[184:187], v[76:79], v[212:215]
    ds_read_b64_tr_b16 a[194:195], v19 offset:35328
    v_mfma_f32_16x16x32_bf16 v[180:183], a[184:187], v[40:43], v[180:183]
    ds_read_b64_tr_b16 a[196:197], v20 offset:33280
    v_mfma_f32_16x16x32_bf16 v[148:151], a[184:187], v[36:39], v[148:151]
    ds_read_b64_tr_b16 a[198:199], v20 offset:35328
    v_mfma_f32_16x16x32_bf16 v[116:119], a[184:187], v[32:35], v[116:119]
    ds_read_b64_tr_b16 a[200:201], v19 offset:36864
    v_mfma_f32_16x16x32_bf16 v[84:87], a[184:187], v[28:31], v[84:87]
    ds_read_b64_tr_b16 a[202:203], v19 offset:38912
    v_mfma_f32_16x16x32_bf16 v[88:91], a[188:191], v[28:31], v[88:91]
    buffer_load_dwordx4 v6, s[28:31], s53 offen offset:1024 nt lds
    v_mfma_f32_16x16x32_bf16 v[120:123], a[188:191], v[32:35], v[120:123]
    s_and_b32 s57, s57, 0x1ffff
    s_sub_u32 s88, 8192, s88
    v_mfma_f32_16x16x32_bf16 v[152:155], a[188:191], v[36:39], v[152:155]
    ds_read_b64_tr_b16 a[204:205], v20 offset:36864
    v_mfma_f32_16x16x32_bf16 v[184:187], a[188:191], v[40:43], v[184:187]
    ds_read_b64_tr_b16 a[206:207], v20 offset:38912
    v_mfma_f32_16x16x32_bf16 v[216:219], a[188:191], v[76:79], v[216:219]
    s_waitcnt lgkmcnt(3)
    ds_read_b64_tr_b16 a[208:209], v19 offset:37376
    v_mfma_f32_16x16x32_bf16 v[220:223], a[192:195], v[76:79], v[220:223]
    ds_read_b64_tr_b16 a[210:211], v19 offset:39424
    v_mfma_f32_16x16x32_bf16 v[188:191], a[192:195], v[40:43], v[188:191]
    ds_read_b64_tr_b16 a[212:213], v20 offset:37376
    v_mfma_f32_16x16x32_bf16 v[156:159], a[192:195], v[36:39], v[156:159]
    buffer_load_dwordx4 v7, s[28:31], s53 offen offset:2048 nt lds
    v_mfma_f32_16x16x32_bf16 v[124:127], a[192:195], v[32:35], v[124:127]
    s_add_u32 s94, s94, 16384
    s_and_b32 s94, s94, 0x1ffff
    v_mfma_f32_16x16x32_bf16 v[92:95], a[192:195], v[28:31], v[92:95]
    ds_read_b64_tr_b16 a[214:215], v20 offset:39424
    v_mfma_f32_16x16x32_bf16 v[96:99], a[196:199], v[28:31], v[96:99]
    v_exp_f32 v44, v44
    v_mfma_f32_16x16x32_bf16 v[128:131], a[196:199], v[32:35], v[128:131]
    v_exp_f32 v45, v45
    v_mfma_f32_16x16x32_bf16 v[160:163], a[196:199], v[36:39], v[160:163]
    v_exp_f32 v46, v46
    v_mfma_f32_16x16x32_bf16 v[192:195], a[196:199], v[40:43], v[192:195]
    v_exp_f32 v47, v47
    v_mfma_f32_16x16x32_bf16 v[224:227], a[196:199], v[76:79], v[224:227]
    s_waitcnt lgkmcnt(1)
    v_cvt_pk_bf16_f32 v44, v44, v45
    v_cvt_pk_bf16_f32 v45, v46, v47
    v_mfma_f32_16x16x32_bf16 v[228:231], a[200:203], v[76:79], v[228:231]
    v_exp_f32 v48, v48
    v_mfma_f32_16x16x32_bf16 v[196:199], a[200:203], v[40:43], v[196:199]
    v_exp_f32 v49, v49
    v_mfma_f32_16x16x32_bf16 v[164:167], a[200:203], v[36:39], v[164:167]
    s_lshr_b32 s97, s97, 1
    s_cbranch_scc0 1
    s_waitcnt vmcnt(3)
    s_waitcnt vmcnt(4) lgkmcnt(0)
    s_barrier
    v_mfma_f32_16x16x32_bf16 v[132:135], a[200:203], v[32:35], v[132:135]
    buffer_load_dwordx4 v8, s[28:31], s53 offen offset:3072 nt lds
    v_mfma_f32_16x16x32_bf16 v[100:103], a[200:203], v[28:31], v[100:103]
    ds_read_b128 a[184:187], v18 offset:49152
    v_mfma_f32_16x16x32_bf16 v[104:107], a[204:207], v[28:31], v[104:107]
    ds_read_b128 a[188:191], v18 offset:49664
    v_mfma_f32_16x16x32_bf16 v[136:139], a[204:207], v[32:35], v[136:139]
    ds_read_b128 a[192:195], v18 offset:53248
    v_mfma_f32_16x16x32_bf16 v[168:171], a[204:207], v[36:39], v[168:171]
    ds_read_b128 a[196:199], v18 offset:53760
    v_mfma_f32_16x16x32_bf16 v[200:203], a[204:207], v[40:43], v[200:203]
    ds_read_b128 a[200:203], v18 offset:51200
    v_mfma_f32_16x16x32_bf16 v[232:235], a[204:207], v[76:79], v[232:235]
    ds_read_b128 a[204:207], v18 offset:51712
    v_mfma_f32_16x16x32_bf16 v[236:239], a[208:211], v[76:79], v[236:239]
    v_exp_f32 v50, v50
    v_mfma_f32_16x16x32_bf16 v[204:207], a[208:211], v[40:43], v[204:207]
    v_exp_f32 v51, v51
    v_mfma_f32_16x16x32_bf16 v[172:175], a[208:211], v[36:39], v[172:175]
    v_cvt_pk_bf16_f32 v48, v48, v49
    v_cvt_pk_bf16_f32 v49, v50, v51
    v_mfma_f32_16x16x32_bf16 v[140:143], a[208:211], v[32:35], v[140:143]
    s_cmp_gt_i32 s88, 0
    s_cselect_b64 s[28:29], s[16:17], s[12:13]
    s_add_u32 m0, s60, s94
    s_add_u32 s53, s58, s57
    v_mfma_f32_16x16x32_bf16 v[108:111], a[208:211], v[28:31], v[108:111]
    buffer_load_dwordx4 v5, s[28:31], s53 offen offset:0 nt lds
    v_mfma_f32_16x16x32_bf16 v[112:115], a[212:215], v[28:31], v[112:115]
    s_add_u32 s57, s57, s88
    ds_read_b128 a[208:211], v18 offset:55296
    v_mfma_f32_16x16x32_bf16 v[144:147], a[212:215], v[32:35], v[144:147]
    v_exp_f32 v52, v52
    v_mfma_f32_16x16x32_bf16 v[176:179], a[212:215], v[36:39], v[176:179]
    v_exp_f32 v53, v53
    v_mfma_f32_16x16x32_bf16 v[208:211], a[212:215], v[40:43], v[208:211]
    v_exp_f32 v54, v54
    v_mfma_f32_16x16x32_bf16 v[240:243], a[212:215], v[76:79], v[240:243]
    s_waitcnt lgkmcnt(1)
    ds_read_b128 a[212:215], v18 offset:55808
    v_mfma_f32_16x16x32_bf16 v[28:31], a[184:187], a[0:3], 0
    v_exp_f32 v55, v55
    v_mfma_f32_16x16x32_bf16 v[28:31], a[188:191], a[4:7], v[28:31]
    v_cvt_pk_bf16_f32 v52, v52, v53
    v_cvt_pk_bf16_f32 v53, v54, v55
    v_mfma_f32_16x16x32_bf16 v[28:31], a[192:195], a[8:11], v[28:31]
    v_exp_f32 v56, v56
    v_mfma_f32_16x16x32_bf16 v[28:31], a[196:199], a[12:15], v[28:31]
    v_exp_f32 v57, v57
    v_mfma_f32_16x16x32_bf16 v[32:35], a[184:187], a[16:19], 0
    v_exp_f32 v58, v58
    v_mfma_f32_16x16x32_bf16 v[32:35], a[188:191], a[20:23], v[32:35]
    buffer_load_dwordx4 v6, s[28:31], s53 offen offset:1024 nt lds
    v_mfma_f32_16x16x32_bf16 v[32:35], a[192:195], a[24:27], v[32:35]
    s_and_b32 s57, s57, 0x1ffff
    s_sub_u32 s88, 8192, s88
    v_mfma_f32_16x16x32_bf16 v[32:35], a[196:199], a[28:31], v[32:35]
    v_exp_f32 v59, v59
    v_mfma_f32_16x16x32_bf16 v[36:39], a[184:187], a[32:35], 0
    v_cvt_pk_bf16_f32 v56, v56, v57
    v_cvt_pk_bf16_f32 v57, v58, v59
    v_mfma_f32_16x16x32_bf16 v[36:39], a[188:191], a[36:39], v[36:39]
    v_exp_f32 v60, v60
    v_mfma_f32_16x16x32_bf16 v[36:39], a[192:195], a[40:43], v[36:39]
    v_exp_f32 v61, v61
    v_mfma_f32_16x16x32_bf16 v[36:39], a[196:199], a[44:47], v[36:39]
    v_exp_f32 v62, v62
    v_mfma_f32_16x16x32_bf16 v[40:43], a[184:187], a[48:51], 0
    v_exp_f32 v63, v63
    v_mfma_f32_16x16x32_bf16 v[40:43], a[188:191], a[52:55], v[40:43]
    v_cvt_pk_bf16_f32 v46, v60, v61
    v_cvt_pk_bf16_f32 v47, v62, v63
    v_mfma_f32_16x16x32_bf16 v[40:43], a[192:195], a[56:59], v[40:43]
    v_exp_f32 v64, v64
    v_mfma_f32_16x16x32_bf16 v[40:43], a[196:199], a[60:63], v[40:43]
    v_exp_f32 v65, v65
    v_mfma_f32_16x16x32_bf16 v[76:79], a[184:187], a[64:67], 0
    v_exp_f32 v66, v66
    v_mfma_f32_16x16x32_bf16 v[76:79], a[188:191], a[68:71], v[76:79]
    v_exp_f32 v67, v67
    v_mfma_f32_16x16x32_bf16 v[76:79], a[192:195], a[72:75], v[76:79]
    v_cvt_pk_bf16_f32 v50, v64, v65
    v_cvt_pk_bf16_f32 v51, v66, v67
    v_mfma_f32_16x16x32_bf16 v[76:79], a[196:199], a[76:79], v[76:79]
    s_waitcnt vmcnt(3) lgkmcnt(0)
    s_barrier
    v_xor_b32 v19, 0x10000, v19
    v_xor_b32 v20, 0x10000, v20
    v_xor_b32 v18, 0x10000, v18
    v_mfma_f32_16x16x32_bf16 v[60:63], a[200:203], a[0:3], 0
    buffer_load_dwordx4 v7, s[28:31], s53 offen offset:2048 nt lds
    v_mfma_f32_16x16x32_bf16 v[60:63], a[204:207], a[4:7], v[60:63]
    s_add_u32 s94, s94, 16384
    s_and_b32 s94, s94, 0x1ffff
    v_mfma_f32_16x16x32_bf16 v[60:63], a[208:211], a[8:11], v[60:63]
    v_exp_f32 v68, v68
    v_mfma_f32_16x16x32_bf16 v[60:63], a[212:215], a[12:15], v[60:63]
    v_exp_f32 v69, v69
    v_mfma_f32_16x16x32_bf16 v[64:67], a[200:203], a[16:19], 0
    v_exp_f32 v70, v70
    v_mfma_f32_16x16x32_bf16 v[64:67], a[204:207], a[20:23], v[64:67]
    v_exp_f32 v71, v71
    v_cvt_pk_bf16_f32 v54, v68, v69
    v_cvt_pk_bf16_f32 v55, v70, v71
    v_mfma_f32_16x16x32_bf16 v[64:67], a[208:211], a[24:27], v[64:67]
    v_exp_f32 v72, v72
    v_mfma_f32_16x16x32_bf16 v[64:67], a[212:215], a[28:31], v[64:67]
    v_exp_f32 v73, v73
    v_mfma_f32_16x16x32_bf16 v[68:71], a[200:203], a[32:35], 0
    buffer_load_dwordx4 v8, s[28:31], s53 offen offset:3072 nt lds
    v_mfma_f32_16x16x32_bf16 v[68:71], a[204:207], a[36:39], v[68:71]
    v_exp_f32 v74, v74
    v_exp_f32 v75, v75
    v_mfma_f32_16x16x32_bf16 v[68:71], a[208:211], a[40:43], v[68:71]
    v_cvt_pk_bf16_f32 v58, v72, v73
    v_cvt_pk_bf16_f32 v59, v74, v75
    v_mfma_f32_16x16x32_bf16 v[68:71], a[212:215], a[44:47], v[68:71]
    ds_read_b64_tr_b16 a[184:185], v19 offset:0
    v_mfma_f32_16x16x32_bf16 v[72:75], a[200:203], a[48:51], 0
    ds_read_b64_tr_b16 a[186:187], v19 offset:2048
    v_mfma_f32_16x16x32_bf16 v[72:75], a[204:207], a[52:55], v[72:75]
    ds_read_b64_tr_b16 a[188:189], v20 offset:0
    v_mfma_f32_16x16x32_bf16 v[72:75], a[208:211], a[56:59], v[72:75]
    ds_read_b64_tr_b16 a[190:191], v20 offset:2048
    v_mfma_f32_16x16x32_bf16 v[72:75], a[212:215], a[60:63], v[72:75]
    ds_read_b64_tr_b16 a[192:193], v19 offset:512
    v_mfma_f32_16x16x32_bf16 v[80:83], a[200:203], a[64:67], 0
    ds_read_b64_tr_b16 a[194:195], v19 offset:2560
    v_mfma_f32_16x16x32_bf16 v[80:83], a[204:207], a[68:71], v[80:83]
    ds_read_b64_tr_b16 a[196:197], v20 offset:512
    v_mfma_f32_16x16x32_bf16 v[80:83], a[208:211], a[72:75], v[80:83]
    s_cmp_gt_i32 s88, 0
    s_cselect_b64 s[28:29], s[16:17], s[12:13]
    s_add_u32 m0, s60, s94
    s_add_u32 s53, s58, s57
    v_mfma_f32_16x16x32_bf16 v[80:83], a[212:215], a[76:79], v[80:83]
    buffer_load_dwordx4 v5, s[28:31], s53 offen offset:0 nt lds
    v_mfma_f32_16x16x32_bf16 a[160:163], a[180:183], v[44:47], a[160:163]
    s_add_u32 s57, s57, s88
    ds_read_b64_tr_b16 a[198:199], v20 offset:2560
    v_mfma_f32_16x16x32_bf16 a[164:167], a[180:183], v[48:51], a[164:167]
    ds_read_b64_tr_b16 a[200:201], v19 offset:4096
    v_mfma_f32_16x16x32_bf16 a[168:171], a[180:183], v[52:55], a[168:171]
    ds_read_b64_tr_b16 a[202:203], v19 offset:6144
    v_mfma_f32_16x16x32_bf16 a[172:175], a[180:183], v[56:59], a[172:175]
    s_waitcnt lgkmcnt(3)
    ds_read_b64_tr_b16 a[204:205], v20 offset:4096
    v_mfma_f32_16x16x32_bf16 v[180:183], a[184:187], v[56:59], v[180:183]
    ds_read_b64_tr_b16 a[206:207], v20 offset:6144
    v_mfma_f32_16x16x32_bf16 v[148:151], a[184:187], v[52:55], v[148:151]
    ds_read_b64_tr_b16 a[208:209], v19 offset:4608
    v_mfma_f32_16x16x32_bf16 v[116:119], a[184:187], v[48:51], v[116:119]
    ds_read_b64_tr_b16 a[210:211], v19 offset:6656
    v_mfma_f32_16x16x32_bf16 v[84:87], a[184:187], v[44:47], v[84:87]
    buffer_load_dwordx4 v6, s[28:31], s53 offen offset:1024 nt lds
    v_mfma_f32_16x16x32_bf16 v[88:91], a[188:191], v[44:47], v[88:91]
    s_and_b32 s57, s57, 0x1ffff
    s_sub_u32 s88, 8192, s88
    v_mfma_f32_16x16x32_bf16 v[120:123], a[188:191], v[48:51], v[120:123]
    ds_read_b64_tr_b16 a[212:213], v20 offset:4608
    v_mfma_f32_16x16x32_bf16 v[152:155], a[188:191], v[52:55], v[152:155]
    ds_read_b64_tr_b16 a[214:215], v20 offset:6656
    v_mfma_f32_16x16x32_bf16 v[184:187], a[188:191], v[56:59], v[184:187]
    v_exp_f32 v28, v28
    v_mfma_f32_16x16x32_bf16 v[188:191], a[192:195], v[56:59], v[188:191]
    v_exp_f32 v29, v29
    v_mfma_f32_16x16x32_bf16 v[156:159], a[192:195], v[52:55], v[156:159]
    v_exp_f32 v30, v30
    v_mfma_f32_16x16x32_bf16 v[124:127], a[192:195], v[48:51], v[124:127]
    v_exp_f32 v31, v31
    v_mfma_f32_16x16x32_bf16 v[92:95], a[192:195], v[44:47], v[92:95]
    s_waitcnt lgkmcnt(1)
    v_cvt_pk_bf16_f32 v28, v28, v29
    v_cvt_pk_bf16_f32 v29, v30, v31
    v_mfma_f32_16x16x32_bf16 v[96:99], a[196:199], v[44:47], v[96:99]
    v_exp_f32 v32, v32
    v_mfma_f32_16x16x32_bf16 v[128:131], a[196:199], v[48:51], v[128:131]
    v_exp_f32 v33, v33
    v_mfma_f32_16x16x32_bf16 v[160:163], a[196:199], v[52:55], v[160:163]
    v_exp_f32 v34, v34
    v_mfma_f32_16x16x32_bf16 v[192:195], a[196:199], v[56:59], v[192:195]
    s_lshr_b32 s97, s97, 1
    s_cbranch_scc0 1
    s_waitcnt vmcnt(3)
    s_waitcnt vmcnt(4) lgkmcnt(0)
    s_barrier
    v_mfma_f32_16x16x32_bf16 v[196:199], a[200:203], v[56:59], v[196:199]
    buffer_load_dwordx4 v7, s[28:31], s53 offen offset:2048 nt lds
    v_mfma_f32_16x16x32_bf16 v[164:167], a[200:203], v[52:55], v[164:167]
    s_add_u32 s94, s94, 16384
    s_and_b32 s94, s94, 0x1ffff
    v_mfma_f32_16x16x32_bf16 v[132:135], a[200:203], v[48:51], v[132:135]
    ds_read_b128 a[184:187], v18 offset:16384
    v_mfma_f32_16x16x32_bf16 v[100:103], a[200:203], v[44:47], v[100:103]
    ds_read_b128 a[188:191], v18 offset:16896
    v_mfma_f32_16x16x32_bf16 v[104:107], a[204:207], v[44:47], v[104:107]
    ds_read_b128 a[192:195], v18 offset:20480
    v_mfma_f32_16x16x32_bf16 v[136:139], a[204:207], v[48:51], v[136:139]
    ds_read_b128 a[196:199], v18 offset:20992
    v_mfma_f32_16x16x32_bf16 v[168:171], a[204:207], v[52:55], v[168:171]
    ds_read_b128 a[200:203], v18 offset:18432
    v_mfma_f32_16x16x32_bf16 v[200:203], a[204:207], v[56:59], v[200:203]
    ds_read_b128 a[204:207], v18 offset:18944
    v_mfma_f32_16x16x32_bf16 v[204:207], a[208:211], v[56:59], v[204:207]
    v_exp_f32 v35, v35
    v_mfma_f32_16x16x32_bf16 v[172:175], a[208:211], v[52:55], v[172:175]
    v_cvt_pk_bf16_f32 v32, v32, v33
    v_cvt_pk_bf16_f32 v33, v34, v35
    v_mfma_f32_16x16x32_bf16 v[140:143], a[208:211], v[48:51], v[140:143]
    v_exp_f32 v36, v36
    v_mfma_f32_16x16x32_bf16 v[108:111], a[208:211], v[44:47], v[108:111]
    ds_read_b128 a[208:211], v18 offset:22528
    v_mfma_f32_16x16x32_bf16 v[112:115], a[212:215], v[44:47], v[112:115]
    v_exp_f32 v37, v37
    v_mfma_f32_16x16x32_bf16 v[144:147], a[212:215], v[48:51], v[144:147]
    buffer_load_dwordx4 v8, s[28:31], s53 offen offset:3072 nt lds
    v_mfma_f32_16x16x32_bf16 v[176:179], a[212:215], v[52:55], v[176:179]
    v_exp_f32 v38, v38
    v_mfma_f32_16x16x32_bf16 v[208:211], a[212:215], v[56:59], v[208:211]
    s_waitcnt lgkmcnt(1)
    ds_read_b128 a[212:215], v18 offset:23040
    v_mfma_f32_16x16x32_bf16 v[44:47], a[184:187], a[0:3], 0
    v_exp_f32 v39, v39
    v_mfma_f32_16x16x32_bf16 v[44:47], a[188:191], a[4:7], v[44:47]
    v_cvt_pk_bf16_f32 v36, v36, v37
    v_cvt_pk_bf16_f32 v37, v38, v39
    v_mfma_f32_16x16x32_bf16 v[44:47], a[192:195], a[8:11], v[44:47]
    v_exp_f32 v40, v40
    v_mfma_f32_16x16x32_bf16 v[44:47], a[196:199], a[12:15], v[44:47]
    v_exp_f32 v41, v41
    v_mfma_f32_16x16x32_bf16 v[48:51], a[184:187], a[16:19], 0
    v_exp_f32 v42, v42
    v_mfma_f32_16x16x32_bf16 v[48:51], a[188:191], a[20:23], v[48:51]
    v_exp_f32 v43, v43
    v_mfma_f32_16x16x32_bf16 v[48:51], a[192:195], a[24:27], v[48:51]
    v_cvt_pk_bf16_f32 v40, v40, v41
    v_cvt_pk_bf16_f32 v41, v42, v43
    v_mfma_f32_16x16x32_bf16 v[48:51], a[196:199], a[28:31], v[48:51]
    v_exp_f32 v76, v76
    v_mfma_f32_16x16x32_bf16 v[52:55], a[184:187], a[32:35], 0
    v_exp_f32 v77, v77
    v_mfma_f32_16x16x32_bf16 v[52:55], a[188:191], a[36:39], v[52:55]
    v_exp_f32 v78, v78
    v_mfma_f32_16x16x32_bf16 v[52:55], a[192:195], a[40:43], v[52:55]
    v_exp_f32 v79, v79
    v_mfma_f32_16x16x32_bf16 v[52:55], a[196:199], a[44:47], v[52:55]
    s_cmp_gt_i32 s88, 0
    s_cselect_b64 s[28:29], s[16:17], s[12:13]
    s_add_u32 m0, s60, s94
    s_add_u32 s53, s58, s57
    v_mfma_f32_16x16x32_bf16 v[56:59], a[184:187], a[48:51], 0
    buffer_load_dwordx4 v5, s[28:31], s53 offen offset:0 nt lds
    v_mfma_f32_16x16x32_bf16 v[56:59], a[188:191], a[52:55], v[56:59]
    s_add_u32 s57, s57, s88
    v_cvt_pk_bf16_f32 v76, v76, v77
    v_cvt_pk_bf16_f32 v77, v78, v79
    v_mfma_f32_16x16x32_bf16 v[56:59], a[192:195], a[56:59], v[56:59]
    v_exp_f32 v60, v60
    v_exp_f32 v61, v61
    v_mfma_f32_16x16x32_bf16 v[56:59], a[196:199], a[60:63], v[56:59]
    v_exp_f32 v62, v62
    v_exp_f32 v63, v63
    v_cvt_pk_bf16_f32 v30, v60, v61
    v_cvt_pk_bf16_f32 v31, v62, v63
    v_mfma_f32_16x16x32_bf16 v[60:63], a[200:203], a[0:3], 0
    v_exp_f32 v64, v64
    v_mfma_f32_16x16x32_bf16 v[60:63], a[204:207], a[4:7], v[60:63]
    s_waitcnt lgkmcnt(0)
    v_exp_f32 v65, v65
    v_exp_f32 v66, v66
    v_mfma_f32_16x16x32_bf16 v[60:63], a[208:211], a[8:11], v[60:63]
    v_exp_f32 v67, v67
    v_cvt_pk_bf16_f32 v34, v64, v65
    v_cvt_pk_bf16_f32 v35, v66, v67
    v_mfma_f32_16x16x32_bf16 v[60:63], a[212:215], a[12:15], v[60:63]
    v_exp_f32 v68, v68
    v_mfma_f32_16x16x32_bf16 v[64:67], a[200:203], a[16:19], 0
    v_exp_f32 v69, v69
    v_mfma_f32_16x16x32_bf16 v[64:67], a[204:207], a[20:23], v[64:67]
    v_exp_f32 v70, v70
    v_exp_f32 v71, v71
    v_mfma_f32_16x16x32_bf16 v[64:67], a[208:211], a[24:27], v[64:67]
    v_cvt_pk_bf16_f32 v38, v68, v69
    v_cvt_pk_bf16_f32 v39, v70, v71
    v_mfma_f32_16x16x32_bf16 v[64:67], a[212:215], a[28:31], v[64:67]
    v_exp_f32 v72, v72
    v_mfma_f32_16x16x32_bf16 v[68:71], a[200:203], a[32:35], 0
    v_exp_f32 v73, v73
    v_mfma_f32_16x16x32_bf16 v[68:71], a[204:207], a[36:39], v[68:71]
    v_exp_f32 v74, v74
    v_exp_f32 v75, v75
    v_mfma_f32_16x16x32_bf16 v[68:71], a[208:211], a[40:43], v[68:71]
    v_cvt_pk_bf16_f32 v42, v72, v73
    v_cvt_pk_bf16_f32 v43, v74, v75
    v_mfma_f32_16x16x32_bf16 v[68:71], a[212:215], a[44:47], v[68:71]
    s_waitcnt vmcnt(3) lgkmcnt(0)
    s_barrier
    ds_read_b64_tr_b16 a[184:185], v19 offset:32768
    ds_read_b64_tr_b16 a[186:187], v19 offset:34816
    v_mfma_f32_16x16x32_bf16 v[72:75], a[200:203], a[48:51], 0
    buffer_load_dwordx4 v6, s[28:31], s53 offen offset:1024 nt lds
    v_mfma_f32_16x16x32_bf16 v[72:75], a[204:207], a[52:55], v[72:75]
    s_and_b32 s57, s57, 0x1ffff
    s_sub_u32 s88, 8192, s88
    v_mfma_f32_16x16x32_bf16 v[72:75], a[208:211], a[56:59], v[72:75]
    ds_read_b64_tr_b16 a[188:189], v20 offset:32768
    v_mfma_f32_16x16x32_bf16 v[72:75], a[212:215], a[60:63], v[72:75]
    ds_read_b64_tr_b16 a[190:191], v20 offset:34816
    v_mfma_f32_16x16x32_bf16 a[160:163], a[180:183], v[28:31], a[160:163]
    v_exp_f32 v80, v80
    v_mfma_f32_16x16x32_bf16 a[164:167], a[180:183], v[32:35], a[164:167]
    v_exp_f32 v81, v81
    v_exp_f32 v82, v82
    v_mfma_f32_16x16x32_bf16 a[168:171], a[180:183], v[36:39], a[168:171]
    buffer_load_dwordx4 v7, s[28:31], s53 offen offset:2048 nt lds
    v_mfma_f32_16x16x32_bf16 a[172:175], a[180:183], v[40:43], a[172:175]
    s_add_u32 s94, s94, 16384
    s_and_b32 s94, s94, 0x1ffff
    v_exp_f32 v83, v83
    v_cvt_pk_bf16_f32 v78, v80, v81
    v_cvt_pk_bf16_f32 v79, v82, v83
    s_nop 1
    v_mfma_f32_16x16x32_bf16 a[176:179], a[180:183], v[76:79], a[176:179]
    s_waitcnt lgkmcnt(0)
    ds_read_b64_tr_b16 a[192:193], v19 offset:33280
    v_mfma_f32_16x16x32_bf16 v[212:215], a[184:187], v[76:79], v[212:215]
    ds_read_b64_tr_b16 a[194:195], v19 offset:35328
    v_mfma_f32_16x16x32_bf16 v[180:183], a[184:187], v[40:43], v[180:183]
    ds_read_b64_tr_b16 a[196:197], v20 offset:33280
    v_mfma_f32_16x16x32_bf16 v[148:151], a[184:187], v[36:39], v[148:151]
    ds_read_b64_tr_b16 a[198:199], v20 offset:35328
    v_mfma_f32_16x16x32_bf16 v[116:119], a[184:187], v[32:35], v[116:119]
    ds_read_b64_tr_b16 a[200:201], v19 offset:36864
    v_mfma_f32_16x16x32_bf16 v[84:87], a[184:187], v[28:31], v[84:87]
    ds_read_b64_tr_b16 a[202:203], v19 offset:38912
    v_mfma_f32_16x16x32_bf16 v[88:91], a[188:191], v[28:31], v[88:91]
    buffer_load_dwordx4 v8, s[28:31], s53 offen offset:3072 nt lds
    v_mfma_f32_16x16x32_bf16 v[120:123], a[188:191], v[32:35], v[120:123]
    ds_read_b64_tr_b16 a[204:205], v20 offset:36864
    v_mfma_f32_16x16x32_bf16 v[152:155], a[188:191], v[36:39], v[152:155]
    ds_read_b64_tr_b16 a[206:207], v20 offset:38912
    v_mfma_f32_16x16x32_bf16 v[184:187], a[188:191], v[40:43], v[184:187]
    ds_read_b64_tr_b16 a[208:209], v19 offset:37376
    v_mfma_f32_16x16x32_bf16 v[216:219], a[188:191], v[76:79], v[216:219]
    s_waitcnt lgkmcnt(5)
    ds_read_b64_tr_b16 a[210:211], v19 offset:39424
    v_mfma_f32_16x16x32_bf16 v[220:223], a[192:195], v[76:79], v[220:223]
    ds_read_b64_tr_b16 a[212:213], v20 offset:37376
    v_mfma_f32_16x16x32_bf16 v[188:191], a[192:195], v[40:43], v[188:191]
    ds_read_b64_tr_b16 a[214:215], v20 offset:39424
    v_mfma_f32_16x16x32_bf16 v[156:159], a[192:195], v[36:39], v[156:159]
    s_cmp_gt_i32 s88, 0
    s_cselect_b64 s[28:29], s[16:17], s[12:13]
    s_add_u32 m0, s60, s94
    s_add_u32 s53, s58, s57
    v_mfma_f32_16x16x32_bf16 v[124:127], a[192:195], v[32:35], v[124:127]
    buffer_load_dwordx4 v5, s[28:31], s53 offen offset:0 nt lds
    v_mfma_f32_16x16x32_bf16 v[92:95], a[192:195], v[28:31], v[92:95]
    s_add_u32 s57, s57, s88
    v_mfma_f32_16x16x32_bf16 v[96:99], a[196:199], v[28:31], v[96:99]
    v_exp_f32 v44, v44
    v_mfma_f32_16x16x32_bf16 v[128:131], a[196:199], v[32:35], v[128:131]
    v_exp_f32 v45, v45
    v_mfma_f32_16x16x32_bf16 v[160:163], a[196:199], v[36:39], v[160:163]
    v_exp_f32 v46, v46
    v_mfma_f32_16x16x32_bf16 v[192:195], a[196:199], v[40:43], v[192:195]
    v_exp_f32 v47, v47
    v_mfma_f32_16x16x32_bf16 v[224:227], a[196:199], v[76:79], v[224:227]
    s_waitcnt lgkmcnt(0)
    v_cvt_pk_bf16_f32 v44, v44, v45
    v_cvt_pk_bf16_f32 v45, v46, v47
    v_mfma_f32_16x16x32_bf16 v[228:231], a[200:203], v[76:79], v[228:231]
    v_exp_f32 v48, v48
    v_mfma_f32_16x16x32_bf16 v[196:199], a[200:203], v[40:43], v[196:199]
    v_exp_f32 v49, v49
    v_mfma_f32_16x16x32_bf16 v[164:167], a[200:203], v[36:39], v[164:167]
    s_lshr_b32 s97, s97, 1
    s_cbranch_scc0 1
    s_waitcnt vmcnt(3)
    s_waitcnt vmcnt(4) lgkmcnt(0)
    s_barrier
    v_mfma_f32_16x16x32_bf16 v[132:135], a[200:203], v[32:35], v[132:135]
    buffer_load_dwordx4 v6, s[28:31], s53 offen offset:1024 nt lds
    v_mfma_f32_16x16x32_bf16 v[100:103], a[200:203], v[28:31], v[100:103]
    s_and_b32 s57, s57, 0x1ffff
    s_sub_u32 s88, 8192, s88
    v_mfma_f32_16x16x32_bf16 v[104:107], a[204:207], v[28:31], v[104:107]
    ds_read_b128 a[184:187], v18 offset:49152
    v_mfma_f32_16x16x32_bf16 v[136:139], a[204:207], v[32:35], v[136:139]
    ds_read_b128 a[188:191], v18 offset:49664
    v_mfma_f32_16x16x32_bf16 v[168:171], a[204:207], v[36:39], v[168:171]
    ds_read_b128 a[192:195], v18 offset:53248
    v_mfma_f32_16x16x32_bf16 v[200:203], a[204:207], v[40:43], v[200:203]
    ds_read_b128 a[196:199], v18 offset:53760
    v_mfma_f32_16x16x32_bf16 v[232:235], a[204:207], v[76:79], v[232:235]
    ds_read_b128 a[200:203], v18 offset:51200
    v_mfma_f32_16x16x32_bf16 v[236:239], a[208:211], v[76:79], v[236:239]
    ds_read_b128 a[204:207], v18 offset:51712
    v_mfma_f32_16x16x32_bf16 v[204:207], a[208:211], v[40:43], v[204:207]
    v_exp_f32 v50, v50
    v_mfma_f32_16x16x32_bf16 v[172:175], a[208:211], v[36:39], v[172:175]
    v_exp_f32 v51, v51
    v_mfma_f32_16x16x32_bf16 v[140:143], a[208:211], v[32:35], v[140:143]
    buffer_load_dwordx4 v7, s[28:31], s53 offen offset:2048 nt lds
    v_mfma_f32_16x16x32_bf16 v[108:111], a[208:211], v[28:31], v[108:111]
    s_add_u32 s94, s94, 16384
    s_and_b32 s94, s94, 0x1ffff
    v_mfma_f32_16x16x32_bf16 v[112:115], a[212:215], v[28:31], v[112:115]
    ds_read_b128 a[208:211], v18 offset:55296
    v_cvt_pk_bf16_f32 v48, v48, v49
    v_mfma_f32_16x16x32_bf16 v[144:147], a[212:215], v[32:35], v[144:147]
    v_cvt_pk_bf16_f32 v49, v50, v51
    v_mfma_f32_16x16x32_bf16 v[176:179], a[212:215], v[36:39], v[176:179]
    v_exp_f32 v52, v52
    v_mfma_f32_16x16x32_bf16 v[208:211], a[212:215], v[40:43], v[208:211]
    v_exp_f32 v53, v53
    v_mfma_f32_16x16x32_bf16 v[240:243], a[212:215], v[76:79], v[240:243]
    s_waitcnt lgkmcnt(1)
    ds_read_b128 a[212:215], v18 offset:55808
    v_mfma_f32_16x16x32_bf16 v[28:31], a[184:187], a[0:3], 0
    v_exp_f32 v54, v54
    v_mfma_f32_16x16x32_bf16 v[28:31], a[188:191], a[4:7], v[28:31]
    v_exp_f32 v55, v55
    v_mfma_f32_16x16x32_bf16 v[28:31], a[192:195], a[8:11], v[28:31]
    v_cvt_pk_bf16_f32 v52, v52, v53
    v_cvt_pk_bf16_f32 v53, v54, v55
    v_mfma_f32_16x16x32_bf16 v[28:31], a[196:199], a[12:15], v[28:31]
    v_exp_f32 v56, v56
    v_mfma_f32_16x16x32_bf16 v[32:35], a[184:187], a[16:19], 0
    v_exp_f32 v57, v57
    v_mfma_f32_16x16x32_bf16 v[32:35], a[188:191], a[20:23], v[32:35]
    buffer_load_dwordx4 v8, s[28:31], s53 offen offset:3072 nt lds
    v_mfma_f32_16x16x32_bf16 v[32:35], a[192:195], a[24:27], v[32:35]
    v_exp_f32 v58, v58
    v_mfma_f32_16x16x32_bf16 v[32:35], a[196:199], a[28:31], v[32:35]
    v_exp_f32 v59, v59
    v_mfma_f32_16x16x32_bf16 v[36:39], a[184:187], a[32:35], 0
    v_cvt_pk_bf16_f32 v56, v56, v57
    v_cvt_pk_bf16_f32 v57, v58, v59
    v_mfma_f32_16x16x32_bf16 v[36:39], a[188:191], a[36:39], v[36:39]
    v_exp_f32 v60, v60
    v_mfma_f32_16x16x32_bf16 v[36:39], a[192:195], a[40:43], v[36:39]
    v_exp_f32 v61, v61
    v_mfma_f32_16x16x32_bf16 v[36:39], a[196:199], a[44:47], v[36:39]
    v_exp_f32 v62, v62
    v_mfma_f32_16x16x32_bf16 v[40:43], a[184:187], a[48:51], 0
    v_exp_f32 v63, v63
    v_mfma_f32_16x16x32_bf16 v[40:43], a[188:191], a[52:55], v[40:43]
    v_cvt_pk_bf16_f32 v46, v60, v61
    v_cvt_pk_bf16_f32 v47, v62, v63
    v_mfma_f32_16x16x32_bf16 v[40:43], a[192:195], a[56:59], v[40:43]
    v_exp_f32 v64, v64
    v_mfma_f32_16x16x32_bf16 v[40:43], a[196:199], a[60:63], v[40:43]
    v_exp_f32 v65, v65
    v_mfma_f32_16x16x32_bf16 v[76:79], a[184:187], a[64:67], 0
    v_exp_f32 v66, v66
    v_mfma_f32_16x16x32_bf16 v[76:79], a[188:191], a[68:71], v[76:79]
    v_exp_f32 v67, v67
    v_mfma_f32_16x16x32_bf16 v[76:79], a[192:195], a[72:75], v[76:79]
    v_cvt_pk_bf16_f32 v50, v64, v65
    v_cvt_pk_bf16_f32 v51, v66, v67
    v_mfma_f32_16x16x32_bf16 v[76:79], a[196:199], a[76:79], v[76:79]
    s_waitcnt vmcnt(3) lgkmcnt(0)
    s_barrier
    v_xor_b32 v19, 0x10000, v19
    v_xor_b32 v20, 0x10000, v20
    v_xor_b32 v18, 0x10000, v18
    s_cmp_gt_i32 s88, 0
    s_cselect_b64 s[28:29], s[16:17], s[12:13]
    v_mfma_f32_16x16x32_bf16 v[60:63], a[200:203], a[0:3], 0
    s_add_u32 m0, s60, s94
    s_add_u32 s53, s58, s57
    v_mfma_f32_16x16x32_bf16 v[60:63], a[204:207], a[4:7], v[60:63]
    buffer_load_dwordx4 v5, s[28:31], s53 offen offset:0 nt lds
    v_mfma_f32_16x16x32_bf16 v[60:63], a[208:211], a[8:11], v[60:63]
    s_add_u32 s57, s57, s88
    ds_read_b64_tr_b16 a[184:185], v19 offset:0
    v_mfma_f32_16x16x32_bf16 v[60:63], a[212:215], a[12:15], v[60:63]
    v_exp_f32 v68, v68
    v_mfma_f32_16x16x32_bf16 v[64:67], a[200:203], a[16:19], 0
    v_exp_f32 v69, v69
    v_mfma_f32_16x16x32_bf16 v[64:67], a[204:207], a[20:23], v[64:67]
    v_exp_f32 v70, v70
    v_exp_f32 v71, v71
    v_mfma_f32_16x16x32_bf16 v[64:67], a[208:211], a[24:27], v[64:67]
    v_cvt_pk_bf16_f32 v54, v68, v69
    v_cvt_pk_bf16_f32 v55, v70, v71
    v_mfma_f32_16x16x32_bf16 v[64:67], a[212:215], a[28:31], v[64:67]
    v_exp_f32 v72, v72
    v_mfma_f32_16x16x32_bf16 v[68:71], a[200:203], a[32:35], 0
    buffer_load_dwordx4 v6, s[28:31], s53 offen offset:1024 nt lds
    v_mfma_f32_16x16x32_bf16 v[68:71], a[204:207], a[36:39], v[68:71]
    s_and_b32 s57, s57, 0x1ffff
    s_sub_u32 s88, 8192, s88
    v_exp_f32 v73, v73
    v_mfma_f32_16x16x32_bf16 v[68:71], a[208:211], a[40:43], v[68:71]
    v_exp_f32 v74, v74
    v_exp_f32 v75, v75
    v_mfma_f32_16x16x32_bf16 v[68:71], a[212:215], a[44:47], v[68:71]
    v_cvt_pk_bf16_f32 v58, v72, v73
    v_cvt_pk_bf16_f32 v59, v74, v75
    v_mfma_f32_16x16x32_bf16 v[72:75], a[200:203], a[48:51], 0
    ds_read_b64_tr_b16 a[186:187], v19 offset:2048
    v_mfma_f32_16x16x32_bf16 v[72:75], a[204:207], a[52:55], v[72:75]
    ds_read_b64_tr_b16 a[188:189], v20 offset:0
    v_mfma_f32_16x16x32_bf16 v[72:75], a[208:211], a[56:59], v[72:75]
    ds_read_b64_tr_b16 a[190:191], v20 offset:2048
    v_mfma_f32_16x16x32_bf16 v[72:75], a[212:215], a[60:63], v[72:75]
    ds_read_b64_tr_b16 a[192:193], v19 offset:512
    v_mfma_f32_16x16x32_bf16 v[80:83], a[200:203], a[64:67], 0
    ds_read_b64_tr_b16 a[194:195], v19 offset:2560
    v_mfma_f32_16x16x32_bf16 v[80:83], a[204:207], a[68:71], v[80:83]
    ds_read_b64_tr_b16 a[196:197], v20 offset:512
    v_mfma_f32_16x16x32_bf16 v[80:83], a[208:211], a[72:75], v[80:83]
    buffer_load_dwordx4 v7, s[28:31], s53 offen offset:2048 nt lds
    v_mfma_f32_16x16x32_bf16 v[80:83], a[212:215], a[76:79], v[80:83]
    s_add_u32 s94, s94, 16384
    s_and_b32 s94, s94, 0x1ffff
    v_mfma_f32_16x16x32_bf16 a[160:163], a[180:183], v[44:47], a[160:163]
    ds_read_b64_tr_b16 a[198:199], v20 offset:2560
    v_mfma_f32_16x16x32_bf16 a[164:167], a[180:183], v[48:51], a[164:167]
    ds_read_b64_tr_b16 a[200:201], v19 offset:4096
    v_mfma_f32_16x16x32_bf16 a[168:171], a[180:183], v[52:55], a[168:171]
    ds_read_b64_tr_b16 a[202:203], v19 offset:6144
    v_mfma_f32_16x16x32_bf16 a[172:175], a[180:183], v[56:59], a[172:175]
    s_waitcnt lgkmcnt(3)
    ds_read_b64_tr_b16 a[204:205], v20 offset:4096
    v_mfma_f32_16x16x32_bf16 v[180:183], a[184:187], v[56:59], v[180:183]
    ds_read_b64_tr_b16 a[206:207], v20 offset:6144
    v_mfma_f32_16x16x32_bf16 v[148:151], a[184:187], v[52:55], v[148:151]
    ds_read_b64_tr_b16 a[208:209], v19 offset:4608
    v_mfma_f32_16x16x32_bf16 v[116:119], a[184:187], v[48:51], v[116:119]
    ds_read_b64_tr_b16 a[210:211], v19 offset:6656
    v_mfma_f32_16x16x32_bf16 v[84:87], a[184:187], v[44:47], v[84:87]
    buffer_load_dwordx4 v8, s[28:31], s53 offen offset:3072 nt lds
    v_mfma_f32_16x16x32_bf16 v[88:91], a[188:191], v[44:47], v[88:91]
    ds_read_b64_tr_b16 a[212:213], v20 offset:4608
    v_mfma_f32_16x16x32_bf16 v[120:123], a[188:191], v[48:51], v[120:123]
    ds_read_b64_tr_b16 a[214:215], v20 offset:6656
    v_mfma_f32_16x16x32_bf16 v[152:155], a[188:191], v[52:55], v[152:155]
    v_exp_f32 v28, v28
    v_mfma_f32_16x16x32_bf16 v[184:187], a[188:191], v[56:59], v[184:187]
    v_exp_f32 v29, v29
    v_mfma_f32_16x16x32_bf16 v[188:191], a[192:195], v[56:59], v[188:191]
    v_exp_f32 v30, v30
    v_mfma_f32_16x16x32_bf16 v[156:159], a[192:195], v[52:55], v[156:159]
    v_exp_f32 v31, v31
    v_mfma_f32_16x16x32_bf16 v[124:127], a[192:195], v[48:51], v[124:127]
    v_cvt_pk_bf16_f32 v28, v28, v29
    v_cvt_pk_bf16_f32 v29, v30, v31
    v_mfma_f32_16x16x32_bf16 v[92:95], a[192:195], v[44:47], v[92:95]
    s_waitcnt lgkmcnt(0)
    v_exp_f32 v32, v32
    v_mfma_f32_16x16x32_bf16 v[96:99], a[196:199], v[44:47], v[96:99]
    v_exp_f32 v33, v33
    v_mfma_f32_16x16x32_bf16 v[128:131], a[196:199], v[48:51], v[128:131]
    v_exp_f32 v34, v34
    v_mfma_f32_16x16x32_bf16 v[160:163], a[196:199], v[52:55], v[160:163]
    v_exp_f32 v35, v35
    v_mfma_f32_16x16x32_bf16 v[192:195], a[196:199], v[56:59], v[192:195]
    s_sub_u32 s92, s92, 1
    s_cbranch_scc0 gqa_kernel_aloop_0
    s_lshr_b32 s97, s97, 1
    s_cbranch_scc0 1
    s_waitcnt vmcnt(3)
    s_waitcnt vmcnt(4) lgkmcnt(0)
    s_barrier
    s_cmp_gt_i32 s88, 0
    s_cselect_b64 s[28:29], s[16:17], s[12:13]
    v_mfma_f32_16x16x32_bf16 v[196:199], a[200:203], v[56:59], v[196:199]
    s_add_u32 m0, s60, s94
    s_add_u32 s53, s58, s57
    v_mfma_f32_16x16x32_bf16 v[164:167], a[200:203], v[52:55], v[164:167]
    buffer_load_dwordx4 v5, s[28:31], s53 offen offset:0 nt lds
    v_mfma_f32_16x16x32_bf16 v[132:135], a[200:203], v[48:51], v[132:135]
    s_add_u32 s57, s57, s88
    ds_read_b128 a[184:187], v18 offset:16384
    v_mfma_f32_16x16x32_bf16 v[100:103], a[200:203], v[44:47], v[100:103]
    ds_read_b128 a[188:191], v18 offset:16896
    v_cvt_pk_bf16_f32 v32, v32, v33
    v_mfma_f32_16x16x32_bf16 v[104:107], a[204:207], v[44:47], v[104:107]
    ds_read_b128 a[192:195], v18 offset:20480
    v_cvt_pk_bf16_f32 v33, v34, v35
    v_mfma_f32_16x16x32_bf16 v[136:139], a[204:207], v[48:51], v[136:139]
    ds_read_b128 a[196:199], v18 offset:20992
    v_mfma_f32_16x16x32_bf16 v[168:171], a[204:207], v[52:55], v[168:171]
    ds_read_b128 a[200:203], v18 offset:18432
    v_mfma_f32_16x16x32_bf16 v[200:203], a[204:207], v[56:59], v[200:203]
    ds_read_b128 a[204:207], v18 offset:18944
    v_mfma_f32_16x16x32_bf16 v[204:207], a[208:211], v[56:59], v[204:207]
    v_exp_f32 v36, v36
    v_mfma_f32_16x16x32_bf16 v[172:175], a[208:211], v[52:55], v[172:175]
    v_exp_f32 v37, v37
    v_mfma_f32_16x16x32_bf16 v[140:143], a[208:211], v[48:51], v[140:143]
    v_exp_f32 v38, v38
    v_mfma_f32_16x16x32_bf16 v[108:111], a[208:211], v[44:47], v[108:111]
    ds_read_b128 a[208:211], v18 offset:22528
    v_mfma_f32_16x16x32_bf16 v[112:115], a[212:215], v[44:47], v[112:115]
    v_exp_f32 v39, v39
    v_mfma_f32_16x16x32_bf16 v[144:147], a[212:215], v[48:51], v[144:147]
    buffer_load_dwordx4 v6, s[28:31], s53 offen offset:1024 nt lds
    v_mfma_f32_16x16x32_bf16 v[176:179], a[212:215], v[52:55], v[176:179]
    s_and_b32 s57, s57, 0x1ffff
    s_sub_u32 s88, 8192, s88
    v_mfma_f32_16x16x32_bf16 v[208:211], a[212:215], v[56:59], v[208:211]
    s_waitcnt lgkmcnt(1)
    ds_read_b128 a[212:215], v18 offset:23040
    v_cvt_pk_bf16_f32 v36, v36, v37
    v_mfma_f32_16x16x32_bf16 v[44:47], a[184:187], a[0:3], 0
    v_cvt_pk_bf16_f32 v37, v38, v39
    v_mfma_f32_16x16x32_bf16 v[44:47], a[188:191], a[4:7], v[44:47]
    v_exp_f32 v40, v40
    v_mfma_f32_16x16x32_bf16 v[44:47], a[192:195], a[8:11], v[44:47]
    v_exp_f32 v41, v41
    v_mfma_f32_16x16x32_bf16 v[44:47], a[196:199], a[12:15], v[44:47]
    v_exp_f32 v42, v42
    v_mfma_f32_16x16x32_bf16 v[48:51], a[184:187], a[16:19], 0
    v_exp_f32 v43, v43
    v_mfma_f32_16x16x32_bf16 v[48:51], a[188:191], a[20:23], v[48:51]
    v_cvt_pk_bf16_f32 v40, v40, v41
    v_cvt_pk_bf16_f32 v41, v42, v43
    v_mfma_f32_16x16x32_bf16 v[48:51], a[192:195], a[24:27], v[48:51]
    v_exp_f32 v76, v76
    v_mfma_f32_16x16x32_bf16 v[48:51], a[196:199], a[28:31], v[48:51]
    v_exp_f32 v77, v77
    v_mfma_f32_16x16x32_bf16 v[52:55], a[184:187], a[32:35], 0
    v_exp_f32 v78, v78
    v_mfma_f32_16x16x32_bf16 v[52:55], a[188:191], a[36:39], v[52:55]
    v_exp_f32 v79, v79
    v_mfma_f32_16x16x32_bf16 v[52:55], a[192:195], a[40:43], v[52:55]
    v_cvt_pk_bf16_f32 v76, v76, v77
    v_cvt_pk_bf16_f32 v77, v78, v79
    v_mfma_f32_16x16x32_bf16 v[52:55], a[196:199], a[44:47], v[52:55]
    buffer_load_dwordx4 v7, s[28:31], s53 offen offset:2048 nt lds
    v_mfma_f32_16x16x32_bf16 v[56:59], a[184:187], a[48:51], 0
    s_add_u32 s94, s94, 16384
    s_and_b32 s94, s94, 0x1ffff
    v_mfma_f32_16x16x32_bf16 v[56:59], a[188:191], a[52:55], v[56:59]
    v_exp_f32 v60, v60
    v_exp_f32 v61, v61
    v_mfma_f32_16x16x32_bf16 v[56:59], a[192:195], a[56:59], v[56:59]
    v_exp_f32 v62, v62
    v_exp_f32 v63, v63
    v_mfma_f32_16x16x32_bf16 v[56:59], a[196:199], a[60:63], v[56:59]
    v_cvt_pk_bf16_f32 v30, v60, v61
    v_cvt_pk_bf16_f32 v31, v62, v63
    v_mfma_f32_16x16x32_bf16 v[60:63], a[200:203], a[0:3], 0
    v_exp_f32 v64, v64
    v_mfma_f32_16x16x32_bf16 v[60:63], a[204:207], a[4:7], v[60:63]
    s_waitcnt lgkmcnt(0)
    v_exp_f32 v65, v65
    v_exp_f32 v66, v66
    v_mfma_f32_16x16x32_bf16 v[60:63], a[208:211], a[8:11], v[60:63]
    v_exp_f32 v67, v67
    v_cvt_pk_bf16_f32 v34, v64, v65
    v_cvt_pk_bf16_f32 v35, v66, v67
    v_mfma_f32_16x16x32_bf16 v[60:63], a[212:215], a[12:15], v[60:63]
    v_exp_f32 v68, v68
    v_mfma_f32_16x16x32_bf16 v[64:67], a[200:203], a[16:19], 0
    v_exp_f32 v69, v69
    v_mfma_f32_16x16x32_bf16 v[64:67], a[204:207], a[20:23], v[64:67]
    v_exp_f32 v70, v70
    v_exp_f32 v71, v71
    v_mfma_f32_16x16x32_bf16 v[64:67], a[208:211], a[24:27], v[64:67]
    v_cvt_pk_bf16_f32 v38, v68, v69
    v_cvt_pk_bf16_f32 v39, v70, v71
    v_mfma_f32_16x16x32_bf16 v[64:67], a[212:215], a[28:31], v[64:67]
    v_exp_f32 v72, v72
    v_mfma_f32_16x16x32_bf16 v[68:71], a[200:203], a[32:35], 0
    v_exp_f32 v73, v73
    v_mfma_f32_16x16x32_bf16 v[68:71], a[204:207], a[36:39], v[68:71]
    v_exp_f32 v74, v74
    v_exp_f32 v75, v75
    v_mfma_f32_16x16x32_bf16 v[68:71], a[208:211], a[40:43], v[68:71]
    v_cvt_pk_bf16_f32 v42, v72, v73
    v_cvt_pk_bf16_f32 v43, v74, v75
    v_mfma_f32_16x16x32_bf16 v[68:71], a[212:215], a[44:47], v[68:71]
    s_cbranch_vccz gqa_kernel_ool22
gqa_kernel_ret22_0:
    s_waitcnt vmcnt(3) lgkmcnt(0)
    s_barrier
    ds_read_b64_tr_b16 a[184:185], v19 offset:32768
    ds_read_b64_tr_b16 a[186:187], v19 offset:34816
    v_mfma_f32_16x16x32_bf16 v[72:75], a[200:203], a[48:51], 0
    buffer_load_dwordx4 v8, s[28:31], s53 offen offset:3072 nt lds
    v_mfma_f32_16x16x32_bf16 v[72:75], a[204:207], a[52:55], v[72:75]
    ds_read_b64_tr_b16 a[188:189], v20 offset:32768
    v_mfma_f32_16x16x32_bf16 v[72:75], a[208:211], a[56:59], v[72:75]
    ds_read_b64_tr_b16 a[190:191], v20 offset:34816
    v_mfma_f32_16x16x32_bf16 v[72:75], a[212:215], a[60:63], v[72:75]
    v_exp_f32 v80, v80
    v_mfma_f32_16x16x32_bf16 a[160:163], a[180:183], v[28:31], a[160:163]
    v_exp_f32 v81, v81
    v_mfma_f32_16x16x32_bf16 a[164:167], a[180:183], v[32:35], a[164:167]
    v_exp_f32 v82, v82
    v_exp_f32 v83, v83
    v_mfma_f32_16x16x32_bf16 a[168:171], a[180:183], v[36:39], a[168:171]
    s_cmp_gt_i32 s88, 0
    s_cselect_b64 s[28:29], s[16:17], s[12:13]
    s_add_u32 m0, s60, s94
    s_add_u32 s53, s58, s57
    v_mfma_f32_16x16x32_bf16 a[172:175], a[180:183], v[40:43], a[172:175]
    buffer_load_dwordx4 v5, s[28:31], s53 offen offset:0 nt lds
    v_cvt_pk_bf16_f32 v78, v80, v81
    v_cvt_pk_bf16_f32 v79, v82, v83
    s_nop 1
    v_mfma_f32_16x16x32_bf16 a[176:179], a[180:183], v[76:79], a[176:179]
    s_add_u32 s57, s57, s88
    ds_read_b64_tr_b16 a[192:193], v19 offset:33280
    s_waitcnt lgkmcnt(1)
    v_mfma_f32_16x16x32_bf16 v[212:215], a[184:187], v[76:79], v[212:215]
    ds_read_b64_tr_b16 a[194:195], v19 offset:35328
    v_mfma_f32_16x16x32_bf16 v[180:183], a[184:187], v[40:43], v[180:183]
    ds_read_b64_tr_b16 a[196:197], v20 offset:33280
    v_mfma_f32_16x16x32_bf16 v[148:151], a[184:187], v[36:39], v[148:151]
    ds_read_b64_tr_b16 a[198:199], v20 offset:35328
    v_mfma_f32_16x16x32_bf16 v[116:119], a[184:187], v[32:35], v[116:119]
    ds_read_b64_tr_b16 a[200:201], v19 offset:36864
    v_mfma_f32_16x16x32_bf16 v[84:87], a[184:187], v[28:31], v[84:87]
    ds_read_b64_tr_b16 a[202:203], v19 offset:38912
    v_mfma_f32_16x16x32_bf16 v[88:91], a[188:191], v[28:31], v[88:91]
    buffer_load_dwordx4 v6, s[28:31], s53 offen offset:1024 nt lds
    v_mfma_f32_16x16x32_bf16 v[120:123], a[188:191], v[32:35], v[120:123]
    s_and_b32 s57, s57, 0x1ffff
    s_sub_u32 s88, 8192, s88
    v_mfma_f32_16x16x32_bf16 v[152:155], a[188:191], v[36:39], v[152:155]
    ds_read_b64_tr_b16 a[204:205], v20 offset:36864
    v_mfma_f32_16x16x32_bf16 v[184:187], a[188:191], v[40:43], v[184:187]
    ds_read_b64_tr_b16 a[206:207], v20 offset:38912
    v_mfma_f32_16x16x32_bf16 v[216:219], a[188:191], v[76:79], v[216:219]
    s_waitcnt lgkmcnt(3)
    ds_read_b64_tr_b16 a[208:209], v19 offset:37376
    v_mfma_f32_16x16x32_bf16 v[220:223], a[192:195], v[76:79], v[220:223]
    ds_read_b64_tr_b16 a[210:211], v19 offset:39424
    v_mfma_f32_16x16x32_bf16 v[188:191], a[192:195], v[40:43], v[188:191]
    ds_read_b64_tr_b16 a[212:213], v20 offset:37376
    v_mfma_f32_16x16x32_bf16 v[156:159], a[192:195], v[36:39], v[156:159]
    buffer_load_dwordx4 v7, s[28:31], s53 offen offset:2048 nt lds
    v_mfma_f32_16x16x32_bf16 v[124:127], a[192:195], v[32:35], v[124:127]
    s_add_u32 s94, s94, 16384
    s_and_b32 s94, s94, 0x1ffff
    v_mfma_f32_16x16x32_bf16 v[92:95], a[192:195], v[28:31], v[92:95]
    ds_read_b64_tr_b16 a[214:215], v20 offset:39424
    v_mfma_f32_16x16x32_bf16 v[96:99], a[196:199], v[28:31], v[96:99]
    v_exp_f32 v44, v44
    v_mfma_f32_16x16x32_bf16 v[128:131], a[196:199], v[32:35], v[128:131]
    v_exp_f32 v45, v45
    v_mfma_f32_16x16x32_bf16 v[160:163], a[196:199], v[36:39], v[160:163]
    v_exp_f32 v46, v46
    v_mfma_f32_16x16x32_bf16 v[192:195], a[196:199], v[40:43], v[192:195]
    v_exp_f32 v47, v47
    v_mfma_f32_16x16x32_bf16 v[224:227], a[196:199], v[76:79], v[224:227]
    s_waitcnt lgkmcnt(1)
    v_cvt_pk_bf16_f32 v44, v44, v45
    v_cvt_pk_bf16_f32 v45, v46, v47
    v_mfma_f32_16x16x32_bf16 v[228:231], a[200:203], v[76:79], v[228:231]
    v_exp_f32 v48, v48
    v_mfma_f32_16x16x32_bf16 v[196:199], a[200:203], v[40:43], v[196:199]
    v_exp_f32 v49, v49
    v_mfma_f32_16x16x32_bf16 v[164:167], a[200:203], v[36:39], v[164:167]
    s_lshr_b32 s97, s97, 1
    s_cbranch_scc0 1
    s_waitcnt vmcnt(3)
    s_waitcnt vmcnt(4) lgkmcnt(0)
    s_barrier
    v_mfma_f32_16x16x32_bf16 v[132:135], a[200:203], v[32:35], v[132:135]
    buffer_load_dwordx4 v8, s[28:31], s53 offen offset:3072 nt lds
    v_mfma_f32_16x16x32_bf16 v[100:103], a[200:203], v[28:31], v[100:103]
    ds_read_b128 a[184:187], v18 offset:49152
    v_mfma_f32_16x16x32_bf16 v[104:107], a[204:207], v[28:31], v[104:107]
    ds_read_b128 a[188:191], v18 offset:49664
    v_mfma_f32_16x16x32_bf16 v[136:139], a[204:207], v[32:35], v[136:139]
    ds_read_b128 a[192:195], v18 offset:53248
    v_mfma_f32_16x16x32_bf16 v[168:171], a[204:207], v[36:39], v[168:171]
    ds_read_b128 a[196:199], v18 offset:53760
    v_mfma_f32_16x16x32_bf16 v[200:203], a[204:207], v[40:43], v[200:203]
    ds_read_b128 a[200:203], v18 offset:51200
    v_mfma_f32_16x16x32_bf16 v[232:235], a[204:207], v[76:79], v[232:235]
    ds_read_b128 a[204:207], v18 offset:51712
    v_mfma_f32_16x16x32_bf16 v[236:239], a[208:211], v[76:79], v[236:239]
    v_exp_f32 v50, v50
    v_mfma_f32_16x16x32_bf16 v[204:207], a[208:211], v[40:43], v[204:207]
    v_exp_f32 v51, v51
    v_mfma_f32_16x16x32_bf16 v[172:175], a[208:211], v[36:39], v[172:175]
    v_cvt_pk_bf16_f32 v48, v48, v49
    v_cvt_pk_bf16_f32 v49, v50, v51
    v_mfma_f32_16x16x32_bf16 v[140:143], a[208:211], v[32:35], v[140:143]
    s_cmp_gt_i32 s88, 0
    s_cselect_b64 s[28:29], s[16:17], s[12:13]
    s_add_u32 m0, s60, s94
    s_add_u32 s53, s58, s57
    v_mfma_f32_16x16x32_bf16 v[108:111], a[208:211], v[28:31], v[108:111]
    buffer_load_dwordx4 v5, s[28:31], s53 offen offset:0 nt lds
    v_mfma_f32_16x16x32_bf16 v[112:115], a[212:215], v[28:31], v[112:115]
    s_add_u32 s57, s57, s88
    ds_read_b128 a[208:211], v18 offset:55296
    v_mfma_f32_16x16x32_bf16 v[144:147], a[212:215], v[32:35], v[144:147]
    v_exp_f32 v52, v52
    v_mfma_f32_16x16x32_bf16 v[176:179], a[212:215], v[36:39], v[176:179]
    v_exp_f32 v53, v53
    v_mfma_f32_16x16x32_bf16 v[208:211], a[212:215], v[40:43], v[208:211]
    v_exp_f32 v54, v54
    v_mfma_f32_16x16x32_bf16 v[240:243], a[212:215], v[76:79], v[240:243]
    s_waitcnt lgkmcnt(1)
    ds_read_b128 a[212:215], v18 offset:55808
    v_mfma_f32_16x16x32_bf16 v[28:31], a[184:187], a[0:3], 0
    v_exp_f32 v55, v55
    v_mfma_f32_16x16x32_bf16 v[28:31], a[188:191], a[4:7], v[28:31]
    v_cvt_pk_bf16_f32 v52, v52, v53
    v_cvt_pk_bf16_f32 v53, v54, v55
    v_mfma_f32_16x16x32_bf16 v[28:31], a[192:195], a[8:11], v[28:31]
    v_exp_f32 v56, v56
    v_mfma_f32_16x16x32_bf16 v[28:31], a[196:199], a[12:15], v[28:31]
    v_exp_f32 v57, v57
    v_mfma_f32_16x16x32_bf16 v[32:35], a[184:187], a[16:19], 0
    v_exp_f32 v58, v58
    v_mfma_f32_16x16x32_bf16 v[32:35], a[188:191], a[20:23], v[32:35]
    buffer_load_dwordx4 v6, s[28:31], s53 offen offset:1024 nt lds
    v_mfma_f32_16x16x32_bf16 v[32:35], a[192:195], a[24:27], v[32:35]
    s_and_b32 s57, s57, 0x1ffff
    s_sub_u32 s88, 8192, s88
    v_mfma_f32_16x16x32_bf16 v[32:35], a[196:199], a[28:31], v[32:35]
    v_exp_f32 v59, v59
    v_mfma_f32_16x16x32_bf16 v[36:39], a[184:187], a[32:35], 0
    v_cvt_pk_bf16_f32 v56, v56, v57
    v_cvt_pk_bf16_f32 v57, v58, v59
    v_mfma_f32_16x16x32_bf16 v[36:39], a[188:191], a[36:39], v[36:39]
    v_exp_f32 v60, v60
    v_mfma_f32_16x16x32_bf16 v[36:39], a[192:195], a[40:43], v[36:39]
    v_exp_f32 v61, v61
    v_mfma_f32_16x16x32_bf16 v[36:39], a[196:199], a[44:47], v[36:39]
    v_exp_f32 v62, v62
    v_mfma_f32_16x16x32_bf16 v[40:43], a[184:187], a[48:51], 0
    v_exp_f32 v63, v63
    v_mfma_f32_16x16x32_bf16 v[40:43], a[188:191], a[52:55], v[40:43]
    v_cvt_pk_bf16_f32 v46, v60, v61
    v_cvt_pk_bf16_f32 v47, v62, v63
    v_mfma_f32_16x16x32_bf16 v[40:43], a[192:195], a[56:59], v[40:43]
    v_exp_f32 v64, v64
    v_mfma_f32_16x16x32_bf16 v[40:43], a[196:199], a[60:63], v[40:43]
    v_exp_f32 v65, v65
    v_mfma_f32_16x16x32_bf16 v[76:79], a[184:187], a[64:67], 0
    v_exp_f32 v66, v66
    v_mfma_f32_16x16x32_bf16 v[76:79], a[188:191], a[68:71], v[76:79]
    v_exp_f32 v67, v67
    v_mfma_f32_16x16x32_bf16 v[76:79], a[192:195], a[72:75], v[76:79]
    v_cvt_pk_bf16_f32 v50, v64, v65
    v_cvt_pk_bf16_f32 v51, v66, v67
    v_mfma_f32_16x16x32_bf16 v[76:79], a[196:199], a[76:79], v[76:79]
    s_cbranch_vccz gqa_kernel_ool24
gqa_kernel_ret24_0:
    s_waitcnt vmcnt(3) lgkmcnt(0)
    s_barrier
    v_xor_b32 v19, 0x10000, v19
    v_xor_b32 v20, 0x10000, v20
    v_xor_b32 v18, 0x10000, v18
    v_mfma_f32_16x16x32_bf16 v[60:63], a[200:203], a[0:3], 0
    buffer_load_dwordx4 v7, s[28:31], s53 offen offset:2048 nt lds
    v_mfma_f32_16x16x32_bf16 v[60:63], a[204:207], a[4:7], v[60:63]
    s_add_u32 s94, s94, 16384
    s_and_b32 s94, s94, 0x1ffff
    v_mfma_f32_16x16x32_bf16 v[60:63], a[208:211], a[8:11], v[60:63]
    v_exp_f32 v68, v68
    v_mfma_f32_16x16x32_bf16 v[60:63], a[212:215], a[12:15], v[60:63]
    v_exp_f32 v69, v69
    v_mfma_f32_16x16x32_bf16 v[64:67], a[200:203], a[16:19], 0
    v_exp_f32 v70, v70
    v_mfma_f32_16x16x32_bf16 v[64:67], a[204:207], a[20:23], v[64:67]
    v_exp_f32 v71, v71
    v_cvt_pk_bf16_f32 v54, v68, v69
    v_cvt_pk_bf16_f32 v55, v70, v71
    v_mfma_f32_16x16x32_bf16 v[64:67], a[208:211], a[24:27], v[64:67]
    v_exp_f32 v72, v72
    v_mfma_f32_16x16x32_bf16 v[64:67], a[212:215], a[28:31], v[64:67]
    v_exp_f32 v73, v73
    v_mfma_f32_16x16x32_bf16 v[68:71], a[200:203], a[32:35], 0
    buffer_load_dwordx4 v8, s[28:31], s53 offen offset:3072 nt lds
    v_mfma_f32_16x16x32_bf16 v[68:71], a[204:207], a[36:39], v[68:71]
    v_exp_f32 v74, v74
    v_exp_f32 v75, v75
    v_mfma_f32_16x16x32_bf16 v[68:71], a[208:211], a[40:43], v[68:71]
    v_cvt_pk_bf16_f32 v58, v72, v73
    v_cvt_pk_bf16_f32 v59, v74, v75
    v_mfma_f32_16x16x32_bf16 v[68:71], a[212:215], a[44:47], v[68:71]
    ds_read_b64_tr_b16 a[184:185], v19 offset:0
    v_mfma_f32_16x16x32_bf16 v[72:75], a[200:203], a[48:51], 0
    ds_read_b64_tr_b16 a[186:187], v19 offset:2048
    v_mfma_f32_16x16x32_bf16 v[72:75], a[204:207], a[52:55], v[72:75]
    ds_read_b64_tr_b16 a[188:189], v20 offset:0
    v_mfma_f32_16x16x32_bf16 v[72:75], a[208:211], a[56:59], v[72:75]
    ds_read_b64_tr_b16 a[190:191], v20 offset:2048
    v_mfma_f32_16x16x32_bf16 v[72:75], a[212:215], a[60:63], v[72:75]
    ds_read_b64_tr_b16 a[192:193], v19 offset:512
    v_mfma_f32_16x16x32_bf16 v[80:83], a[200:203], a[64:67], 0
    ds_read_b64_tr_b16 a[194:195], v19 offset:2560
    v_mfma_f32_16x16x32_bf16 v[80:83], a[204:207], a[68:71], v[80:83]
    ds_read_b64_tr_b16 a[196:197], v20 offset:512
    v_mfma_f32_16x16x32_bf16 v[80:83], a[208:211], a[72:75], v[80:83]
    s_cmp_gt_i32 s88, 0
    s_cselect_b64 s[28:29], s[16:17], s[12:13]
    s_add_u32 m0, s60, s94
    s_add_u32 s53, s58, s57
    v_mfma_f32_16x16x32_bf16 v[80:83], a[212:215], a[76:79], v[80:83]
    buffer_load_dwordx4 v5, s[28:31], s53 offen offset:0 nt lds
    v_mfma_f32_16x16x32_bf16 a[160:163], a[180:183], v[44:47], a[160:163]
    s_add_u32 s57, s57, s88
    ds_read_b64_tr_b16 a[198:199], v20 offset:2560
    v_mfma_f32_16x16x32_bf16 a[164:167], a[180:183], v[48:51], a[164:167]
    ds_read_b64_tr_b16 a[200:201], v19 offset:4096
    v_mfma_f32_16x16x32_bf16 a[168:171], a[180:183], v[52:55], a[168:171]
    ds_read_b64_tr_b16 a[202:203], v19 offset:6144
    v_mfma_f32_16x16x32_bf16 a[172:175], a[180:183], v[56:59], a[172:175]
    s_waitcnt lgkmcnt(3)
    ds_read_b64_tr_b16 a[204:205], v20 offset:4096
    v_mfma_f32_16x16x32_bf16 v[180:183], a[184:187], v[56:59], v[180:183]
    ds_read_b64_tr_b16 a[206:207], v20 offset:6144
    v_mfma_f32_16x16x32_bf16 v[148:151], a[184:187], v[52:55], v[148:151]
    ds_read_b64_tr_b16 a[208:209], v19 offset:4608
    v_mfma_f32_16x16x32_bf16 v[116:119], a[184:187], v[48:51], v[116:119]
    ds_read_b64_tr_b16 a[210:211], v19 offset:6656
    v_mfma_f32_16x16x32_bf16 v[84:87], a[184:187], v[44:47], v[84:87]
    buffer_load_dwordx4 v6, s[28:31], s53 offen offset:1024 nt lds
    v_mfma_f32_16x16x32_bf16 v[88:91], a[188:191], v[44:47], v[88:91]
    s_and_b32 s57, s57, 0x1ffff
    s_sub_u32 s88, 8192, s88
    v_mfma_f32_16x16x32_bf16 v[120:123], a[188:191], v[48:51], v[120:123]
    ds_read_b64_tr_b16 a[212:213], v20 offset:4608
    v_mfma_f32_16x16x32_bf16 v[152:155], a[188:191], v[52:55], v[152:155]
    ds_read_b64_tr_b16 a[214:215], v20 offset:6656
    v_mfma_f32_16x16x32_bf16 v[184:187], a[188:191], v[56:59], v[184:187]
    v_exp_f32 v28, v28
    v_mfma_f32_16x16x32_bf16 v[188:191], a[192:195], v[56:59], v[188:191]
    v_exp_f32 v29, v29
    v_mfma_f32_16x16x32_bf16 v[156:159], a[192:195], v[52:55], v[156:159]
    v_exp_f32 v30, v30
    v_mfma_f32_16x16x32_bf16 v[124:127], a[192:195], v[48:51], v[124:127]
    v_exp_f32 v31, v31
    v_mfma_f32_16x16x32_bf16 v[92:95], a[192:195], v[44:47], v[92:95]
    s_waitcnt lgkmcnt(1)
    v_cvt_pk_bf16_f32 v28, v28, v29
    v_cvt_pk_bf16_f32 v29, v30, v31
    v_mfma_f32_16x16x32_bf16 v[96:99], a[196:199], v[44:47], v[96:99]
    v_exp_f32 v32, v32
    v_mfma_f32_16x16x32_bf16 v[128:131], a[196:199], v[48:51], v[128:131]
    v_exp_f32 v33, v33
    v_mfma_f32_16x16x32_bf16 v[160:163], a[196:199], v[52:55], v[160:163]
    v_exp_f32 v34, v34
    v_mfma_f32_16x16x32_bf16 v[192:195], a[196:199], v[56:59], v[192:195]
    s_lshr_b32 s97, s97, 1
    s_cbranch_scc0 1
    s_waitcnt vmcnt(3)
    s_waitcnt vmcnt(4) lgkmcnt(0)
    s_barrier
    v_mfma_f32_16x16x32_bf16 v[196:199], a[200:203], v[56:59], v[196:199]
    buffer_load_dwordx4 v7, s[28:31], s53 offen offset:2048 nt lds
    v_mfma_f32_16x16x32_bf16 v[164:167], a[200:203], v[52:55], v[164:167]
    s_add_u32 s94, s94, 16384
    s_and_b32 s94, s94, 0x1ffff
    v_mfma_f32_16x16x32_bf16 v[132:135], a[200:203], v[48:51], v[132:135]
    ds_read_b128 a[184:187], v18 offset:16384
    v_mfma_f32_16x16x32_bf16 v[100:103], a[200:203], v[44:47], v[100:103]
    ds_read_b128 a[188:191], v18 offset:16896
    v_mfma_f32_16x16x32_bf16 v[104:107], a[204:207], v[44:47], v[104:107]
    ds_read_b128 a[192:195], v18 offset:20480
    v_mfma_f32_16x16x32_bf16 v[136:139], a[204:207], v[48:51], v[136:139]
    ds_read_b128 a[196:199], v18 offset:20992
    v_mfma_f32_16x16x32_bf16 v[168:171], a[204:207], v[52:55], v[168:171]
    ds_read_b128 a[200:203], v18 offset:18432
    v_mfma_f32_16x16x32_bf16 v[200:203], a[204:207], v[56:59], v[200:203]
    ds_read_b128 a[204:207], v18 offset:18944
    v_mfma_f32_16x16x32_bf16 v[204:207], a[208:211], v[56:59], v[204:207]
    v_exp_f32 v35, v35
    v_mfma_f32_16x16x32_bf16 v[172:175], a[208:211], v[52:55], v[172:175]
    v_cvt_pk_bf16_f32 v32, v32, v33
    v_cvt_pk_bf16_f32 v33, v34, v35
    v_mfma_f32_16x16x32_bf16 v[140:143], a[208:211], v[48:51], v[140:143]
    v_exp_f32 v36, v36
    v_mfma_f32_16x16x32_bf16 v[108:111], a[208:211], v[44:47], v[108:111]
    ds_read_b128 a[208:211], v18 offset:22528
    v_mfma_f32_16x16x32_bf16 v[112:115], a[212:215], v[44:47], v[112:115]
    v_exp_f32 v37, v37
    v_mfma_f32_16x16x32_bf16 v[144:147], a[212:215], v[48:51], v[144:147]
    buffer_load_dwordx4 v8, s[28:31], s53 offen offset:3072 nt lds
    v_mfma_f32_16x16x32_bf16 v[176:179], a[212:215], v[52:55], v[176:179]
    v_exp_f32 v38, v38
    v_mfma_f32_16x16x32_bf16 v[208:211], a[212:215], v[56:59], v[208:211]
    s_waitcnt lgkmcnt(1)
    ds_read_b128 a[212:215], v18 offset:23040
    v_mfma_f32_16x16x32_bf16 v[44:47], a[184:187], a[0:3], 0
    v_exp_f32 v39, v39
    v_mfma_f32_16x16x32_bf16 v[44:47], a[188:191], a[4:7], v[44:47]
    v_cvt_pk_bf16_f32 v36, v36, v37
    v_cvt_pk_bf16_f32 v37, v38, v39
    v_mfma_f32_16x16x32_bf16 v[44:47], a[192:195], a[8:11], v[44:47]
    v_exp_f32 v40, v40
    v_mfma_f32_16x16x32_bf16 v[44:47], a[196:199], a[12:15], v[44:47]
    v_exp_f32 v41, v41
    v_mfma_f32_16x16x32_bf16 v[48:51], a[184:187], a[16:19], 0
    v_exp_f32 v42, v42
    v_mfma_f32_16x16x32_bf16 v[48:51], a[188:191], a[20:23], v[48:51]
    v_exp_f32 v43, v43
    v_mfma_f32_16x16x32_bf16 v[48:51], a[192:195], a[24:27], v[48:51]
    v_cvt_pk_bf16_f32 v40, v40, v41
    v_cvt_pk_bf16_f32 v41, v42, v43
    v_mfma_f32_16x16x32_bf16 v[48:51], a[196:199], a[28:31], v[48:51]
    v_exp_f32 v76, v76
    v_mfma_f32_16x16x32_bf16 v[52:55], a[184:187], a[32:35], 0
    v_exp_f32 v77, v77
    v_mfma_f32_16x16x32_bf16 v[52:55], a[188:191], a[36:39], v[52:55]
    v_exp_f32 v78, v78
    v_mfma_f32_16x16x32_bf16 v[52:55], a[192:195], a[40:43], v[52:55]
    v_exp_f32 v79, v79
    v_mfma_f32_16x16x32_bf16 v[52:55], a[196:199], a[44:47], v[52:55]
    s_cmp_gt_i32 s88, 0
    s_cselect_b64 s[28:29], s[16:17], s[12:13]
    s_add_u32 m0, s60, s94
    s_add_u32 s53, s58, s57
    v_mfma_f32_16x16x32_bf16 v[56:59], a[184:187], a[48:51], 0
    buffer_load_dwordx4 v5, s[28:31], s53 offen offset:0 nt lds
    v_mfma_f32_16x16x32_bf16 v[56:59], a[188:191], a[52:55], v[56:59]
    s_add_u32 s57, s57, s88
    v_cvt_pk_bf16_f32 v76, v76, v77
    v_cvt_pk_bf16_f32 v77, v78, v79
    v_mfma_f32_16x16x32_bf16 v[56:59], a[192:195], a[56:59], v[56:59]
    v_exp_f32 v60, v60
    v_exp_f32 v61, v61
    v_mfma_f32_16x16x32_bf16 v[56:59], a[196:199], a[60:63], v[56:59]
    v_exp_f32 v62, v62
    v_exp_f32 v63, v63
    v_cvt_pk_bf16_f32 v30, v60, v61
    v_cvt_pk_bf16_f32 v31, v62, v63
    v_mfma_f32_16x16x32_bf16 v[60:63], a[200:203], a[0:3], 0
    v_exp_f32 v64, v64
    v_mfma_f32_16x16x32_bf16 v[60:63], a[204:207], a[4:7], v[60:63]
    s_waitcnt lgkmcnt(0)
    v_exp_f32 v65, v65
    v_exp_f32 v66, v66
    v_mfma_f32_16x16x32_bf16 v[60:63], a[208:211], a[8:11], v[60:63]
    v_exp_f32 v67, v67
    v_cvt_pk_bf16_f32 v34, v64, v65
    v_cvt_pk_bf16_f32 v35, v66, v67
    v_mfma_f32_16x16x32_bf16 v[60:63], a[212:215], a[12:15], v[60:63]
    v_exp_f32 v68, v68
    v_mfma_f32_16x16x32_bf16 v[64:67], a[200:203], a[16:19], 0
    v_exp_f32 v69, v69
    v_mfma_f32_16x16x32_bf16 v[64:67], a[204:207], a[20:23], v[64:67]
    v_exp_f32 v70, v70
    v_exp_f32 v71, v71
    v_mfma_f32_16x16x32_bf16 v[64:67], a[208:211], a[24:27], v[64:67]
    v_cvt_pk_bf16_f32 v38, v68, v69
    v_cvt_pk_bf16_f32 v39, v70, v71
    v_mfma_f32_16x16x32_bf16 v[64:67], a[212:215], a[28:31], v[64:67]
    v_exp_f32 v72, v72
    v_mfma_f32_16x16x32_bf16 v[68:71], a[200:203], a[32:35], 0
    v_exp_f32 v73, v73
    v_mfma_f32_16x16x32_bf16 v[68:71], a[204:207], a[36:39], v[68:71]
    v_exp_f32 v74, v74
    v_exp_f32 v75, v75
    v_mfma_f32_16x16x32_bf16 v[68:71], a[208:211], a[40:43], v[68:71]
    v_cvt_pk_bf16_f32 v42, v72, v73
    v_cvt_pk_bf16_f32 v43, v74, v75
    v_mfma_f32_16x16x32_bf16 v[68:71], a[212:215], a[44:47], v[68:71]
    s_cbranch_vccz gqa_kernel_ool26
gqa_kernel_ret26_0:
    s_waitcnt vmcnt(3) lgkmcnt(0)
    s_barrier
    ds_read_b64_tr_b16 a[184:185], v19 offset:32768
    ds_read_b64_tr_b16 a[186:187], v19 offset:34816
    v_mfma_f32_16x16x32_bf16 v[72:75], a[200:203], a[48:51], 0
    buffer_load_dwordx4 v6, s[28:31], s53 offen offset:1024 nt lds
    v_mfma_f32_16x16x32_bf16 v[72:75], a[204:207], a[52:55], v[72:75]
    s_and_b32 s57, s57, 0x1ffff
    s_sub_u32 s88, 8192, s88
    v_mfma_f32_16x16x32_bf16 v[72:75], a[208:211], a[56:59], v[72:75]
    ds_read_b64_tr_b16 a[188:189], v20 offset:32768
    v_mfma_f32_16x16x32_bf16 v[72:75], a[212:215], a[60:63], v[72:75]
    ds_read_b64_tr_b16 a[190:191], v20 offset:34816
    v_mfma_f32_16x16x32_bf16 a[160:163], a[180:183], v[28:31], a[160:163]
    v_exp_f32 v80, v80
    v_mfma_f32_16x16x32_bf16 a[164:167], a[180:183], v[32:35], a[164:167]
    v_exp_f32 v81, v81
    v_exp_f32 v82, v82
    v_mfma_f32_16x16x32_bf16 a[168:171], a[180:183], v[36:39], a[168:171]
    buffer_load_dwordx4 v7, s[28:31], s53 offen offset:2048 nt lds
    v_mfma_f32_16x16x32_bf16 a[172:175], a[180:183], v[40:43], a[172:175]
    s_add_u32 s94, s94, 16384
    s_and_b32 s94, s94, 0x1ffff
    v_exp_f32 v83, v83
    v_cvt_pk_bf16_f32 v78, v80, v81
    v_cvt_pk_bf16_f32 v79, v82, v83
    s_nop 1
    v_mfma_f32_16x16x32_bf16 a[176:179], a[180:183], v[76:79], a[176:179]
    s_waitcnt lgkmcnt(0)
    ds_read_b64_tr_b16 a[192:193], v19 offset:33280
    v_mfma_f32_16x16x32_bf16 v[212:215], a[184:187], v[76:79], v[212:215]
    ds_read_b64_tr_b16 a[194:195], v19 offset:35328
    v_mfma_f32_16x16x32_bf16 v[180:183], a[184:187], v[40:43], v[180:183]
    ds_read_b64_tr_b16 a[196:197], v20 offset:33280
    v_mfma_f32_16x16x32_bf16 v[148:151], a[184:187], v[36:39], v[148:151]
    ds_read_b64_tr_b16 a[198:199], v20 offset:35328
    v_mfma_f32_16x16x32_bf16 v[116:119], a[184:187], v[32:35], v[116:119]
    ds_write_b128 v247, a[80:83] offset:1024
    v_mfma_f32_16x16x32_bf16 v[84:87], a[184:187], v[28:31], v[84:87]
    ds_write_b128 v248, a[96:99] offset:1024
    v_mfma_f32_16x16x32_bf16 v[88:91], a[188:191], v[28:31], v[88:91]
    buffer_load_dwordx4 v8, s[28:31], s53 offen offset:3072 nt lds
    v_mfma_f32_16x16x32_bf16 v[120:123], a[188:191], v[32:35], v[120:123]
    ds_write_b128 v249, a[112:115] offset:1024
    v_mfma_f32_16x16x32_bf16 v[152:155], a[188:191], v[36:39], v[152:155]
    ds_write_b128 v250, a[128:131] offset:1024
    v_mfma_f32_16x16x32_bf16 v[184:187], a[188:191], v[40:43], v[184:187]
    ds_read_b64_tr_b16 a[200:201], v19 offset:36864
    v_mfma_f32_16x16x32_bf16 v[216:219], a[188:191], v[76:79], v[216:219]
    s_waitcnt lgkmcnt(5)
    ds_read_b64_tr_b16 a[202:203], v19 offset:38912
    v_mfma_f32_16x16x32_bf16 v[220:223], a[192:195], v[76:79], v[220:223]
    ds_write_b128 v251, a[144:147] offset:0
    v_mfma_f32_16x16x32_bf16 v[188:191], a[192:195], v[40:43], v[188:191]
    ds_read_b64_tr_b16 a[204:205], v20 offset:36864
    v_mfma_f32_16x16x32_bf16 v[156:159], a[192:195], v[36:39], v[156:159]
    s_cmp_gt_i32 s88, 0
    s_cselect_b64 s[28:29], s[16:17], s[12:13]
    s_add_u32 m0, s60, s94
    s_add_u32 s53, s58, s57
    v_mfma_f32_16x16x32_bf16 v[124:127], a[192:195], v[32:35], v[124:127]
    buffer_load_dwordx4 v5, s[28:31], s53 offen offset:0 nt lds
    v_mfma_f32_16x16x32_bf16 v[92:95], a[192:195], v[28:31], v[92:95]
    s_add_u32 s57, s57, s88
    ds_read_b64_tr_b16 a[206:207], v20 offset:38912
    v_mfma_f32_16x16x32_bf16 v[96:99], a[196:199], v[28:31], v[96:99]
    ds_read_b64_tr_b16 a[208:209], v19 offset:37376
    v_mfma_f32_16x16x32_bf16 v[128:131], a[196:199], v[32:35], v[128:131]
    ds_read_b64_tr_b16 a[210:211], v19 offset:39424
    v_mfma_f32_16x16x32_bf16 v[160:163], a[196:199], v[36:39], v[160:163]
    ds_read_b64_tr_b16 a[212:213], v20 offset:37376
    v_mfma_f32_16x16x32_bf16 v[192:195], a[196:199], v[40:43], v[192:195]
    ds_read_b64_tr_b16 a[214:215], v20 offset:39424
    v_mfma_f32_16x16x32_bf16 v[224:227], a[196:199], v[76:79], v[224:227]
    s_waitcnt lgkmcnt(5)
    v_exp_f32 v44, v44
    v_mfma_f32_16x16x32_bf16 v[228:231], a[200:203], v[76:79], v[228:231]
    v_exp_f32 v45, v45
    v_mfma_f32_16x16x32_bf16 v[196:199], a[200:203], v[40:43], v[196:199]
    v_exp_f32 v46, v46
    v_mfma_f32_16x16x32_bf16 v[164:167], a[200:203], v[36:39], v[164:167]
    s_lshr_b32 s97, s97, 1
    s_cbranch_scc0 1
    s_waitcnt vmcnt(3)
    s_waitcnt vmcnt(4) lgkmcnt(0)
    s_barrier
    v_mfma_f32_16x16x32_bf16 v[132:135], a[200:203], v[32:35], v[132:135]
    buffer_load_dwordx4 v6, s[28:31], s53 offen offset:1024 nt lds
    v_mfma_f32_16x16x32_bf16 v[100:103], a[200:203], v[28:31], v[100:103]
    s_and_b32 s57, s57, 0x1ffff
    s_sub_u32 s88, 8192, s88
    v_mfma_f32_16x16x32_bf16 v[104:107], a[204:207], v[28:31], v[104:107]
    ds_read_b128 a[184:187], v18 offset:49152
    v_mfma_f32_16x16x32_bf16 v[136:139], a[204:207], v[32:35], v[136:139]
    ds_read_b128 a[188:191], v18 offset:49664
    v_mfma_f32_16x16x32_bf16 v[168:171], a[204:207], v[36:39], v[168:171]
    ds_read_b128 a[192:195], v18 offset:53248
    v_mfma_f32_16x16x32_bf16 v[200:203], a[204:207], v[40:43], v[200:203]
    ds_read_b128 a[196:199], v18 offset:53760
    v_mfma_f32_16x16x32_bf16 v[232:235], a[204:207], v[76:79], v[232:235]
    ds_write_b128 v247, a[84:87] offset:19456
    v_mfma_f32_16x16x32_bf16 v[236:239], a[208:211], v[76:79], v[236:239]
    ds_read_b128 a[200:203], v18 offset:51200
    v_mfma_f32_16x16x32_bf16 v[204:207], a[208:211], v[40:43], v[204:207]
    ds_write_b128 v248, a[100:103] offset:19456
    v_mfma_f32_16x16x32_bf16 v[172:175], a[208:211], v[36:39], v[172:175]
    ds_read_b128 a[204:207], v18 offset:51712
    v_mfma_f32_16x16x32_bf16 v[140:143], a[208:211], v[32:35], v[140:143]
    buffer_load_dwordx4 v7, s[28:31], s53 offen offset:2048 nt lds
    v_mfma_f32_16x16x32_bf16 v[108:111], a[208:211], v[28:31], v[108:111]
    s_add_u32 s94, s94, 16384
    s_and_b32 s94, s94, 0x1ffff
    v_mfma_f32_16x16x32_bf16 v[112:115], a[212:215], v[28:31], v[112:115]
    ds_read_b128 a[208:211], v18 offset:55296
    v_mfma_f32_16x16x32_bf16 v[144:147], a[212:215], v[32:35], v[144:147]
    ds_write_b128 v249, a[116:119] offset:19456
    v_mfma_f32_16x16x32_bf16 v[176:179], a[212:215], v[36:39], v[176:179]
    v_exp_f32 v47, v47
    v_mfma_f32_16x16x32_bf16 v[208:211], a[212:215], v[40:43], v[208:211]
    v_cvt_pk_bf16_f32 v44, v44, v45
    v_cvt_pk_bf16_f32 v45, v46, v47
    v_mfma_f32_16x16x32_bf16 v[240:243], a[212:215], v[76:79], v[240:243]
    s_waitcnt lgkmcnt(2)
    ds_read_b128 a[212:215], v18 offset:55808
    v_mfma_f32_16x16x32_bf16 v[28:31], a[184:187], a[0:3], 0
    v_exp_f32 v48, v48
    v_mfma_f32_16x16x32_bf16 v[28:31], a[188:191], a[4:7], v[28:31]
    ds_write_b128 v250, a[132:135] offset:19456
    v_mfma_f32_16x16x32_bf16 v[28:31], a[192:195], a[8:11], v[28:31]
    v_exp_f32 v49, v49
    v_mfma_f32_16x16x32_bf16 v[28:31], a[196:199], a[12:15], v[28:31]
    v_exp_f32 v50, v50
    v_mfma_f32_16x16x32_bf16 v[32:35], a[184:187], a[16:19], 0
    v_exp_f32 v51, v51
    v_mfma_f32_16x16x32_bf16 v[32:35], a[188:191], a[20:23], v[32:35]
    buffer_load_dwordx4 v8, s[28:31], s53 offen offset:3072 nt lds
    v_mfma_f32_16x16x32_bf16 v[32:35], a[192:195], a[24:27], v[32:35]
    ds_write_b128 v251, a[148:151] offset:18432
    v_mfma_f32_16x16x32_bf16 v[32:35], a[196:199], a[28:31], v[32:35]
    v_cvt_pk_bf16_f32 v48, v48, v49
    v_cvt_pk_bf16_f32 v49, v50, v51
    v_mfma_f32_16x16x32_bf16 v[36:39], a[184:187], a[32:35], 0
    v_exp_f32 v52, v52
    v_mfma_f32_16x16x32_bf16 v[36:39], a[188:191], a[36:39], v[36:39]
    v_exp_f32 v53, v53
    v_mfma_f32_16x16x32_bf16 v[36:39], a[192:195], a[40:43], v[36:39]
    v_exp_f32 v54, v54
    v_mfma_f32_16x16x32_bf16 v[36:39], a[196:199], a[44:47], v[36:39]
    v_exp_f32 v55, v55
    v_mfma_f32_16x16x32_bf16 v[40:43], a[184:187], a[48:51], 0
    v_cvt_pk_bf16_f32 v52, v52, v53
    v_cvt_pk_bf16_f32 v53, v54, v55
    v_mfma_f32_16x16x32_bf16 v[40:43], a[188:191], a[52:55], v[40:43]
    v_exp_f32 v56, v56
    v_mfma_f32_16x16x32_bf16 v[40:43], a[192:195], a[56:59], v[40:43]
    v_exp_f32 v57, v57
    v_mfma_f32_16x16x32_bf16 v[40:43], a[196:199], a[60:63], v[40:43]
    v_exp_f32 v58, v58
    v_mfma_f32_16x16x32_bf16 v[76:79], a[184:187], a[64:67], 0
    v_exp_f32 v59, v59
    v_mfma_f32_16x16x32_bf16 v[76:79], a[188:191], a[68:71], v[76:79]
    v_cvt_pk_bf16_f32 v56, v56, v57
    v_cvt_pk_bf16_f32 v57, v58, v59
    v_exp_f32 v60, v60
    v_mfma_f32_16x16x32_bf16 v[76:79], a[192:195], a[72:75], v[76:79]
    v_exp_f32 v61, v61
    v_exp_f32 v62, v62
    v_mfma_f32_16x16x32_bf16 v[76:79], a[196:199], a[76:79], v[76:79]
    v_exp_f32 v63, v63
    v_cvt_pk_bf16_f32 v46, v60, v61
    v_cvt_pk_bf16_f32 v47, v62, v63
    s_waitcnt vmcnt(3) lgkmcnt(0)
    s_barrier
    v_xor_b32 v19, 0x10000, v19
    v_xor_b32 v20, 0x10000, v20
    v_xor_b32 v18, 0x10000, v18
    v_mfma_f32_16x16x32_bf16 v[60:63], a[200:203], a[0:3], 0
    s_add_u32 m0, s60, 114688
    s_add_u32 s53, s56, 122880
    s_and_b32 s53, s53, 0x1ffff
    s_add_u32 s53, s53, s58
    v_mfma_f32_16x16x32_bf16 v[60:63], a[204:207], a[4:7], v[60:63]
    buffer_load_dwordx4 v5, s[16:19], s53 offen offset:0 nt lds
    v_mfma_f32_16x16x32_bf16 v[60:63], a[208:211], a[8:11], v[60:63]
    v_exp_f32 v64, v64
    v_exp_f32 v65, v65
    v_mfma_f32_16x16x32_bf16 v[60:63], a[212:215], a[12:15], v[60:63]
    v_exp_f32 v66, v66
    v_exp_f32 v67, v67
    v_cvt_pk_bf16_f32 v50, v64, v65
    v_cvt_pk_bf16_f32 v51, v66, v67
    v_mfma_f32_16x16x32_bf16 v[64:67], a[200:203], a[16:19], 0
    v_exp_f32 v68, v68
    v_mfma_f32_16x16x32_bf16 v[64:67], a[204:207], a[20:23], v[64:67]
    v_exp_f32 v69, v69
    v_exp_f32 v70, v70
    v_mfma_f32_16x16x32_bf16 v[64:67], a[208:211], a[24:27], v[64:67]
    v_exp_f32 v71, v71
    v_cvt_pk_bf16_f32 v54, v68, v69
    v_cvt_pk_bf16_f32 v55, v70, v71
    v_mfma_f32_16x16x32_bf16 v[64:67], a[212:215], a[28:31], v[64:67]
    v_exp_f32 v72, v72
    v_mfma_f32_16x16x32_bf16 v[68:71], a[200:203], a[32:35], 0
    buffer_load_dwordx4 v6, s[16:19], s53 offen offset:1024 nt lds
    v_mfma_f32_16x16x32_bf16 v[68:71], a[204:207], a[36:39], v[68:71]
    v_exp_f32 v73, v73
    v_exp_f32 v74, v74
    v_mfma_f32_16x16x32_bf16 v[68:71], a[208:211], a[40:43], v[68:71]
    v_exp_f32 v75, v75
    v_cvt_pk_bf16_f32 v58, v72, v73
    v_cvt_pk_bf16_f32 v59, v74, v75
    v_mfma_f32_16x16x32_bf16 v[68:71], a[212:215], a[44:47], v[68:71]
    ds_read_b64_tr_b16 a[184:185], v19 offset:0
    v_mfma_f32_16x16x32_bf16 v[72:75], a[200:203], a[48:51], 0
    ds_read_b64_tr_b16 a[186:187], v19 offset:2048
    v_mfma_f32_16x16x32_bf16 v[72:75], a[204:207], a[52:55], v[72:75]
    ds_read_b64_tr_b16 a[188:189], v20 offset:0
    v_mfma_f32_16x16x32_bf16 v[72:75], a[208:211], a[56:59], v[72:75]
    ds_read_b64_tr_b16 a[190:191], v20 offset:2048
    v_mfma_f32_16x16x32_bf16 v[72:75], a[212:215], a[60:63], v[72:75]
    ds_read_b64_tr_b16 a[192:193], v19 offset:512
    v_mfma_f32_16x16x32_bf16 v[80:83], a[200:203], a[64:67], 0
    ds_read_b64_tr_b16 a[194:195], v19 offset:2560
    v_mfma_f32_16x16x32_bf16 v[80:83], a[204:207], a[68:71], v[80:83]
    ds_write_b128 v247, a[88:91] offset:37888
    v_mfma_f32_16x16x32_bf16 v[80:83], a[208:211], a[72:75], v[80:83]
    buffer_load_dwordx4 v7, s[16:19], s53 offen offset:2048 nt lds
    v_mfma_f32_16x16x32_bf16 v[80:83], a[212:215], a[76:79], v[80:83]
    ds_write_b128 v248, a[104:107] offset:37888
    v_mfma_f32_16x16x32_bf16 a[160:163], a[180:183], v[44:47], a[160:163]
    ds_write_b128 v249, a[120:123] offset:37888
    v_mfma_f32_16x16x32_bf16 a[164:167], a[180:183], v[48:51], a[164:167]
    ds_read_b64_tr_b16 a[196:197], v20 offset:512
    v_mfma_f32_16x16x32_bf16 a[168:171], a[180:183], v[52:55], a[168:171]
    ds_read_b64_tr_b16 a[198:199], v20 offset:2560
    v_mfma_f32_16x16x32_bf16 a[172:175], a[180:183], v[56:59], a[172:175]
    s_waitcnt lgkmcnt(5)
    ds_read_b64_tr_b16 a[200:201], v19 offset:4096
    v_mfma_f32_16x16x32_bf16 v[180:183], a[184:187], v[56:59], v[180:183]
    ds_write_b128 v250, a[136:139] offset:37888
    v_mfma_f32_16x16x32_bf16 v[148:151], a[184:187], v[52:55], v[148:151]
    ds_read_b64_tr_b16 a[202:203], v19 offset:6144
    v_mfma_f32_16x16x32_bf16 v[116:119], a[184:187], v[48:51], v[116:119]
    ds_read_b64_tr_b16 a[204:205], v20 offset:4096
    v_mfma_f32_16x16x32_bf16 v[84:87], a[184:187], v[44:47], v[84:87]
    buffer_load_dwordx4 v8, s[16:19], s53 offen offset:3072 nt lds
    v_mfma_f32_16x16x32_bf16 v[88:91], a[188:191], v[44:47], v[88:91]
    ds_read_b64_tr_b16 a[206:207], v20 offset:6144
    v_mfma_f32_16x16x32_bf16 v[120:123], a[188:191], v[48:51], v[120:123]
    ds_read_b64_tr_b16 a[208:209], v19 offset:4608
    v_mfma_f32_16x16x32_bf16 v[152:155], a[188:191], v[52:55], v[152:155]
    ds_read_b64_tr_b16 a[210:211], v19 offset:6656
    v_mfma_f32_16x16x32_bf16 v[184:187], a[188:191], v[56:59], v[184:187]
    ds_read_b64_tr_b16 a[212:213], v20 offset:4608
    v_mfma_f32_16x16x32_bf16 v[188:191], a[192:195], v[56:59], v[188:191]
    ds_read_b64_tr_b16 a[214:215], v20 offset:6656
    v_mfma_f32_16x16x32_bf16 v[156:159], a[192:195], v[52:55], v[156:159]
    v_exp_f32 v28, v28
    v_mfma_f32_16x16x32_bf16 v[124:127], a[192:195], v[48:51], v[124:127]
    v_exp_f32 v29, v29
    v_mfma_f32_16x16x32_bf16 v[92:95], a[192:195], v[44:47], v[92:95]
    s_waitcnt lgkmcnt(4)
    v_exp_f32 v30, v30
    v_mfma_f32_16x16x32_bf16 v[96:99], a[196:199], v[44:47], v[96:99]
    v_exp_f32 v31, v31
    v_mfma_f32_16x16x32_bf16 v[128:131], a[196:199], v[48:51], v[128:131]
    v_cvt_pk_bf16_f32 v28, v28, v29
    v_cvt_pk_bf16_f32 v29, v30, v31
    v_mfma_f32_16x16x32_bf16 v[160:163], a[196:199], v[52:55], v[160:163]
    v_exp_f32 v32, v32
    v_mfma_f32_16x16x32_bf16 v[192:195], a[196:199], v[56:59], v[192:195]
    s_lshr_b32 s97, s97, 1
    s_cbranch_scc0 1
    s_waitcnt vmcnt(3)
    s_waitcnt vmcnt(4) lgkmcnt(0)
    s_barrier
    s_add_u32 m0, s89, 0
    s_add_u32 s53, s56, 0
    v_mfma_f32_16x16x32_bf16 v[196:199], a[200:203], v[56:59], v[196:199]
    s_and_b32 s53, s53, 0x1ffff
    s_add_u32 s53, s53, s91
    v_mfma_f32_16x16x32_bf16 v[164:167], a[200:203], v[52:55], v[164:167]
    buffer_load_dwordx4 v5, s[12:15], s53 offen offset:0 nt lds
    v_mfma_f32_16x16x32_bf16 v[132:135], a[200:203], v[48:51], v[132:135]
    ds_read_b128 a[184:187], v18 offset:16384
    v_mfma_f32_16x16x32_bf16 v[100:103], a[200:203], v[44:47], v[100:103]
    ds_read_b128 a[188:191], v18 offset:16896
    v_mfma_f32_16x16x32_bf16 v[104:107], a[204:207], v[44:47], v[104:107]
    ds_read_b128 a[192:195], v18 offset:20480
    v_mfma_f32_16x16x32_bf16 v[136:139], a[204:207], v[48:51], v[136:139]
    ds_read_b128 a[196:199], v18 offset:20992
    v_mfma_f32_16x16x32_bf16 v[168:171], a[204:207], v[52:55], v[168:171]
    ds_read_b128 a[200:203], v18 offset:18432
    v_mfma_f32_16x16x32_bf16 v[200:203], a[204:207], v[56:59], v[200:203]
    ds_read_b128 a[204:207], v18 offset:18944
    v_mfma_f32_16x16x32_bf16 v[204:207], a[208:211], v[56:59], v[204:207]
    ds_write_b128 v247, a[92:95] offset:56320
    v_mfma_f32_16x16x32_bf16 v[172:175], a[208:211], v[52:55], v[172:175]
    buffer_load_dwordx4 v6, s[12:15], s53 offen offset:1024 nt lds
    v_mfma_f32_16x16x32_bf16 v[140:143], a[208:211], v[48:51], v[140:143]
    v_exp_f32 v33, v33
    v_mfma_f32_16x16x32_bf16 v[108:111], a[208:211], v[44:47], v[108:111]
    ds_read_b128 a[208:211], v18 offset:22528
    v_mfma_f32_16x16x32_bf16 v[112:115], a[212:215], v[44:47], v[112:115]
    ds_write_b128 v248, a[108:111] offset:56320
    v_mfma_f32_16x16x32_bf16 v[144:147], a[212:215], v[48:51], v[144:147]
    v_exp_f32 v34, v34
    v_mfma_f32_16x16x32_bf16 v[176:179], a[212:215], v[52:55], v[176:179]
    v_exp_f32 v35, v35
    v_mfma_f32_16x16x32_bf16 v[208:211], a[212:215], v[56:59], v[208:211]
    s_waitcnt lgkmcnt(2)
    ds_read_b128 a[212:215], v18 offset:23040
    v_cvt_pk_bf16_f32 v32, v32, v33
    v_mfma_f32_16x16x32_bf16 v[44:47], a[184:187], a[0:3], 0
    v_cvt_pk_bf16_f32 v33, v34, v35
    v_mfma_f32_16x16x32_bf16 v[44:47], a[188:191], a[4:7], v[44:47]
    v_exp_f32 v36, v36
    v_mfma_f32_16x16x32_bf16 v[44:47], a[192:195], a[8:11], v[44:47]
    v_exp_f32 v37, v37
    v_mfma_f32_16x16x32_bf16 v[44:47], a[196:199], a[12:15], v[44:47]
    ds_write_b128 v249, a[124:127] offset:56320
    v_mfma_f32_16x16x32_bf16 v[48:51], a[184:187], a[16:19], 0
    buffer_load_dwordx4 v7, s[12:15], s53 offen offset:2048 nt lds
    v_mfma_f32_16x16x32_bf16 v[48:51], a[188:191], a[20:23], v[48:51]
    v_exp_f32 v38, v38
    v_mfma_f32_16x16x32_bf16 v[48:51], a[192:195], a[24:27], v[48:51]
    v_exp_f32 v39, v39
    v_mfma_f32_16x16x32_bf16 v[48:51], a[196:199], a[28:31], v[48:51]
    v_cvt_pk_bf16_f32 v36, v36, v37
    v_cvt_pk_bf16_f32 v37, v38, v39
    v_mfma_f32_16x16x32_bf16 v[52:55], a[184:187], a[32:35], 0
    v_exp_f32 v40, v40
    v_mfma_f32_16x16x32_bf16 v[52:55], a[188:191], a[36:39], v[52:55]
    v_exp_f32 v41, v41
    v_mfma_f32_16x16x32_bf16 v[52:55], a[192:195], a[40:43], v[52:55]
    v_exp_f32 v42, v42
    v_mfma_f32_16x16x32_bf16 v[52:55], a[196:199], a[44:47], v[52:55]
    ds_write_b128 v250, a[140:143] offset:56320
    v_mfma_f32_16x16x32_bf16 v[56:59], a[184:187], a[48:51], 0
    v_exp_f32 v43, v43
    v_mfma_f32_16x16x32_bf16 v[56:59], a[188:191], a[52:55], v[56:59]
    v_cvt_pk_bf16_f32 v40, v40, v41
    v_cvt_pk_bf16_f32 v41, v42, v43
    v_exp_f32 v76, v76
    v_mfma_f32_16x16x32_bf16 v[56:59], a[192:195], a[56:59], v[56:59]
    buffer_load_dwordx4 v8, s[12:15], s53 offen offset:3072 nt lds
    v_mfma_f32_16x16x32_bf16 v[56:59], a[196:199], a[60:63], v[56:59]
    v_exp_f32 v77, v77
    v_exp_f32 v78, v78
    v_exp_f32 v79, v79
    v_cvt_pk_bf16_f32 v76, v76, v77
    v_cvt_pk_bf16_f32 v77, v78, v79
    v_exp_f32 v60, v60
    v_exp_f32 v61, v61
    v_exp_f32 v62, v62
    v_exp_f32 v63, v63
    v_cvt_pk_bf16_f32 v30, v60, v61
    v_cvt_pk_bf16_f32 v31, v62, v63
    v_mfma_f32_16x16x32_bf16 v[60:63], a[200:203], a[0:3], 0
    v_exp_f32 v64, v64
    v_mfma_f32_16x16x32_bf16 v[60:63], a[204:207], a[4:7], v[60:63]
    s_waitcnt lgkmcnt(0)
    v_exp_f32 v65, v65
    v_exp_f32 v66, v66
    v_mfma_f32_16x16x32_bf16 v[60:63], a[208:211], a[8:11], v[60:63]
    v_exp_f32 v67, v67
    v_cvt_pk_bf16_f32 v34, v64, v65
    v_cvt_pk_bf16_f32 v35, v66, v67
    v_mfma_f32_16x16x32_bf16 v[60:63], a[212:215], a[12:15], v[60:63]
    v_exp_f32 v68, v68
    v_mfma_f32_16x16x32_bf16 v[64:67], a[200:203], a[16:19], 0
    v_exp_f32 v69, v69
    v_mfma_f32_16x16x32_bf16 v[64:67], a[204:207], a[20:23], v[64:67]
    v_exp_f32 v70, v70
    v_exp_f32 v71, v71
    v_mfma_f32_16x16x32_bf16 v[64:67], a[208:211], a[24:27], v[64:67]
    v_cvt_pk_bf16_f32 v38, v68, v69
    v_cvt_pk_bf16_f32 v39, v70, v71
    v_mfma_f32_16x16x32_bf16 v[64:67], a[212:215], a[28:31], v[64:67]
    v_exp_f32 v72, v72
    v_mfma_f32_16x16x32_bf16 v[68:71], a[200:203], a[32:35], 0
    v_exp_f32 v73, v73
    v_mfma_f32_16x16x32_bf16 v[68:71], a[204:207], a[36:39], v[68:71]
    v_exp_f32 v74, v74
    v_exp_f32 v75, v75
    v_mfma_f32_16x16x32_bf16 v[68:71], a[208:211], a[40:43], v[68:71]
    v_cvt_pk_bf16_f32 v42, v72, v73
    v_cvt_pk_bf16_f32 v43, v74, v75
    v_mfma_f32_16x16x32_bf16 v[68:71], a[212:215], a[44:47], v[68:71]
    s_cbranch_vccnz 1
    s_waitcnt vmcnt(4)
    s_waitcnt lgkmcnt(0)
    s_barrier
    s_add_u32 m0, s89, 16384
    s_add_u32 s53, s56, 8192
    v_mfma_f32_16x16x32_bf16 v[72:75], a[200:203], a[48:51], 0
    s_and_b32 s53, s53, 0x1ffff
    s_add_u32 s53, s53, s91
    ds_read_b64_tr_b16 a[184:185], v19 offset:32768
    ds_read_b64_tr_b16 a[186:187], v19 offset:34816
    v_mfma_f32_16x16x32_bf16 v[72:75], a[204:207], a[52:55], v[72:75]
    buffer_load_dwordx4 v5, s[12:15], s53 offen offset:0 nt lds
    v_mfma_f32_16x16x32_bf16 v[72:75], a[208:211], a[56:59], v[72:75]
    ds_read_b64_tr_b16 a[188:189], v20 offset:32768
    v_mfma_f32_16x16x32_bf16 v[72:75], a[212:215], a[60:63], v[72:75]
    ds_read_b64_tr_b16 a[190:191], v20 offset:34816
    v_mfma_f32_16x16x32_bf16 a[160:163], a[180:183], v[28:31], a[160:163]
    v_exp_f32 v80, v80
    v_mfma_f32_16x16x32_bf16 a[164:167], a[180:183], v[32:35], a[164:167]
    s_add_u32 s45, s98, 245760
    v_exp_f32 v81, v81
    v_mfma_f32_16x16x32_bf16 a[168:171], a[180:183], v[36:39], a[168:171]
    s_cbranch_vccz 2
    buffer_load_dwordx4 a[0:3], v24, s[24:27], s45 offen offset:0 sc1
    v_mfma_f32_16x16x32_bf16 a[172:175], a[180:183], v[40:43], a[172:175]
    v_exp_f32 v82, v82
    v_exp_f32 v83, v83
    v_cvt_pk_bf16_f32 v78, v80, v81
    v_cvt_pk_bf16_f32 v79, v82, v83
    s_nop 1
    v_mfma_f32_16x16x32_bf16 a[176:179], a[180:183], v[76:79], a[176:179]
    s_waitcnt lgkmcnt(0)
    ds_read_b64_tr_b16 a[192:193], v19 offset:33280
    v_mfma_f32_16x16x32_bf16 v[212:215], a[184:187], v[76:79], v[212:215]
    ds_read_b64_tr_b16 a[194:195], v19 offset:35328
    v_mfma_f32_16x16x32_bf16 v[180:183], a[184:187], v[40:43], v[180:183]
    buffer_load_dwordx4 v6, s[12:15], s53 offen offset:1024 nt lds
    v_mfma_f32_16x16x32_bf16 v[148:151], a[184:187], v[36:39], v[148:151]
    s_cbranch_vccz 2
    buffer_load_dwordx4 a[4:7], v24, s[24:27], s45 offen offset:1024 sc1
    v_mfma_f32_16x16x32_bf16 v[116:119], a[184:187], v[32:35], v[116:119]
    ds_read_b64_tr_b16 a[196:197], v20 offset:33280
    v_mfma_f32_16x16x32_bf16 v[84:87], a[184:187], v[28:31], v[84:87]
    ds_read_b64_tr_b16 a[198:199], v20 offset:35328
    v_mfma_f32_16x16x32_bf16 v[88:91], a[188:191], v[28:31], v[88:91]
    ds_read_b64_tr_b16 a[200:201], v19 offset:36864
    v_mfma_f32_16x16x32_bf16 v[120:123], a[188:191], v[32:35], v[120:123]
    ds_read_b64_tr_b16 a[202:203], v19 offset:38912
    v_mfma_f32_16x16x32_bf16 v[152:155], a[188:191], v[36:39], v[152:155]
    ds_read_b64_tr_b16 a[204:205], v20 offset:36864
    v_mfma_f32_16x16x32_bf16 v[184:187], a[188:191], v[40:43], v[184:187]
    s_add_u32 s45, s98, 286720
    ds_read_b64_tr_b16 a[206:207], v20 offset:38912
    v_mfma_f32_16x16x32_bf16 v[216:219], a[188:191], v[76:79], v[216:219]
    s_cbranch_vccz 2
    buffer_load_dwordx4 a[8:11], v24, s[24:27], s45 offen offset:0 sc1
    s_waitcnt lgkmcnt(5)
    v_mfma_f32_16x16x32_bf16 v[220:223], a[192:195], v[76:79], v[220:223]
    ds_read_b64_tr_b16 a[208:209], v19 offset:37376
    v_mfma_f32_16x16x32_bf16 v[188:191], a[192:195], v[40:43], v[188:191]
    ds_read_b64_tr_b16 a[210:211], v19 offset:39424
    v_mfma_f32_16x16x32_bf16 v[156:159], a[192:195], v[36:39], v[156:159]
    ds_read_b64_tr_b16 a[212:213], v20 offset:37376
    v_mfma_f32_16x16x32_bf16 v[124:127], a[192:195], v[32:35], v[124:127]
    buffer_load_dwordx4 v7, s[12:15], s53 offen offset:2048 nt lds
    v_mfma_f32_16x16x32_bf16 v[92:95], a[192:195], v[28:31], v[92:95]
    s_cbranch_vccz 2
    buffer_load_dwordx4 a[12:15], v24, s[24:27], s45 offen offset:1024 sc1
    s_waitcnt lgkmcnt(3)
    v_mfma_f32_16x16x32_bf16 v[96:99], a[196:199], v[28:31], v[96:99]
    ds_read_b64_tr_b16 a[214:215], v20 offset:39424
    v_mfma_f32_16x16x32_bf16 v[128:131], a[196:199], v[32:35], v[128:131]
    v_exp_f32 v44, v44
    v_mfma_f32_16x16x32_bf16 v[160:163], a[196:199], v[36:39], v[160:163]
    v_exp_f32 v45, v45
    v_mfma_f32_16x16x32_bf16 v[192:195], a[196:199], v[40:43], v[192:195]
    v_exp_f32 v46, v46
    v_mfma_f32_16x16x32_bf16 v[224:227], a[196:199], v[76:79], v[224:227]
    v_exp_f32 v47, v47
    v_mfma_f32_16x16x32_bf16 v[228:231], a[200:203], v[76:79], v[228:231]
    s_add_u32 s45, s98, 327680
    v_cvt_pk_bf16_f32 v44, v44, v45
    v_mfma_f32_16x16x32_bf16 v[196:199], a[200:203], v[40:43], v[196:199]
    s_cbranch_vccz 2
    buffer_load_dwordx4 a[16:19], v24, s[24:27], s45 offen offset:0 sc1
    v_mfma_f32_16x16x32_bf16 v[164:167], a[200:203], v[36:39], v[164:167]
    v_cvt_pk_bf16_f32 v45, v46, v47
    v_mfma_f32_16x16x32_bf16 v[132:135], a[200:203], v[32:35], v[132:135]
    v_exp_f32 v48, v48
    v_mfma_f32_16x16x32_bf16 v[100:103], a[200:203], v[28:31], v[100:103]
    v_exp_f32 v49, v49
    v_mfma_f32_16x16x32_bf16 v[104:107], a[204:207], v[28:31], v[104:107]
    v_exp_f32 v50, v50
    v_mfma_f32_16x16x32_bf16 v[136:139], a[204:207], v[32:35], v[136:139]
    s_cbranch_vccz 2
    buffer_load_dwordx4 a[20:23], v24, s[24:27], s45 offen offset:1024 sc1
    v_mfma_f32_16x16x32_bf16 v[168:171], a[204:207], v[36:39], v[168:171]
    s_cbranch_vccnz 1
    s_waitcnt vmcnt(3)
    s_waitcnt vmcnt(7) lgkmcnt(0)
    s_barrier
    v_mfma_f32_16x16x32_bf16 v[200:203], a[204:207], v[40:43], v[200:203]
    buffer_load_dwordx4 v8, s[12:15], s53 offen offset:3072 nt lds
    v_mfma_f32_16x16x32_bf16 v[232:235], a[204:207], v[76:79], v[232:235]
    ds_read_b64_tr_b16 a[184:185], v19 offset:49152
    v_mfma_f32_16x16x32_bf16 v[236:239], a[208:211], v[76:79], v[236:239]
    ds_read_b64_tr_b16 a[186:187], v19 offset:51200
    v_mfma_f32_16x16x32_bf16 v[204:207], a[208:211], v[40:43], v[204:207]
    v_exp_f32 v51, v51
    v_mfma_f32_16x16x32_bf16 v[172:175], a[208:211], v[36:39], v[172:175]
    s_add_u32 s45, s98, 368640
    v_cvt_pk_bf16_f32 v48, v48, v49
    v_mfma_f32_16x16x32_bf16 v[140:143], a[208:211], v[32:35], v[140:143]
    s_cbranch_vccz 2
    buffer_load_dwordx4 a[24:27], v24, s[24:27], s45 offen offset:0 sc1
    v_mfma_f32_16x16x32_bf16 v[108:111], a[208:211], v[28:31], v[108:111]
    v_cvt_pk_bf16_f32 v49, v50, v51
    ds_read_b64_tr_b16 a[188:189], v20 offset:49152
    v_mfma_f32_16x16x32_bf16 v[112:115], a[212:215], v[28:31], v[112:115]
    v_exp_f32 v52, v52
    v_mfma_f32_16x16x32_bf16 v[144:147], a[212:215], v[32:35], v[144:147]
    v_exp_f32 v53, v53
    v_mfma_f32_16x16x32_bf16 v[176:179], a[212:215], v[36:39], v[176:179]
    v_exp_f32 v54, v54
    v_exp_f32 v55, v55
    v_mfma_f32_16x16x32_bf16 v[208:211], a[212:215], v[40:43], v[208:211]
    v_cvt_pk_bf16_f32 v52, v52, v53
    v_cvt_pk_bf16_f32 v53, v54, v55
    v_exp_f32 v56, v56
    v_mfma_f32_16x16x32_bf16 v[240:243], a[212:215], v[76:79], v[240:243]
    v_exp_f32 v57, v57
    v_exp_f32 v58, v58
    v_exp_f32 v59, v59
    v_cvt_pk_bf16_f32 v56, v56, v57
    v_cvt_pk_bf16_f32 v57, v58, v59
    v_exp_f32 v60, v60
    v_exp_f32 v61, v61
    v_exp_f32 v62, v62
    v_exp_f32 v63, v63
    v_cvt_pk_bf16_f32 v46, v60, v61
    v_cvt_pk_bf16_f32 v47, v62, v63
    s_nop 1
    v_mfma_f32_16x16x32_bf16 a[160:163], a[180:183], v[44:47], a[160:163]
    ds_read_b64_tr_b16 a[190:191], v20 offset:51200
    v_exp_f32 v64, v64
    v_exp_f32 v65, v65
    v_exp_f32 v66, v66
    v_exp_f32 v67, v67
    v_cvt_pk_bf16_f32 v50, v64, v65
    v_cvt_pk_bf16_f32 v51, v66, v67
    s_nop 1
    v_mfma_f32_16x16x32_bf16 a[164:167], a[180:183], v[48:51], a[164:167]
    s_add_u32 m0, s89, 32768
    s_add_u32 s53, s56, 0
    s_and_b32 s53, s53, 0x1ffff
    s_add_u32 s53, s53, s91
    v_exp_f32 v68, v68
    v_exp_f32 v69, v69
    v_exp_f32 v70, v70
    v_exp_f32 v71, v71
    v_cvt_pk_bf16_f32 v54, v68, v69
    v_cvt_pk_bf16_f32 v55, v70, v71
    s_nop 1
    v_mfma_f32_16x16x32_bf16 a[168:171], a[180:183], v[52:55], a[168:171]
    buffer_load_dwordx4 v5, s[16:19], s53 offen offset:0 nt lds
    v_exp_f32 v72, v72
    v_exp_f32 v73, v73
    v_exp_f32 v74, v74
    v_exp_f32 v75, v75
    v_cvt_pk_bf16_f32 v58, v72, v73
    v_cvt_pk_bf16_f32 v59, v74, v75
    s_nop 1
    v_mfma_f32_16x16x32_bf16 a[172:175], a[180:183], v[56:59], a[172:175]
    s_cbranch_vccz 2
    buffer_load_dwordx4 a[28:31], v24, s[24:27], s45 offen offset:1024 sc1
    s_waitcnt lgkmcnt(0)
    v_mfma_f32_16x16x32_bf16 v[180:183], a[184:187], v[56:59], v[180:183]
    ds_read_b64_tr_b16 a[192:193], v19 offset:49664
    ds_read_b64_tr_b16 a[194:195], v19 offset:51712
    s_add_u32 s45, s98, 409600
    v_mfma_f32_16x16x32_bf16 v[148:151], a[184:187], v[52:55], v[148:151]
    s_cbranch_vccz 2
    buffer_load_dwordx4 a[32:35], v24, s[24:27], s45 offen offset:0 sc1
    v_mfma_f32_16x16x32_bf16 v[116:119], a[184:187], v[48:51], v[116:119]
    ds_read_b64_tr_b16 a[196:197], v20 offset:49664
    ds_read_b64_tr_b16 a[198:199], v20 offset:51712
    v_mfma_f32_16x16x32_bf16 v[84:87], a[184:187], v[44:47], v[84:87]
    ds_read_b64_tr_b16 a[200:201], v19 offset:53248
    v_mfma_f32_16x16x32_bf16 v[88:91], a[188:191], v[44:47], v[88:91]
    ds_read_b64_tr_b16 a[202:203], v19 offset:55296
    v_mfma_f32_16x16x32_bf16 v[120:123], a[188:191], v[48:51], v[120:123]
    ds_read_b64_tr_b16 a[204:205], v20 offset:53248
    v_mfma_f32_16x16x32_bf16 v[152:155], a[188:191], v[52:55], v[152:155]
    s_cbranch_vccz 2
    buffer_load_dwordx4 a[36:39], v24, s[24:27], s45 offen offset:1024 sc1
    v_mfma_f32_16x16x32_bf16 v[184:187], a[188:191], v[56:59], v[184:187]
    s_waitcnt lgkmcnt(5)
    ds_read_b64_tr_b16 a[206:207], v20 offset:55296
    v_mfma_f32_16x16x32_bf16 v[188:191], a[192:195], v[56:59], v[188:191]
    ds_read_b64_tr_b16 a[208:209], v19 offset:53760
    v_mfma_f32_16x16x32_bf16 v[156:159], a[192:195], v[52:55], v[156:159]
    ds_read_b64_tr_b16 a[210:211], v19 offset:55808
    v_mfma_f32_16x16x32_bf16 v[124:127], a[192:195], v[48:51], v[124:127]
    ds_read_b128 a[48:51], v24 offset:0
    v_mfma_f32_16x16x32_bf16 v[92:95], a[192:195], v[44:47], v[92:95]
    buffer_load_dwordx4 v6, s[16:19], s53 offen offset:1024 nt lds
    s_waitcnt lgkmcnt(4)
    v_mfma_f32_16x16x32_bf16 v[96:99], a[196:199], v[44:47], v[96:99]
    s_add_u32 s45, s98, 450560
    ds_read_b128 a[52:55], v24 offset:18432
    v_mfma_f32_16x16x32_bf16 v[128:131], a[196:199], v[48:51], v[128:131]
    s_cbranch_vccz 2
    buffer_load_dwordx4 a[40:43], v24, s[24:27], s45 offen offset:0 sc1
    v_mfma_f32_16x16x32_bf16 v[160:163], a[196:199], v[52:55], v[160:163]
    ds_read_b128 a[56:59], v24 offset:36864
    v_mfma_f32_16x16x32_bf16 v[192:195], a[196:199], v[56:59], v[192:195]
    ds_read_b128 a[60:63], v24 offset:55296
    v_mfma_f32_16x16x32_bf16 v[196:199], a[200:203], v[56:59], v[196:199]
    ds_read_b128 a[64:67], v24 offset:9216
    v_mfma_f32_16x16x32_bf16 v[164:167], a[200:203], v[52:55], v[164:167]
    ds_read_b128 a[68:71], v24 offset:27648
    v_mfma_f32_16x16x32_bf16 v[132:135], a[200:203], v[48:51], v[132:135]
    s_cbranch_vccz 2
    buffer_load_dwordx4 a[44:47], v24, s[24:27], s45 offen offset:1024 sc1
    v_mfma_f32_16x16x32_bf16 v[100:103], a[200:203], v[44:47], v[100:103]
    s_waitcnt lgkmcnt(4)
    ds_read_b128 a[72:75], v24 offset:46080
    v_mfma_f32_16x16x32_bf16 v[104:107], a[204:207], v[44:47], v[104:107]
    ds_read_b128 a[76:79], v24 offset:64512
    v_mfma_f32_16x16x32_bf16 v[136:139], a[204:207], v[48:51], v[136:139]
    ds_read_b64_tr_b16 a[212:213], v20 offset:53760
    v_mfma_f32_16x16x32_bf16 v[168:171], a[204:207], v[52:55], v[168:171]
    ds_read_b64_tr_b16 a[214:215], v20 offset:55808
    v_mfma_f32_16x16x32_bf16 v[200:203], a[204:207], v[56:59], v[200:203]
    v_mfma_f32_16x16x32_bf16 v[204:207], a[208:211], v[56:59], v[204:207]
    v_mfma_f32_16x16x32_bf16 v[172:175], a[208:211], v[52:55], v[172:175]
    v_mfma_f32_16x16x32_bf16 v[140:143], a[208:211], v[48:51], v[140:143]
    v_mfma_f32_16x16x32_bf16 v[108:111], a[208:211], v[44:47], v[108:111]
    s_waitcnt lgkmcnt(0)
    v_mfma_f32_16x16x32_bf16 v[112:115], a[212:215], v[44:47], v[112:115]
    s_cbranch_vccnz 1
    s_waitcnt vmcnt(3)
    s_waitcnt lgkmcnt(0)
    s_barrier
    v_xor_b32 v19, 0x10000, v19
    v_xor_b32 v20, 0x10000, v20
    v_xor_b32 v18, 0x10000, v18
    v_mfma_f32_16x16x32_bf16 v[144:147], a[212:215], v[48:51], v[144:147]
    v_mfma_f32_16x16x32_bf16 v[176:179], a[212:215], v[52:55], v[176:179]
    v_mfma_f32_16x16x32_bf16 v[208:211], a[212:215], v[56:59], v[208:211]
    s_cmp_eq_u32 s51, 0
    s_cbranch_scc0 gqa_kernel_P0
    s_branch gqa_kernel_F
gqa_kernel_A1:
    s_waitcnt vmcnt(3) lgkmcnt(0)
    s_barrier
    ds_read_b128 a[184:187], v18 offset:512
    s_waitcnt lgkmcnt(0)
    v_mfma_f32_16x16x32_bf16 v[28:31], a[184:187], a[0:3], 0
    ds_read_b128 a[188:191], v18 offset:0
    ds_read_b128 a[192:195], v18 offset:4608
    s_waitcnt lgkmcnt(1)
    v_mfma_f32_16x16x32_bf16 v[28:31], a[188:191], a[4:7], v[28:31]
    s_waitcnt lgkmcnt(0)
    ds_read_b128 a[196:199], v18 offset:4096
    v_mfma_f32_16x16x32_bf16 v[28:31], a[192:195], a[8:11], v[28:31]
    s_waitcnt lgkmcnt(0)
    ds_read_b128 a[200:203], v18 offset:2560
    v_mfma_f32_16x16x32_bf16 v[28:31], a[196:199], a[12:15], v[28:31]
    ds_read_b128 a[204:207], v18 offset:2048
    v_mfma_f32_16x16x32_bf16 v[32:35], a[184:187], a[16:19], 0
    s_add_u32 s45, s98, 0
    ds_read_b128 a[208:211], v18 offset:6656
    v_mfma_f32_16x16x32_bf16 v[32:35], a[188:191], a[20:23], v[32:35]
    s_cbranch_vccz 2
    buffer_load_dwordx4 a[216:219], v24, s[24:27], s45 offen offset:0 sc1
    v_mfma_f32_16x16x32_bf16 v[32:35], a[192:195], a[24:27], v[32:35]
    ds_read_b128 a[212:215], v18 offset:6144
    v_mfma_f32_16x16x32_bf16 v[32:35], a[196:199], a[28:31], v[32:35]
    v_exp_f32 v28, v28
    v_mfma_f32_16x16x32_bf16 v[36:39], a[184:187], a[32:35], 0
    v_exp_f32 v29, v29
    v_mfma_f32_16x16x32_bf16 v[36:39], a[188:191], a[36:39], v[36:39]
    v_exp_f32 v30, v30
    v_mfma_f32_16x16x32_bf16 v[36:39], a[192:195], a[40:43], v[36:39]
    v_exp_f32 v31, v31
    v_mfma_f32_16x16x32_bf16 v[36:39], a[196:199], a[44:47], v[36:39]
    v_cvt_pk_bf16_f32 v28, v28, v29
    v_cvt_pk_bf16_f32 v29, v30, v31
    v_mfma_f32_16x16x32_bf16 v[40:43], a[184:187], a[48:51], 0
    v_exp_f32 v32, v32
    v_mfma_f32_16x16x32_bf16 v[40:43], a[188:191], a[52:55], v[40:43]
    s_cbranch_vccz 2
    buffer_load_dwordx4 a[220:223], v24, s[24:27], s45 offen offset:1024 sc1
    v_mfma_f32_16x16x32_bf16 v[40:43], a[192:195], a[56:59], v[40:43]
    v_exp_f32 v33, v33
    v_mfma_f32_16x16x32_bf16 v[40:43], a[196:199], a[60:63], v[40:43]
    s_waitcnt lgkmcnt(0)
    v_exp_f32 v34, v34
    v_mfma_f32_16x16x32_bf16 v[60:63], a[200:203], a[0:3], 0
    v_exp_f32 v35, v35
    v_mfma_f32_16x16x32_bf16 v[60:63], a[204:207], a[4:7], v[60:63]
    v_cvt_pk_bf16_f32 v32, v32, v33
    v_cvt_pk_bf16_f32 v33, v34, v35
    v_mfma_f32_16x16x32_bf16 v[60:63], a[208:211], a[8:11], v[60:63]
    v_exp_f32 v36, v36
    v_mfma_f32_16x16x32_bf16 v[60:63], a[212:215], a[12:15], v[60:63]
    v_exp_f32 v37, v37
    v_mfma_f32_16x16x32_bf16 v[64:67], a[200:203], a[16:19], 0
    v_exp_f32 v38, v38
    v_mfma_f32_16x16x32_bf16 v[64:67], a[204:207], a[20:23], v[64:67]
    v_exp_f32 v39, v39
    v_mfma_f32_16x16x32_bf16 v[64:67], a[208:211], a[24:27], v[64:67]
    s_add_u32 s45, s98, 40960
    v_cvt_pk_bf16_f32 v36, v36, v37
    s_cbranch_vccz 2
    buffer_load_dwordx4 a[224:227], v24, s[24:27], s45 offen offset:0 sc1
    v_mfma_f32_16x16x32_bf16 v[64:67], a[212:215], a[28:31], v[64:67]
    s_lshr_b32 s97, s97, 1
    s_cbranch_scc0 1
    s_waitcnt vmcnt(7)
    s_cbranch_vccnz 1
    s_waitcnt vmcnt(4)
    s_waitcnt vmcnt(8) lgkmcnt(0)
    s_barrier
    s_add_u32 m0, s60, 0
    s_add_u32 s53, s56, 24576
    v_mfma_f32_16x16x32_bf16 v[68:71], a[200:203], a[32:35], 0
    s_and_b32 s53, s53, 0x1ffff
    s_add_u32 s53, s53, s58
    ds_read_b128 a[184:187], v18 offset:16896
    ds_read_b128 a[188:191], v18 offset:16384
    v_mfma_f32_16x16x32_bf16 v[68:71], a[204:207], a[36:39], v[68:71]
    buffer_load_dwordx4 v5, s[16:19], s53 offen offset:0 nt lds
    v_mfma_f32_16x16x32_bf16 v[68:71], a[208:211], a[40:43], v[68:71]
    ds_read_b128 a[192:195], v18 offset:20992
    ds_read_b128 a[196:199], v18 offset:20480
    v_mfma_f32_16x16x32_bf16 v[68:71], a[212:215], a[44:47], v[68:71]
    v_cvt_pk_bf16_f32 v37, v38, v39
    v_mfma_f32_16x16x32_bf16 v[72:75], a[200:203], a[48:51], 0
    ds_read_b128 a[200:203], v18 offset:18944
    v_mfma_f32_16x16x32_bf16 v[72:75], a[204:207], a[52:55], v[72:75]
    ds_read_b128 a[204:207], v18 offset:18432
    v_mfma_f32_16x16x32_bf16 v[72:75], a[208:211], a[56:59], v[72:75]
    ds_read_b128 a[208:211], v18 offset:23040
    v_mfma_f32_16x16x32_bf16 v[72:75], a[212:215], a[60:63], v[72:75]
    s_waitcnt lgkmcnt(5)
    ds_read_b128 a[212:215], v18 offset:22528
    v_mfma_f32_16x16x32_bf16 v[44:47], a[184:187], a[0:3], 0
    s_cbranch_vccz 2
    buffer_load_dwordx4 a[228:231], v24, s[24:27], s45 offen offset:1024 sc1
    v_mfma_f32_16x16x32_bf16 v[44:47], a[188:191], a[4:7], v[44:47]
    s_waitcnt lgkmcnt(4)
    v_exp_f32 v40, v40
    v_mfma_f32_16x16x32_bf16 v[44:47], a[192:195], a[8:11], v[44:47]
    v_exp_f32 v41, v41
    v_mfma_f32_16x16x32_bf16 v[44:47], a[196:199], a[12:15], v[44:47]
    v_exp_f32 v42, v42
    v_mfma_f32_16x16x32_bf16 v[48:51], a[184:187], a[16:19], 0
    v_exp_f32 v43, v43
    v_mfma_f32_16x16x32_bf16 v[48:51], a[188:191], a[20:23], v[48:51]
    buffer_load_dwordx4 v6, s[16:19], s53 offen offset:1024 nt lds
    v_mfma_f32_16x16x32_bf16 v[48:51], a[192:195], a[24:27], v[48:51]
    s_add_u32 s45, s98, 81920
    v_cvt_pk_bf16_f32 v40, v40, v41
    v_mfma_f32_16x16x32_bf16 v[48:51], a[196:199], a[28:31], v[48:51]
    s_cbranch_vccz 2
    buffer_load_dwordx4 a[232:235], v24, s[24:27], s45 offen offset:0 sc1
    v_mfma_f32_16x16x32_bf16 v[52:55], a[184:187], a[32:35], 0
    v_cvt_pk_bf16_f32 v41, v42, v43
    v_mfma_f32_16x16x32_bf16 v[52:55], a[188:191], a[36:39], v[52:55]
    v_exp_f32 v60, v60
    v_mfma_f32_16x16x32_bf16 v[52:55], a[192:195], a[40:43], v[52:55]
    v_exp_f32 v61, v61
    v_mfma_f32_16x16x32_bf16 v[52:55], a[196:199], a[44:47], v[52:55]
    v_exp_f32 v62, v62
    v_mfma_f32_16x16x32_bf16 v[56:59], a[184:187], a[48:51], 0
    v_exp_f32 v63, v63
    v_mfma_f32_16x16x32_bf16 v[56:59], a[188:191], a[52:55], v[56:59]
    v_cvt_pk_bf16_f32 v30, v60, v61
    v_cvt_pk_bf16_f32 v31, v62, v63
    v_mfma_f32_16x16x32_bf16 v[56:59], a[192:195], a[56:59], v[56:59]
    s_cbranch_vccz 2
    buffer_load_dwordx4 a[236:239], v24, s[24:27], s45 offen offset:1024 sc1
    v_mfma_f32_16x16x32_bf16 v[56:59], a[196:199], a[60:63], v[56:59]
    v_exp_f32 v64, v64
    v_mfma_f32_16x16x32_bf16 v[76:79], a[184:187], a[64:67], 0
    v_exp_f32 v65, v65
    v_mfma_f32_16x16x32_bf16 v[76:79], a[188:191], a[68:71], v[76:79]
    v_exp_f32 v66, v66
    v_mfma_f32_16x16x32_bf16 v[76:79], a[192:195], a[72:75], v[76:79]
    v_exp_f32 v67, v67
    v_mfma_f32_16x16x32_bf16 v[76:79], a[196:199], a[76:79], v[76:79]
    buffer_load_dwordx4 v7, s[16:19], s53 offen offset:2048 nt lds
    s_waitcnt lgkmcnt(0)
    v_mfma_f32_16x16x32_bf16 v[60:63], a[200:203], a[0:3], 0
    v_cvt_pk_bf16_f32 v34, v64, v65
    v_cvt_pk_bf16_f32 v35, v66, v67
    v_mfma_f32_16x16x32_bf16 v[60:63], a[204:207], a[4:7], v[60:63]
    v_exp_f32 v68, v68
    v_mfma_f32_16x16x32_bf16 v[60:63], a[208:211], a[8:11], v[60:63]
    v_exp_f32 v69, v69
    v_mfma_f32_16x16x32_bf16 v[60:63], a[212:215], a[12:15], v[60:63]
    v_exp_f32 v70, v70
    v_mfma_f32_16x16x32_bf16 v[64:67], a[200:203], a[16:19], 0
    v_exp_f32 v71, v71
    v_mfma_f32_16x16x32_bf16 v[64:67], a[204:207], a[20:23], v[64:67]
    v_cvt_pk_bf16_f32 v38, v68, v69
    v_cvt_pk_bf16_f32 v39, v70, v71
    v_mfma_f32_16x16x32_bf16 v[64:67], a[208:211], a[24:27], v[64:67]
    v_exp_f32 v72, v72
    v_mfma_f32_16x16x32_bf16 v[64:67], a[212:215], a[28:31], v[64:67]
    v_exp_f32 v73, v73
    v_mfma_f32_16x16x32_bf16 v[68:71], a[200:203], a[32:35], 0
    v_exp_f32 v74, v74
    v_mfma_f32_16x16x32_bf16 v[68:71], a[204:207], a[36:39], v[68:71]
    v_exp_f32 v75, v75
    v_cvt_pk_bf16_f32 v42, v72, v73
    v_cvt_pk_bf16_f32 v43, v74, v75
    v_mfma_f32_16x16x32_bf16 v[68:71], a[208:211], a[40:43], v[68:71]
    v_exp_f32 v44, v44
    v_mfma_f32_16x16x32_bf16 v[68:71], a[212:215], a[44:47], v[68:71]
    v_exp_f32 v45, v45
    v_mfma_f32_16x16x32_bf16 v[72:75], a[200:203], a[48:51], 0
    v_exp_f32 v46, v46
    v_mfma_f32_16x16x32_bf16 v[72:75], a[204:207], a[52:55], v[72:75]
    v_exp_f32 v47, v47
    v_mfma_f32_16x16x32_bf16 v[72:75], a[208:211], a[56:59], v[72:75]
    v_cvt_pk_bf16_f32 v44, v44, v45
    v_cvt_pk_bf16_f32 v45, v46, v47
    v_mfma_f32_16x16x32_bf16 v[72:75], a[212:215], a[60:63], v[72:75]
    s_cbranch_vccnz 1
    s_waitcnt vmcnt(4)
    s_waitcnt vmcnt(7) lgkmcnt(0)
    s_barrier
    ds_read_b64_tr_b16 a[184:185], v19 offset:32768
    ds_read_b64_tr_b16 a[186:187], v19 offset:34816
    v_mfma_f32_16x16x32_bf16 v[80:83], a[200:203], a[64:67], 0
    buffer_load_dwordx4 v8, s[16:19], s53 offen offset:3072 nt lds
    v_mfma_f32_16x16x32_bf16 v[80:83], a[204:207], a[68:71], v[80:83]
    ds_read_b64_tr_b16 a[188:189], v20 offset:32768
    v_mfma_f32_16x16x32_bf16 v[80:83], a[208:211], a[72:75], v[80:83]
    ds_read_b64_tr_b16 a[190:191], v20 offset:34816
    v_mfma_f32_16x16x32_bf16 v[80:83], a[212:215], a[76:79], v[80:83]
    ds_read_b64_tr_b16 a[192:193], v19 offset:33280
    v_mfma_f32_16x16x32_bf16 a[160:163], a[180:183], v[28:31], 0
    ds_read_b64_tr_b16 a[194:195], v19 offset:35328
    s_add_u32 s45, s98, 122880
    v_mfma_f32_16x16x32_bf16 a[164:167], a[180:183], v[32:35], 0
    ds_read_b64_tr_b16 a[196:197], v20 offset:33280
    v_mfma_f32_16x16x32_bf16 a[168:171], a[180:183], v[36:39], 0
    ds_read_b64_tr_b16 a[198:199], v20 offset:35328
    v_mfma_f32_16x16x32_bf16 a[172:175], a[180:183], v[40:43], 0
    s_cbranch_vccz 2
    buffer_load_dwordx4 a[240:243], v24, s[24:27], s45 offen offset:0 sc1
    s_waitcnt lgkmcnt(5)
    v_mfma_f32_16x16x32_bf16 v[180:183], a[184:187], v[40:43], 0
    ds_read_b64_tr_b16 a[200:201], v19 offset:36864
    v_mfma_f32_16x16x32_bf16 v[148:151], a[184:187], v[36:39], 0
    s_add_u32 m0, s60, 16384
    s_add_u32 s53, s56, 40960
    s_and_b32 s53, s53, 0x1ffff
    s_add_u32 s53, s53, s58
    v_mfma_f32_16x16x32_bf16 v[116:119], a[184:187], v[32:35], 0
    buffer_load_dwordx4 v5, s[12:15], s53 offen offset:0 nt lds
    v_mfma_f32_16x16x32_bf16 v[84:87], a[184:187], v[28:31], 0
    s_waitcnt lgkmcnt(1)
    ds_read_b64_tr_b16 a[202:203], v19 offset:38912
    v_mfma_f32_16x16x32_bf16 v[88:91], a[188:191], v[28:31], 0
    ds_read_b64_tr_b16 a[204:205], v20 offset:36864
    v_mfma_f32_16x16x32_bf16 v[120:123], a[188:191], v[32:35], 0
    s_cbranch_vccz 2
    buffer_load_dwordx4 a[244:247], v24, s[24:27], s45 offen offset:1024 sc1
    v_mfma_f32_16x16x32_bf16 v[152:155], a[188:191], v[36:39], 0
    ds_read_b64_tr_b16 a[206:207], v20 offset:38912
    v_mfma_f32_16x16x32_bf16 v[184:187], a[188:191], v[40:43], 0
    ds_read_b64_tr_b16 a[208:209], v19 offset:37376
    v_mfma_f32_16x16x32_bf16 v[188:191], a[192:195], v[40:43], 0
    ds_read_b64_tr_b16 a[210:211], v19 offset:39424
    v_mfma_f32_16x16x32_bf16 v[156:159], a[192:195], v[36:39], 0
    ds_read_b64_tr_b16 a[212:213], v20 offset:37376
    v_mfma_f32_16x16x32_bf16 v[124:127], a[192:195], v[32:35], 0
    ds_read_b64_tr_b16 a[214:215], v20 offset:39424
    v_mfma_f32_16x16x32_bf16 v[92:95], a[192:195], v[28:31], 0
    buffer_load_dwordx4 v6, s[12:15], s53 offen offset:1024 nt lds
    v_mfma_f32_16x16x32_bf16 v[96:99], a[196:199], v[28:31], 0
    v_exp_f32 v48, v48
    v_mfma_f32_16x16x32_bf16 v[128:131], a[196:199], v[32:35], 0
    v_exp_f32 v49, v49
    v_mfma_f32_16x16x32_bf16 v[160:163], a[196:199], v[36:39], 0
    s_add_u32 s45, s98, 163840
    v_mfma_f32_16x16x32_bf16 v[192:195], a[196:199], v[40:43], 0
    s_cbranch_vccz 2
    buffer_load_dwordx4 a[248:251], v24, s[24:27], s45 offen offset:0 sc1
    s_waitcnt lgkmcnt(2)
    v_mfma_f32_16x16x32_bf16 v[196:199], a[200:203], v[40:43], 0
    v_exp_f32 v50, v50
    v_mfma_f32_16x16x32_bf16 v[164:167], a[200:203], v[36:39], 0
    v_exp_f32 v51, v51
    v_mfma_f32_16x16x32_bf16 v[132:135], a[200:203], v[32:35], 0
    v_cvt_pk_bf16_f32 v48, v48, v49
    v_cvt_pk_bf16_f32 v49, v50, v51
    v_mfma_f32_16x16x32_bf16 v[100:103], a[200:203], v[28:31], 0
    v_exp_f32 v52, v52
    v_mfma_f32_16x16x32_bf16 v[104:107], a[204:207], v[28:31], 0
    v_exp_f32 v53, v53
    v_mfma_f32_16x16x32_bf16 v[136:139], a[204:207], v[32:35], 0
    v_exp_f32 v54, v54
    v_mfma_f32_16x16x32_bf16 v[168:171], a[204:207], v[36:39], 0
    v_exp_f32 v55, v55
    v_mfma_f32_16x16x32_bf16 v[200:203], a[204:207], v[40:43], 0
    s_lshr_b32 s97, s97, 1
    s_cbranch_scc0 1
    s_waitcnt vmcnt(7)
    s_cbranch_vccnz 1
    s_waitcnt vmcnt(4)
    s_waitcnt vmcnt(8) lgkmcnt(0)
    s_barrier
    ds_read_b128 a[184:187], v18 offset:49664
    ds_read_b128 a[188:191], v18 offset:49152
    v_mfma_f32_16x16x32_bf16 v[204:207], a[208:211], v[40:43], 0
    buffer_load_dwordx4 v7, s[12:15], s53 offen offset:2048 nt lds
    v_mfma_f32_16x16x32_bf16 v[172:175], a[208:211], v[36:39], 0
    ds_read_b128 a[192:195], v18 offset:53760
    ds_read_b128 a[196:199], v18 offset:53248
    v_mfma_f32_16x16x32_bf16 v[140:143], a[208:211], v[32:35], 0
    ds_read_b128 a[200:203], v18 offset:51712
    v_cvt_pk_bf16_f32 v52, v52, v53
    v_mfma_f32_16x16x32_bf16 v[108:111], a[208:211], v[28:31], 0
    ds_read_b128 a[204:207], v18 offset:51200
    v_cvt_pk_bf16_f32 v53, v54, v55
    v_mfma_f32_16x16x32_bf16 v[112:115], a[212:215], v[28:31], 0
    s_cbranch_vccz 2
    buffer_load_dwordx4 a[252:255], v24, s[24:27], s45 offen offset:1024 sc1
    v_mfma_f32_16x16x32_bf16 v[144:147], a[212:215], v[32:35], 0
    ds_read_b128 a[208:211], v18 offset:55808
    v_mfma_f32_16x16x32_bf16 v[176:179], a[212:215], v[36:39], 0
    v_exp_f32 v56, v56
    v_mfma_f32_16x16x32_bf16 v[208:211], a[212:215], v[40:43], 0
    s_waitcnt lgkmcnt(3)
    ds_read_b128 a[212:215], v18 offset:55296
    v_mfma_f32_16x16x32_bf16 v[28:31], a[184:187], a[0:3], 0
    v_exp_f32 v57, v57
    v_mfma_f32_16x16x32_bf16 v[28:31], a[188:191], a[4:7], v[28:31]
    v_exp_f32 v58, v58
    v_mfma_f32_16x16x32_bf16 v[28:31], a[192:195], a[8:11], v[28:31]
    v_exp_f32 v59, v59
    v_mfma_f32_16x16x32_bf16 v[28:31], a[196:199], a[12:15], v[28:31]
    v_cvt_pk_bf16_f32 v56, v56, v57
    v_cvt_pk_bf16_f32 v57, v58, v59
    v_mfma_f32_16x16x32_bf16 v[32:35], a[184:187], a[16:19], 0
    v_exp_f32 v76, v76
    v_mfma_f32_16x16x32_bf16 v[32:35], a[188:191], a[20:23], v[32:35]
    s_add_u32 s45, s98, 204800
    v_mfma_f32_16x16x32_bf16 v[32:35], a[192:195], a[24:27], v[32:35]
    s_cbranch_vccz 2
    buffer_load_dwordx4 v[10:13], v24, s[24:27], s45 offen offset:0 sc1
    v_mfma_f32_16x16x32_bf16 v[32:35], a[196:199], a[28:31], v[32:35]
    v_exp_f32 v77, v77
    v_mfma_f32_16x16x32_bf16 v[36:39], a[184:187], a[32:35], 0
    buffer_load_dwordx4 v8, s[12:15], s53 offen offset:3072 nt lds
    v_mfma_f32_16x16x32_bf16 v[36:39], a[188:191], a[36:39], v[36:39]
    v_exp_f32 v78, v78
    v_mfma_f32_16x16x32_bf16 v[36:39], a[192:195], a[40:43], v[36:39]
    v_exp_f32 v79, v79
    v_mfma_f32_16x16x32_bf16 v[36:39], a[196:199], a[44:47], v[36:39]
    v_cvt_pk_bf16_f32 v76, v76, v77
    v_cvt_pk_bf16_f32 v77, v78, v79
    v_mfma_f32_16x16x32_bf16 v[40:43], a[184:187], a[48:51], 0
    v_exp_f32 v60, v60
    v_mfma_f32_16x16x32_bf16 v[40:43], a[188:191], a[52:55], v[40:43]
    v_exp_f32 v61, v61
    v_exp_f32 v62, v62
    v_mfma_f32_16x16x32_bf16 v[40:43], a[192:195], a[56:59], v[40:43]
    s_cbranch_vccz 2
    buffer_load_dwordx4 v[14:17], v24, s[24:27], s45 offen offset:1024 sc1
    v_mfma_f32_16x16x32_bf16 v[40:43], a[196:199], a[60:63], v[40:43]
    s_waitcnt lgkmcnt(0)
    v_exp_f32 v63, v63
    v_cvt_pk_bf16_f32 v46, v60, v61
    v_cvt_pk_bf16_f32 v47, v62, v63
    v_mfma_f32_16x16x32_bf16 v[60:63], a[200:203], a[0:3], 0
    v_exp_f32 v64, v64
    v_mfma_f32_16x16x32_bf16 v[60:63], a[204:207], a[4:7], v[60:63]
    v_exp_f32 v65, v65
    v_exp_f32 v66, v66
    v_mfma_f32_16x16x32_bf16 v[60:63], a[208:211], a[8:11], v[60:63]
    v_exp_f32 v67, v67
    v_cvt_pk_bf16_f32 v50, v64, v65
    v_cvt_pk_bf16_f32 v51, v66, v67
    v_mfma_f32_16x16x32_bf16 v[60:63], a[212:215], a[12:15], v[60:63]
    v_exp_f32 v68, v68
    v_mfma_f32_16x16x32_bf16 v[64:67], a[200:203], a[16:19], 0
    v_exp_f32 v69, v69
    v_mfma_f32_16x16x32_bf16 v[64:67], a[204:207], a[20:23], v[64:67]
    v_exp_f32 v70, v70
    v_exp_f32 v71, v71
    v_mfma_f32_16x16x32_bf16 v[64:67], a[208:211], a[24:27], v[64:67]
    v_cvt_pk_bf16_f32 v54, v68, v69
    v_cvt_pk_bf16_f32 v55, v70, v71
    v_mfma_f32_16x16x32_bf16 v[64:67], a[212:215], a[28:31], v[64:67]
    v_exp_f32 v72, v72
    v_mfma_f32_16x16x32_bf16 v[68:71], a[200:203], a[32:35], 0
    v_exp_f32 v73, v73
    v_mfma_f32_16x16x32_bf16 v[68:71], a[204:207], a[36:39], v[68:71]
    v_exp_f32 v74, v74
    v_exp_f32 v75, v75
    v_mfma_f32_16x16x32_bf16 v[68:71], a[208:211], a[40:43], v[68:71]
    v_cvt_pk_bf16_f32 v58, v72, v73
    v_cvt_pk_bf16_f32 v59, v74, v75
    v_mfma_f32_16x16x32_bf16 v[68:71], a[212:215], a[44:47], v[68:71]
    v_exp_f32 v80, v80
    v_mfma_f32_16x16x32_bf16 v[72:75], a[200:203], a[48:51], 0
    s_cbranch_vccnz 1
    s_waitcnt vmcnt(4)
    s_waitcnt vmcnt(7) lgkmcnt(0)
    s_barrier
    v_xor_b32 v19, 0x10000, v19
    v_xor_b32 v20, 0x10000, v20
    v_xor_b32 v18, 0x10000, v18
    s_add_u32 s57, s56, 32768
    s_and_b32 s57, s57, 0x1ffff
    v_mfma_f32_16x16x32_bf16 v[72:75], a[204:207], a[52:55], v[72:75]
    s_mov_b32 s88, 16384
    s_mov_b32 s94, 32768
    s_cmp_gt_i32 s88, 0
    s_cselect_b64 s[28:29], s[16:17], s[12:13]
    v_mfma_f32_16x16x32_bf16 v[72:75], a[208:211], a[56:59], v[72:75]
    s_add_u32 m0, s60, s94
    s_add_u32 s53, s58, s57
    ds_read_b64_tr_b16 a[184:185], v19 offset:0
    ds_read_b64_tr_b16 a[186:187], v19 offset:2048
    v_mfma_f32_16x16x32_bf16 v[72:75], a[212:215], a[60:63], v[72:75]
    buffer_load_dwordx4 v5, s[28:31], s53 offen offset:0 nt lds
    v_mfma_f32_16x16x32_bf16 a[160:163], a[180:183], v[44:47], a[160:163]
    s_add_u32 s57, s57, s88
    ds_read_b64_tr_b16 a[188:189], v20 offset:0
    ds_read_b64_tr_b16 a[190:191], v20 offset:2048
    v_mfma_f32_16x16x32_bf16 a[164:167], a[180:183], v[48:51], a[164:167]
    v_exp_f32 v81, v81
    v_exp_f32 v82, v82
    v_mfma_f32_16x16x32_bf16 a[168:171], a[180:183], v[52:55], a[168:171]
    v_exp_f32 v83, v83
    v_cvt_pk_bf16_f32 v78, v80, v81
    v_cvt_pk_bf16_f32 v79, v82, v83
    v_mfma_f32_16x16x32_bf16 a[172:175], a[180:183], v[56:59], a[172:175]
    ds_read_b64_tr_b16 a[192:193], v19 offset:512
    v_mfma_f32_16x16x32_bf16 a[176:179], a[180:183], v[76:79], 0
    s_waitcnt lgkmcnt(3)
    ds_read_b64_tr_b16 a[194:195], v19 offset:2560
    v_mfma_f32_16x16x32_bf16 v[228:231], a[184:187], v[76:79], 0
    buffer_load_dwordx4 v6, s[28:31], s53 offen offset:1024 nt lds
    v_mfma_f32_16x16x32_bf16 v[180:183], a[184:187], v[56:59], v[180:183]
    s_and_b32 s57, s57, 0x1ffff
    s_sub_u32 s88, 8192, s88
    v_mfma_f32_16x16x32_bf16 v[148:151], a[184:187], v[52:55], v[148:151]
    ds_read_b64_tr_b16 a[196:197], v20 offset:512
    v_mfma_f32_16x16x32_bf16 v[116:119], a[184:187], v[48:51], v[116:119]
    ds_read_b64_tr_b16 a[198:199], v20 offset:2560
    v_mfma_f32_16x16x32_bf16 v[84:87], a[184:187], v[44:47], v[84:87]
    s_waitcnt lgkmcnt(3)
    ds_read_b64_tr_b16 a[200:201], v19 offset:4096
    v_mfma_f32_16x16x32_bf16 v[88:91], a[188:191], v[44:47], v[88:91]
    ds_read_b64_tr_b16 a[202:203], v19 offset:6144
    v_mfma_f32_16x16x32_bf16 v[120:123], a[188:191], v[48:51], v[120:123]
    ds_read_b64_tr_b16 a[204:205], v20 offset:4096
    v_mfma_f32_16x16x32_bf16 v[152:155], a[188:191], v[52:55], v[152:155]
    ds_read_b64_tr_b16 a[206:207], v20 offset:6144
    v_mfma_f32_16x16x32_bf16 v[184:187], a[188:191], v[56:59], v[184:187]
    ds_read_b64_tr_b16 a[208:209], v19 offset:4608
    v_mfma_f32_16x16x32_bf16 v[232:235], a[188:191], v[76:79], 0
    s_waitcnt lgkmcnt(5)
    ds_read_b64_tr_b16 a[210:211], v19 offset:6656
    v_mfma_f32_16x16x32_bf16 v[236:239], a[192:195], v[76:79], 0
    buffer_load_dwordx4 v7, s[28:31], s53 offen offset:2048 nt lds
    v_mfma_f32_16x16x32_bf16 v[188:191], a[192:195], v[56:59], v[188:191]
    s_add_u32 s94, s94, 16384
    s_and_b32 s94, s94, 0x1ffff
    v_mfma_f32_16x16x32_bf16 v[156:159], a[192:195], v[52:55], v[156:159]
    ds_read_b64_tr_b16 a[212:213], v20 offset:4608
    v_mfma_f32_16x16x32_bf16 v[124:127], a[192:195], v[48:51], v[124:127]
    ds_read_b64_tr_b16 a[214:215], v20 offset:6656
    v_mfma_f32_16x16x32_bf16 v[92:95], a[192:195], v[44:47], v[92:95]
    v_exp_f32 v28, v28
    v_mfma_f32_16x16x32_bf16 v[96:99], a[196:199], v[44:47], v[96:99]
    v_exp_f32 v29, v29
    v_mfma_f32_16x16x32_bf16 v[128:131], a[196:199], v[48:51], v[128:131]
    v_exp_f32 v30, v30
    v_mfma_f32_16x16x32_bf16 v[160:163], a[196:199], v[52:55], v[160:163]
    v_exp_f32 v31, v31
    v_mfma_f32_16x16x32_bf16 v[192:195], a[196:199], v[56:59], v[192:195]
    v_cvt_pk_bf16_f32 v28, v28, v29
    v_cvt_pk_bf16_f32 v29, v30, v31
    v_mfma_f32_16x16x32_bf16 v[240:243], a[196:199], v[76:79], 0
    buffer_load_dwordx4 v8, s[28:31], s53 offen offset:3072 nt lds
    s_waitcnt lgkmcnt(0)
    v_mfma_f32_16x16x32_bf16 v[212:215], a[200:203], v[76:79], 0
    v_exp_f32 v32, v32
    v_mfma_f32_16x16x32_bf16 v[196:199], a[200:203], v[56:59], v[196:199]
    v_exp_f32 v33, v33
    v_mfma_f32_16x16x32_bf16 v[164:167], a[200:203], v[52:55], v[164:167]
    v_exp_f32 v34, v34
    v_mfma_f32_16x16x32_bf16 v[132:135], a[200:203], v[48:51], v[132:135]
    v_exp_f32 v35, v35
    v_mfma_f32_16x16x32_bf16 v[100:103], a[200:203], v[44:47], v[100:103]
    v_cvt_pk_bf16_f32 v32, v32, v33
    v_cvt_pk_bf16_f32 v33, v34, v35
    v_mfma_f32_16x16x32_bf16 v[104:107], a[204:207], v[44:47], v[104:107]
    v_exp_f32 v36, v36
    v_mfma_f32_16x16x32_bf16 v[136:139], a[204:207], v[48:51], v[136:139]
    v_exp_f32 v37, v37
    v_mfma_f32_16x16x32_bf16 v[168:171], a[204:207], v[52:55], v[168:171]
    v_exp_f32 v38, v38
    v_mfma_f32_16x16x32_bf16 v[200:203], a[204:207], v[56:59], v[200:203]
    v_exp_f32 v39, v39
    v_mfma_f32_16x16x32_bf16 v[216:219], a[204:207], v[76:79], 0
    v_cvt_pk_bf16_f32 v36, v36, v37
    v_cvt_pk_bf16_f32 v37, v38, v39
    v_mfma_f32_16x16x32_bf16 v[220:223], a[208:211], v[76:79], 0
    v_exp_f32 v40, v40
    v_mfma_f32_16x16x32_bf16 v[204:207], a[208:211], v[56:59], v[204:207]
    s_lshr_b32 s97, s97, 1
    s_cbranch_scc0 1
    s_waitcnt vmcnt(3)
    s_waitcnt vmcnt(4) lgkmcnt(0)
    s_barrier
    s_cmp_gt_i32 s88, 0
    s_cselect_b64 s[28:29], s[16:17], s[12:13]
    v_mfma_f32_16x16x32_bf16 v[172:175], a[208:211], v[52:55], v[172:175]
    s_add_u32 m0, s60, s94
    s_add_u32 s53, s58, s57
    ds_read_b128 a[184:187], v18 offset:16896
    ds_read_b128 a[188:191], v18 offset:16384
    v_mfma_f32_16x16x32_bf16 v[140:143], a[208:211], v[48:51], v[140:143]
    buffer_load_dwordx4 v5, s[28:31], s53 offen offset:0 nt lds
    v_mfma_f32_16x16x32_bf16 v[108:111], a[208:211], v[44:47], v[108:111]
    s_add_u32 s57, s57, s88
    ds_read_b128 a[192:195], v18 offset:20992
    ds_read_b128 a[196:199], v18 offset:20480
    v_mfma_f32_16x16x32_bf16 v[112:115], a[212:215], v[44:47], v[112:115]
    ds_read_b128 a[200:203], v18 offset:18944
    v_mfma_f32_16x16x32_bf16 v[144:147], a[212:215], v[48:51], v[144:147]
    ds_read_b128 a[204:207], v18 offset:18432
    v_mfma_f32_16x16x32_bf16 v[176:179], a[212:215], v[52:55], v[176:179]
    ds_read_b128 a[208:211], v18 offset:23040
    v_mfma_f32_16x16x32_bf16 v[208:211], a[212:215], v[56:59], v[208:211]
    v_exp_f32 v41, v41
    v_mfma_f32_16x16x32_bf16 v[224:227], a[212:215], v[76:79], 0
    s_waitcnt lgkmcnt(5)
    ds_read_b128 a[212:215], v18 offset:22528
    v_mfma_f32_16x16x32_bf16 v[44:47], a[184:187], a[0:3], 0
    v_exp_f32 v42, v42
    v_mfma_f32_16x16x32_bf16 v[44:47], a[188:191], a[4:7], v[44:47]
    s_waitcnt lgkmcnt(3)
    v_exp_f32 v43, v43
    v_mfma_f32_16x16x32_bf16 v[44:47], a[192:195], a[8:11], v[44:47]
    v_cvt_pk_bf16_f32 v40, v40, v41
    v_cvt_pk_bf16_f32 v41, v42, v43
    v_mfma_f32_16x16x32_bf16 v[44:47], a[196:199], a[12:15], v[44:47]
    v_exp_f32 v60, v60
    v_mfma_f32_16x16x32_bf16 v[48:51], a[184:187], a[16:19], 0
    v_exp_f32 v61, v61
    v_mfma_f32_16x16x32_bf16 v[48:51], a[188:191], a[20:23], v[48:51]
    buffer_load_dwordx4 v6, s[28:31], s53 offen offset:1024 nt lds
    v_mfma_f32_16x16x32_bf16 v[48:51], a[192:195], a[24:27], v[48:51]
    s_and_b32 s57, s57, 0x1ffff
    s_sub_u32 s88, 8192, s88
    v_mfma_f32_16x16x32_bf16 v[48:51], a[196:199], a[28:31], v[48:51]
    v_exp_f32 v62, v62
    v_mfma_f32_16x16x32_bf16 v[52:55], a[184:187], a[32:35], 0
    v_exp_f32 v63, v63
    v_mfma_f32_16x16x32_bf16 v[52:55], a[188:191], a[36:39], v[52:55]
    v_cvt_pk_bf16_f32 v30, v60, v61
    v_cvt_pk_bf16_f32 v31, v62, v63
    v_mfma_f32_16x16x32_bf16 v[52:55], a[192:195], a[40:43], v[52:55]
    v_exp_f32 v64, v64
    v_mfma_f32_16x16x32_bf16 v[52:55], a[196:199], a[44:47], v[52:55]
    v_exp_f32 v65, v65
    v_mfma_f32_16x16x32_bf16 v[56:59], a[184:187], a[48:51], 0
    v_exp_f32 v66, v66
    v_mfma_f32_16x16x32_bf16 v[56:59], a[188:191], a[52:55], v[56:59]
    v_exp_f32 v67, v67
    v_mfma_f32_16x16x32_bf16 v[56:59], a[192:195], a[56:59], v[56:59]
    v_cvt_pk_bf16_f32 v34, v64, v65
    v_cvt_pk_bf16_f32 v35, v66, v67
    v_mfma_f32_16x16x32_bf16 v[56:59], a[196:199], a[60:63], v[56:59]
    v_exp_f32 v68, v68
    v_mfma_f32_16x16x32_bf16 v[76:79], a[184:187], a[64:67], 0
    v_exp_f32 v69, v69
    v_mfma_f32_16x16x32_bf16 v[76:79], a[188:191], a[68:71], v[76:79]
    v_exp_f32 v70, v70
    v_mfma_f32_16x16x32_bf16 v[76:79], a[192:195], a[72:75], v[76:79]
    v_exp_f32 v71, v71
    v_mfma_f32_16x16x32_bf16 v[76:79], a[196:199], a[76:79], v[76:79]
    buffer_load_dwordx4 v7, s[28:31], s53 offen offset:2048 nt lds
    v_mfma_f32_16x16x32_bf16 v[60:63], a[200:203], a[0:3], 0
    s_add_u32 s94, s94, 16384
    s_and_b32 s94, s94, 0x1ffff
    s_waitcnt lgkmcnt(0)
    v_mfma_f32_16x16x32_bf16 v[60:63], a[204:207], a[4:7], v[60:63]
    v_cvt_pk_bf16_f32 v38, v68, v69
    v_cvt_pk_bf16_f32 v39, v70, v71
    v_mfma_f32_16x16x32_bf16 v[60:63], a[208:211], a[8:11], v[60:63]
    v_exp_f32 v72, v72
    v_mfma_f32_16x16x32_bf16 v[60:63], a[212:215], a[12:15], v[60:63]
    v_exp_f32 v73, v73
    v_mfma_f32_16x16x32_bf16 v[64:67], a[200:203], a[16:19], 0
    v_exp_f32 v74, v74
    v_mfma_f32_16x16x32_bf16 v[64:67], a[204:207], a[20:23], v[64:67]
    v_exp_f32 v75, v75
    v_mfma_f32_16x16x32_bf16 v[64:67], a[208:211], a[24:27], v[64:67]
    v_cvt_pk_bf16_f32 v42, v72, v73
    v_cvt_pk_bf16_f32 v43, v74, v75
    v_mfma_f32_16x16x32_bf16 v[64:67], a[212:215], a[28:31], v[64:67]
    v_exp_f32 v44, v44
    v_mfma_f32_16x16x32_bf16 v[68:71], a[200:203], a[32:35], 0
    v_exp_f32 v45, v45
    v_mfma_f32_16x16x32_bf16 v[68:71], a[204:207], a[36:39], v[68:71]
    v_exp_f32 v46, v46
    v_mfma_f32_16x16x32_bf16 v[68:71], a[208:211], a[40:43], v[68:71]
    v_exp_f32 v47, v47
    v_mfma_f32_16x16x32_bf16 v[68:71], a[212:215], a[44:47], v[68:71]
    v_cvt_pk_bf16_f32 v44, v44, v45
    v_cvt_pk_bf16_f32 v45, v46, v47
    v_mfma_f32_16x16x32_bf16 v[72:75], a[200:203], a[48:51], 0
    v_exp_f32 v48, v48
    v_mfma_f32_16x16x32_bf16 v[72:75], a[204:207], a[52:55], v[72:75]
    v_exp_f32 v49, v49
    v_mfma_f32_16x16x32_bf16 v[72:75], a[208:211], a[56:59], v[72:75]
    v_exp_f32 v50, v50
    v_mfma_f32_16x16x32_bf16 v[72:75], a[212:215], a[60:63], v[72:75]
    s_mov_b32 s92, 1
gqa_kernel_aloop_1:
    s_waitcnt vmcnt(3) lgkmcnt(0)
    s_barrier
    ds_read_b64_tr_b16 a[184:185], v19 offset:32768
    ds_read_b64_tr_b16 a[186:187], v19 offset:34816
    v_mfma_f32_16x16x32_bf16 v[80:83], a[200:203], a[64:67], 0
    buffer_load_dwordx4 v8, s[28:31], s53 offen offset:3072 nt lds
    v_mfma_f32_16x16x32_bf16 v[80:83], a[204:207], a[68:71], v[80:83]
    ds_read_b64_tr_b16 a[188:189], v20 offset:32768
    v_mfma_f32_16x16x32_bf16 v[80:83], a[208:211], a[72:75], v[80:83]
    ds_read_b64_tr_b16 a[190:191], v20 offset:34816
    v_mfma_f32_16x16x32_bf16 v[80:83], a[212:215], a[76:79], v[80:83]
    ds_read_b64_tr_b16 a[192:193], v19 offset:33280
    v_mfma_f32_16x16x32_bf16 a[160:163], a[180:183], v[28:31], a[160:163]
    ds_read_b64_tr_b16 a[194:195], v19 offset:35328
    v_mfma_f32_16x16x32_bf16 a[164:167], a[180:183], v[32:35], a[164:167]
    ds_read_b64_tr_b16 a[196:197], v20 offset:33280
    v_mfma_f32_16x16x32_bf16 a[168:171], a[180:183], v[36:39], a[168:171]
    s_cmp_gt_i32 s88, 0
    s_cselect_b64 s[28:29], s[16:17], s[12:13]
    s_add_u32 m0, s60, s94
    s_add_u32 s53, s58, s57
    v_mfma_f32_16x16x32_bf16 a[172:175], a[180:183], v[40:43], a[172:175]
    buffer_load_dwordx4 v5, s[28:31], s53 offen offset:0 nt lds
    s_waitcnt lgkmcnt(3)
    v_mfma_f32_16x16x32_bf16 v[180:183], a[184:187], v[40:43], v[180:183]
    s_add_u32 s57, s57, s88
    ds_read_b64_tr_b16 a[198:199], v20 offset:35328
    v_mfma_f32_16x16x32_bf16 v[148:151], a[184:187], v[36:39], v[148:151]
    ds_read_b64_tr_b16 a[200:201], v19 offset:36864
    v_mfma_f32_16x16x32_bf16 v[116:119], a[184:187], v[32:35], v[116:119]
    ds_read_b64_tr_b16 a[202:203], v19 offset:38912
    v_mfma_f32_16x16x32_bf16 v[84:87], a[184:187], v[28:31], v[84:87]
    ds_read_b64_tr_b16 a[204:205], v20 offset:36864
    v_mfma_f32_16x16x32_bf16 v[88:91], a[188:191], v[28:31], v[88:91]
    ds_read_b64_tr_b16 a[206:207], v20 offset:38912
    v_mfma_f32_16x16x32_bf16 v[120:123], a[188:191], v[32:35], v[120:123]
    ds_read_b64_tr_b16 a[208:209], v19 offset:37376
    v_mfma_f32_16x16x32_bf16 v[152:155], a[188:191], v[36:39], v[152:155]
    buffer_load_dwordx4 v6, s[28:31], s53 offen offset:1024 nt lds
    v_mfma_f32_16x16x32_bf16 v[184:187], a[188:191], v[40:43], v[184:187]
    s_and_b32 s57, s57, 0x1ffff
    s_sub_u32 s88, 8192, s88
    s_waitcnt lgkmcnt(4)
    v_mfma_f32_16x16x32_bf16 v[188:191], a[192:195], v[40:43], v[188:191]
    ds_read_b64_tr_b16 a[210:211], v19 offset:39424
    v_mfma_f32_16x16x32_bf16 v[156:159], a[192:195], v[36:39], v[156:159]
    ds_read_b64_tr_b16 a[212:213], v20 offset:37376
    v_mfma_f32_16x16x32_bf16 v[124:127], a[192:195], v[32:35], v[124:127]
    ds_read_b64_tr_b16 a[214:215], v20 offset:39424
    v_mfma_f32_16x16x32_bf16 v[92:95], a[192:195], v[28:31], v[92:95]
    v_exp_f32 v51, v51
    v_mfma_f32_16x16x32_bf16 v[96:99], a[196:199], v[28:31], v[96:99]
    v_cvt_pk_bf16_f32 v48, v48, v49
    v_cvt_pk_bf16_f32 v49, v50, v51
    v_mfma_f32_16x16x32_bf16 v[128:131], a[196:199], v[32:35], v[128:131]
    buffer_load_dwordx4 v7, s[28:31], s53 offen offset:2048 nt lds
    v_mfma_f32_16x16x32_bf16 v[160:163], a[196:199], v[36:39], v[160:163]
    s_add_u32 s94, s94, 16384
    s_and_b32 s94, s94, 0x1ffff
    v_mfma_f32_16x16x32_bf16 v[192:195], a[196:199], v[40:43], v[192:195]
    s_waitcnt lgkmcnt(1)
    v_exp_f32 v52, v52
    v_mfma_f32_16x16x32_bf16 v[196:199], a[200:203], v[40:43], v[196:199]
    v_exp_f32 v53, v53
    v_mfma_f32_16x16x32_bf16 v[164:167], a[200:203], v[36:39], v[164:167]
    v_exp_f32 v54, v54
    v_mfma_f32_16x16x32_bf16 v[132:135], a[200:203], v[32:35], v[132:135]
    v_exp_f32 v55, v55
    v_mfma_f32_16x16x32_bf16 v[100:103], a[200:203], v[28:31], v[100:103]
    v_cvt_pk_bf16_f32 v52, v52, v53
    v_cvt_pk_bf16_f32 v53, v54, v55
    v_mfma_f32_16x16x32_bf16 v[104:107], a[204:207], v[28:31], v[104:107]
    v_exp_f32 v56, v56
    v_mfma_f32_16x16x32_bf16 v[136:139], a[204:207], v[32:35], v[136:139]
    v_exp_f32 v57, v57
    v_mfma_f32_16x16x32_bf16 v[168:171], a[204:207], v[36:39], v[168:171]
    v_exp_f32 v58, v58
    v_mfma_f32_16x16x32_bf16 v[200:203], a[204:207], v[40:43], v[200:203]
    s_lshr_b32 s97, s97, 1
    s_cbranch_scc0 1
    s_waitcnt vmcnt(3)
    s_waitcnt vmcnt(4) lgkmcnt(0)
    s_barrier
    ds_read_b128 a[184:187], v18 offset:49664
    ds_read_b128 a[188:191], v18 offset:49152
    v_mfma_f32_16x16x32_bf16 v[204:207], a[208:211], v[40:43], v[204:207]
    buffer_load_dwordx4 v8, s[28:31], s53 offen offset:3072 nt lds
    v_mfma_f32_16x16x32_bf16 v[172:175], a[208:211], v[36:39], v[172:175]
    ds_read_b128 a[192:195], v18 offset:53760
    ds_read_b128 a[196:199], v18 offset:53248
    v_mfma_f32_16x16x32_bf16 v[140:143], a[208:211], v[32:35], v[140:143]
    ds_read_b128 a[200:203], v18 offset:51712
    v_mfma_f32_16x16x32_bf16 v[108:111], a[208:211], v[28:31], v[108:111]
    ds_read_b128 a[204:207], v18 offset:51200
    v_mfma_f32_16x16x32_bf16 v[112:115], a[212:215], v[28:31], v[112:115]
    ds_read_b128 a[208:211], v18 offset:55808
    v_mfma_f32_16x16x32_bf16 v[144:147], a[212:215], v[32:35], v[144:147]
    v_exp_f32 v59, v59
    v_mfma_f32_16x16x32_bf16 v[176:179], a[212:215], v[36:39], v[176:179]
    v_cvt_pk_bf16_f32 v56, v56, v57
    v_cvt_pk_bf16_f32 v57, v58, v59
    v_mfma_f32_16x16x32_bf16 v[208:211], a[212:215], v[40:43], v[208:211]
    s_waitcnt lgkmcnt(3)
    ds_read_b128 a[212:215], v18 offset:55296
    v_mfma_f32_16x16x32_bf16 v[28:31], a[184:187], a[0:3], 0
    v_exp_f32 v76, v76
    v_mfma_f32_16x16x32_bf16 v[28:31], a[188:191], a[4:7], v[28:31]
    v_exp_f32 v77, v77
    v_mfma_f32_16x16x32_bf16 v[28:31], a[192:195], a[8:11], v[28:31]
    s_cmp_gt_i32 s88, 0
    s_cselect_b64 s[28:29], s[16:17], s[12:13]
    s_add_u32 m0, s60, s94
    s_add_u32 s53, s58, s57
    v_mfma_f32_16x16x32_bf16 v[28:31], a[196:199], a[12:15], v[28:31]
    buffer_load_dwordx4 v5, s[28:31], s53 offen offset:0 nt lds
    v_mfma_f32_16x16x32_bf16 v[32:35], a[184:187], a[16:19], 0
    s_add_u32 s57, s57, s88
    v_mfma_f32_16x16x32_bf16 v[32:35], a[188:191], a[20:23], v[32:35]
    v_exp_f32 v78, v78
    v_mfma_f32_16x16x32_bf16 v[32:35], a[192:195], a[24:27], v[32:35]
    v_exp_f32 v79, v79
    v_mfma_f32_16x16x32_bf16 v[32:35], a[196:199], a[28:31], v[32:35]
    v_cvt_pk_bf16_f32 v76, v76, v77
    v_cvt_pk_bf16_f32 v77, v78, v79
    v_mfma_f32_16x16x32_bf16 v[36:39], a[184:187], a[32:35], 0
    v_exp_f32 v60, v60
    v_mfma_f32_16x16x32_bf16 v[36:39], a[188:191], a[36:39], v[36:39]
    v_exp_f32 v61, v61
    v_mfma_f32_16x16x32_bf16 v[36:39], a[192:195], a[40:43], v[36:39]
    v_exp_f32 v62, v62
    v_mfma_f32_16x16x32_bf16 v[36:39], a[196:199], a[44:47], v[36:39]
    v_exp_f32 v63, v63
    v_mfma_f32_16x16x32_bf16 v[40:43], a[184:187], a[48:51], 0
    v_cvt_pk_bf16_f32 v46, v60, v61
    v_cvt_pk_bf16_f32 v47, v62, v63
    v_mfma_f32_16x16x32_bf16 v[40:43], a[188:191], a[52:55], v[40:43]
    v_exp_f32 v64, v64
    v_mfma_f32_16x16x32_bf16 v[40:43], a[192:195], a[56:59], v[40:43]
    buffer_load_dwordx4 v6, s[28:31], s53 offen offset:1024 nt lds
    v_mfma_f32_16x16x32_bf16 v[40:43], a[196:199], a[60:63], v[40:43]
    s_and_b32 s57, s57, 0x1ffff
    s_sub_u32 s88, 8192, s88
    s_waitcnt lgkmcnt(0)
    v_mfma_f32_16x16x32_bf16 v[60:63], a[200:203], a[0:3], 0
    v_exp_f32 v65, v65
    v_mfma_f32_16x16x32_bf16 v[60:63], a[204:207], a[4:7], v[60:63]
    v_exp_f32 v66, v66
    v_exp_f32 v67, v67
    v_mfma_f32_16x16x32_bf16 v[60:63], a[208:211], a[8:11], v[60:63]
    v_cvt_pk_bf16_f32 v50, v64, v65
    v_cvt_pk_bf16_f32 v51, v66, v67
    v_mfma_f32_16x16x32_bf16 v[60:63], a[212:215], a[12:15], v[60:63]
    v_exp_f32 v68, v68
    v_mfma_f32_16x16x32_bf16 v[64:67], a[200:203], a[16:19], 0
    v_exp_f32 v69, v69
    v_mfma_f32_16x16x32_bf16 v[64:67], a[204:207], a[20:23], v[64:67]
    v_exp_f32 v70, v70
    v_exp_f32 v71, v71
    v_mfma_f32_16x16x32_bf16 v[64:67], a[208:211], a[24:27], v[64:67]
    v_cvt_pk_bf16_f32 v54, v68, v69
    v_cvt_pk_bf16_f32 v55, v70, v71
    v_mfma_f32_16x16x32_bf16 v[64:67], a[212:215], a[28:31], v[64:67]
    v_exp_f32 v72, v72
    v_mfma_f32_16x16x32_bf16 v[68:71], a[200:203], a[32:35], 0
    v_exp_f32 v73, v73
    v_mfma_f32_16x16x32_bf16 v[68:71], a[204:207], a[36:39], v[68:71]
    v_exp_f32 v74, v74
    v_exp_f32 v75, v75
    v_mfma_f32_16x16x32_bf16 v[68:71], a[208:211], a[40:43], v[68:71]
    v_cvt_pk_bf16_f32 v58, v72, v73
    v_cvt_pk_bf16_f32 v59, v74, v75
    v_mfma_f32_16x16x32_bf16 v[68:71], a[212:215], a[44:47], v[68:71]
    v_exp_f32 v80, v80
    v_mfma_f32_16x16x32_bf16 v[72:75], a[200:203], a[48:51], 0
    s_waitcnt vmcnt(3) lgkmcnt(0)
    s_barrier
    v_xor_b32 v19, 0x10000, v19
    v_xor_b32 v20, 0x10000, v20
    v_xor_b32 v18, 0x10000, v18
    ds_read_b64_tr_b16 a[184:185], v19 offset:0
    ds_read_b64_tr_b16 a[186:187], v19 offset:2048
    v_mfma_f32_16x16x32_bf16 v[72:75], a[204:207], a[52:55], v[72:75]
    buffer_load_dwordx4 v7, s[28:31], s53 offen offset:2048 nt lds
    v_mfma_f32_16x16x32_bf16 v[72:75], a[208:211], a[56:59], v[72:75]
    s_add_u32 s94, s94, 16384
    s_and_b32 s94, s94, 0x1ffff
    v_mfma_f32_16x16x32_bf16 v[72:75], a[212:215], a[60:63], v[72:75]
    ds_read_b64_tr_b16 a[188:189], v20 offset:0
    v_mfma_f32_16x16x32_bf16 a[160:163], a[180:183], v[44:47], a[160:163]
    ds_read_b64_tr_b16 a[190:191], v20 offset:2048
    v_mfma_f32_16x16x32_bf16 a[164:167], a[180:183], v[48:51], a[164:167]
    v_exp_f32 v81, v81
    v_exp_f32 v82, v82
    v_mfma_f32_16x16x32_bf16 a[168:171], a[180:183], v[52:55], a[168:171]
    v_exp_f32 v83, v83
    v_cvt_pk_bf16_f32 v78, v80, v81
    v_cvt_pk_bf16_f32 v79, v82, v83
    v_mfma_f32_16x16x32_bf16 a[172:175], a[180:183], v[56:59], a[172:175]
    ds_read_b64_tr_b16 a[192:193], v19 offset:512
    v_mfma_f32_16x16x32_bf16 a[176:179], a[180:183], v[76:79], a[176:179]
    s_waitcnt lgkmcnt(2)
    ds_read_b64_tr_b16 a[194:195], v19 offset:2560
    v_mfma_f32_16x16x32_bf16 v[228:231], a[184:187], v[76:79], v[228:231]
    buffer_load_dwordx4 v8, s[28:31], s53 offen offset:3072 nt lds
    v_mfma_f32_16x16x32_bf16 v[180:183], a[184:187], v[56:59], v[180:183]
    ds_read_b64_tr_b16 a[196:197], v20 offset:512
    v_mfma_f32_16x16x32_bf16 v[148:151], a[184:187], v[52:55], v[148:151]
    ds_read_b64_tr_b16 a[198:199], v20 offset:2560
    v_mfma_f32_16x16x32_bf16 v[116:119], a[184:187], v[48:51], v[116:119]
    ds_read_b64_tr_b16 a[200:201], v19 offset:4096
    v_mfma_f32_16x16x32_bf16 v[84:87], a[184:187], v[44:47], v[84:87]
    s_waitcnt lgkmcnt(4)
    ds_read_b64_tr_b16 a[202:203], v19 offset:6144
    v_mfma_f32_16x16x32_bf16 v[88:91], a[188:191], v[44:47], v[88:91]
    ds_read_b64_tr_b16 a[204:205], v20 offset:4096
    v_mfma_f32_16x16x32_bf16 v[120:123], a[188:191], v[48:51], v[120:123]
    ds_read_b64_tr_b16 a[206:207], v20 offset:6144
    v_mfma_f32_16x16x32_bf16 v[152:155], a[188:191], v[52:55], v[152:155]
    ds_read_b64_tr_b16 a[208:209], v19 offset:4608
    v_mfma_f32_16x16x32_bf16 v[184:187], a[188:191], v[56:59], v[184:187]
    ds_read_b64_tr_b16 a[210:211], v19 offset:6656
    v_mfma_f32_16x16x32_bf16 v[232:235], a[188:191], v[76:79], v[232:235]
    s_waitcnt lgkmcnt(5)
    ds_read_b64_tr_b16 a[212:213], v20 offset:4608
    v_mfma_f32_16x16x32_bf16 v[236:239], a[192:195], v[76:79], v[236:239]
    s_cmp_gt_i32 s88, 0
    s_cselect_b64 s[28:29], s[16:17], s[12:13]
    s_add_u32 m0, s60, s94
    s_add_u32 s53, s58, s57
    v_mfma_f32_16x16x32_bf16 v[188:191], a[192:195], v[56:59], v[188:191]
    buffer_load_dwordx4 v5, s[28:31], s53 offen offset:0 nt lds
    v_mfma_f32_16x16x32_bf16 v[156:159], a[192:195], v[52:55], v[156:159]
    s_add_u32 s57, s57, s88
    ds_read_b64_tr_b16 a[214:215], v20 offset:6656
    v_mfma_f32_16x16x32_bf16 v[124:127], a[192:195], v[48:51], v[124:127]
    v_exp_f32 v28, v28
    v_mfma_f32_16x16x32_bf16 v[92:95], a[192:195], v[44:47], v[92:95]
    v_exp_f32 v29, v29
    v_mfma_f32_16x16x32_bf16 v[96:99], a[196:199], v[44:47], v[96:99]
    v_exp_f32 v30, v30
    v_mfma_f32_16x16x32_bf16 v[128:131], a[196:199], v[48:51], v[128:131]
    v_exp_f32 v31, v31
    v_mfma_f32_16x16x32_bf16 v[160:163], a[196:199], v[52:55], v[160:163]
    v_cvt_pk_bf16_f32 v28, v28, v29
    v_cvt_pk_bf16_f32 v29, v30, v31
    v_mfma_f32_16x16x32_bf16 v[192:195], a[196:199], v[56:59], v[192:195]
    v_exp_f32 v32, v32
    v_mfma_f32_16x16x32_bf16 v[240:243], a[196:199], v[76:79], v[240:243]
    buffer_load_dwordx4 v6, s[28:31], s53 offen offset:1024 nt lds
    s_waitcnt lgkmcnt(0)
    v_mfma_f32_16x16x32_bf16 v[212:215], a[200:203], v[76:79], v[212:215]
    s_and_b32 s57, s57, 0x1ffff
    s_sub_u32 s88, 8192, s88
    v_mfma_f32_16x16x32_bf16 v[196:199], a[200:203], v[56:59], v[196:199]
    v_exp_f32 v33, v33
    v_mfma_f32_16x16x32_bf16 v[164:167], a[200:203], v[52:55], v[164:167]
    v_exp_f32 v34, v34
    v_mfma_f32_16x16x32_bf16 v[132:135], a[200:203], v[48:51], v[132:135]
    v_exp_f32 v35, v35
    v_mfma_f32_16x16x32_bf16 v[100:103], a[200:203], v[44:47], v[100:103]
    v_cvt_pk_bf16_f32 v32, v32, v33
    v_cvt_pk_bf16_f32 v33, v34, v35
    v_mfma_f32_16x16x32_bf16 v[104:107], a[204:207], v[44:47], v[104:107]
    v_exp_f32 v36, v36
    v_mfma_f32_16x16x32_bf16 v[136:139], a[204:207], v[48:51], v[136:139]
    v_exp_f32 v37, v37
    v_mfma_f32_16x16x32_bf16 v[168:171], a[204:207], v[52:55], v[168:171]
    v_exp_f32 v38, v38
    v_mfma_f32_16x16x32_bf16 v[200:203], a[204:207], v[56:59], v[200:203]
    v_exp_f32 v39, v39
    v_mfma_f32_16x16x32_bf16 v[216:219], a[204:207], v[76:79], v[216:219]
    v_cvt_pk_bf16_f32 v36, v36, v37
    v_cvt_pk_bf16_f32 v37, v38, v39
    v_mfma_f32_16x16x32_bf16 v[220:223], a[208:211], v[76:79], v[220:223]
    v_exp_f32 v40, v40
    v_mfma_f32_16x16x32_bf16 v[204:207], a[208:211], v[56:59], v[204:207]
    s_lshr_b32 s97, s97, 1
    s_cbranch_scc0 1
    s_waitcnt vmcnt(3)
    s_waitcnt vmcnt(4) lgkmcnt(0)
    s_barrier
    ds_read_b128 a[184:187], v18 offset:16896
    ds_read_b128 a[188:191], v18 offset:16384
    v_mfma_f32_16x16x32_bf16 v[172:175], a[208:211], v[52:55], v[172:175]
    buffer_load_dwordx4 v7, s[28:31], s53 offen offset:2048 nt lds
    v_mfma_f32_16x16x32_bf16 v[140:143], a[208:211], v[48:51], v[140:143]
    s_add_u32 s94, s94, 16384
    s_and_b32 s94, s94, 0x1ffff
    ds_read_b128 a[192:195], v18 offset:20992
    ds_read_b128 a[196:199], v18 offset:20480
    v_mfma_f32_16x16x32_bf16 v[108:111], a[208:211], v[44:47], v[108:111]
    ds_read_b128 a[200:203], v18 offset:18944
    v_mfma_f32_16x16x32_bf16 v[112:115], a[212:215], v[44:47], v[112:115]
    ds_read_b128 a[204:207], v18 offset:18432
    v_mfma_f32_16x16x32_bf16 v[144:147], a[212:215], v[48:51], v[144:147]
    ds_read_b128 a[208:211], v18 offset:23040
    v_mfma_f32_16x16x32_bf16 v[176:179], a[212:215], v[52:55], v[176:179]
    v_exp_f32 v41, v41
    v_mfma_f32_16x16x32_bf16 v[208:211], a[212:215], v[56:59], v[208:211]
    v_exp_f32 v42, v42
    v_mfma_f32_16x16x32_bf16 v[224:227], a[212:215], v[76:79], v[224:227]
    s_waitcnt lgkmcnt(4)
    ds_read_b128 a[212:215], v18 offset:22528
    v_mfma_f32_16x16x32_bf16 v[44:47], a[184:187], a[0:3], 0
    v_exp_f32 v43, v43
    v_mfma_f32_16x16x32_bf16 v[44:47], a[188:191], a[4:7], v[44:47]
    v_cvt_pk_bf16_f32 v40, v40, v41
    v_cvt_pk_bf16_f32 v41, v42, v43
    v_mfma_f32_16x16x32_bf16 v[44:47], a[192:195], a[8:11], v[44:47]
    s_waitcnt lgkmcnt(1)
    v_exp_f32 v60, v60
    v_mfma_f32_16x16x32_bf16 v[44:47], a[196:199], a[12:15], v[44:47]
    v_exp_f32 v61, v61
    v_mfma_f32_16x16x32_bf16 v[48:51], a[184:187], a[16:19], 0
    v_exp_f32 v62, v62
    v_mfma_f32_16x16x32_bf16 v[48:51], a[188:191], a[20:23], v[48:51]
    buffer_load_dwordx4 v8, s[28:31], s53 offen offset:3072 nt lds
    v_mfma_f32_16x16x32_bf16 v[48:51], a[192:195], a[24:27], v[48:51]
    v_exp_f32 v63, v63
    v_mfma_f32_16x16x32_bf16 v[48:51], a[196:199], a[28:31], v[48:51]
    v_cvt_pk_bf16_f32 v30, v60, v61
    v_cvt_pk_bf16_f32 v31, v62, v63
    v_mfma_f32_16x16x32_bf16 v[52:55], a[184:187], a[32:35], 0
    v_exp_f32 v64, v64
    v_mfma_f32_16x16x32_bf16 v[52:55], a[188:191], a[36:39], v[52:55]
    v_exp_f32 v65, v65
    v_mfma_f32_16x16x32_bf16 v[52:55], a[192:195], a[40:43], v[52:55]
    v_exp_f32 v66, v66
    v_mfma_f32_16x16x32_bf16 v[52:55], a[196:199], a[44:47], v[52:55]
    v_exp_f32 v67, v67
    v_mfma_f32_16x16x32_bf16 v[56:59], a[184:187], a[48:51], 0
    v_cvt_pk_bf16_f32 v34, v64, v65
    v_cvt_pk_bf16_f32 v35, v66, v67
    v_mfma_f32_16x16x32_bf16 v[56:59], a[188:191], a[52:55], v[56:59]
    v_exp_f32 v68, v68
    v_mfma_f32_16x16x32_bf16 v[56:59], a[192:195], a[56:59], v[56:59]
    v_exp_f32 v69, v69
    v_mfma_f32_16x16x32_bf16 v[56:59], a[196:199], a[60:63], v[56:59]
    v_exp_f32 v70, v70
    v_mfma_f32_16x16x32_bf16 v[76:79], a[184:187], a[64:67], 0
    v_exp_f32 v71, v71
    v_mfma_f32_16x16x32_bf16 v[76:79], a[188:191], a[68:71], v[76:79]
    v_cvt_pk_bf16_f32 v38, v68, v69
    v_cvt_pk_bf16_f32 v39, v70, v71
    v_mfma_f32_16x16x32_bf16 v[76:79], a[192:195], a[72:75], v[76:79]
    v_exp_f32 v72, v72
    v_mfma_f32_16x16x32_bf16 v[76:79], a[196:199], a[76:79], v[76:79]
    s_cmp_gt_i32 s88, 0
    s_cselect_b64 s[28:29], s[16:17], s[12:13]
    s_add_u32 m0, s60, s94
    s_add_u32 s53, s58, s57
    v_mfma_f32_16x16x32_bf16 v[60:63], a[200:203], a[0:3], 0
    buffer_load_dwordx4 v5, s[28:31], s53 offen offset:0 nt lds
    v_mfma_f32_16x16x32_bf16 v[60:63], a[204:207], a[4:7], v[60:63]
    s_add_u32 s57, s57, s88
    v_mfma_f32_16x16x32_bf16 v[60:63], a[208:211], a[8:11], v[60:63]
    s_waitcnt lgkmcnt(0)
    v_exp_f32 v73, v73
    v_mfma_f32_16x16x32_bf16 v[60:63], a[212:215], a[12:15], v[60:63]
    v_exp_f32 v74, v74
    v_mfma_f32_16x16x32_bf16 v[64:67], a[200:203], a[16:19], 0
    v_exp_f32 v75, v75
    v_mfma_f32_16x16x32_bf16 v[64:67], a[204:207], a[20:23], v[64:67]
    v_cvt_pk_bf16_f32 v42, v72, v73
    v_cvt_pk_bf16_f32 v43, v74, v75
    v_mfma_f32_16x16x32_bf16 v[64:67], a[208:211], a[24:27], v[64:67]
    v_exp_f32 v44, v44
    v_mfma_f32_16x16x32_bf16 v[64:67], a[212:215], a[28:31], v[64:67]
    v_exp_f32 v45, v45
    v_mfma_f32_16x16x32_bf16 v[68:71], a[200:203], a[32:35], 0
    v_exp_f32 v46, v46
    v_mfma_f32_16x16x32_bf16 v[68:71], a[204:207], a[36:39], v[68:71]
    v_exp_f32 v47, v47
    v_mfma_f32_16x16x32_bf16 v[68:71], a[208:211], a[40:43], v[68:71]
    v_cvt_pk_bf16_f32 v44, v44, v45
    v_cvt_pk_bf16_f32 v45, v46, v47
    v_mfma_f32_16x16x32_bf16 v[68:71], a[212:215], a[44:47], v[68:71]
    v_exp_f32 v48, v48
    v_mfma_f32_16x16x32_bf16 v[72:75], a[200:203], a[48:51], 0
    v_exp_f32 v49, v49
    v_mfma_f32_16x16x32_bf16 v[72:75], a[204:207], a[52:55], v[72:75]
    v_exp_f32 v50, v50
    v_mfma_f32_16x16x32_bf16 v[72:75], a[208:211], a[56:59], v[72:75]
    v_exp_f32 v51, v51
    v_mfma_f32_16x16x32_bf16 v[72:75], a[212:215], a[60:63], v[72:75]
    s_waitcnt vmcnt(3) lgkmcnt(0)
    s_barrier
    ds_read_b64_tr_b16 a[184:185], v19 offset:32768
    ds_read_b64_tr_b16 a[186:187], v19 offset:34816
    v_mfma_f32_16x16x32_bf16 v[80:83], a[200:203], a[64:67], 0
    buffer_load_dwordx4 v6, s[28:31], s53 offen offset:1024 nt lds
    v_mfma_f32_16x16x32_bf16 v[80:83], a[204:207], a[68:71], v[80:83]
    s_and_b32 s57, s57, 0x1ffff
    s_sub_u32 s88, 8192, s88
    v_mfma_f32_16x16x32_bf16 v[80:83], a[208:211], a[72:75], v[80:83]
    ds_read_b64_tr_b16 a[188:189], v20 offset:32768
    ds_read_b64_tr_b16 a[190:191], v20 offset:34816
    v_mfma_f32_16x16x32_bf16 v[80:83], a[212:215], a[76:79], v[80:83]
    ds_read_b64_tr_b16 a[192:193], v19 offset:33280
    v_cvt_pk_bf16_f32 v48, v48, v49
    v_mfma_f32_16x16x32_bf16 a[160:163], a[180:183], v[28:31], a[160:163]
    ds_read_b64_tr_b16 a[194:195], v19 offset:35328
    v_cvt_pk_bf16_f32 v49, v50, v51
    v_mfma_f32_16x16x32_bf16 a[164:167], a[180:183], v[32:35], a[164:167]
    ds_read_b64_tr_b16 a[196:197], v20 offset:33280
    v_mfma_f32_16x16x32_bf16 a[168:171], a[180:183], v[36:39], a[168:171]
    buffer_load_dwordx4 v7, s[28:31], s53 offen offset:2048 nt lds
    v_mfma_f32_16x16x32_bf16 a[172:175], a[180:183], v[40:43], a[172:175]
    s_add_u32 s94, s94, 16384
    s_and_b32 s94, s94, 0x1ffff
    s_waitcnt lgkmcnt(3)
    v_mfma_f32_16x16x32_bf16 v[180:183], a[184:187], v[40:43], v[180:183]
    ds_read_b64_tr_b16 a[198:199], v20 offset:35328
    v_mfma_f32_16x16x32_bf16 v[148:151], a[184:187], v[36:39], v[148:151]
    ds_read_b64_tr_b16 a[200:201], v19 offset:36864
    v_mfma_f32_16x16x32_bf16 v[116:119], a[184:187], v[32:35], v[116:119]
    ds_read_b64_tr_b16 a[202:203], v19 offset:38912
    v_mfma_f32_16x16x32_bf16 v[84:87], a[184:187], v[28:31], v[84:87]
    ds_read_b64_tr_b16 a[204:205], v20 offset:36864
    v_mfma_f32_16x16x32_bf16 v[88:91], a[188:191], v[28:31], v[88:91]
    ds_read_b64_tr_b16 a[206:207], v20 offset:38912
    v_mfma_f32_16x16x32_bf16 v[120:123], a[188:191], v[32:35], v[120:123]
    ds_read_b64_tr_b16 a[208:209], v19 offset:37376
    v_mfma_f32_16x16x32_bf16 v[152:155], a[188:191], v[36:39], v[152:155]
    buffer_load_dwordx4 v8, s[28:31], s53 offen offset:3072 nt lds
    v_mfma_f32_16x16x32_bf16 v[184:187], a[188:191], v[40:43], v[184:187]
    s_waitcnt lgkmcnt(5)
    ds_read_b64_tr_b16 a[210:211], v19 offset:39424
    v_mfma_f32_16x16x32_bf16 v[188:191], a[192:195], v[40:43], v[188:191]
    ds_read_b64_tr_b16 a[212:213], v20 offset:37376
    v_mfma_f32_16x16x32_bf16 v[156:159], a[192:195], v[36:39], v[156:159]
    ds_read_b64_tr_b16 a[214:215], v20 offset:39424
    v_mfma_f32_16x16x32_bf16 v[124:127], a[192:195], v[32:35], v[124:127]
    v_exp_f32 v52, v52
    v_mfma_f32_16x16x32_bf16 v[92:95], a[192:195], v[28:31], v[92:95]
    v_exp_f32 v53, v53
    v_mfma_f32_16x16x32_bf16 v[96:99], a[196:199], v[28:31], v[96:99]
    v_exp_f32 v54, v54
    v_mfma_f32_16x16x32_bf16 v[128:131], a[196:199], v[32:35], v[128:131]
    s_cmp_gt_i32 s88, 0
    s_cselect_b64 s[28:29], s[16:17], s[12:13]
    s_add_u32 m0, s60, s94
    s_add_u32 s53, s58, s57
    v_mfma_f32_16x16x32_bf16 v[160:163], a[196:199], v[36:39], v[160:163]
    buffer_load_dwordx4 v5, s[28:31], s53 offen offset:0 nt lds
    v_mfma_f32_16x16x32_bf16 v[192:195], a[196:199], v[40:43], v[192:195]
    s_add_u32 s57, s57, s88
    s_waitcnt lgkmcnt(0)
    v_mfma_f32_16x16x32_bf16 v[196:199], a[200:203], v[40:43], v[196:199]
    v_exp_f32 v55, v55
    v_mfma_f32_16x16x32_bf16 v[164:167], a[200:203], v[36:39], v[164:167]
    v_cvt_pk_bf16_f32 v52, v52, v53
    v_cvt_pk_bf16_f32 v53, v54, v55
    v_mfma_f32_16x16x32_bf16 v[132:135], a[200:203], v[32:35], v[132:135]
    v_exp_f32 v56, v56
    v_mfma_f32_16x16x32_bf16 v[100:103], a[200:203], v[28:31], v[100:103]
    v_exp_f32 v57, v57
    v_mfma_f32_16x16x32_bf16 v[104:107], a[204:207], v[28:31], v[104:107]
    v_exp_f32 v58, v58
    v_mfma_f32_16x16x32_bf16 v[136:139], a[204:207], v[32:35], v[136:139]
    v_exp_f32 v59, v59
    v_mfma_f32_16x16x32_bf16 v[168:171], a[204:207], v[36:39], v[168:171]
    v_cvt_pk_bf16_f32 v56, v56, v57
    v_cvt_pk_bf16_f32 v57, v58, v59
    v_mfma_f32_16x16x32_bf16 v[200:203], a[204:207], v[40:43], v[200:203]
    s_lshr_b32 s97, s97, 1
    s_cbranch_scc0 1
    s_waitcnt vmcnt(3)
    s_waitcnt vmcnt(4) lgkmcnt(0)
    s_barrier
    ds_read_b128 a[184:187], v18 offset:49664
    ds_read_b128 a[188:191], v18 offset:49152
    v_mfma_f32_16x16x32_bf16 v[204:207], a[208:211], v[40:43], v[204:207]
    buffer_load_dwordx4 v6, s[28:31], s53 offen offset:1024 nt lds
    v_mfma_f32_16x16x32_bf16 v[172:175], a[208:211], v[36:39], v[172:175]
    s_and_b32 s57, s57, 0x1ffff
    s_sub_u32 s88, 8192, s88
    ds_read_b128 a[192:195], v18 offset:53760
    ds_read_b128 a[196:199], v18 offset:53248
    v_mfma_f32_16x16x32_bf16 v[140:143], a[208:211], v[32:35], v[140:143]
    ds_read_b128 a[200:203], v18 offset:51712
    v_mfma_f32_16x16x32_bf16 v[108:111], a[208:211], v[28:31], v[108:111]
    ds_read_b128 a[204:207], v18 offset:51200
    v_mfma_f32_16x16x32_bf16 v[112:115], a[212:215], v[28:31], v[112:115]
    ds_read_b128 a[208:211], v18 offset:55808
    v_mfma_f32_16x16x32_bf16 v[144:147], a[212:215], v[32:35], v[144:147]
    v_exp_f32 v76, v76
    v_mfma_f32_16x16x32_bf16 v[176:179], a[212:215], v[36:39], v[176:179]
    v_exp_f32 v77, v77
    v_mfma_f32_16x16x32_bf16 v[208:211], a[212:215], v[40:43], v[208:211]
    s_waitcnt lgkmcnt(4)
    ds_read_b128 a[212:215], v18 offset:55296
    v_mfma_f32_16x16x32_bf16 v[28:31], a[184:187], a[0:3], 0
    v_exp_f32 v78, v78
    v_mfma_f32_16x16x32_bf16 v[28:31], a[188:191], a[4:7], v[28:31]
    v_exp_f32 v79, v79
    v_mfma_f32_16x16x32_bf16 v[28:31], a[192:195], a[8:11], v[28:31]
    buffer_load_dwordx4 v7, s[28:31], s53 offen offset:2048 nt lds
    s_waitcnt lgkmcnt(1)
    v_mfma_f32_16x16x32_bf16 v[28:31], a[196:199], a[12:15], v[28:31]
    s_add_u32 s94, s94, 16384
    s_and_b32 s94, s94, 0x1ffff
    v_mfma_f32_16x16x32_bf16 v[32:35], a[184:187], a[16:19], 0
    v_cvt_pk_bf16_f32 v76, v76, v77
    v_cvt_pk_bf16_f32 v77, v78, v79
    v_mfma_f32_16x16x32_bf16 v[32:35], a[188:191], a[20:23], v[32:35]
    v_exp_f32 v60, v60
    v_mfma_f32_16x16x32_bf16 v[32:35], a[192:195], a[24:27], v[32:35]
    v_exp_f32 v61, v61
    v_mfma_f32_16x16x32_bf16 v[32:35], a[196:199], a[28:31], v[32:35]
    v_exp_f32 v62, v62
    v_mfma_f32_16x16x32_bf16 v[36:39], a[184:187], a[32:35], 0
    v_exp_f32 v63, v63
    v_mfma_f32_16x16x32_bf16 v[36:39], a[188:191], a[36:39], v[36:39]
    v_cvt_pk_bf16_f32 v46, v60, v61
    v_cvt_pk_bf16_f32 v47, v62, v63
    v_mfma_f32_16x16x32_bf16 v[36:39], a[192:195], a[40:43], v[36:39]
    v_exp_f32 v64, v64
    v_mfma_f32_16x16x32_bf16 v[36:39], a[196:199], a[44:47], v[36:39]
    v_exp_f32 v65, v65
    v_mfma_f32_16x16x32_bf16 v[40:43], a[184:187], a[48:51], 0
    v_exp_f32 v66, v66
    v_mfma_f32_16x16x32_bf16 v[40:43], a[188:191], a[52:55], v[40:43]
    v_exp_f32 v67, v67
    v_mfma_f32_16x16x32_bf16 v[40:43], a[192:195], a[56:59], v[40:43]
    buffer_load_dwordx4 v8, s[28:31], s53 offen offset:3072 nt lds
    v_mfma_f32_16x16x32_bf16 v[40:43], a[196:199], a[60:63], v[40:43]
    v_cvt_pk_bf16_f32 v50, v64, v65
    v_cvt_pk_bf16_f32 v51, v66, v67
    v_mfma_f32_16x16x32_bf16 v[60:63], a[200:203], a[0:3], 0
    v_exp_f32 v68, v68
    v_mfma_f32_16x16x32_bf16 v[60:63], a[204:207], a[4:7], v[60:63]
    v_exp_f32 v69, v69
    v_mfma_f32_16x16x32_bf16 v[60:63], a[208:211], a[8:11], v[60:63]
    s_waitcnt lgkmcnt(0)
    v_exp_f32 v70, v70
    v_mfma_f32_16x16x32_bf16 v[60:63], a[212:215], a[12:15], v[60:63]
    v_exp_f32 v71, v71
    v_mfma_f32_16x16x32_bf16 v[64:67], a[200:203], a[16:19], 0
    v_cvt_pk_bf16_f32 v54, v68, v69
    v_cvt_pk_bf16_f32 v55, v70, v71
    v_mfma_f32_16x16x32_bf16 v[64:67], a[204:207], a[20:23], v[64:67]
    v_exp_f32 v72, v72
    v_mfma_f32_16x16x32_bf16 v[64:67], a[208:211], a[24:27], v[64:67]
    v_exp_f32 v73, v73
    v_mfma_f32_16x16x32_bf16 v[64:67], a[212:215], a[28:31], v[64:67]
    v_exp_f32 v74, v74
    v_mfma_f32_16x16x32_bf16 v[68:71], a[200:203], a[32:35], 0
    v_exp_f32 v75, v75
    v_mfma_f32_16x16x32_bf16 v[68:71], a[204:207], a[36:39], v[68:71]
    v_cvt_pk_bf16_f32 v58, v72, v73
    v_cvt_pk_bf16_f32 v59, v74, v75
    v_mfma_f32_16x16x32_bf16 v[68:71], a[208:211], a[40:43], v[68:71]
    v_exp_f32 v80, v80
    v_mfma_f32_16x16x32_bf16 v[68:71], a[212:215], a[44:47], v[68:71]
    v_exp_f32 v81, v81
    v_mfma_f32_16x16x32_bf16 v[72:75], a[200:203], a[48:51], 0
    s_waitcnt vmcnt(3) lgkmcnt(0)
    s_barrier
    v_xor_b32 v19, 0x10000, v19
    v_xor_b32 v20, 0x10000, v20
    v_xor_b32 v18, 0x10000, v18
    s_cmp_gt_i32 s88, 0
    s_cselect_b64 s[28:29], s[16:17], s[12:13]
    v_mfma_f32_16x16x32_bf16 v[72:75], a[204:207], a[52:55], v[72:75]
    s_add_u32 m0, s60, s94
    s_add_u32 s53, s58, s57
    ds_read_b64_tr_b16 a[184:185], v19 offset:0
    ds_read_b64_tr_b16 a[186:187], v19 offset:2048
    v_mfma_f32_16x16x32_bf16 v[72:75], a[208:211], a[56:59], v[72:75]
    buffer_load_dwordx4 v5, s[28:31], s53 offen offset:0 nt lds
    v_mfma_f32_16x16x32_bf16 v[72:75], a[212:215], a[60:63], v[72:75]
    s_add_u32 s57, s57, s88
    ds_read_b64_tr_b16 a[188:189], v20 offset:0
    v_mfma_f32_16x16x32_bf16 a[160:163], a[180:183], v[44:47], a[160:163]
    ds_read_b64_tr_b16 a[190:191], v20 offset:2048
    v_mfma_f32_16x16x32_bf16 a[164:167], a[180:183], v[48:51], a[164:167]
    v_exp_f32 v82, v82
    v_exp_f32 v83, v83
    v_mfma_f32_16x16x32_bf16 a[168:171], a[180:183], v[52:55], a[168:171]
    v_cvt_pk_bf16_f32 v78, v80, v81
    v_cvt_pk_bf16_f32 v79, v82, v83
    v_mfma_f32_16x16x32_bf16 a[172:175], a[180:183], v[56:59], a[172:175]
    ds_read_b64_tr_b16 a[192:193], v19 offset:512
    v_mfma_f32_16x16x32_bf16 a[176:179], a[180:183], v[76:79], a[176:179]
    s_waitcnt lgkmcnt(3)
    ds_read_b64_tr_b16 a[194:195], v19 offset:2560
    v_mfma_f32_16x16x32_bf16 v[228:231], a[184:187], v[76:79], v[228:231]
    buffer_load_dwordx4 v6, s[28:31], s53 offen offset:1024 nt lds
    v_mfma_f32_16x16x32_bf16 v[180:183], a[184:187], v[56:59], v[180:183]
    s_and_b32 s57, s57, 0x1ffff
    s_sub_u32 s88, 8192, s88
    v_mfma_f32_16x16x32_bf16 v[148:151], a[184:187], v[52:55], v[148:151]
    ds_read_b64_tr_b16 a[196:197], v20 offset:512
    v_mfma_f32_16x16x32_bf16 v[116:119], a[184:187], v[48:51], v[116:119]
    ds_read_b64_tr_b16 a[198:199], v20 offset:2560
    v_mfma_f32_16x16x32_bf16 v[84:87], a[184:187], v[44:47], v[84:87]
    s_waitcnt lgkmcnt(3)
    ds_read_b64_tr_b16 a[200:201], v19 offset:4096
    v_mfma_f32_16x16x32_bf16 v[88:91], a[188:191], v[44:47], v[88:91]
    ds_read_b64_tr_b16 a[202:203], v19 offset:6144
    v_mfma_f32_16x16x32_bf16 v[120:123], a[188:191], v[48:51], v[120:123]
    ds_read_b64_tr_b16 a[204:205], v20 offset:4096
    v_mfma_f32_16x16x32_bf16 v[152:155], a[188:191], v[52:55], v[152:155]
    ds_read_b64_tr_b16 a[206:207], v20 offset:6144
    v_mfma_f32_16x16x32_bf16 v[184:187], a[188:191], v[56:59], v[184:187]
    ds_read_b64_tr_b16 a[208:209], v19 offset:4608
    v_mfma_f32_16x16x32_bf16 v[232:235], a[188:191], v[76:79], v[232:235]
    s_waitcnt lgkmcnt(5)
    ds_read_b64_tr_b16 a[210:211], v19 offset:6656
    v_mfma_f32_16x16x32_bf16 v[236:239], a[192:195], v[76:79], v[236:239]
    buffer_load_dwordx4 v7, s[28:31], s53 offen offset:2048 nt lds
    v_mfma_f32_16x16x32_bf16 v[188:191], a[192:195], v[56:59], v[188:191]
    s_add_u32 s94, s94, 16384
    s_and_b32 s94, s94, 0x1ffff
    v_mfma_f32_16x16x32_bf16 v[156:159], a[192:195], v[52:55], v[156:159]
    ds_read_b64_tr_b16 a[212:213], v20 offset:4608
    v_mfma_f32_16x16x32_bf16 v[124:127], a[192:195], v[48:51], v[124:127]
    ds_read_b64_tr_b16 a[214:215], v20 offset:6656
    v_mfma_f32_16x16x32_bf16 v[92:95], a[192:195], v[44:47], v[92:95]
    v_exp_f32 v28, v28
    v_mfma_f32_16x16x32_bf16 v[96:99], a[196:199], v[44:47], v[96:99]
    v_exp_f32 v29, v29
    v_mfma_f32_16x16x32_bf16 v[128:131], a[196:199], v[48:51], v[128:131]
    v_exp_f32 v30, v30
    v_mfma_f32_16x16x32_bf16 v[160:163], a[196:199], v[52:55], v[160:163]
    v_exp_f32 v31, v31
    v_mfma_f32_16x16x32_bf16 v[192:195], a[196:199], v[56:59], v[192:195]
    v_cvt_pk_bf16_f32 v28, v28, v29
    v_cvt_pk_bf16_f32 v29, v30, v31
    v_mfma_f32_16x16x32_bf16 v[240:243], a[196:199], v[76:79], v[240:243]
    buffer_load_dwordx4 v8, s[28:31], s53 offen offset:3072 nt lds
    s_waitcnt lgkmcnt(0)
    v_mfma_f32_16x16x32_bf16 v[212:215], a[200:203], v[76:79], v[212:215]
    v_exp_f32 v32, v32
    v_mfma_f32_16x16x32_bf16 v[196:199], a[200:203], v[56:59], v[196:199]
    v_exp_f32 v33, v33
    v_mfma_f32_16x16x32_bf16 v[164:167], a[200:203], v[52:55], v[164:167]
    v_exp_f32 v34, v34
    v_mfma_f32_16x16x32_bf16 v[132:135], a[200:203], v[48:51], v[132:135]
    v_exp_f32 v35, v35
    v_mfma_f32_16x16x32_bf16 v[100:103], a[200:203], v[44:47], v[100:103]
    v_cvt_pk_bf16_f32 v32, v32, v33
    v_cvt_pk_bf16_f32 v33, v34, v35
    v_mfma_f32_16x16x32_bf16 v[104:107], a[204:207], v[44:47], v[104:107]
    v_exp_f32 v36, v36
    v_mfma_f32_16x16x32_bf16 v[136:139], a[204:207], v[48:51], v[136:139]
    v_exp_f32 v37, v37
    v_mfma_f32_16x16x32_bf16 v[168:171], a[204:207], v[52:55], v[168:171]
    v_exp_f32 v38, v38
    v_mfma_f32_16x16x32_bf16 v[200:203], a[204:207], v[56:59], v[200:203]
    v_exp_f32 v39, v39
    v_mfma_f32_16x16x32_bf16 v[216:219], a[204:207], v[76:79], v[216:219]
    v_cvt_pk_bf16_f32 v36, v36, v37
    v_cvt_pk_bf16_f32 v37, v38, v39
    v_mfma_f32_16x16x32_bf16 v[220:223], a[208:211], v[76:79], v[220:223]
    v_exp_f32 v40, v40
    v_mfma_f32_16x16x32_bf16 v[204:207], a[208:211], v[56:59], v[204:207]
    s_lshr_b32 s97, s97, 1
    s_cbranch_scc0 1
    s_waitcnt vmcnt(3)
    s_waitcnt vmcnt(4) lgkmcnt(0)
    s_barrier
    s_cmp_gt_i32 s88, 0
    s_cselect_b64 s[28:29], s[16:17], s[12:13]
    v_mfma_f32_16x16x32_bf16 v[172:175], a[208:211], v[52:55], v[172:175]
    s_add_u32 m0, s60, s94
    s_add_u32 s53, s58, s57
    ds_read_b128 a[184:187], v18 offset:16896
    ds_read_b128 a[188:191], v18 offset:16384
    v_mfma_f32_16x16x32_bf16 v[140:143], a[208:211], v[48:51], v[140:143]
    buffer_load_dwordx4 v5, s[28:31], s53 offen offset:0 nt lds
    v_mfma_f32_16x16x32_bf16 v[108:111], a[208:211], v[44:47], v[108:111]
    s_add_u32 s57, s57, s88
    ds_read_b128 a[192:195], v18 offset:20992
    ds_read_b128 a[196:199], v18 offset:20480
    v_mfma_f32_16x16x32_bf16 v[112:115], a[212:215], v[44:47], v[112:115]
    ds_read_b128 a[200:203], v18 offset:18944
    v_mfma_f32_16x16x32_bf16 v[144:147], a[212:215], v[48:51], v[144:147]
    ds_read_b128 a[204:207], v18 offset:18432
    v_mfma_f32_16x16x32_bf16 v[176:179], a[212:215], v[52:55], v[176:179]
    ds_read_b128 a[208:211], v18 offset:23040
    v_mfma_f32_16x16x32_bf16 v[208:211], a[212:215], v[56:59], v[208:211]
    v_exp_f32 v41, v41
    v_mfma_f32_16x16x32_bf16 v[224:227], a[212:215], v[76:79], v[224:227]
    s_waitcnt lgkmcnt(5)
    ds_read_b128 a[212:215], v18 offset:22528
    v_mfma_f32_16x16x32_bf16 v[44:47], a[184:187], a[0:3], 0
    v_exp_f32 v42, v42
    v_mfma_f32_16x16x32_bf16 v[44:47], a[188:191], a[4:7], v[44:47]
    s_waitcnt lgkmcnt(3)
    v_exp_f32 v43, v43
    v_mfma_f32_16x16x32_bf16 v[44:47], a[192:195], a[8:11], v[44:47]
    v_cvt_pk_bf16_f32 v40, v40, v41
    v_cvt_pk_bf16_f32 v41, v42, v43
    v_mfma_f32_16x16x32_bf16 v[44:47], a[196:199], a[12:15], v[44:47]
    v_exp_f32 v60, v60
    v_mfma_f32_16x16x32_bf16 v[48:51], a[184:187], a[16:19], 0
    v_exp_f32 v61, v61
    v_mfma_f32_16x16x32_bf16 v[48:51], a[188:191], a[20:23], v[48:51]
    buffer_load_dwordx4 v6, s[28:31], s53 offen offset:1024 nt lds
    v_mfma_f32_16x16x32_bf16 v[48:51], a[192:195], a[24:27], v[48:51]
    s_and_b32 s57, s57, 0x1ffff
    s_sub_u32 s88, 8192, s88
    v_mfma_f32_16x16x32_bf16 v[48:51], a[196:199], a[28:31], v[48:51]
    v_exp_f32 v62, v62
    v_mfma_f32_16x16x32_bf16 v[52:55], a[184:187], a[32:35], 0
    v_exp_f32 v63, v63
    v_mfma_f32_16x16x32_bf16 v[52:55], a[188:191], a[36:39], v[52:55]
    v_cvt_pk_bf16_f32 v30, v60, v61
    v_cvt_pk_bf16_f32 v31, v62, v63
    v_mfma_f32_16x16x32_bf16 v[52:55], a[192:195], a[40:43], v[52:55]
    v_exp_f32 v64, v64
    v_mfma_f32_16x16x32_bf16 v[52:55], a[196:199], a[44:47], v[52:55]
    v_exp_f32 v65, v65
    v_mfma_f32_16x16x32_bf16 v[56:59], a[184:187], a[48:51], 0
    v_exp_f32 v66, v66
    v_mfma_f32_16x16x32_bf16 v[56:59], a[188:191], a[52:55], v[56:59]
    v_exp_f32 v67, v67
    v_mfma_f32_16x16x32_bf16 v[56:59], a[192:195], a[56:59], v[56:59]
    v_cvt_pk_bf16_f32 v34, v64, v65
    v_cvt_pk_bf16_f32 v35, v66, v67
    v_mfma_f32_16x16x32_bf16 v[56:59], a[196:199], a[60:63], v[56:59]
    v_exp_f32 v68, v68
    v_mfma_f32_16x16x32_bf16 v[76:79], a[184:187], a[64:67], 0
    v_exp_f32 v69, v69
    v_mfma_f32_16x16x32_bf16 v[76:79], a[188:191], a[68:71], v[76:79]
    v_exp_f32 v70, v70
    v_mfma_f32_16x16x32_bf16 v[76:79], a[192:195], a[72:75], v[76:79]
    v_exp_f32 v71, v71
    v_mfma_f32_16x16x32_bf16 v[76:79], a[196:199], a[76:79], v[76:79]
    buffer_load_dwordx4 v7, s[28:31], s53 offen offset:2048 nt lds
    v_mfma_f32_16x16x32_bf16 v[60:63], a[200:203], a[0:3], 0
    s_add_u32 s94, s94, 16384
    s_and_b32 s94, s94, 0x1ffff
    s_waitcnt lgkmcnt(0)
    v_mfma_f32_16x16x32_bf16 v[60:63], a[204:207], a[4:7], v[60:63]
    v_cvt_pk_bf16_f32 v38, v68, v69
    v_cvt_pk_bf16_f32 v39, v70, v71
    v_mfma_f32_16x16x32_bf16 v[60:63], a[208:211], a[8:11], v[60:63]
    v_exp_f32 v72, v72
    v_mfma_f32_16x16x32_bf16 v[60:63], a[212:215], a[12:15], v[60:63]
    v_exp_f32 v73, v73
    v_mfma_f32_16x16x32_bf16 v[64:67], a[200:203], a[16:19], 0
    v_exp_f32 v74, v74
    v_mfma_f32_16x16x32_bf16 v[64:67], a[204:207], a[20:23], v[64:67]
    v_exp_f32 v75, v75
    v_mfma_f32_16x16x32_bf16 v[64:67], a[208:211], a[24:27], v[64:67]
    v_cvt_pk_bf16_f32 v42, v72, v73
    v_cvt_pk_bf16_f32 v43, v74, v75
    v_mfma_f32_16x16x32_bf16 v[64:67], a[212:215], a[28:31], v[64:67]
    v_exp_f32 v44, v44
    v_mfma_f32_16x16x32_bf16 v[68:71], a[200:203], a[32:35], 0
    v_exp_f32 v45, v45
    v_mfma_f32_16x16x32_bf16 v[68:71], a[204:207], a[36:39], v[68:71]
    v_exp_f32 v46, v46
    v_mfma_f32_16x16x32_bf16 v[68:71], a[208:211], a[40:43], v[68:71]
    v_exp_f32 v47, v47
    v_mfma_f32_16x16x32_bf16 v[68:71], a[212:215], a[44:47], v[68:71]
    v_cvt_pk_bf16_f32 v44, v44, v45
    v_cvt_pk_bf16_f32 v45, v46, v47
    v_mfma_f32_16x16x32_bf16 v[72:75], a[200:203], a[48:51], 0
    v_exp_f32 v48, v48
    v_mfma_f32_16x16x32_bf16 v[72:75], a[204:207], a[52:55], v[72:75]
    v_exp_f32 v49, v49
    v_mfma_f32_16x16x32_bf16 v[72:75], a[208:211], a[56:59], v[72:75]
    v_exp_f32 v50, v50
    v_mfma_f32_16x16x32_bf16 v[72:75], a[212:215], a[60:63], v[72:75]
    s_sub_u32 s92, s92, 1
    s_cbranch_scc0 gqa_kernel_aloop_1
    s_cbranch_vccz gqa_kernel_ool22
gqa_kernel_ret22_1:
    s_waitcnt vmcnt(3) lgkmcnt(0)
    s_barrier
    ds_read_b64_tr_b16 a[184:185], v19 offset:32768
    ds_read_b64_tr_b16 a[186:187], v19 offset:34816
    v_mfma_f32_16x16x32_bf16 v[80:83], a[200:203], a[64:67], 0
    buffer_load_dwordx4 v8, s[28:31], s53 offen offset:3072 nt lds
    v_mfma_f32_16x16x32_bf16 v[80:83], a[204:207], a[68:71], v[80:83]
    ds_read_b64_tr_b16 a[188:189], v20 offset:32768
    v_mfma_f32_16x16x32_bf16 v[80:83], a[208:211], a[72:75], v[80:83]
    ds_read_b64_tr_b16 a[190:191], v20 offset:34816
    v_mfma_f32_16x16x32_bf16 v[80:83], a[212:215], a[76:79], v[80:83]
    ds_read_b64_tr_b16 a[192:193], v19 offset:33280
    v_mfma_f32_16x16x32_bf16 a[160:163], a[180:183], v[28:31], a[160:163]
    ds_read_b64_tr_b16 a[194:195], v19 offset:35328
    v_mfma_f32_16x16x32_bf16 a[164:167], a[180:183], v[32:35], a[164:167]
    ds_read_b64_tr_b16 a[196:197], v20 offset:33280
    v_mfma_f32_16x16x32_bf16 a[168:171], a[180:183], v[36:39], a[168:171]
    s_cmp_gt_i32 s88, 0
    s_cselect_b64 s[28:29], s[16:17], s[12:13]
    s_add_u32 m0, s60, s94
    s_add_u32 s53, s58, s57
    v_mfma_f32_16x16x32_bf16 a[172:175], a[180:183], v[40:43], a[172:175]
    buffer_load_dwordx4 v5, s[28:31], s53 offen offset:0 nt lds
    s_waitcnt lgkmcnt(3)
    v_mfma_f32_16x16x32_bf16 v[180:183], a[184:187], v[40:43], v[180:183]
    s_add_u32 s57, s57, s88
    ds_read_b64_tr_b16 a[198:199], v20 offset:35328
    v_mfma_f32_16x16x32_bf16 v[148:151], a[184:187], v[36:39], v[148:151]
    ds_read_b64_tr_b16 a[200:201], v19 offset:36864
    v_mfma_f32_16x16x32_bf16 v[116:119], a[184:187], v[32:35], v[116:119]
    ds_read_b64_tr_b16 a[202:203], v19 offset:38912
    v_mfma_f32_16x16x32_bf16 v[84:87], a[184:187], v[28:31], v[84:87]
    ds_read_b64_tr_b16 a[204:205], v20 offset:36864
    v_mfma_f32_16x16x32_bf16 v[88:91], a[188:191], v[28:31], v[88:91]
    ds_read_b64_tr_b16 a[206:207], v20 offset:38912
    v_mfma_f32_16x16x32_bf16 v[120:123], a[188:191], v[32:35], v[120:123]
    ds_read_b64_tr_b16 a[208:209], v19 offset:37376
    v_mfma_f32_16x16x32_bf16 v[152:155], a[188:191], v[36:39], v[152:155]
    buffer_load_dwordx4 v6, s[28:31], s53 offen offset:1024 nt lds
    v_mfma_f32_16x16x32_bf16 v[184:187], a[188:191], v[40:43], v[184:187]
    s_and_b32 s57, s57, 0x1ffff
    s_sub_u32 s88, 8192, s88
    s_waitcnt lgkmcnt(4)
    v_mfma_f32_16x16x32_bf16 v[188:191], a[192:195], v[40:43], v[188:191]
    ds_read_b64_tr_b16 a[210:211], v19 offset:39424
    v_mfma_f32_16x16x32_bf16 v[156:159], a[192:195], v[36:39], v[156:159]
    ds_read_b64_tr_b16 a[212:213], v20 offset:37376
    v_mfma_f32_16x16x32_bf16 v[124:127], a[192:195], v[32:35], v[124:127]
    ds_read_b64_tr_b16 a[214:215], v20 offset:39424
    v_mfma_f32_16x16x32_bf16 v[92:95], a[192:195], v[28:31], v[92:95]
    v_exp_f32 v51, v51
    v_mfma_f32_16x16x32_bf16 v[96:99], a[196:199], v[28:31], v[96:99]
    v_cvt_pk_bf16_f32 v48, v48, v49
    v_cvt_pk_bf16_f32 v49, v50, v51
    v_mfma_f32_16x16x32_bf16 v[128:131], a[196:199], v[32:35], v[128:131]
    buffer_load_dwordx4 v7, s[28:31], s53 offen offset:2048 nt lds
    v_mfma_f32_16x16x32_bf16 v[160:163], a[196:199], v[36:39], v[160:163]
    s_add_u32 s94, s94, 16384
    s_and_b32 s94, s94, 0x1ffff
    v_mfma_f32_16x16x32_bf16 v[192:195], a[196:199], v[40:43], v[192:195]
    s_waitcnt lgkmcnt(1)
    v_exp_f32 v52, v52
    v_mfma_f32_16x16x32_bf16 v[196:199], a[200:203], v[40:43], v[196:199]
    v_exp_f32 v53, v53
    v_mfma_f32_16x16x32_bf16 v[164:167], a[200:203], v[36:39], v[164:167]
    v_exp_f32 v54, v54
    v_mfma_f32_16x16x32_bf16 v[132:135], a[200:203], v[32:35], v[132:135]
    v_exp_f32 v55, v55
    v_mfma_f32_16x16x32_bf16 v[100:103], a[200:203], v[28:31], v[100:103]
    v_cvt_pk_bf16_f32 v52, v52, v53
    v_cvt_pk_bf16_f32 v53, v54, v55
    v_mfma_f32_16x16x32_bf16 v[104:107], a[204:207], v[28:31], v[104:107]
    v_exp_f32 v56, v56
    v_mfma_f32_16x16x32_bf16 v[136:139], a[204:207], v[32:35], v[136:139]
    v_exp_f32 v57, v57
    v_mfma_f32_16x16x32_bf16 v[168:171], a[204:207], v[36:39], v[168:171]
    v_exp_f32 v58, v58
    v_mfma_f32_16x16x32_bf16 v[200:203], a[204:207], v[40:43], v[200:203]
    s_lshr_b32 s97, s97, 1
    s_cbranch_scc0 1
    s_waitcnt vmcnt(3)
    s_waitcnt vmcnt(4) lgkmcnt(0)
    s_barrier
    ds_read_b128 a[184:187], v18 offset:49664
    ds_read_b128 a[188:191], v18 offset:49152
    v_mfma_f32_16x16x32_bf16 v[204:207], a[208:211], v[40:43], v[204:207]
    buffer_load_dwordx4 v8, s[28:31], s53 offen offset:3072 nt lds
    v_mfma_f32_16x16x32_bf16 v[172:175], a[208:211], v[36:39], v[172:175]
    ds_read_b128 a[192:195], v18 offset:53760
    ds_read_b128 a[196:199], v18 offset:53248
    v_mfma_f32_16x16x32_bf16 v[140:143], a[208:211], v[32:35], v[140:143]
    ds_read_b128 a[200:203], v18 offset:51712
    v_mfma_f32_16x16x32_bf16 v[108:111], a[208:211], v[28:31], v[108:111]
    ds_read_b128 a[204:207], v18 offset:51200
    v_mfma_f32_16x16x32_bf16 v[112:115], a[212:215], v[28:31], v[112:115]
    ds_read_b128 a[208:211], v18 offset:55808
    v_mfma_f32_16x16x32_bf16 v[144:147], a[212:215], v[32:35], v[144:147]
    v_exp_f32 v59, v59
    v_mfma_f32_16x16x32_bf16 v[176:179], a[212:215], v[36:39], v[176:179]
    v_cvt_pk_bf16_f32 v56, v56, v57
    v_cvt_pk_bf16_f32 v57, v58, v59
    v_mfma_f32_16x16x32_bf16 v[208:211], a[212:215], v[40:43], v[208:211]
    s_waitcnt lgkmcnt(3)
    ds_read_b128 a[212:215], v18 offset:55296
    v_mfma_f32_16x16x32_bf16 v[28:31], a[184:187], a[0:3], 0
    v_exp_f32 v76, v76
    v_mfma_f32_16x16x32_bf16 v[28:31], a[188:191], a[4:7], v[28:31]
    v_exp_f32 v77, v77
    v_mfma_f32_16x16x32_bf16 v[28:31], a[192:195], a[8:11], v[28:31]
    s_cmp_gt_i32 s88, 0
    s_cselect_b64 s[28:29], s[16:17], s[12:13]
    s_add_u32 m0, s60, s94
    s_add_u32 s53, s58, s57
    v_mfma_f32_16x16x32_bf16 v[28:31], a[196:199], a[12:15], v[28:31]
    buffer_load_dwordx4 v5, s[28:31], s53 offen offset:0 nt lds
    v_mfma_f32_16x16x32_bf16 v[32:35], a[184:187], a[16:19], 0
    s_add_u32 s57, s57, s88
    v_mfma_f32_16x16x32_bf16 v[32:35], a[188:191], a[20:23], v[32:35]
    v_exp_f32 v78, v78
    v_mfma_f32_16x16x32_bf16 v[32:35], a[192:195], a[24:27], v[32:35]
    v_exp_f32 v79, v79
    v_mfma_f32_16x16x32_bf16 v[32:35], a[196:199], a[28:31], v[32:35]
    v_cvt_pk_bf16_f32 v76, v76, v77
    v_cvt_pk_bf16_f32 v77, v78, v79
    v_mfma_f32_16x16x32_bf16 v[36:39], a[184:187], a[32:35], 0
    v_exp_f32 v60, v60
    v_mfma_f32_16x16x32_bf16 v[36:39], a[188:191], a[36:39], v[36:39]
    v_exp_f32 v61, v61
    v_mfma_f32_16x16x32_bf16 v[36:39], a[192:195], a[40:43], v[36:39]
    v_exp_f32 v62, v62
    v_mfma_f32_16x16x32_bf16 v[36:39], a[196:199], a[44:47], v[36:39]
    v_exp_f32 v63, v63
    v_mfma_f32_16x16x32_bf16 v[40:43], a[184:187], a[48:51], 0
    v_cvt_pk_bf16_f32 v46, v60, v61
    v_cvt_pk_bf16_f32 v47, v62, v63
    v_mfma_f32_16x16x32_bf16 v[40:43], a[188:191], a[52:55], v[40:43]
    v_exp_f32 v64, v64
    v_mfma_f32_16x16x32_bf16 v[40:43], a[192:195], a[56:59], v[40:43]
    buffer_load_dwordx4 v6, s[28:31], s53 offen offset:1024 nt lds
    v_mfma_f32_16x16x32_bf16 v[40:43], a[196:199], a[60:63], v[40:43]
    s_and_b32 s57, s57, 0x1ffff
    s_sub_u32 s88, 8192, s88
    s_waitcnt lgkmcnt(0)
    v_mfma_f32_16x16x32_bf16 v[60:63], a[200:203], a[0:3], 0
    v_exp_f32 v65, v65
    v_mfma_f32_16x16x32_bf16 v[60:63], a[204:207], a[4:7], v[60:63]
    v_exp_f32 v66, v66
    v_exp_f32 v67, v67
    v_mfma_f32_16x16x32_bf16 v[60:63], a[208:211], a[8:11], v[60:63]
    v_cvt_pk_bf16_f32 v50, v64, v65
    v_cvt_pk_bf16_f32 v51, v66, v67
    v_mfma_f32_16x16x32_bf16 v[60:63], a[212:215], a[12:15], v[60:63]
    v_exp_f32 v68, v68
    v_mfma_f32_16x16x32_bf16 v[64:67], a[200:203], a[16:19], 0
    v_exp_f32 v69, v69
    v_mfma_f32_16x16x32_bf16 v[64:67], a[204:207], a[20:23], v[64:67]
    v_exp_f32 v70, v70
    v_exp_f32 v71, v71
    v_mfma_f32_16x16x32_bf16 v[64:67], a[208:211], a[24:27], v[64:67]
    v_cvt_pk_bf16_f32 v54, v68, v69
    v_cvt_pk_bf16_f32 v55, v70, v71
    v_mfma_f32_16x16x32_bf16 v[64:67], a[212:215], a[28:31], v[64:67]
    v_exp_f32 v72, v72
    v_mfma_f32_16x16x32_bf16 v[68:71], a[200:203], a[32:35], 0
    v_exp_f32 v73, v73
    v_mfma_f32_16x16x32_bf16 v[68:71], a[204:207], a[36:39], v[68:71]
    v_exp_f32 v74, v74
    v_exp_f32 v75, v75
    v_mfma_f32_16x16x32_bf16 v[68:71], a[208:211], a[40:43], v[68:71]
    v_cvt_pk_bf16_f32 v58, v72, v73
    v_cvt_pk_bf16_f32 v59, v74, v75
    v_mfma_f32_16x16x32_bf16 v[68:71], a[212:215], a[44:47], v[68:71]
    v_exp_f32 v80, v80
    v_mfma_f32_16x16x32_bf16 v[72:75], a[200:203], a[48:51], 0
    s_cbranch_vccz gqa_kernel_ool24
gqa_kernel_ret24_1:
    s_waitcnt vmcnt(3) lgkmcnt(0)
    s_barrier
    v_xor_b32 v19, 0x10000, v19
    v_xor_b32 v20, 0x10000, v20
    v_xor_b32 v18, 0x10000, v18
    ds_read_b64_tr_b16 a[184:185], v19 offset:0
    ds_read_b64_tr_b16 a[186:187], v19 offset:2048
    v_mfma_f32_16x16x32_bf16 v[72:75], a[204:207], a[52:55], v[72:75]
    buffer_load_dwordx4 v7, s[28:31], s53 offen offset:2048 nt lds
    v_mfma_f32_16x16x32_bf16 v[72:75], a[208:211], a[56:59], v[72:75]
    s_add_u32 s94, s94, 16384
    s_and_b32 s94, s94, 0x1ffff
    v_mfma_f32_16x16x32_bf16 v[72:75], a[212:215], a[60:63], v[72:75]
    ds_read_b64_tr_b16 a[188:189], v20 offset:0
    v_mfma_f32_16x16x32_bf16 a[160:163], a[180:183], v[44:47], a[160:163]
    ds_read_b64_tr_b16 a[190:191], v20 offset:2048
    v_mfma_f32_16x16x32_bf16 a[164:167], a[180:183], v[48:51], a[164:167]
    v_exp_f32 v81, v81
    v_exp_f32 v82, v82
    v_mfma_f32_16x16x32_bf16 a[168:171], a[180:183], v[52:55], a[168:171]
    v_exp_f32 v83, v83
    v_cvt_pk_bf16_f32 v78, v80, v81
    v_cvt_pk_bf16_f32 v79, v82, v83
    v_mfma_f32_16x16x32_bf16 a[172:175], a[180:183], v[56:59], a[172:175]
    ds_read_b64_tr_b16 a[192:193], v19 offset:512
    v_mfma_f32_16x16x32_bf16 a[176:179], a[180:183], v[76:79], a[176:179]
    s_waitcnt lgkmcnt(2)
    ds_read_b64_tr_b16 a[194:195], v19 offset:2560
    v_mfma_f32_16x16x32_bf16 v[228:231], a[184:187], v[76:79], v[228:231]
    buffer_load_dwordx4 v8, s[28:31], s53 offen offset:3072 nt lds
    v_mfma_f32_16x16x32_bf16 v[180:183], a[184:187], v[56:59], v[180:183]
    ds_read_b64_tr_b16 a[196:197], v20 offset:512
    v_mfma_f32_16x16x32_bf16 v[148:151], a[184:187], v[52:55], v[148:151]
    ds_read_b64_tr_b16 a[198:199], v20 offset:2560
    v_mfma_f32_16x16x32_bf16 v[116:119], a[184:187], v[48:51], v[116:119]
    ds_read_b64_tr_b16 a[200:201], v19 offset:4096
    v_mfma_f32_16x16x32_bf16 v[84:87], a[184:187], v[44:47], v[84:87]
    s_waitcnt lgkmcnt(4)
    ds_read_b64_tr_b16 a[202:203], v19 offset:6144
    v_mfma_f32_16x16x32_bf16 v[88:91], a[188:191], v[44:47], v[88:91]
    ds_read_b64_tr_b16 a[204:205], v20 offset:4096
    v_mfma_f32_16x16x32_bf16 v[120:123], a[188:191], v[48:51], v[120:123]
    ds_read_b64_tr_b16 a[206:207], v20 offset:6144
    v_mfma_f32_16x16x32_bf16 v[152:155], a[188:191], v[52:55], v[152:155]
    ds_read_b64_tr_b16 a[208:209], v19 offset:4608
    v_mfma_f32_16x16x32_bf16 v[184:187], a[188:191], v[56:59], v[184:187]
    ds_read_b64_tr_b16 a[210:211], v19 offset:6656
    v_mfma_f32_16x16x32_bf16 v[232:235], a[188:191], v[76:79], v[232:235]
    s_waitcnt lgkmcnt(5)
    ds_read_b64_tr_b16 a[212:213], v20 offset:4608
    v_mfma_f32_16x16x32_bf16 v[236:239], a[192:195], v[76:79], v[236:239]
    s_cmp_gt_i32 s88, 0
    s_cselect_b64 s[28:29], s[16:17], s[12:13]
    s_add_u32 m0, s60, s94
    s_add_u32 s53, s58, s57
    v_mfma_f32_16x16x32_bf16 v[188:191], a[192:195], v[56:59], v[188:191]
    buffer_load_dwordx4 v5, s[28:31], s53 offen offset:0 nt lds
    v_mfma_f32_16x16x32_bf16 v[156:159], a[192:195], v[52:55], v[156:159]
    s_add_u32 s57, s57, s88
    ds_read_b64_tr_b16 a[214:215], v20 offset:6656
    v_mfma_f32_16x16x32_bf16 v[124:127], a[192:195], v[48:51], v[124:127]
    v_exp_f32 v28, v28
    v_mfma_f32_16x16x32_bf16 v[92:95], a[192:195], v[44:47], v[92:95]
    v_exp_f32 v29, v29
    v_mfma_f32_16x16x32_bf16 v[96:99], a[196:199], v[44:47], v[96:99]
    v_exp_f32 v30, v30
    v_mfma_f32_16x16x32_bf16 v[128:131], a[196:199], v[48:51], v[128:131]
    v_exp_f32 v31, v31
    v_mfma_f32_16x16x32_bf16 v[160:163], a[196:199], v[52:55], v[160:163]
    v_cvt_pk_bf16_f32 v28, v28, v29
    v_cvt_pk_bf16_f32 v29, v30, v31
    v_mfma_f32_16x16x32_bf16 v[192:195], a[196:199], v[56:59], v[192:195]
    v_exp_f32 v32, v32
    v_mfma_f32_16x16x32_bf16 v[240:243], a[196:199], v[76:79], v[240:243]
    buffer_load_dwordx4 v6, s[28:31], s53 offen offset:1024 nt lds
    s_waitcnt lgkmcnt(0)
    v_mfma_f32_16x16x32_bf16 v[212:215], a[200:203], v[76:79], v[212:215]
    s_and_b32 s57, s57, 0x1ffff
    s_sub_u32 s88, 8192, s88
    v_mfma_f32_16x16x32_bf16 v[196:199], a[200:203], v[56:59], v[196:199]
    v_exp_f32 v33, v33
    v_mfma_f32_16x16x32_bf16 v[164:167], a[200:203], v[52:55], v[164:167]
    v_exp_f32 v34, v34
    v_mfma_f32_16x16x32_bf16 v[132:135], a[200:203], v[48:51], v[132:135]
    v_exp_f32 v35, v35
    v_mfma_f32_16x16x32_bf16 v[100:103], a[200:203], v[44:47], v[100:103]
    v_cvt_pk_bf16_f32 v32, v32, v33
    v_cvt_pk_bf16_f32 v33, v34, v35
    v_mfma_f32_16x16x32_bf16 v[104:107], a[204:207], v[44:47], v[104:107]
    v_exp_f32 v36, v36
    v_mfma_f32_16x16x32_bf16 v[136:139], a[204:207], v[48:51], v[136:139]
    v_exp_f32 v37, v37
    v_mfma_f32_16x16x32_bf16 v[168:171], a[204:207], v[52:55], v[168:171]
    v_exp_f32 v38, v38
    v_mfma_f32_16x16x32_bf16 v[200:203], a[204:207], v[56:59], v[200:203]
    v_exp_f32 v39, v39
    v_mfma_f32_16x16x32_bf16 v[216:219], a[204:207], v[76:79], v[216:219]
    v_cvt_pk_bf16_f32 v36, v36, v37
    v_cvt_pk_bf16_f32 v37, v38, v39
    v_mfma_f32_16x16x32_bf16 v[220:223], a[208:211], v[76:79], v[220:223]
    v_exp_f32 v40, v40
    v_mfma_f32_16x16x32_bf16 v[204:207], a[208:211], v[56:59], v[204:207]
    s_lshr_b32 s97, s97, 1
    s_cbranch_scc0 1
    s_waitcnt vmcnt(3)
    s_waitcnt vmcnt(4) lgkmcnt(0)
    s_barrier
    ds_read_b128 a[184:187], v18 offset:16896
    ds_read_b128 a[188:191], v18 offset:16384
    v_mfma_f32_16x16x32_bf16 v[172:175], a[208:211], v[52:55], v[172:175]
    buffer_load_dwordx4 v7, s[28:31], s53 offen offset:2048 nt lds
    v_mfma_f32_16x16x32_bf16 v[140:143], a[208:211], v[48:51], v[140:143]
    s_add_u32 s94, s94, 16384
    s_and_b32 s94, s94, 0x1ffff
    ds_read_b128 a[192:195], v18 offset:20992
    ds_read_b128 a[196:199], v18 offset:20480
    v_mfma_f32_16x16x32_bf16 v[108:111], a[208:211], v[44:47], v[108:111]
    ds_read_b128 a[200:203], v18 offset:18944
    v_mfma_f32_16x16x32_bf16 v[112:115], a[212:215], v[44:47], v[112:115]
    ds_read_b128 a[204:207], v18 offset:18432
    v_mfma_f32_16x16x32_bf16 v[144:147], a[212:215], v[48:51], v[144:147]
    ds_read_b128 a[208:211], v18 offset:23040
    v_mfma_f32_16x16x32_bf16 v[176:179], a[212:215], v[52:55], v[176:179]
    v_exp_f32 v41, v41
    v_mfma_f32_16x16x32_bf16 v[208:211], a[212:215], v[56:59], v[208:211]
    v_exp_f32 v42, v42
    v_mfma_f32_16x16x32_bf16 v[224:227], a[212:215], v[76:79], v[224:227]
    s_waitcnt lgkmcnt(4)
    ds_read_b128 a[212:215], v18 offset:22528
    v_mfma_f32_16x16x32_bf16 v[44:47], a[184:187], a[0:3], 0
    v_exp_f32 v43, v43
    v_mfma_f32_16x16x32_bf16 v[44:47], a[188:191], a[4:7], v[44:47]
    v_cvt_pk_bf16_f32 v40, v40, v41
    v_cvt_pk_bf16_f32 v41, v42, v43
    v_mfma_f32_16x16x32_bf16 v[44:47], a[192:195], a[8:11], v[44:47]
    s_waitcnt lgkmcnt(1)
    v_exp_f32 v60, v60
    v_mfma_f32_16x16x32_bf16 v[44:47], a[196:199], a[12:15], v[44:47]
    v_exp_f32 v61, v61
    v_mfma_f32_16x16x32_bf16 v[48:51], a[184:187], a[16:19], 0
    v_exp_f32 v62, v62
    v_mfma_f32_16x16x32_bf16 v[48:51], a[188:191], a[20:23], v[48:51]
    buffer_load_dwordx4 v8, s[28:31], s53 offen offset:3072 nt lds
    v_mfma_f32_16x16x32_bf16 v[48:51], a[192:195], a[24:27], v[48:51]
    v_exp_f32 v63, v63
    v_mfma_f32_16x16x32_bf16 v[48:51], a[196:199], a[28:31], v[48:51]
    v_cvt_pk_bf16_f32 v30, v60, v61
    v_cvt_pk_bf16_f32 v31, v62, v63
    v_mfma_f32_16x16x32_bf16 v[52:55], a[184:187], a[32:35], 0
    v_exp_f32 v64, v64
    v_mfma_f32_16x16x32_bf16 v[52:55], a[188:191], a[36:39], v[52:55]
    v_exp_f32 v65, v65
    v_mfma_f32_16x16x32_bf16 v[52:55], a[192:195], a[40:43], v[52:55]
    v_exp_f32 v66, v66
    v_mfma_f32_16x16x32_bf16 v[52:55], a[196:199], a[44:47], v[52:55]
    v_exp_f32 v67, v67
    v_mfma_f32_16x16x32_bf16 v[56:59], a[184:187], a[48:51], 0
    v_cvt_pk_bf16_f32 v34, v64, v65
    v_cvt_pk_bf16_f32 v35, v66, v67
    v_mfma_f32_16x16x32_bf16 v[56:59], a[188:191], a[52:55], v[56:59]
    v_exp_f32 v68, v68
    v_mfma_f32_16x16x32_bf16 v[56:59], a[192:195], a[56:59], v[56:59]
    v_exp_f32 v69, v69
    v_mfma_f32_16x16x32_bf16 v[56:59], a[196:199], a[60:63], v[56:59]
    v_exp_f32 v70, v70
    v_mfma_f32_16x16x32_bf16 v[76:79], a[184:187], a[64:67], 0
    v_exp_f32 v71, v71
    v_mfma_f32_16x16x32_bf16 v[76:79], a[188:191], a[68:71], v[76:79]
    v_cvt_pk_bf16_f32 v38, v68, v69
    v_cvt_pk_bf16_f32 v39, v70, v71
    v_mfma_f32_16x16x32_bf16 v[76:79], a[192:195], a[72:75], v[76:79]
    v_exp_f32 v72, v72
    v_mfma_f32_16x16x32_bf16 v[76:79], a[196:199], a[76:79], v[76:79]
    s_cmp_gt_i32 s88, 0
    s_cselect_b64 s[28:29], s[16:17], s[12:13]
    s_add_u32 m0, s60, s94
    s_add_u32 s53, s58, s57
    v_mfma_f32_16x16x32_bf16 v[60:63], a[200:203], a[0:3], 0
    buffer_load_dwordx4 v5, s[28:31], s53 offen offset:0 nt lds
    v_mfma_f32_16x16x32_bf16 v[60:63], a[204:207], a[4:7], v[60:63]
    s_add_u32 s57, s57, s88
    v_mfma_f32_16x16x32_bf16 v[60:63], a[208:211], a[8:11], v[60:63]
    s_waitcnt lgkmcnt(0)
    v_exp_f32 v73, v73
    v_mfma_f32_16x16x32_bf16 v[60:63], a[212:215], a[12:15], v[60:63]
    v_exp_f32 v74, v74
    v_mfma_f32_16x16x32_bf16 v[64:67], a[200:203], a[16:19], 0
    v_exp_f32 v75, v75
    v_mfma_f32_16x16x32_bf16 v[64:67], a[204:207], a[20:23], v[64:67]
    v_cvt_pk_bf16_f32 v42, v72, v73
    v_cvt_pk_bf16_f32 v43, v74, v75
    v_mfma_f32_16x16x32_bf16 v[64:67], a[208:211], a[24:27], v[64:67]
    v_exp_f32 v44, v44
    v_mfma_f32_16x16x32_bf16 v[64:67], a[212:215], a[28:31], v[64:67]
    v_exp_f32 v45, v45
    v_mfma_f32_16x16x32_bf16 v[68:71], a[200:203], a[32:35], 0
    v_exp_f32 v46, v46
    v_mfma_f32_16x16x32_bf16 v[68:71], a[204:207], a[36:39], v[68:71]
    v_exp_f32 v47, v47
    v_mfma_f32_16x16x32_bf16 v[68:71], a[208:211], a[40:43], v[68:71]
    v_cvt_pk_bf16_f32 v44, v44, v45
    v_cvt_pk_bf16_f32 v45, v46, v47
    v_mfma_f32_16x16x32_bf16 v[68:71], a[212:215], a[44:47], v[68:71]
    v_exp_f32 v48, v48
    v_mfma_f32_16x16x32_bf16 v[72:75], a[200:203], a[48:51], 0
    v_exp_f32 v49, v49
    v_mfma_f32_16x16x32_bf16 v[72:75], a[204:207], a[52:55], v[72:75]
    v_exp_f32 v50, v50
    v_mfma_f32_16x16x32_bf16 v[72:75], a[208:211], a[56:59], v[72:75]
    v_exp_f32 v51, v51
    v_mfma_f32_16x16x32_bf16 v[72:75], a[212:215], a[60:63], v[72:75]
    s_cbranch_vccz gqa_kernel_ool26
gqa_kernel_ret26_1:
    s_waitcnt vmcnt(3) lgkmcnt(0)
    s_barrier
    ds_read_b64_tr_b16 a[184:185], v19 offset:32768
    ds_read_b64_tr_b16 a[186:187], v19 offset:34816
    v_mfma_f32_16x16x32_bf16 v[80:83], a[200:203], a[64:67], 0
    buffer_load_dwordx4 v6, s[28:31], s53 offen offset:1024 nt lds
    v_mfma_f32_16x16x32_bf16 v[80:83], a[204:207], a[68:71], v[80:83]
    s_and_b32 s57, s57, 0x1ffff
    s_sub_u32 s88, 8192, s88
    v_mfma_f32_16x16x32_bf16 v[80:83], a[208:211], a[72:75], v[80:83]
    ds_read_b64_tr_b16 a[188:189], v20 offset:32768
    ds_read_b64_tr_b16 a[190:191], v20 offset:34816
    v_mfma_f32_16x16x32_bf16 v[80:83], a[212:215], a[76:79], v[80:83]
    ds_read_b64_tr_b16 a[192:193], v19 offset:33280
    v_cvt_pk_bf16_f32 v48, v48, v49
    v_mfma_f32_16x16x32_bf16 a[160:163], a[180:183], v[28:31], a[160:163]
    ds_read_b64_tr_b16 a[194:195], v19 offset:35328
    v_cvt_pk_bf16_f32 v49, v50, v51
    v_mfma_f32_16x16x32_bf16 a[164:167], a[180:183], v[32:35], a[164:167]
    ds_read_b64_tr_b16 a[196:197], v20 offset:33280
    v_mfma_f32_16x16x32_bf16 a[168:171], a[180:183], v[36:39], a[168:171]
    buffer_load_dwordx4 v7, s[28:31], s53 offen offset:2048 nt lds
    v_mfma_f32_16x16x32_bf16 a[172:175], a[180:183], v[40:43], a[172:175]
    s_add_u32 s94, s94, 16384
    s_and_b32 s94, s94, 0x1ffff
    s_waitcnt lgkmcnt(3)
    v_mfma_f32_16x16x32_bf16 v[180:183], a[184:187], v[40:43], v[180:183]
    ds_read_b64_tr_b16 a[198:199], v20 offset:35328
    v_mfma_f32_16x16x32_bf16 v[148:151], a[184:187], v[36:39], v[148:151]
    ds_read_b64_tr_b16 a[200:201], v19 offset:36864
    v_mfma_f32_16x16x32_bf16 v[116:119], a[184:187], v[32:35], v[116:119]
    ds_read_b64_tr_b16 a[202:203], v19 offset:38912
    v_mfma_f32_16x16x32_bf16 v[84:87], a[184:187], v[28:31], v[84:87]
    ds_write_b128 v247, a[80:83] offset:1024
    v_mfma_f32_16x16x32_bf16 v[88:91], a[188:191], v[28:31], v[88:91]
    ds_write_b128 v248, a[96:99] offset:1024
    v_mfma_f32_16x16x32_bf16 v[120:123], a[188:191], v[32:35], v[120:123]
    ds_write_b128 v249, a[112:115] offset:1024
    v_mfma_f32_16x16x32_bf16 v[152:155], a[188:191], v[36:39], v[152:155]
    buffer_load_dwordx4 v8, s[28:31], s53 offen offset:3072 nt lds
    v_mfma_f32_16x16x32_bf16 v[184:187], a[188:191], v[40:43], v[184:187]
    s_waitcnt lgkmcnt(5)
    ds_read_b64_tr_b16 a[204:205], v20 offset:36864
    v_mfma_f32_16x16x32_bf16 v[188:191], a[192:195], v[40:43], v[188:191]
    ds_read_b64_tr_b16 a[206:207], v20 offset:38912
    v_mfma_f32_16x16x32_bf16 v[156:159], a[192:195], v[36:39], v[156:159]
    ds_read_b64_tr_b16 a[208:209], v19 offset:37376
    v_mfma_f32_16x16x32_bf16 v[124:127], a[192:195], v[32:35], v[124:127]
    ds_write_b128 v250, a[128:131] offset:1024
    v_mfma_f32_16x16x32_bf16 v[92:95], a[192:195], v[28:31], v[92:95]
    ds_read_b64_tr_b16 a[210:211], v19 offset:39424
    v_mfma_f32_16x16x32_bf16 v[96:99], a[196:199], v[28:31], v[96:99]
    ds_read_b64_tr_b16 a[212:213], v20 offset:37376
    v_mfma_f32_16x16x32_bf16 v[128:131], a[196:199], v[32:35], v[128:131]
    s_cmp_gt_i32 s88, 0
    s_cselect_b64 s[28:29], s[16:17], s[12:13]
    s_add_u32 m0, s60, s94
    s_add_u32 s53, s58, s57
    v_mfma_f32_16x16x32_bf16 v[160:163], a[196:199], v[36:39], v[160:163]
    buffer_load_dwordx4 v5, s[28:31], s53 offen offset:0 nt lds
    v_mfma_f32_16x16x32_bf16 v[192:195], a[196:199], v[40:43], v[192:195]
    s_add_u32 s57, s57, s88
    ds_read_b64_tr_b16 a[214:215], v20 offset:39424
    s_waitcnt lgkmcnt(3)
    v_mfma_f32_16x16x32_bf16 v[196:199], a[200:203], v[40:43], v[196:199]
    v_exp_f32 v52, v52
    v_mfma_f32_16x16x32_bf16 v[164:167], a[200:203], v[36:39], v[164:167]
    v_exp_f32 v53, v53
    v_mfma_f32_16x16x32_bf16 v[132:135], a[200:203], v[32:35], v[132:135]
    v_exp_f32 v54, v54
    v_mfma_f32_16x16x32_bf16 v[100:103], a[200:203], v[28:31], v[100:103]
    v_exp_f32 v55, v55
    v_mfma_f32_16x16x32_bf16 v[104:107], a[204:207], v[28:31], v[104:107]
    v_cvt_pk_bf16_f32 v52, v52, v53
    v_cvt_pk_bf16_f32 v53, v54, v55
    v_mfma_f32_16x16x32_bf16 v[136:139], a[204:207], v[32:35], v[136:139]
    v_exp_f32 v56, v56
    v_mfma_f32_16x16x32_bf16 v[168:171], a[204:207], v[36:39], v[168:171]
    v_exp_f32 v57, v57
    v_mfma_f32_16x16x32_bf16 v[200:203], a[204:207], v[40:43], v[200:203]
    s_lshr_b32 s97, s97, 1
    s_cbranch_scc0 1
    s_waitcnt vmcnt(3)
    s_waitcnt vmcnt(4) lgkmcnt(0)
    s_barrier
    ds_read_b128 a[184:187], v18 offset:49664
    ds_read_b128 a[188:191], v18 offset:49152
    v_mfma_f32_16x16x32_bf16 v[204:207], a[208:211], v[40:43], v[204:207]
    buffer_load_dwordx4 v6, s[28:31], s53 offen offset:1024 nt lds
    v_mfma_f32_16x16x32_bf16 v[172:175], a[208:211], v[36:39], v[172:175]
    s_and_b32 s57, s57, 0x1ffff
    s_sub_u32 s88, 8192, s88
    ds_read_b128 a[192:195], v18 offset:53760
    ds_read_b128 a[196:199], v18 offset:53248
    v_mfma_f32_16x16x32_bf16 v[140:143], a[208:211], v[32:35], v[140:143]
    ds_read_b128 a[200:203], v18 offset:51712
    v_mfma_f32_16x16x32_bf16 v[108:111], a[208:211], v[28:31], v[108:111]
    ds_read_b128 a[204:207], v18 offset:51200
    v_mfma_f32_16x16x32_bf16 v[112:115], a[212:215], v[28:31], v[112:115]
    ds_read_b128 a[208:211], v18 offset:55808
    v_mfma_f32_16x16x32_bf16 v[144:147], a[212:215], v[32:35], v[144:147]
    ds_write_b128 v247, a[84:87] offset:19456
    v_mfma_f32_16x16x32_bf16 v[176:179], a[212:215], v[36:39], v[176:179]
    v_exp_f32 v58, v58
    v_mfma_f32_16x16x32_bf16 v[208:211], a[212:215], v[40:43], v[208:211]
    s_waitcnt lgkmcnt(5)
    ds_read_b128 a[212:215], v18 offset:55296
    v_mfma_f32_16x16x32_bf16 v[28:31], a[184:187], a[0:3], 0
    v_exp_f32 v59, v59
    v_mfma_f32_16x16x32_bf16 v[28:31], a[188:191], a[4:7], v[28:31]
    ds_write_b128 v248, a[100:103] offset:19456
    v_mfma_f32_16x16x32_bf16 v[28:31], a[192:195], a[8:11], v[28:31]
    buffer_load_dwordx4 v7, s[28:31], s53 offen offset:2048 nt lds
    s_waitcnt lgkmcnt(3)
    v_mfma_f32_16x16x32_bf16 v[28:31], a[196:199], a[12:15], v[28:31]
    s_add_u32 s94, s94, 16384
    s_and_b32 s94, s94, 0x1ffff
    v_mfma_f32_16x16x32_bf16 v[32:35], a[184:187], a[16:19], 0
    v_cvt_pk_bf16_f32 v56, v56, v57
    v_cvt_pk_bf16_f32 v57, v58, v59
    v_mfma_f32_16x16x32_bf16 v[32:35], a[188:191], a[20:23], v[32:35]
    v_exp_f32 v76, v76
    v_mfma_f32_16x16x32_bf16 v[32:35], a[192:195], a[24:27], v[32:35]
    v_exp_f32 v77, v77
    v_mfma_f32_16x16x32_bf16 v[32:35], a[196:199], a[28:31], v[32:35]
    ds_write_b128 v249, a[116:119] offset:19456
    v_mfma_f32_16x16x32_bf16 v[36:39], a[184:187], a[32:35], 0
    v_exp_f32 v78, v78
    v_mfma_f32_16x16x32_bf16 v[36:39], a[188:191], a[36:39], v[36:39]
    v_exp_f32 v79, v79
    v_mfma_f32_16x16x32_bf16 v[36:39], a[192:195], a[40:43], v[36:39]
    v_cvt_pk_bf16_f32 v76, v76, v77
    v_cvt_pk_bf16_f32 v77, v78, v79
    v_mfma_f32_16x16x32_bf16 v[36:39], a[196:199], a[44:47], v[36:39]
    v_exp_f32 v60, v60
    v_mfma_f32_16x16x32_bf16 v[40:43], a[184:187], a[48:51], 0
    v_exp_f32 v61, v61
    v_mfma_f32_16x16x32_bf16 v[40:43], a[188:191], a[52:55], v[40:43]
    ds_write_b128 v250, a[132:135] offset:19456
    v_mfma_f32_16x16x32_bf16 v[40:43], a[192:195], a[56:59], v[40:43]
    buffer_load_dwordx4 v8, s[28:31], s53 offen offset:3072 nt lds
    v_mfma_f32_16x16x32_bf16 v[40:43], a[196:199], a[60:63], v[40:43]
    v_exp_f32 v62, v62
    v_exp_f32 v63, v63
    v_cvt_pk_bf16_f32 v46, v60, v61
    v_cvt_pk_bf16_f32 v47, v62, v63
    v_mfma_f32_16x16x32_bf16 v[60:63], a[200:203], a[0:3], 0
    v_exp_f32 v64, v64
    v_mfma_f32_16x16x32_bf16 v[60:63], a[204:207], a[4:7], v[60:63]
    v_exp_f32 v65, v65
    v_exp_f32 v66, v66
    v_mfma_f32_16x16x32_bf16 v[60:63], a[208:211], a[8:11], v[60:63]
    s_waitcnt lgkmcnt(0)
    v_exp_f32 v67, v67
    v_cvt_pk_bf16_f32 v50, v64, v65
    v_cvt_pk_bf16_f32 v51, v66, v67
    v_mfma_f32_16x16x32_bf16 v[60:63], a[212:215], a[12:15], v[60:63]
    v_exp_f32 v68, v68
    v_mfma_f32_16x16x32_bf16 v[64:67], a[200:203], a[16:19], 0
    v_exp_f32 v69, v69
    v_mfma_f32_16x16x32_bf16 v[64:67], a[204:207], a[20:23], v[64:67]
    v_exp_f32 v70, v70
    v_exp_f32 v71, v71
    v_mfma_f32_16x16x32_bf16 v[64:67], a[208:211], a[24:27], v[64:67]
    v_cvt_pk_bf16_f32 v54, v68, v69
    v_cvt_pk_bf16_f32 v55, v70, v71
    v_mfma_f32_16x16x32_bf16 v[64:67], a[212:215], a[28:31], v[64:67]
    v_exp_f32 v72, v72
    v_mfma_f32_16x16x32_bf16 v[68:71], a[200:203], a[32:35], 0
    v_exp_f32 v73, v73
    v_mfma_f32_16x16x32_bf16 v[68:71], a[204:207], a[36:39], v[68:71]
    v_exp_f32 v74, v74
    v_exp_f32 v75, v75
    v_mfma_f32_16x16x32_bf16 v[68:71], a[208:211], a[40:43], v[68:71]
    v_cvt_pk_bf16_f32 v58, v72, v73
    v_cvt_pk_bf16_f32 v59, v74, v75
    v_mfma_f32_16x16x32_bf16 v[68:71], a[212:215], a[44:47], v[68:71]
    v_exp_f32 v80, v80
    v_mfma_f32_16x16x32_bf16 v[72:75], a[200:203], a[48:51], 0
    s_waitcnt vmcnt(3) lgkmcnt(0)
    s_barrier
    v_xor_b32 v19, 0x10000, v19
    v_xor_b32 v20, 0x10000, v20
    v_xor_b32 v18, 0x10000, v18
    s_add_u32 m0, s60, 114688
    s_add_u32 s53, s56, 122880
    v_mfma_f32_16x16x32_bf16 v[72:75], a[204:207], a[52:55], v[72:75]
    s_and_b32 s53, s53, 0x1ffff
    s_add_u32 s53, s53, s58
    ds_read_b64_tr_b16 a[184:185], v19 offset:0
    ds_read_b64_tr_b16 a[186:187], v19 offset:2048
    v_mfma_f32_16x16x32_bf16 v[72:75], a[208:211], a[56:59], v[72:75]
    buffer_load_dwordx4 v5, s[16:19], s53 offen offset:0 nt lds
    v_mfma_f32_16x16x32_bf16 v[72:75], a[212:215], a[60:63], v[72:75]
    ds_read_b64_tr_b16 a[188:189], v20 offset:0
    v_mfma_f32_16x16x32_bf16 a[160:163], a[180:183], v[44:47], a[160:163]
    ds_read_b64_tr_b16 a[190:191], v20 offset:2048
    v_mfma_f32_16x16x32_bf16 a[164:167], a[180:183], v[48:51], a[164:167]
    v_exp_f32 v81, v81
    v_exp_f32 v82, v82
    v_mfma_f32_16x16x32_bf16 a[168:171], a[180:183], v[52:55], a[168:171]
    v_exp_f32 v83, v83
    v_cvt_pk_bf16_f32 v78, v80, v81
    v_cvt_pk_bf16_f32 v79, v82, v83
    v_mfma_f32_16x16x32_bf16 a[172:175], a[180:183], v[56:59], a[172:175]
    ds_read_b64_tr_b16 a[192:193], v19 offset:512
    v_mfma_f32_16x16x32_bf16 a[176:179], a[180:183], v[76:79], a[176:179]
    s_waitcnt lgkmcnt(2)
    ds_read_b64_tr_b16 a[194:195], v19 offset:2560
    v_mfma_f32_16x16x32_bf16 v[228:231], a[184:187], v[76:79], v[228:231]
    buffer_load_dwordx4 v6, s[16:19], s53 offen offset:1024 nt lds
    v_mfma_f32_16x16x32_bf16 v[180:183], a[184:187], v[56:59], v[180:183]
    ds_read_b64_tr_b16 a[196:197], v20 offset:512
    v_mfma_f32_16x16x32_bf16 v[148:151], a[184:187], v[52:55], v[148:151]
    ds_read_b64_tr_b16 a[198:199], v20 offset:2560
    v_mfma_f32_16x16x32_bf16 v[116:119], a[184:187], v[48:51], v[116:119]
    ds_read_b64_tr_b16 a[200:201], v19 offset:4096
    v_mfma_f32_16x16x32_bf16 v[84:87], a[184:187], v[44:47], v[84:87]
    s_waitcnt lgkmcnt(4)
    ds_read_b64_tr_b16 a[202:203], v19 offset:6144
    v_mfma_f32_16x16x32_bf16 v[88:91], a[188:191], v[44:47], v[88:91]
    ds_read_b64_tr_b16 a[204:205], v20 offset:4096
    v_mfma_f32_16x16x32_bf16 v[120:123], a[188:191], v[48:51], v[120:123]
    ds_read_b64_tr_b16 a[206:207], v20 offset:6144
    v_mfma_f32_16x16x32_bf16 v[152:155], a[188:191], v[52:55], v[152:155]
    ds_write_b128 v247, a[88:91] offset:37888
    v_mfma_f32_16x16x32_bf16 v[184:187], a[188:191], v[56:59], v[184:187]
    ds_write_b128 v248, a[104:107] offset:37888
    v_mfma_f32_16x16x32_bf16 v[232:235], a[188:191], v[76:79], v[232:235]
    s_waitcnt lgkmcnt(5)
    ds_write_b128 v249, a[120:123] offset:37888
    v_mfma_f32_16x16x32_bf16 v[236:239], a[192:195], v[76:79], v[236:239]
    buffer_load_dwordx4 v7, s[16:19], s53 offen offset:2048 nt lds
    v_mfma_f32_16x16x32_bf16 v[188:191], a[192:195], v[56:59], v[188:191]
    ds_read_b64_tr_b16 a[208:209], v19 offset:4608
    v_mfma_f32_16x16x32_bf16 v[156:159], a[192:195], v[52:55], v[156:159]
    ds_read_b64_tr_b16 a[210:211], v19 offset:6656
    v_mfma_f32_16x16x32_bf16 v[124:127], a[192:195], v[48:51], v[124:127]
    ds_write_b128 v250, a[136:139] offset:37888
    v_mfma_f32_16x16x32_bf16 v[92:95], a[192:195], v[44:47], v[92:95]
    ds_read_b64_tr_b16 a[212:213], v20 offset:4608
    v_mfma_f32_16x16x32_bf16 v[96:99], a[196:199], v[44:47], v[96:99]
    ds_read_b64_tr_b16 a[214:215], v20 offset:6656
    v_mfma_f32_16x16x32_bf16 v[128:131], a[196:199], v[48:51], v[128:131]
    v_exp_f32 v28, v28
    v_mfma_f32_16x16x32_bf16 v[160:163], a[196:199], v[52:55], v[160:163]
    v_exp_f32 v29, v29
    v_mfma_f32_16x16x32_bf16 v[192:195], a[196:199], v[56:59], v[192:195]
    v_exp_f32 v30, v30
    v_mfma_f32_16x16x32_bf16 v[240:243], a[196:199], v[76:79], v[240:243]
    buffer_load_dwordx4 v8, s[16:19], s53 offen offset:3072 nt lds
    s_waitcnt lgkmcnt(3)
    v_mfma_f32_16x16x32_bf16 v[212:215], a[200:203], v[76:79], v[212:215]
    ds_write_b128 v251, a[144:147] offset:0
    v_mfma_f32_16x16x32_bf16 v[196:199], a[200:203], v[56:59], v[196:199]
    v_exp_f32 v31, v31
    v_mfma_f32_16x16x32_bf16 v[164:167], a[200:203], v[52:55], v[164:167]
    v_cvt_pk_bf16_f32 v28, v28, v29
    v_cvt_pk_bf16_f32 v29, v30, v31
    v_mfma_f32_16x16x32_bf16 v[132:135], a[200:203], v[48:51], v[132:135]
    v_exp_f32 v32, v32
    v_mfma_f32_16x16x32_bf16 v[100:103], a[200:203], v[44:47], v[100:103]
    v_exp_f32 v33, v33
    v_mfma_f32_16x16x32_bf16 v[104:107], a[204:207], v[44:47], v[104:107]
    v_exp_f32 v34, v34
    v_mfma_f32_16x16x32_bf16 v[136:139], a[204:207], v[48:51], v[136:139]
    v_exp_f32 v35, v35
    v_mfma_f32_16x16x32_bf16 v[168:171], a[204:207], v[52:55], v[168:171]
    v_cvt_pk_bf16_f32 v32, v32, v33
    v_cvt_pk_bf16_f32 v33, v34, v35
    v_mfma_f32_16x16x32_bf16 v[200:203], a[204:207], v[56:59], v[200:203]
    v_exp_f32 v36, v36
    v_mfma_f32_16x16x32_bf16 v[216:219], a[204:207], v[76:79], v[216:219]
    v_exp_f32 v37, v37
    v_mfma_f32_16x16x32_bf16 v[220:223], a[208:211], v[76:79], v[220:223]
    v_exp_f32 v38, v38
    v_mfma_f32_16x16x32_bf16 v[204:207], a[208:211], v[56:59], v[204:207]
    s_lshr_b32 s97, s97, 1
    s_cbranch_scc0 1
    s_waitcnt vmcnt(3)
    s_waitcnt vmcnt(4) lgkmcnt(0)
    s_barrier
    s_add_u32 m0, s89, 0
    s_add_u32 s53, s56, 0
    v_mfma_f32_16x16x32_bf16 v[172:175], a[208:211], v[52:55], v[172:175]
    s_and_b32 s53, s53, 0x1ffff
    s_add_u32 s53, s53, s91
    ds_read_b128 a[184:187], v18 offset:16896
    ds_read_b128 a[188:191], v18 offset:16384
    v_mfma_f32_16x16x32_bf16 v[140:143], a[208:211], v[48:51], v[140:143]
    buffer_load_dwordx4 v5, s[12:15], s53 offen offset:0 nt lds
    v_mfma_f32_16x16x32_bf16 v[108:111], a[208:211], v[44:47], v[108:111]
    ds_read_b128 a[192:195], v18 offset:20992
    ds_read_b128 a[196:199], v18 offset:20480
    v_mfma_f32_16x16x32_bf16 v[112:115], a[212:215], v[44:47], v[112:115]
    ds_read_b128 a[200:203], v18 offset:18944
    v_mfma_f32_16x16x32_bf16 v[144:147], a[212:215], v[48:51], v[144:147]
    ds_read_b128 a[204:207], v18 offset:18432
    v_mfma_f32_16x16x32_bf16 v[176:179], a[212:215], v[52:55], v[176:179]
    ds_read_b128 a[208:211], v18 offset:23040
    v_mfma_f32_16x16x32_bf16 v[208:211], a[212:215], v[56:59], v[208:211]
    v_exp_f32 v39, v39
    v_mfma_f32_16x16x32_bf16 v[224:227], a[212:215], v[76:79], v[224:227]
    s_waitcnt lgkmcnt(5)
    ds_read_b128 a[212:215], v18 offset:22528
    v_cvt_pk_bf16_f32 v36, v36, v37
    v_mfma_f32_16x16x32_bf16 v[44:47], a[184:187], a[0:3], 0
    v_cvt_pk_bf16_f32 v37, v38, v39
    v_mfma_f32_16x16x32_bf16 v[44:47], a[188:191], a[4:7], v[44:47]
    buffer_load_dwordx4 v6, s[12:15], s53 offen offset:1024 nt lds
    s_waitcnt lgkmcnt(3)
    v_mfma_f32_16x16x32_bf16 v[44:47], a[192:195], a[8:11], v[44:47]
    v_exp_f32 v40, v40
    v_mfma_f32_16x16x32_bf16 v[44:47], a[196:199], a[12:15], v[44:47]
    v_exp_f32 v41, v41
    v_mfma_f32_16x16x32_bf16 v[48:51], a[184:187], a[16:19], 0
    v_exp_f32 v42, v42
    v_mfma_f32_16x16x32_bf16 v[48:51], a[188:191], a[20:23], v[48:51]
    v_exp_f32 v43, v43
    v_mfma_f32_16x16x32_bf16 v[48:51], a[192:195], a[24:27], v[48:51]
    v_cvt_pk_bf16_f32 v40, v40, v41
    v_cvt_pk_bf16_f32 v41, v42, v43
    v_mfma_f32_16x16x32_bf16 v[48:51], a[196:199], a[28:31], v[48:51]
    v_exp_f32 v60, v60
    v_mfma_f32_16x16x32_bf16 v[52:55], a[184:187], a[32:35], 0
    v_exp_f32 v61, v61
    v_mfma_f32_16x16x32_bf16 v[52:55], a[188:191], a[36:39], v[52:55]
    v_exp_f32 v62, v62
    v_mfma_f32_16x16x32_bf16 v[52:55], a[192:195], a[40:43], v[52:55]
    v_exp_f32 v63, v63
    v_mfma_f32_16x16x32_bf16 v[52:55], a[196:199], a[44:47], v[52:55]
    v_cvt_pk_bf16_f32 v30, v60, v61
    v_cvt_pk_bf16_f32 v31, v62, v63
    v_mfma_f32_16x16x32_bf16 v[56:59], a[184:187], a[48:51], 0
    buffer_load_dwordx4 v7, s[12:15], s53 offen offset:2048 nt lds
    v_mfma_f32_16x16x32_bf16 v[56:59], a[188:191], a[52:55], v[56:59]
    ds_write_b128 v247, a[92:95] offset:56320
    v_mfma_f32_16x16x32_bf16 v[56:59], a[192:195], a[56:59], v[56:59]
    ds_write_b128 v248, a[108:111] offset:56320
    v_mfma_f32_16x16x32_bf16 v[56:59], a[196:199], a[60:63], v[56:59]
    ds_write_b128 v249, a[124:127] offset:56320
    v_mfma_f32_16x16x32_bf16 v[76:79], a[184:187], a[64:67], 0
    ds_write_b128 v250, a[140:143] offset:56320
    v_mfma_f32_16x16x32_bf16 v[76:79], a[188:191], a[68:71], v[76:79]
    v_exp_f32 v64, v64
    v_mfma_f32_16x16x32_bf16 v[76:79], a[192:195], a[72:75], v[76:79]
    v_exp_f32 v65, v65
    v_mfma_f32_16x16x32_bf16 v[76:79], a[196:199], a[76:79], v[76:79]
    ds_write_b128 v251, a[148:151] offset:18432
    v_mfma_f32_16x16x32_bf16 v[60:63], a[200:203], a[0:3], 0
    s_waitcnt lgkmcnt(4)
    v_exp_f32 v66, v66
    v_mfma_f32_16x16x32_bf16 v[60:63], a[204:207], a[4:7], v[60:63]
    v_exp_f32 v67, v67
    v_cvt_pk_bf16_f32 v34, v64, v65
    v_cvt_pk_bf16_f32 v35, v66, v67
    v_mfma_f32_16x16x32_bf16 v[60:63], a[208:211], a[8:11], v[60:63]
    buffer_load_dwordx4 v8, s[12:15], s53 offen offset:3072 nt lds
    v_mfma_f32_16x16x32_bf16 v[60:63], a[212:215], a[12:15], v[60:63]
    v_exp_f32 v68, v68
    v_mfma_f32_16x16x32_bf16 v[64:67], a[200:203], a[16:19], 0
    v_exp_f32 v69, v69
    v_mfma_f32_16x16x32_bf16 v[64:67], a[204:207], a[20:23], v[64:67]
    v_exp_f32 v70, v70
    v_exp_f32 v71, v71
    v_mfma_f32_16x16x32_bf16 v[64:67], a[208:211], a[24:27], v[64:67]
    v_cvt_pk_bf16_f32 v38, v68, v69
    v_cvt_pk_bf16_f32 v39, v70, v71
    v_mfma_f32_16x16x32_bf16 v[64:67], a[212:215], a[28:31], v[64:67]
    v_exp_f32 v72, v72
    v_mfma_f32_16x16x32_bf16 v[68:71], a[200:203], a[32:35], 0
    v_exp_f32 v73, v73
    v_mfma_f32_16x16x32_bf16 v[68:71], a[204:207], a[36:39], v[68:71]
    v_exp_f32 v74, v74
    v_exp_f32 v75, v75
    v_mfma_f32_16x16x32_bf16 v[68:71], a[208:211], a[40:43], v[68:71]
    v_cvt_pk_bf16_f32 v42, v72, v73
    v_cvt_pk_bf16_f32 v43, v74, v75
    v_mfma_f32_16x16x32_bf16 v[68:71], a[212:215], a[44:47], v[68:71]
    v_exp_f32 v44, v44
    v_mfma_f32_16x16x32_bf16 v[72:75], a[200:203], a[48:51], 0
    v_exp_f32 v45, v45
    v_mfma_f32_16x16x32_bf16 v[72:75], a[204:207], a[52:55], v[72:75]
    v_exp_f32 v46, v46
    v_mfma_f32_16x16x32_bf16 v[72:75], a[208:211], a[56:59], v[72:75]
    v_exp_f32 v47, v47
    v_mfma_f32_16x16x32_bf16 v[72:75], a[212:215], a[60:63], v[72:75]
    s_cbranch_vccnz 1
    s_waitcnt vmcnt(4)
    s_waitcnt lgkmcnt(0)
    s_barrier
    s_add_u32 m0, s89, 16384
    s_add_u32 s53, s56, 8192
    v_mfma_f32_16x16x32_bf16 v[80:83], a[200:203], a[64:67], 0
    s_and_b32 s53, s53, 0x1ffff
    s_add_u32 s53, s53, s91
    ds_read_b64_tr_b16 a[184:185], v19 offset:32768
    ds_read_b64_tr_b16 a[186:187], v19 offset:34816
    v_mfma_f32_16x16x32_bf16 v[80:83], a[204:207], a[68:71], v[80:83]
    buffer_load_dwordx4 v5, s[12:15], s53 offen offset:0 nt lds
    v_mfma_f32_16x16x32_bf16 v[80:83], a[208:211], a[72:75], v[80:83]
    ds_read_b64_tr_b16 a[188:189], v20 offset:32768
    ds_read_b64_tr_b16 a[190:191], v20 offset:34816
    v_mfma_f32_16x16x32_bf16 v[80:83], a[212:215], a[76:79], v[80:83]
    ds_read_b64_tr_b16 a[192:193], v19 offset:33280
    v_cvt_pk_bf16_f32 v44, v44, v45
    v_mfma_f32_16x16x32_bf16 a[160:163], a[180:183], v[28:31], a[160:163]
    ds_read_b64_tr_b16 a[194:195], v19 offset:35328
    v_cvt_pk_bf16_f32 v45, v46, v47
    v_mfma_f32_16x16x32_bf16 a[164:167], a[180:183], v[32:35], a[164:167]
    s_add_u32 s45, s98, 245760
    ds_read_b64_tr_b16 a[196:197], v20 offset:33280
    v_mfma_f32_16x16x32_bf16 a[168:171], a[180:183], v[36:39], a[168:171]
    s_cbranch_vccz 2
    buffer_load_dwordx4 a[0:3], v24, s[24:27], s45 offen offset:0 sc1
    v_mfma_f32_16x16x32_bf16 a[172:175], a[180:183], v[40:43], a[172:175]
    s_waitcnt lgkmcnt(3)
    ds_read_b64_tr_b16 a[198:199], v20 offset:35328
    v_mfma_f32_16x16x32_bf16 v[180:183], a[184:187], v[40:43], v[180:183]
    ds_read_b64_tr_b16 a[200:201], v19 offset:36864
    v_mfma_f32_16x16x32_bf16 v[148:151], a[184:187], v[36:39], v[148:151]
    ds_read_b64_tr_b16 a[202:203], v19 offset:38912
    v_mfma_f32_16x16x32_bf16 v[116:119], a[184:187], v[32:35], v[116:119]
    buffer_load_dwordx4 v6, s[12:15], s53 offen offset:1024 nt lds
    v_mfma_f32_16x16x32_bf16 v[84:87], a[184:187], v[28:31], v[84:87]
    s_cbranch_vccz 2
    buffer_load_dwordx4 a[4:7], v24, s[24:27], s45 offen offset:1024 sc1
    v_mfma_f32_16x16x32_bf16 v[88:91], a[188:191], v[28:31], v[88:91]
    ds_read_b64_tr_b16 a[204:205], v20 offset:36864
    v_mfma_f32_16x16x32_bf16 v[120:123], a[188:191], v[32:35], v[120:123]
    ds_read_b64_tr_b16 a[206:207], v20 offset:38912
    v_mfma_f32_16x16x32_bf16 v[152:155], a[188:191], v[36:39], v[152:155]
    ds_read_b64_tr_b16 a[208:209], v19 offset:37376
    v_mfma_f32_16x16x32_bf16 v[184:187], a[188:191], v[40:43], v[184:187]
    s_waitcnt lgkmcnt(4)
    ds_read_b64_tr_b16 a[210:211], v19 offset:39424
    v_mfma_f32_16x16x32_bf16 v[188:191], a[192:195], v[40:43], v[188:191]
    ds_read_b64_tr_b16 a[212:213], v20 offset:37376
    v_mfma_f32_16x16x32_bf16 v[156:159], a[192:195], v[36:39], v[156:159]
    s_add_u32 s45, s98, 286720
    ds_read_b64_tr_b16 a[214:215], v20 offset:39424
    v_mfma_f32_16x16x32_bf16 v[124:127], a[192:195], v[32:35], v[124:127]
    s_cbranch_vccz 2
    buffer_load_dwordx4 a[8:11], v24, s[24:27], s45 offen offset:0 sc1
    v_mfma_f32_16x16x32_bf16 v[92:95], a[192:195], v[28:31], v[92:95]
    v_exp_f32 v48, v48
    v_mfma_f32_16x16x32_bf16 v[96:99], a[196:199], v[28:31], v[96:99]
    v_exp_f32 v49, v49
    v_mfma_f32_16x16x32_bf16 v[128:131], a[196:199], v[32:35], v[128:131]
    v_exp_f32 v50, v50
    v_mfma_f32_16x16x32_bf16 v[160:163], a[196:199], v[36:39], v[160:163]
    buffer_load_dwordx4 v7, s[12:15], s53 offen offset:2048 nt lds
    v_mfma_f32_16x16x32_bf16 v[192:195], a[196:199], v[40:43], v[192:195]
    s_cbranch_vccz 2
    buffer_load_dwordx4 a[12:15], v24, s[24:27], s45 offen offset:1024 sc1
    s_waitcnt lgkmcnt(1)
    v_mfma_f32_16x16x32_bf16 v[196:199], a[200:203], v[40:43], v[196:199]
    v_exp_f32 v51, v51
    v_mfma_f32_16x16x32_bf16 v[164:167], a[200:203], v[36:39], v[164:167]
    v_cvt_pk_bf16_f32 v48, v48, v49
    v_cvt_pk_bf16_f32 v49, v50, v51
    v_mfma_f32_16x16x32_bf16 v[132:135], a[200:203], v[32:35], v[132:135]
    v_exp_f32 v52, v52
    v_mfma_f32_16x16x32_bf16 v[100:103], a[200:203], v[28:31], v[100:103]
    v_exp_f32 v53, v53
    v_mfma_f32_16x16x32_bf16 v[104:107], a[204:207], v[28:31], v[104:107]
    v_exp_f32 v54, v54
    v_mfma_f32_16x16x32_bf16 v[136:139], a[204:207], v[32:35], v[136:139]
    s_add_u32 s45, s98, 327680
    v_mfma_f32_16x16x32_bf16 v[168:171], a[204:207], v[36:39], v[168:171]
    s_cbranch_vccz 2
    buffer_load_dwordx4 a[16:19], v24, s[24:27], s45 offen offset:0 sc1
    v_mfma_f32_16x16x32_bf16 v[200:203], a[204:207], v[40:43], v[200:203]
    v_exp_f32 v55, v55
    v_mfma_f32_16x16x32_bf16 v[204:207], a[208:211], v[40:43], v[204:207]
    v_cvt_pk_bf16_f32 v52, v52, v53
    v_cvt_pk_bf16_f32 v53, v54, v55
    v_mfma_f32_16x16x32_bf16 v[172:175], a[208:211], v[36:39], v[172:175]
    v_exp_f32 v56, v56
    v_mfma_f32_16x16x32_bf16 v[140:143], a[208:211], v[32:35], v[140:143]
    v_exp_f32 v57, v57
    v_mfma_f32_16x16x32_bf16 v[108:111], a[208:211], v[28:31], v[108:111]
    s_cbranch_vccz 2
    buffer_load_dwordx4 a[20:23], v24, s[24:27], s45 offen offset:1024 sc1
    s_waitcnt lgkmcnt(0)
    v_mfma_f32_16x16x32_bf16 v[112:115], a[212:215], v[28:31], v[112:115]
    s_cbranch_vccnz 1
    s_waitcnt vmcnt(3)
    s_waitcnt vmcnt(7) lgkmcnt(0)
    s_barrier
    ds_read_b64_tr_b16 a[184:185], v19 offset:49152
    ds_read_b64_tr_b16 a[186:187], v19 offset:51200
    v_mfma_f32_16x16x32_bf16 v[144:147], a[212:215], v[32:35], v[144:147]
    buffer_load_dwordx4 v8, s[12:15], s53 offen offset:3072 nt lds
    v_mfma_f32_16x16x32_bf16 v[176:179], a[212:215], v[36:39], v[176:179]
    v_exp_f32 v58, v58
    v_exp_f32 v59, v59
    v_mfma_f32_16x16x32_bf16 v[208:211], a[212:215], v[40:43], v[208:211]
    v_cvt_pk_bf16_f32 v56, v56, v57
    v_cvt_pk_bf16_f32 v57, v58, v59
    v_exp_f32 v76, v76
    v_exp_f32 v77, v77
    v_exp_f32 v78, v78
    v_exp_f32 v79, v79
    v_cvt_pk_bf16_f32 v76, v76, v77
    v_cvt_pk_bf16_f32 v77, v78, v79
    v_exp_f32 v60, v60
    v_exp_f32 v61, v61
    v_exp_f32 v62, v62
    v_exp_f32 v63, v63
    v_cvt_pk_bf16_f32 v46, v60, v61
    v_cvt_pk_bf16_f32 v47, v62, v63
    s_nop 1
    v_mfma_f32_16x16x32_bf16 a[160:163], a[180:183], v[44:47], a[160:163]
    v_exp_f32 v64, v64
    v_exp_f32 v65, v65
    v_exp_f32 v66, v66
    v_exp_f32 v67, v67
    v_cvt_pk_bf16_f32 v50, v64, v65
    v_cvt_pk_bf16_f32 v51, v66, v67
    s_nop 1
    v_mfma_f32_16x16x32_bf16 a[164:167], a[180:183], v[48:51], a[164:167]
    v_exp_f32 v68, v68
    v_exp_f32 v69, v69
    v_exp_f32 v70, v70
    v_exp_f32 v71, v71
    v_cvt_pk_bf16_f32 v54, v68, v69
    v_cvt_pk_bf16_f32 v55, v70, v71
    s_nop 1
    v_mfma_f32_16x16x32_bf16 a[168:171], a[180:183], v[52:55], a[168:171]
    ds_read_b64_tr_b16 a[188:189], v20 offset:49152
    ds_read_b64_tr_b16 a[190:191], v20 offset:51200
    v_exp_f32 v72, v72
    v_exp_f32 v73, v73
    v_exp_f32 v74, v74
    v_exp_f32 v75, v75
    v_cvt_pk_bf16_f32 v58, v72, v73
    v_cvt_pk_bf16_f32 v59, v74, v75
    s_nop 1
    v_mfma_f32_16x16x32_bf16 a[172:175], a[180:183], v[56:59], a[172:175]
    s_add_u32 s45, s98, 368640
    v_exp_f32 v80, v80
    v_exp_f32 v81, v81
    v_exp_f32 v82, v82
    v_exp_f32 v83, v83
    v_cvt_pk_bf16_f32 v78, v80, v81
    v_cvt_pk_bf16_f32 v79, v82, v83
    s_nop 1
    v_mfma_f32_16x16x32_bf16 a[176:179], a[180:183], v[76:79], a[176:179]
    s_cbranch_vccz 2
    buffer_load_dwordx4 a[24:27], v24, s[24:27], s45 offen offset:0 sc1
    s_waitcnt lgkmcnt(0)
    v_mfma_f32_16x16x32_bf16 v[228:231], a[184:187], v[76:79], v[228:231]
    ds_read_b64_tr_b16 a[192:193], v19 offset:49664
    ds_read_b64_tr_b16 a[194:195], v19 offset:51712
    v_mfma_f32_16x16x32_bf16 v[180:183], a[184:187], v[56:59], v[180:183]
    ds_read_b64_tr_b16 a[196:197], v20 offset:49664
    v_mfma_f32_16x16x32_bf16 v[148:151], a[184:187], v[52:55], v[148:151]
    s_cbranch_vccz 2
    buffer_load_dwordx4 a[28:31], v24, s[24:27], s45 offen offset:1024 sc1
    v_mfma_f32_16x16x32_bf16 v[116:119], a[184:187], v[48:51], v[116:119]
    ds_read_b64_tr_b16 a[198:199], v20 offset:51712
    v_mfma_f32_16x16x32_bf16 v[84:87], a[184:187], v[44:47], v[84:87]
    ds_read_b64_tr_b16 a[200:201], v19 offset:53248
    v_mfma_f32_16x16x32_bf16 v[88:91], a[188:191], v[44:47], v[88:91]
    s_add_u32 m0, s89, 32768
    s_add_u32 s53, s56, 0
    s_and_b32 s53, s53, 0x1ffff
    s_add_u32 s53, s53, s91
    v_mfma_f32_16x16x32_bf16 v[120:123], a[188:191], v[48:51], v[120:123]
    buffer_load_dwordx4 v5, s[16:19], s53 offen offset:0 nt lds
    v_mfma_f32_16x16x32_bf16 v[152:155], a[188:191], v[52:55], v[152:155]
    ds_read_b64_tr_b16 a[202:203], v19 offset:55296
    v_mfma_f32_16x16x32_bf16 v[184:187], a[188:191], v[56:59], v[184:187]
    s_add_u32 s45, s98, 409600
    ds_read_b64_tr_b16 a[204:205], v20 offset:53248
    v_mfma_f32_16x16x32_bf16 v[232:235], a[188:191], v[76:79], v[232:235]
    s_cbranch_vccz 2
    buffer_load_dwordx4 a[32:35], v24, s[24:27], s45 offen offset:0 sc1
    s_waitcnt lgkmcnt(2)
    v_mfma_f32_16x16x32_bf16 v[236:239], a[192:195], v[76:79], v[236:239]
    ds_read_b64_tr_b16 a[206:207], v20 offset:55296
    v_mfma_f32_16x16x32_bf16 v[188:191], a[192:195], v[56:59], v[188:191]
    ds_read_b64_tr_b16 a[208:209], v19 offset:53760
    v_mfma_f32_16x16x32_bf16 v[156:159], a[192:195], v[52:55], v[156:159]
    ds_read_b64_tr_b16 a[210:211], v19 offset:55808
    v_mfma_f32_16x16x32_bf16 v[124:127], a[192:195], v[48:51], v[124:127]
    ds_read_b128 a[48:51], v24 offset:0
    v_mfma_f32_16x16x32_bf16 v[92:95], a[192:195], v[44:47], v[92:95]
    s_cbranch_vccz 2
    buffer_load_dwordx4 a[36:39], v24, s[24:27], s45 offen offset:1024 sc1
    v_mfma_f32_16x16x32_bf16 v[96:99], a[196:199], v[44:47], v[96:99]
    ds_read_b128 a[52:55], v24 offset:18432
    v_mfma_f32_16x16x32_bf16 v[128:131], a[196:199], v[48:51], v[128:131]
    ds_read_b128 a[56:59], v24 offset:36864
    v_mfma_f32_16x16x32_bf16 v[160:163], a[196:199], v[52:55], v[160:163]
    ds_read_b128 a[60:63], v24 offset:55296
    v_mfma_f32_16x16x32_bf16 v[192:195], a[196:199], v[56:59], v[192:195]
    ds_read_b128 a[64:67], v24 offset:9216
    v_mfma_f32_16x16x32_bf16 v[240:243], a[196:199], v[76:79], v[240:243]
    buffer_load_dwordx4 v6, s[16:19], s53 offen offset:1024 nt lds
    s_waitcnt lgkmcnt(5)
    v_mfma_f32_16x16x32_bf16 v[212:215], a[200:203], v[76:79], v[212:215]
    s_add_u32 s45, s98, 450560
    ds_read_b128 a[68:71], v24 offset:27648
    v_mfma_f32_16x16x32_bf16 v[196:199], a[200:203], v[56:59], v[196:199]
    s_cbranch_vccz 2
    buffer_load_dwordx4 a[40:43], v24, s[24:27], s45 offen offset:0 sc1
    v_mfma_f32_16x16x32_bf16 v[164:167], a[200:203], v[52:55], v[164:167]
    ds_read_b128 a[72:75], v24 offset:46080
    v_mfma_f32_16x16x32_bf16 v[132:135], a[200:203], v[48:51], v[132:135]
    ds_read_b128 a[76:79], v24 offset:64512
    v_mfma_f32_16x16x32_bf16 v[100:103], a[200:203], v[44:47], v[100:103]
    ds_read_b64_tr_b16 a[212:213], v20 offset:53760
    v_mfma_f32_16x16x32_bf16 v[104:107], a[204:207], v[44:47], v[104:107]
    ds_read_b64_tr_b16 a[214:215], v20 offset:55808
    v_mfma_f32_16x16x32_bf16 v[136:139], a[204:207], v[48:51], v[136:139]
    s_cbranch_vccz 2
    buffer_load_dwordx4 a[44:47], v24, s[24:27], s45 offen offset:1024 sc1
    v_mfma_f32_16x16x32_bf16 v[168:171], a[204:207], v[52:55], v[168:171]
    v_mfma_f32_16x16x32_bf16 v[200:203], a[204:207], v[56:59], v[200:203]
    v_mfma_f32_16x16x32_bf16 v[216:219], a[204:207], v[76:79], v[216:219]
    v_mfma_f32_16x16x32_bf16 v[220:223], a[208:211], v[76:79], v[220:223]
    v_mfma_f32_16x16x32_bf16 v[204:207], a[208:211], v[56:59], v[204:207]
    v_mfma_f32_16x16x32_bf16 v[172:175], a[208:211], v[52:55], v[172:175]
    v_mfma_f32_16x16x32_bf16 v[140:143], a[208:211], v[48:51], v[140:143]
    v_mfma_f32_16x16x32_bf16 v[108:111], a[208:211], v[44:47], v[108:111]
    s_waitcnt lgkmcnt(0)
    v_mfma_f32_16x16x32_bf16 v[112:115], a[212:215], v[44:47], v[112:115]
    v_mfma_f32_16x16x32_bf16 v[144:147], a[212:215], v[48:51], v[144:147]
    s_cbranch_vccnz 1
    s_waitcnt vmcnt(3)
    s_waitcnt lgkmcnt(0)
    s_barrier
    v_xor_b32 v19, 0x10000, v19
    v_xor_b32 v20, 0x10000, v20
    v_xor_b32 v18, 0x10000, v18
    v_mfma_f32_16x16x32_bf16 v[176:179], a[212:215], v[52:55], v[176:179]
    v_mfma_f32_16x16x32_bf16 v[208:211], a[212:215], v[56:59], v[208:211]
    v_mfma_f32_16x16x32_bf16 v[224:227], a[212:215], v[76:79], v[224:227]
    s_cmp_eq_u32 s51, 0
    s_cbranch_scc0 gqa_kernel_P0
gqa_kernel_F:
    buffer_load_dwordx2 v[252:253], v21, s[24:27], s78 offen offset:0 sc1
    v_lshl_add_u32 v76, s3, 12, v24
    v_add_u32 v76, 147456, v76
    v_xor_b32 v77, 4096, v76
    ds_write_b128 v77, v[228:231] offset:0
    ds_write_b128 v77, v[232:235] offset:1024
    ds_write_b128 v77, v[236:239] offset:2048
    ds_write_b128 v77, v[240:243] offset:3072
    v_subrev_u32 v78, 16384, v76
    buffer_load_dwordx4 v7, s[16:19], s53 offen offset:2048 nt lds
    v_subrev_u32 v79, 16384, v77
    ds_write_b32 v79, a176 offset:0
    v_accvgpr_read_b32 v30, a160
    v_accvgpr_read_b32 v32, a164
    v_accvgpr_read_b32 v34, a168
    v_accvgpr_read_b32 v36, a172
    v_accvgpr_read_b32 v38, a176
    v_rcp_f32 v30, v30
    v_rcp_f32 v32, v32
    v_rcp_f32 v34, v34
    v_rcp_f32 v36, v36
    v_mov_b32 v31, v30
    v_mov_b32 v33, v32
    v_mov_b32 v35, v34
    v_mov_b32 v37, v36
    s_waitcnt lgkmcnt(0)
    v_pk_mul_f32 v[84:85], v[84:85], v[30:31]
    v_pk_mul_f32 v[86:87], v[86:87], v[30:31]
    v_pk_mul_f32 v[88:89], v[88:89], v[30:31]
    v_pk_mul_f32 v[90:91], v[90:91], v[30:31]
    v_cvt_pk_bf16_f32 v84, v84, v85
    v_cvt_pk_bf16_f32 v85, v86, v87
    v_cvt_pk_bf16_f32 v86, v88, v89
    v_cvt_pk_bf16_f32 v87, v90, v91
    v_pk_mul_f32 v[92:93], v[92:93], v[30:31]
    v_pk_mul_f32 v[94:95], v[94:95], v[30:31]
    v_pk_mul_f32 v[96:97], v[96:97], v[30:31]
    v_pk_mul_f32 v[98:99], v[98:99], v[30:31]
    buffer_load_dwordx4 v8, s[16:19], s53 offen offset:3072 nt lds
    v_cvt_pk_bf16_f32 v92, v92, v93
    v_cvt_pk_bf16_f32 v93, v94, v95
    v_cvt_pk_bf16_f32 v94, v96, v97
    v_cvt_pk_bf16_f32 v95, v98, v99
    v_pk_mul_f32 v[100:101], v[100:101], v[30:31]
    v_pk_mul_f32 v[102:103], v[102:103], v[30:31]
    v_pk_mul_f32 v[104:105], v[104:105], v[30:31]
    v_pk_mul_f32 v[106:107], v[106:107], v[30:31]
    v_cvt_pk_bf16_f32 v100, v100, v101
    v_cvt_pk_bf16_f32 v101, v102, v103
    v_cvt_pk_bf16_f32 v102, v104, v105
    v_cvt_pk_bf16_f32 v103, v106, v107
    v_pk_mul_f32 v[108:109], v[108:109], v[30:31]
    v_pk_mul_f32 v[110:111], v[110:111], v[30:31]
    v_pk_mul_f32 v[112:113], v[112:113], v[30:31]
    v_pk_mul_f32 v[114:115], v[114:115], v[30:31]
    v_cvt_pk_bf16_f32 v108, v108, v109
    v_cvt_pk_bf16_f32 v109, v110, v111
    v_cvt_pk_bf16_f32 v110, v112, v113
    v_cvt_pk_bf16_f32 v111, v114, v115
    s_barrier
    ds_read_b128 v[44:47], v76 offset:0
    ds_read_b128 v[48:51], v76 offset:1024
    ds_read_b128 v[52:55], v76 offset:2048
    ds_read_b128 v[56:59], v76 offset:3072
    ds_read_b32 v28, v78 offset:0
    v_pk_mul_f32 v[116:117], v[116:117], v[32:33]
    s_add_u32 m0, s89, 49152
    s_add_u32 s53, s56, 16384
    s_and_b32 s53, s53, 0x1ffff
    s_add_u32 s53, s53, s91
    buffer_load_dwordx4 v5, s[12:15], s53 offen offset:0 nt lds
    v_pk_mul_f32 v[118:119], v[118:119], v[32:33]
    v_pk_mul_f32 v[120:121], v[120:121], v[32:33]
    v_pk_mul_f32 v[122:123], v[122:123], v[32:33]
    v_cvt_pk_bf16_f32 v116, v116, v117
    v_cvt_pk_bf16_f32 v117, v118, v119
    v_cvt_pk_bf16_f32 v118, v120, v121
    v_cvt_pk_bf16_f32 v119, v122, v123
    v_pk_mul_f32 v[124:125], v[124:125], v[32:33]
    v_pk_mul_f32 v[126:127], v[126:127], v[32:33]
    v_pk_mul_f32 v[128:129], v[128:129], v[32:33]
    v_pk_mul_f32 v[130:131], v[130:131], v[32:33]
    v_cvt_pk_bf16_f32 v124, v124, v125
    v_cvt_pk_bf16_f32 v125, v126, v127
    v_cvt_pk_bf16_f32 v126, v128, v129
    v_cvt_pk_bf16_f32 v127, v130, v131
    v_pk_mul_f32 v[132:133], v[132:133], v[32:33]
    v_pk_mul_f32 v[134:135], v[134:135], v[32:33]
    v_pk_mul_f32 v[136:137], v[136:137], v[32:33]
    v_pk_mul_f32 v[138:139], v[138:139], v[32:33]
    v_cvt_pk_bf16_f32 v132, v132, v133
    buffer_load_dwordx4 v6, s[12:15], s53 offen offset:1024 nt lds
    v_cvt_pk_bf16_f32 v133, v134, v135
    v_cvt_pk_bf16_f32 v134, v136, v137
    v_cvt_pk_bf16_f32 v135, v138, v139
    v_pk_mul_f32 v[140:141], v[140:141], v[32:33]
    v_pk_mul_f32 v[142:143], v[142:143], v[32:33]
    v_pk_mul_f32 v[144:145], v[144:145], v[32:33]
    v_pk_mul_f32 v[146:147], v[146:147], v[32:33]
    v_cvt_pk_bf16_f32 v140, v140, v141
    v_cvt_pk_bf16_f32 v141, v142, v143
    v_cvt_pk_bf16_f32 v142, v144, v145
    v_cvt_pk_bf16_f32 v143, v146, v147
    v_pk_mul_f32 v[148:149], v[148:149], v[34:35]
    v_pk_mul_f32 v[150:151], v[150:151], v[34:35]
    v_pk_mul_f32 v[152:153], v[152:153], v[34:35]
    v_pk_mul_f32 v[154:155], v[154:155], v[34:35]
    v_cvt_pk_bf16_f32 v148, v148, v149
    v_cvt_pk_bf16_f32 v149, v150, v151
    v_cvt_pk_bf16_f32 v150, v152, v153
    v_cvt_pk_bf16_f32 v151, v154, v155
    v_pk_mul_f32 v[156:157], v[156:157], v[34:35]
    buffer_load_dwordx4 v7, s[12:15], s53 offen offset:2048 nt lds
    v_pk_mul_f32 v[158:159], v[158:159], v[34:35]
    v_pk_mul_f32 v[160:161], v[160:161], v[34:35]
    v_pk_mul_f32 v[162:163], v[162:163], v[34:35]
    v_cvt_pk_bf16_f32 v156, v156, v157
    v_cvt_pk_bf16_f32 v157, v158, v159
    v_cvt_pk_bf16_f32 v158, v160, v161
    v_cvt_pk_bf16_f32 v159, v162, v163
    v_pk_mul_f32 v[164:165], v[164:165], v[34:35]
    v_pk_mul_f32 v[166:167], v[166:167], v[34:35]
    v_pk_mul_f32 v[168:169], v[168:169], v[34:35]
    v_pk_mul_f32 v[170:171], v[170:171], v[34:35]
    v_cvt_pk_bf16_f32 v164, v164, v165
    v_cvt_pk_bf16_f32 v165, v166, v167
    v_cvt_pk_bf16_f32 v166, v168, v169
    v_cvt_pk_bf16_f32 v167, v170, v171
    s_waitcnt lgkmcnt(0)
    v_add_f32 v38, v38, v28
    v_rcp_f32 v38, v38
    s_nop 0
    v_mov_b32 v39, v38
    v_pk_mul_f32 v[172:173], v[172:173], v[34:35]
    v_pk_mul_f32 v[174:175], v[174:175], v[34:35]
    v_pk_mul_f32 v[176:177], v[176:177], v[34:35]
    v_pk_mul_f32 v[178:179], v[178:179], v[34:35]
    buffer_load_dwordx4 v8, s[12:15], s53 offen offset:3072 nt lds
    v_cvt_pk_bf16_f32 v172, v172, v173
    v_cvt_pk_bf16_f32 v173, v174, v175
    v_cvt_pk_bf16_f32 v174, v176, v177
    v_cvt_pk_bf16_f32 v175, v178, v179
    v_pk_add_f32 v[212:213], v[212:213], v[44:45]
    v_pk_add_f32 v[214:215], v[214:215], v[46:47]
    v_pk_add_f32 v[216:217], v[216:217], v[48:49]
    v_pk_add_f32 v[218:219], v[218:219], v[50:51]
    v_pk_mul_f32 v[212:213], v[212:213], v[38:39]
    v_pk_mul_f32 v[214:215], v[214:215], v[38:39]
    v_pk_mul_f32 v[216:217], v[216:217], v[38:39]
    v_pk_mul_f32 v[218:219], v[218:219], v[38:39]
    v_cvt_pk_bf16_f32 v212, v212, v213
    v_cvt_pk_bf16_f32 v213, v214, v215
    v_cvt_pk_bf16_f32 v214, v216, v217
    v_cvt_pk_bf16_f32 v215, v218, v219
    v_pk_add_f32 v[220:221], v[220:221], v[52:53]
    v_pk_add_f32 v[222:223], v[222:223], v[54:55]
    v_pk_add_f32 v[224:225], v[224:225], v[56:57]
    v_pk_add_f32 v[226:227], v[226:227], v[58:59]
    s_add_u32 m0, s90, 0
    s_add_u32 s53, s56, 8192
    s_and_b32 s53, s53, 0x1ffff
    s_add_u32 s53, s53, s91
    buffer_load_dwordx4 v5, s[16:19], s53 offen offset:0 nt lds
    v_pk_mul_f32 v[220:221], v[220:221], v[38:39]
    v_pk_mul_f32 v[222:223], v[222:223], v[38:39]
    v_pk_mul_f32 v[224:225], v[224:225], v[38:39]
    v_pk_mul_f32 v[226:227], v[226:227], v[38:39]
    v_cvt_pk_bf16_f32 v220, v220, v221
    v_cvt_pk_bf16_f32 v221, v222, v223
    v_cvt_pk_bf16_f32 v222, v224, v225
    v_cvt_pk_bf16_f32 v223, v226, v227
    v_pk_mul_f32 v[180:181], v[180:181], v[36:37]
    v_pk_mul_f32 v[182:183], v[182:183], v[36:37]
    v_pk_mul_f32 v[184:185], v[184:185], v[36:37]
    v_pk_mul_f32 v[186:187], v[186:187], v[36:37]
    v_cvt_pk_bf16_f32 v180, v180, v181
    v_cvt_pk_bf16_f32 v181, v182, v183
    v_cvt_pk_bf16_f32 v182, v184, v185
    v_cvt_pk_bf16_f32 v183, v186, v187
    v_pk_mul_f32 v[188:189], v[188:189], v[36:37]
    v_pk_mul_f32 v[190:191], v[190:191], v[36:37]
    v_pk_mul_f32 v[192:193], v[192:193], v[36:37]
    v_pk_mul_f32 v[194:195], v[194:195], v[36:37]
    buffer_load_dwordx4 v6, s[16:19], s53 offen offset:1024 nt lds
    v_cvt_pk_bf16_f32 v188, v188, v189
    v_cvt_pk_bf16_f32 v189, v190, v191
    v_cvt_pk_bf16_f32 v190, v192, v193
    v_cvt_pk_bf16_f32 v191, v194, v195
    v_pk_mul_f32 v[196:197], v[196:197], v[36:37]
    v_pk_mul_f32 v[198:199], v[198:199], v[36:37]
    v_pk_mul_f32 v[200:201], v[200:201], v[36:37]
    v_pk_mul_f32 v[202:203], v[202:203], v[36:37]
    v_cvt_pk_bf16_f32 v196, v196, v197
    v_cvt_pk_bf16_f32 v197, v198, v199
    v_cvt_pk_bf16_f32 v198, v200, v201
    v_cvt_pk_bf16_f32 v199, v202, v203
    v_pk_mul_f32 v[204:205], v[204:205], v[36:37]
    v_pk_mul_f32 v[206:207], v[206:207], v[36:37]
    v_pk_mul_f32 v[208:209], v[208:209], v[36:37]
    v_pk_mul_f32 v[210:211], v[210:211], v[36:37]
    v_cvt_pk_bf16_f32 v204, v204, v205
    v_cvt_pk_bf16_f32 v205, v206, v207
    v_cvt_pk_bf16_f32 v206, v208, v209
    v_cvt_pk_bf16_f32 v207, v210, v211
    buffer_load_dwordx4 v7, s[16:19], s53 offen offset:2048 nt lds
    v_max3_f32 v28, v30, v32, v34
    v_min3_f32 v29, v30, v32, v34
    v_max3_f32 v28, v28, v36, v38
    v_min3_f32 v29, v29, v36, v38
    v_cmp_nle_f32 vcc, v28, s82
    s_or_b64 s[54:55], s[54:55], vcc
    v_cmp_nge_f32 vcc, v29, s81
    s_or_b64 s[54:55], s[54:55], vcc
    s_mov_b32 s51, 1
    v_mfma_f32_16x16x32_bf16 v[40:43], a[180:183], v[84:87], 0
    v_accvgpr_mov_b32 a0, a80
    v_accvgpr_mov_b32 a1, a81
    v_accvgpr_mov_b32 a2, a82
    v_accvgpr_mov_b32 a3, a83
    v_mfma_f32_16x16x32_bf16 v[40:43], a[180:183], v[92:95], v[40:43]
    v_accvgpr_mov_b32 a4, a84
    v_accvgpr_mov_b32 a5, a85
    v_accvgpr_mov_b32 a6, a86
    v_accvgpr_mov_b32 a7, a87
    v_mfma_f32_16x16x32_bf16 v[40:43], a[180:183], v[100:103], v[40:43]
    v_accvgpr_mov_b32 a8, a88
    v_accvgpr_mov_b32 a9, a89
    v_accvgpr_mov_b32 a10, a90
    v_accvgpr_mov_b32 a11, a91
    v_mfma_f32_16x16x32_bf16 v[40:43], a[180:183], v[108:111], v[40:43]
    v_accvgpr_mov_b32 a12, a92
    v_accvgpr_mov_b32 a13, a93
    v_accvgpr_mov_b32 a14, a94
    v_accvgpr_mov_b32 a15, a95
    v_mfma_f32_16x16x32_bf16 v[40:43], a[180:183], v[116:119], v[40:43]
    v_accvgpr_mov_b32 a16, a96
    v_accvgpr_mov_b32 a17, a97
    v_accvgpr_mov_b32 a18, a98
    v_accvgpr_mov_b32 a19, a99
    v_mfma_f32_16x16x32_bf16 v[40:43], a[180:183], v[124:127], v[40:43]
    v_accvgpr_mov_b32 a20, a100
    ds_write_b128 v9, a[224:227] offset:32768
    v_accvgpr_mov_b32 a21, a101
    v_accvgpr_mov_b32 a22, a102
    buffer_load_dwordx4 v8, s[16:19], s53 offen offset:3072 nt lds
    v_accvgpr_mov_b32 a23, a103
    v_mfma_f32_16x16x32_bf16 v[40:43], a[180:183], v[132:135], v[40:43]
    v_accvgpr_mov_b32 a24, a104
    v_accvgpr_mov_b32 a25, a105
    v_accvgpr_mov_b32 a26, a106
    v_accvgpr_mov_b32 a27, a107
    v_mfma_f32_16x16x32_bf16 v[40:43], a[180:183], v[140:143], v[40:43]
    v_accvgpr_mov_b32 a28, a108
    v_accvgpr_mov_b32 a29, a109
    v_accvgpr_mov_b32 a30, a110
    ds_write_b128 v9, a[228:231] offset:33792
    v_accvgpr_mov_b32 a31, a111
    v_mfma_f32_16x16x32_bf16 v[40:43], a[180:183], v[148:151], v[40:43]
    v_accvgpr_mov_b32 a32, a112
    v_accvgpr_mov_b32 a33, a113
    v_accvgpr_mov_b32 a34, a114
    v_accvgpr_mov_b32 a35, a115
    v_mfma_f32_16x16x32_bf16 v[40:43], a[180:183], v[156:159], v[40:43]
    v_accvgpr_mov_b32 a36, a116
    v_accvgpr_mov_b32 a37, a117
    v_accvgpr_mov_b32 a38, a118
    v_accvgpr_mov_b32 a39, a119
    v_mfma_f32_16x16x32_bf16 v[40:43], a[180:183], v[164:167], v[40:43]
    v_accvgpr_mov_b32 a40, a120
    v_accvgpr_mov_b32 a41, a121
    v_accvgpr_mov_b32 a42, a122
    ds_write_b128 v9, a[232:235] offset:34816
    v_accvgpr_mov_b32 a43, a123
    v_mfma_f32_16x16x32_bf16 v[40:43], a[180:183], v[172:175], v[40:43]
    v_accvgpr_mov_b32 a44, a124
    v_accvgpr_mov_b32 a45, a125
    v_accvgpr_mov_b32 a46, a126
    v_accvgpr_mov_b32 a47, a127
    v_mfma_f32_16x16x32_bf16 v[40:43], a[180:183], v[212:215], v[40:43]
    v_accvgpr_mov_b32 a48, a128
    v_accvgpr_mov_b32 a49, a129
    v_accvgpr_mov_b32 a50, a130
    v_accvgpr_mov_b32 a51, a131
    v_mfma_f32_16x16x32_bf16 v[40:43], a[180:183], v[220:223], v[40:43]
    v_accvgpr_mov_b32 a52, a132
    v_accvgpr_mov_b32 a53, a133
    v_accvgpr_mov_b32 a54, a134
    ds_write_b128 v9, a[236:239] offset:35840
    v_accvgpr_mov_b32 a55, a135
    v_mfma_f32_16x16x32_bf16 v[40:43], a[180:183], v[180:183], v[40:43]
    v_accvgpr_mov_b32 a56, a136
    v_accvgpr_mov_b32 a57, a137
    v_accvgpr_mov_b32 a58, a138
    v_accvgpr_mov_b32 a59, a139
    v_mfma_f32_16x16x32_bf16 v[40:43], a[180:183], v[188:191], v[40:43]
    v_accvgpr_mov_b32 a60, a140
    v_accvgpr_mov_b32 a61, a141
    v_accvgpr_mov_b32 a62, a142
    v_accvgpr_mov_b32 a63, a143
    v_mfma_f32_16x16x32_bf16 v[40:43], a[180:183], v[196:199], v[40:43]
    v_accvgpr_mov_b32 a64, a144
    v_accvgpr_mov_b32 a65, a145
    ds_write_b128 v9, a[240:243] offset:49152
    v_accvgpr_mov_b32 a66, a146
    v_accvgpr_mov_b32 a67, a147
    v_mfma_f32_16x16x32_bf16 v[40:43], a[180:183], v[204:207], v[40:43]
    v_accvgpr_mov_b32 a68, a148
    v_accvgpr_mov_b32 a69, a149
    v_accvgpr_mov_b32 a70, a150
    v_accvgpr_mov_b32 a71, a151
    v_accvgpr_mov_b32 a72, a152
    v_accvgpr_mov_b32 a73, a153
    v_accvgpr_mov_b32 a74, a154
    v_accvgpr_mov_b32 a75, a155
    ds_write_b128 v9, a[244:247] offset:50176
    v_accvgpr_mov_b32 a76, a156
    v_accvgpr_mov_b32 a77, a157
    v_accvgpr_mov_b32 a78, a158
    v_accvgpr_mov_b32 a79, a159
    v_accvgpr_write_b32 a80, v84
    v_accvgpr_write_b32 a81, v85
    v_accvgpr_write_b32 a82, v86
    v_accvgpr_write_b32 a83, v87
    v_accvgpr_write_b32 a84, v92
    ds_write_b128 v9, a[248:251] offset:51200
    v_accvgpr_write_b32 a85, v93
    v_accvgpr_write_b32 a86, v94
    v_accvgpr_write_b32 a87, v95
    v_accvgpr_write_b32 a88, v100
    v_accvgpr_write_b32 a89, v101
    v_accvgpr_write_b32 a90, v102
    v_accvgpr_write_b32 a91, v103
    v_accvgpr_write_b32 a92, v108
    ds_write_b128 v9, a[252:255] offset:52224
    v_accvgpr_write_b32 a93, v109
    v_accvgpr_write_b32 a94, v110
    v_accvgpr_write_b32 a95, v111
    v_accvgpr_write_b32 a96, v116
    v_accvgpr_write_b32 a97, v117
    v_accvgpr_write_b32 a98, v118
    v_accvgpr_write_b32 a99, v119
    v_accvgpr_write_b32 a100, v124
    v_accvgpr_write_b32 a101, v125
    ds_write_b128 v9, v[10:13] offset:16384
    v_accvgpr_write_b32 a102, v126
    v_accvgpr_write_b32 a103, v127
    v_accvgpr_write_b32 a104, v132
    v_accvgpr_write_b32 a105, v133
    v_accvgpr_write_b32 a106, v134
    v_accvgpr_write_b32 a107, v135
    v_accvgpr_write_b32 a108, v140
    v_accvgpr_write_b32 a109, v141
    v_accvgpr_write_b32 a110, v142
    ds_write_b128 v9, v[14:17] offset:17408
    v_accvgpr_write_b32 a111, v143
    v_accvgpr_write_b32 a112, v148
    v_accvgpr_write_b32 a113, v149
    v_accvgpr_write_b32 a114, v150
    v_accvgpr_write_b32 a115, v151
    v_accvgpr_write_b32 a116, v156
    v_accvgpr_write_b32 a117, v157
    v_accvgpr_write_b32 a118, v158
    ds_write_b128 v9, a[216:219] offset:18432
    v_accvgpr_write_b32 a119, v159
    v_accvgpr_write_b32 a120, v164
    v_accvgpr_write_b32 a121, v165
    v_accvgpr_write_b32 a122, v166
    v_accvgpr_write_b32 a123, v167
    v_accvgpr_write_b32 a124, v172
    v_accvgpr_write_b32 a125, v173
    v_accvgpr_write_b32 a126, v174
    v_accvgpr_write_b32 a127, v175
    ds_write_b128 v9, a[220:223] offset:19456
    v_accvgpr_write_b32 a144, v212
    v_accvgpr_write_b32 a145, v213
    v_accvgpr_write_b32 a146, v214
    v_accvgpr_write_b32 a147, v215
    v_accvgpr_write_b32 a148, v220
    v_accvgpr_write_b32 a149, v221
    v_accvgpr_write_b32 a150, v222
    v_accvgpr_write_b32 a151, v223
    v_accvgpr_write_b32 a128, v180
    v_accvgpr_write_b32 a129, v181
    v_accvgpr_write_b32 a130, v182
    v_accvgpr_write_b32 a131, v183
    v_accvgpr_write_b32 a132, v188
    v_accvgpr_write_b32 a133, v189
    v_accvgpr_write_b32 a134, v190
    v_accvgpr_write_b32 a135, v191
    v_accvgpr_write_b32 a136, v196
    v_accvgpr_write_b32 a137, v197
    v_accvgpr_write_b32 a138, v198
    v_accvgpr_write_b32 a139, v199
    v_accvgpr_write_b32 a140, v204
    v_accvgpr_write_b32 a141, v205
    v_accvgpr_write_b32 a142, v206
    v_accvgpr_write_b32 a143, v207
    s_movk_i32 s45, 0x207
    v_cmp_class_f32 vcc, v40, s45
    s_or_b64 s[54:55], s[54:55], vcc
    global_load_dword v254, v[2:3], off
    s_mul_i32 s40, s44, 9216
    v_add_u32 v251, s40, v24
    s_cmp_lt_u32 s43, 5
    s_cselect_b32 s40, 1, 0
    s_xor_b32 s40, s40, s95
    v_lshl_add_u32 v247, s40, 12, v251
    v_add_u32 v248, 1024, v247
    v_add_u32 v249, 2048, v247
    v_add_u32 v250, 3072, v247
    s_mul_i32 s40, s95, 36864
    v_add_u32 v251, s40, v251
    s_mul_i32 s40, s42, 1
    s_lshr_b32 s40, s40, 5
    s_add_u32 s40, s40, 0
    s_lshl_b32 s97, 1, s40
gqa_kernel_wpoll:
    s_waitcnt vmcnt(11)
    v_cmp_ne_u32 vcc, s48, v252
    v_cmp_ne_u32 s[86:87], s49, v253
    s_or_b64 vcc, vcc, s[86:87]
    s_cbranch_scc0 gqa_kernel_wpoll_ok
    s_sub_u32 s50, s50, 1
    s_cbranch_scc1 gqa_kernel_wpoll_ok
    s_sleep 2
    buffer_load_dwordx2 v[252:253], v21, s[24:27], s78 offen offset:0 sc1
    s_waitcnt vmcnt(0)
    s_branch gqa_kernel_wpoll
gqa_kernel_wpoll_ok:
    s_branch gqa_kernel_A
gqa_kernel_ool22:
    s_mul_i32 s86, s42, 1474560
    s_lshl_b32 s41, s3, 11
    s_add_u32 s86, s86, s41
    s_add_u32 s86, s86, 5242880
    s_mul_i32 s87, s42, 184320
    s_lshl_b32 s41, s3, 6
    s_add_u32 s87, s87, s41
    s_sub_u32 s40, s43, 5
    s_cselect_b32 s84, s43, s40
    s_cselect_b32 s85, 0, 1
    s_add_u32 s62, s86, 655360
    s_mul_i32 s40, s85, 327680
    s_add_u32 s67, s86, s40
    s_sub_u32 s63, s86, s40
    s_add_u32 s63, s63, 327680
    s_add_u32 s64, s63, 81920
    s_add_u32 s65, s64, 81920
    s_add_u32 s66, s65, 81920
    s_add_u32 s68, s67, 81920
    s_add_u32 s69, s68, 81920
    s_add_u32 s70, s69, 81920
    s_lshl_b32 s40, s84, 13
    s_add_u32 s77, s67, s40
    s_mul_i32 s52, s85, 81920
    s_add_u32 s52, s52, s87
    s_lshl_b32 s40, s84, 8
    s_add_u32 s52, s52, s40
    s_mul_i32 s101, s43, 655360
    s_lshl_b32 s40, s3, 11
    s_add_u32 s101, s101, s40
    s_add_u32 s84, s84, 1
    s_cmp_eq_u32 s84, 5
    s_cselect_b32 s84, 0, s84
    s_lshl_b32 s76, s84, 13
    s_add_u32 s76, s76, s101
    s_add_u32 s101, s101, 40960
    s_and_b32 s40, s85, 1
    s_lshl3_add_u32 s40, s84, s40
    s_lshl_b32 s4, s40, 10
    s_cmp_lt_u32 s84, 3
    s_addc_u32 s85, s85, 1
    s_cmp_eq_u32 s95, 1
    s_cbranch_scc1 gqa_kernel_ret22_1
    s_branch gqa_kernel_ret22_0
gqa_kernel_ool24:
    s_add_u32 s84, s84, 1
    s_cmp_eq_u32 s84, 5
    s_cselect_b32 s84, 0, s84
    s_and_b32 s40, s85, 1
    s_lshl3_add_u32 s40, s84, s40
    s_lshl_b32 s5, s40, 10
    s_bitcmp1_b32 s85, 1
    s_cselect_b32 s40, 40960, 0
    s_add_u32 s5, s5, s40
    s_cmp_lt_u32 s84, 3
    s_addc_u32 s85, s85, 1
    s_add_u32 s84, s84, 1
    s_cmp_eq_u32 s84, 5
    s_cselect_b32 s84, 0, s84
    s_and_b32 s40, s85, 1
    s_lshl3_add_u32 s40, s84, s40
    s_lshl_b32 s6, s40, 10
    s_bitcmp1_b32 s85, 1
    s_cselect_b32 s40, 40960, 0
    s_add_u32 s6, s6, s40
    s_bitcmp1_b32 s85, 2
    s_cselect_b32 s40, 737280, 0
    s_add_u32 s6, s6, s40
    s_cmp_lt_u32 s84, 3
    s_addc_u32 s85, s85, 1
    s_add_u32 s84, s84, 1
    s_cmp_eq_u32 s84, 5
    s_cselect_b32 s84, 0, s84
    s_and_b32 s40, s85, 1
    s_lshl3_add_u32 s40, s84, s40
    s_lshl_b32 s7, s40, 10
    s_bitcmp1_b32 s85, 1
    s_cselect_b32 s40, 40960, 0
    s_add_u32 s7, s7, s40
    s_bitcmp1_b32 s85, 2
    s_cselect_b32 s40, 737280, 0
    s_add_u32 s7, s7, s40
    s_cmp_lt_u32 s84, 3
    s_addc_u32 s85, s85, 1
    s_add_u32 s84, s84, 1
    s_cmp_eq_u32 s84, 5
    s_cselect_b32 s84, 0, s84
    s_and_b32 s40, s85, 1
    s_lshl3_add_u32 s40, s84, s40
    s_lshl_b32 s74, s40, 10
    s_bitcmp1_b32 s85, 1
    s_cselect_b32 s40, 40960, 0
    s_add_u32 s74, s74, s40
    s_bitcmp1_b32 s85, 2
    s_cselect_b32 s40, 737280, 0
    s_add_u32 s74, s74, s40
    s_bitcmp1_b32 s85, 0
    s_cselect_b32 s40, 0, 1024
    s_add_u32 s83, s77, s40
    s_cmp_eq_u32 s95, 1
    s_cbranch_scc1 gqa_kernel_ret24_1
    s_branch gqa_kernel_ret24_0
gqa_kernel_ool26:
    s_add_u32 s45, s43, 11
    s_and_b32 s40, s45, 3
    s_add_u32 s40, s40, 4
    s_lshr_b32 s41, s45, 2
    s_sub_u32 s41, s41, 1
    s_cmp_lt_u32 s43, 5
    s_cselect_b32 s40, 8, s40
    s_cselect_b32 s41, s43, s41
    s_mul_i32 s79, s40, 10
    s_add_u32 s79, s79, s41
    s_lshl_b32 s79, s79, 13
    s_add_u32 s79, s79, s86
    s_mul_i32 s61, s40, 80
    s_add_u32 s61, s61, s41
    s_lshl_b32 s61, s61, 8
    s_add_u32 s61, s61, s87
    s_add_u32 s45, s43, 19
    s_and_b32 s40, s45, 3
    s_add_u32 s40, s40, 4
    s_lshr_b32 s41, s45, 2
    s_sub_u32 s41, s41, 1
    s_mul_i32 s80, s40, 10
    s_add_u32 s80, s80, s41
    s_lshl_b32 s80, s80, 13
    s_add_u32 s80, s80, s86
    s_mul_i32 s100, s40, 80
    s_add_u32 s100, s100, s41
    s_lshl_b32 s100, s100, 8
    s_add_u32 s100, s100, s87
    s_cmp_ge_u32 s43, 5
    s_cselect_b32 s80, 0x40000000, s80
    s_cselect_b32 s100, 0x40000000, s100
    s_lshl2_add_u32 s73, s42, s3
    s_mul_i32 s73, s73, 512
    s_add_u32 s73, s73, 1126178560
    s_lshl_b32 s72, s43, 3
    s_add_u32 s72, s72, s73
    s_mov_b32 s71, 0
    s_cmp_eq_u32 s95, 1
    s_cbranch_scc1 gqa_kernel_ret26_1
    s_branch gqa_kernel_ret26_0
gqa_kernel_P0:
    v_mfma_f32_16x16x32_bf16 v[60:63], a[216:219], a[48:51], 0
    v_add_u32 v2, 49152, v24
    v_add_u32 v3, 98304, v24
    ds_read_b128 a[80:83], v24 offset:1024
    v_mfma_f32_16x16x32_bf16 v[60:63], a[224:227], a[52:55], v[60:63]
    ds_read_b128 a[84:87], v24 offset:19456
    v_lshl_add_u32 v76, s3, 12, v24
    v_mfma_f32_16x16x32_bf16 v[60:63], a[232:235], a[56:59], v[60:63]
    ds_read_b128 a[88:91], v24 offset:37888
    v_add_u32 v76, 147456, v76
    v_mfma_f32_16x16x32_bf16 v[60:63], a[240:243], a[60:63], v[60:63]
    v_xor_b32 v77, 4096, v76
    v_mfma_f32_16x16x32_bf16 v[64:67], a[220:223], a[48:51], 0
    ds_read_b128 a[92:95], v2 offset:7168
    v_mfma_f32_16x16x32_bf16 v[64:67], a[228:231], a[52:55], v[64:67]
    ds_write_b128 v77, v[228:231] offset:0
    v_mfma_f32_16x16x32_bf16 v[64:67], a[236:239], a[56:59], v[64:67]
    ds_write_b128 v77, v[232:235] offset:1024
    v_mfma_f32_16x16x32_bf16 v[64:67], a[244:247], a[60:63], v[64:67]
    ds_write_b128 v77, v[236:239] offset:2048
    v_mfma_f32_16x16x32_bf16 v[60:63], a[248:251], a[64:67], v[60:63]
    ds_write_b128 v77, v[240:243] offset:3072
    s_mul_i32 s40, s95, 73728
    s_sub_u32 s40, 110592, s40
    v_add_u32 v79, s40, v251
    ds_write_b32 v79, a176 offset:0
    ds_read_b128 a[96:99], v24 offset:10240
    v_mfma_f32_16x16x32_bf16 v[60:63], v[10:13], a[68:71], v[60:63]
    s_waitcnt vmcnt(11)
    ds_read_b128 a[100:103], v24 offset:28672
    v_mfma_f32_16x16x32_bf16 v[60:63], a[0:3], a[72:75], v[60:63]
    ds_read_b128 a[104:107], v24 offset:47104
    v_accvgpr_read_b32 v30, a160
    v_mfma_f32_16x16x32_bf16 v[60:63], a[8:11], a[76:79], v[60:63]
    v_accvgpr_read_b32 v32, a164
    v_accvgpr_read_b32 v34, a168
    v_mfma_f32_16x16x32_bf16 v[64:67], a[252:255], a[64:67], v[64:67]
    ds_read_b128 a[108:111], v2 offset:16384
    v_accvgpr_read_b32 v36, a172
    v_mfma_f32_16x16x32_bf16 v[64:67], v[14:17], a[68:71], v[64:67]
    v_accvgpr_read_b32 v38, a176
    v_add_u32 v247, 73728, v247
    v_mfma_f32_16x16x32_bf16 v[64:67], a[4:7], a[72:75], v[64:67]
    ds_read_b128 a[112:115], v24 offset:2048
    v_add_u32 v248, 73728, v248
    v_mfma_f32_16x16x32_bf16 v[64:67], a[12:15], a[76:79], v[64:67]
    s_waitcnt lgkmcnt(2)
    v_add_u32 v249, 73728, v249
    v_add_u32 v250, 73728, v250
    v_mfma_f32_16x16x32_bf16 v[68:71], a[216:219], a[80:83], 0
    ds_read_b128 a[116:119], v24 offset:20480
    v_add_u32 v251, 73728, v251
    v_rcp_f32 v30, v30
    s_nop 0
    v_mov_b32 v31, v30
    v_pk_mul_f32 v[84:85], v[84:85], v[30:31]
    v_pk_mul_f32 v[86:87], v[86:87], v[30:31]
    v_pk_mul_f32 v[88:89], v[88:89], v[30:31]
    v_pk_mul_f32 v[90:91], v[90:91], v[30:31]
    v_mfma_f32_16x16x32_bf16 v[68:71], a[224:227], a[84:87], v[68:71]
    v_cvt_pk_bf16_f32 v84, v84, v85
    v_cvt_pk_bf16_f32 v85, v86, v87
    v_mfma_f32_16x16x32_bf16 v[68:71], a[232:235], a[88:91], v[68:71]
    ds_read_b128 a[120:123], v24 offset:38912
    v_cvt_pk_bf16_f32 v86, v88, v89
    v_mfma_f32_16x16x32_bf16 v[68:71], a[240:243], a[92:95], v[68:71]
    v_cvt_pk_bf16_f32 v87, v90, v91
    s_add_u32 s53, s76, 491520
    v_mfma_f32_16x16x32_bf16 v[72:75], a[220:223], a[80:83], 0
    buffer_load_dwordx4 a[48:51], v24, s[24:27], s53 offen offset:0 sc1
    v_mfma_f32_16x16x32_bf16 v[72:75], a[228:231], a[84:87], v[72:75]
    ds_read_b128 a[124:127], v2 offset:8192
    v_mfma_f32_16x16x32_bf16 v[40:43], a[180:183], v[84:87], 0
    ds_write_b128 v247, v[84:87] offset:1024
    v_pk_mul_f32 v[92:93], v[92:93], v[30:31]
    v_pk_mul_f32 v[94:95], v[94:95], v[30:31]
    v_pk_mul_f32 v[96:97], v[96:97], v[30:31]
    v_pk_mul_f32 v[98:99], v[98:99], v[30:31]
    v_mfma_f32_16x16x32_bf16 v[72:75], a[236:239], a[88:91], v[72:75]
    ds_read_b128 a[128:131], v24 offset:11264
    v_cvt_pk_bf16_f32 v92, v92, v93
    v_mfma_f32_16x16x32_bf16 v[72:75], a[244:247], a[92:95], v[72:75]
    v_cvt_pk_bf16_f32 v93, v94, v95
    v_cvt_pk_bf16_f32 v94, v96, v97
    v_mfma_f32_16x16x32_bf16 v[68:71], a[248:251], a[96:99], v[68:71]
    v_cvt_pk_bf16_f32 v95, v98, v99
    v_mfma_f32_16x16x32_bf16 v[68:71], v[10:13], a[100:103], v[68:71]
    ds_read_b128 a[132:135], v24 offset:29696
    v_mfma_f32_16x16x32_bf16 v[68:71], a[0:3], a[104:107], v[68:71]
    buffer_load_dwordx4 a[52:55], v24, s[24:27], s53 offen offset:1024 sc1
    v_mfma_f32_16x16x32_bf16 v[40:43], a[180:183], v[92:95], v[40:43]
    s_waitcnt lgkmcnt(1)
    ds_write_b128 v247, v[92:95] offset:19456
    v_pk_mul_f32 v[100:101], v[100:101], v[30:31]
    v_pk_mul_f32 v[102:103], v[102:103], v[30:31]
    v_pk_mul_f32 v[104:105], v[104:105], v[30:31]
    v_pk_mul_f32 v[106:107], v[106:107], v[30:31]
    v_mfma_f32_16x16x32_bf16 v[68:71], a[8:11], a[108:111], v[68:71]
    ds_read_b128 a[136:139], v24 offset:48128
    v_cvt_pk_bf16_f32 v100, v100, v101
    v_mfma_f32_16x16x32_bf16 v[72:75], a[252:255], a[96:99], v[72:75]
    ds_read_b128 a[140:143], v2 offset:17408
    v_cvt_pk_bf16_f32 v101, v102, v103
    v_mfma_f32_16x16x32_bf16 v[72:75], v[14:17], a[100:103], v[72:75]
    v_cvt_pk_bf16_f32 v102, v104, v105
    v_cvt_pk_bf16_f32 v103, v106, v107
    v_mfma_f32_16x16x32_bf16 v[72:75], a[4:7], a[104:107], v[72:75]
    s_add_u32 s53, s76, 532480
    v_mfma_f32_16x16x32_bf16 v[72:75], a[12:15], a[108:111], v[72:75]
    ds_read_b128 a[80:83], v24 offset:3072
    v_mfma_f32_16x16x32_bf16 v[92:95], a[216:219], a[112:115], 0
    buffer_load_dwordx4 a[56:59], v24, s[24:27], s53 offen offset:0 sc1
    v_mfma_f32_16x16x32_bf16 v[40:43], a[180:183], v[100:103], v[40:43]
    ds_write_b128 v247, v[100:103] offset:37888
    v_pk_mul_f32 v[108:109], v[108:109], v[30:31]
    v_pk_mul_f32 v[110:111], v[110:111], v[30:31]
    v_pk_mul_f32 v[112:113], v[112:113], v[30:31]
    v_pk_mul_f32 v[114:115], v[114:115], v[30:31]
    v_mfma_f32_16x16x32_bf16 v[92:95], a[224:227], a[116:119], v[92:95]
    s_barrier
    ds_read_b128 a[84:87], v24 offset:21504
    v_mfma_f32_16x16x32_bf16 v[92:95], a[232:235], a[120:123], v[92:95]
    ds_read_b128 a[88:91], v24 offset:39936
    v_cvt_pk_bf16_f32 v108, v108, v109
    v_mfma_f32_16x16x32_bf16 v[92:95], a[240:243], a[124:127], v[92:95]
    v_cvt_pk_bf16_f32 v109, v110, v111
    v_cvt_pk_bf16_f32 v110, v112, v113
    v_mfma_f32_16x16x32_bf16 v[96:99], a[220:223], a[112:115], 0
    v_cvt_pk_bf16_f32 v111, v114, v115
    ds_read_b128 v[44:47], v76 offset:0
    v_mfma_f32_16x16x32_bf16 v[96:99], a[228:231], a[116:119], v[96:99]
    ds_read_b128 a[92:95], v2 offset:9216
    v_mfma_f32_16x16x32_bf16 v[96:99], a[236:239], a[120:123], v[96:99]
    buffer_load_dwordx4 a[60:63], v24, s[24:27], s53 offen offset:1024 sc1
    v_mfma_f32_16x16x32_bf16 v[40:43], a[180:183], v[108:111], v[40:43]
    ds_read_b128 a[96:99], v24 offset:12288
    s_add_u32 s53, s76, 573440
    v_rcp_f32 v32, v32
    s_nop 0
    v_mov_b32 v33, v32
    ds_write_b128 v247, v[108:111] offset:56320
    v_pk_mul_f32 v[116:117], v[116:117], v[32:33]
    v_pk_mul_f32 v[118:119], v[118:119], v[32:33]
    v_pk_mul_f32 v[120:121], v[120:121], v[32:33]
    v_pk_mul_f32 v[122:123], v[122:123], v[32:33]
    v_mfma_f32_16x16x32_bf16 v[96:99], a[244:247], a[124:127], v[96:99]
    v_cvt_pk_bf16_f32 v116, v116, v117
    v_cvt_pk_bf16_f32 v117, v118, v119
    v_mfma_f32_16x16x32_bf16 v[92:95], a[248:251], a[128:131], v[92:95]
    s_waitcnt lgkmcnt(1)
    ds_read_b128 a[100:103], v24 offset:30720
    v_cvt_pk_bf16_f32 v118, v120, v121
    v_mfma_f32_16x16x32_bf16 v[92:95], v[10:13], a[132:135], v[92:95]
    v_cvt_pk_bf16_f32 v119, v122, v123
    ds_read_b128 v[48:51], v76 offset:1024
    v_mfma_f32_16x16x32_bf16 v[92:95], a[0:3], a[136:139], v[92:95]
    buffer_load_dwordx4 a[64:67], v24, s[24:27], s53 offen offset:0 sc1
    v_mfma_f32_16x16x32_bf16 v[92:95], a[8:11], a[140:143], v[92:95]
    ds_read_b128 a[104:107], v2 offset:0
    v_mfma_f32_16x16x32_bf16 v[96:99], a[252:255], a[128:131], v[96:99]
    ds_read_b128 v[52:55], v76 offset:2048
    v_mfma_f32_16x16x32_bf16 v[40:43], a[180:183], v[116:119], v[40:43]
    ds_write_b128 v248, v[116:119] offset:1024
    v_pk_mul_f32 v[124:125], v[124:125], v[32:33]
    v_pk_mul_f32 v[126:127], v[126:127], v[32:33]
    v_pk_mul_f32 v[128:129], v[128:129], v[32:33]
    v_pk_mul_f32 v[130:131], v[130:131], v[32:33]
    v_mfma_f32_16x16x32_bf16 v[96:99], v[14:17], a[132:135], v[96:99]
    ds_read_b128 a[108:111], v2 offset:18432
    v_cvt_pk_bf16_f32 v124, v124, v125
    v_mfma_f32_16x16x32_bf16 v[96:99], a[4:7], a[136:139], v[96:99]
    ds_read_b128 a[112:115], v24 offset:4096
    v_cvt_pk_bf16_f32 v125, v126, v127
    v_mfma_f32_16x16x32_bf16 v[96:99], a[12:15], a[140:143], v[96:99]
    v_cvt_pk_bf16_f32 v126, v128, v129
    v_cvt_pk_bf16_f32 v127, v130, v131
    v_mfma_f32_16x16x32_bf16 v[100:103], a[216:219], a[80:83], 0
    buffer_load_dwordx4 a[68:71], v24, s[24:27], s53 offen offset:1024 sc1
    v_mfma_f32_16x16x32_bf16 v[100:103], a[224:227], a[84:87], v[100:103]
    ds_read_b128 a[116:119], v24 offset:22528
    s_add_u32 s53, s76, 614400
    v_mfma_f32_16x16x32_bf16 v[100:103], a[232:235], a[88:91], v[100:103]
    ds_read_b128 v[56:59], v76 offset:3072
    v_mfma_f32_16x16x32_bf16 v[40:43], a[180:183], v[124:127], v[40:43]
    ds_write_b128 v248, v[124:127] offset:19456
    v_pk_mul_f32 v[132:133], v[132:133], v[32:33]
    v_pk_mul_f32 v[134:135], v[134:135], v[32:33]
    v_pk_mul_f32 v[136:137], v[136:137], v[32:33]
    v_pk_mul_f32 v[138:139], v[138:139], v[32:33]
    v_mfma_f32_16x16x32_bf16 v[100:103], a[240:243], a[92:95], v[100:103]
    ds_read_b128 a[120:123], v24 offset:40960
    v_cvt_pk_bf16_f32 v132, v132, v133
    v_mfma_f32_16x16x32_bf16 v[104:107], a[220:223], a[80:83], 0
    buffer_load_dwordx4 a[72:75], v24, s[24:27], s53 offen offset:0 sc1
    v_mfma_f32_16x16x32_bf16 v[104:107], a[228:231], a[84:87], v[104:107]
    ds_read_b128 a[124:127], v2 offset:10240
    v_cvt_pk_bf16_f32 v133, v134, v135
    v_mfma_f32_16x16x32_bf16 v[104:107], a[236:239], a[88:91], v[104:107]
    v_cvt_pk_bf16_f32 v134, v136, v137
    v_cvt_pk_bf16_f32 v135, v138, v139
    v_mfma_f32_16x16x32_bf16 v[104:107], a[244:247], a[92:95], v[104:107]
    buffer_load_dwordx4 a[76:79], v24, s[24:27], s53 offen offset:1024 sc1
    v_mfma_f32_16x16x32_bf16 v[40:43], a[180:183], v[132:135], v[40:43]
    ds_write_b128 v248, v[132:135] offset:37888
    v_pk_mul_f32 v[140:141], v[140:141], v[32:33]
    v_pk_mul_f32 v[142:143], v[142:143], v[32:33]
    v_pk_mul_f32 v[144:145], v[144:145], v[32:33]
    v_pk_mul_f32 v[146:147], v[146:147], v[32:33]
    v_mfma_f32_16x16x32_bf16 v[100:103], a[248:251], a[96:99], v[100:103]
    s_add_u32 s98, s76, 8192
    s_sub_u32 s45, s101, 40960
    s_cmp_eq_u32 s98, s101
    s_cselect_b32 s98, s45, s98
    ds_read_b128 a[128:131], v24 offset:13312
    s_waitcnt lgkmcnt(2)
    v_mfma_f32_16x16x32_bf16 v[100:103], v[10:13], a[100:103], v[100:103]
    ds_read_b128 a[132:135], v24 offset:31744
    v_cvt_pk_bf16_f32 v140, v140, v141
    v_mfma_f32_16x16x32_bf16 v[100:103], a[0:3], a[104:107], v[100:103]
    ds_read_b32 v28, v251 offset:0
    v_cvt_pk_bf16_f32 v141, v142, v143
    v_mfma_f32_16x16x32_bf16 v[100:103], a[8:11], a[108:111], v[100:103]
    ds_read_b128 a[136:139], v2 offset:1024
    v_cvt_pk_bf16_f32 v142, v144, v145
    v_mfma_f32_16x16x32_bf16 v[104:107], a[252:255], a[96:99], v[104:107]
    v_cvt_pk_bf16_f32 v143, v146, v147
    s_add_u32 s53, s98, 0
    v_mfma_f32_16x16x32_bf16 v[104:107], v[14:17], a[100:103], v[104:107]
    ds_read_b128 a[140:143], v2 offset:19456
    v_mfma_f32_16x16x32_bf16 v[40:43], a[180:183], v[140:143], v[40:43]
    buffer_load_dwordx4 a[160:163], v24, s[24:27], s53 offen offset:0 sc1
    v_rcp_f32 v34, v34
    s_nop 0
    v_mov_b32 v35, v34
    ds_write_b128 v248, v[140:143] offset:56320
    v_pk_mul_f32 v[148:149], v[148:149], v[34:35]
    v_pk_mul_f32 v[150:151], v[150:151], v[34:35]
    v_pk_mul_f32 v[152:153], v[152:153], v[34:35]
    v_pk_mul_f32 v[154:155], v[154:155], v[34:35]
    v_mfma_f32_16x16x32_bf16 v[104:107], a[4:7], a[104:107], v[104:107]
    ds_read_b128 a[80:83], v24 offset:5120
    v_cvt_pk_bf16_f32 v148, v148, v149
    v_mfma_f32_16x16x32_bf16 v[104:107], a[12:15], a[108:111], v[104:107]
    v_cvt_pk_bf16_f32 v149, v150, v151
    v_cvt_pk_bf16_f32 v150, v152, v153
    v_mfma_f32_16x16x32_bf16 v[108:111], a[216:219], a[112:115], 0
    ds_read_b128 a[84:87], v24 offset:23552
    v_cvt_pk_bf16_f32 v151, v154, v155
    v_mfma_f32_16x16x32_bf16 v[108:111], a[224:227], a[116:119], v[108:111]
    buffer_load_dwordx4 a[164:167], v24, s[24:27], s53 offen offset:1024 sc1
    v_mfma_f32_16x16x32_bf16 v[108:111], a[232:235], a[120:123], v[108:111]
    v_rcp_f32 v36, v36
    v_mfma_f32_16x16x32_bf16 v[108:111], a[240:243], a[124:127], v[108:111]
    ds_read_b128 a[88:91], v24 offset:41984
    s_add_u32 s53, s98, 40960
    v_mfma_f32_16x16x32_bf16 v[40:43], a[180:183], v[148:151], v[40:43]
    ds_write_b128 v249, v[148:151] offset:1024
    v_pk_mul_f32 v[156:157], v[156:157], v[34:35]
    v_pk_mul_f32 v[158:159], v[158:159], v[34:35]
    v_pk_mul_f32 v[160:161], v[160:161], v[34:35]
    v_pk_mul_f32 v[162:163], v[162:163], v[34:35]
    v_mfma_f32_16x16x32_bf16 v[112:115], a[220:223], a[112:115], 0
    ds_read_b128 a[92:95], v2 offset:11264
    v_cvt_pk_bf16_f32 v156, v156, v157
    v_mfma_f32_16x16x32_bf16 v[112:115], a[228:231], a[116:119], v[112:115]
    v_cvt_pk_bf16_f32 v157, v158, v159
    v_cvt_pk_bf16_f32 v158, v160, v161
    v_mfma_f32_16x16x32_bf16 v[112:115], a[236:239], a[120:123], v[112:115]
    ds_read_b128 a[96:99], v24 offset:14336
    v_cvt_pk_bf16_f32 v159, v162, v163
    v_mfma_f32_16x16x32_bf16 v[112:115], a[244:247], a[124:127], v[112:115]
    buffer_load_dwordx4 a[168:171], v24, s[24:27], s53 offen offset:0 sc1
    s_waitcnt lgkmcnt(2)
    v_mfma_f32_16x16x32_bf16 v[108:111], a[248:251], a[128:131], v[108:111]
    v_mov_b32 v37, v36
    v_add_f32 v38, v38, v28
    v_mfma_f32_16x16x32_bf16 v[108:111], v[10:13], a[132:135], v[108:111]
    ds_read_b128 a[100:103], v24 offset:32768
    v_mfma_f32_16x16x32_bf16 v[40:43], a[180:183], v[156:159], v[40:43]
    ds_write_b128 v249, v[156:159] offset:19456
    v_pk_mul_f32 v[164:165], v[164:165], v[34:35]
    v_pk_mul_f32 v[166:167], v[166:167], v[34:35]
    v_pk_mul_f32 v[168:169], v[168:169], v[34:35]
    v_pk_mul_f32 v[170:171], v[170:171], v[34:35]
    v_mfma_f32_16x16x32_bf16 v[108:111], a[0:3], a[136:139], v[108:111]
    ds_read_b128 a[104:107], v2 offset:2048
    v_cvt_pk_bf16_f32 v164, v164, v165
    v_mfma_f32_16x16x32_bf16 v[108:111], a[8:11], a[140:143], v[108:111]
    v_cvt_pk_bf16_f32 v165, v166, v167
    v_cvt_pk_bf16_f32 v166, v168, v169
    v_mfma_f32_16x16x32_bf16 v[112:115], a[252:255], a[128:131], v[112:115]
    ds_read_b128 a[108:111], v2 offset:20480
    v_cvt_pk_bf16_f32 v167, v170, v171
    v_mfma_f32_16x16x32_bf16 v[112:115], v[14:17], a[132:135], v[112:115]
    v_rcp_f32 v38, v38
    v_mfma_f32_16x16x32_bf16 v[112:115], a[4:7], a[136:139], v[112:115]
    v_mov_b32 v39, v38
    v_max3_f32 v28, v30, v32, v34
    v_mfma_f32_16x16x32_bf16 v[112:115], a[12:15], a[140:143], v[112:115]
    ds_read_b128 a[112:115], v24 offset:6144
    v_min3_f32 v29, v30, v32, v34
    v_mfma_f32_16x16x32_bf16 v[40:43], a[180:183], v[164:167], v[40:43]
    ds_write_b128 v249, v[164:167] offset:37888
    v_pk_mul_f32 v[172:173], v[172:173], v[34:35]
    v_pk_mul_f32 v[174:175], v[174:175], v[34:35]
    v_pk_mul_f32 v[176:177], v[176:177], v[34:35]
    v_pk_mul_f32 v[178:179], v[178:179], v[34:35]
    v_mfma_f32_16x16x32_bf16 v[116:119], a[216:219], a[80:83], 0
    buffer_load_dwordx4 a[172:175], v24, s[24:27], s53 offen offset:1024 sc1
    v_mfma_f32_16x16x32_bf16 v[116:119], a[224:227], a[84:87], v[116:119]
    ds_read_b128 a[116:119], v24 offset:24576
    v_cvt_pk_bf16_f32 v172, v172, v173
    v_mfma_f32_16x16x32_bf16 v[116:119], a[232:235], a[88:91], v[116:119]
    s_waitcnt lgkmcnt(2)
    v_cvt_pk_bf16_f32 v173, v174, v175
    v_cvt_pk_bf16_f32 v174, v176, v177
    v_mfma_f32_16x16x32_bf16 v[116:119], a[240:243], a[92:95], v[116:119]
    v_cvt_pk_bf16_f32 v175, v178, v179
    ds_read_b128 a[120:123], v24 offset:43008
    v_mfma_f32_16x16x32_bf16 v[120:123], a[220:223], a[80:83], 0
    s_add_u32 s53, s98, 81920
    v_max3_f32 v28, v28, v36, v38
    v_mfma_f32_16x16x32_bf16 v[40:43], a[180:183], v[172:175], v[40:43]
    ds_write_b128 v249, v[172:175] offset:56320
    v_pk_add_f32 v[212:213], v[212:213], v[44:45]
    v_pk_add_f32 v[214:215], v[214:215], v[46:47]
    v_pk_add_f32 v[216:217], v[216:217], v[48:49]
    v_pk_add_f32 v[218:219], v[218:219], v[50:51]
    v_pk_mul_f32 v[212:213], v[212:213], v[38:39]
    v_pk_mul_f32 v[214:215], v[214:215], v[38:39]
    v_pk_mul_f32 v[216:217], v[216:217], v[38:39]
    v_pk_mul_f32 v[218:219], v[218:219], v[38:39]
    v_mfma_f32_16x16x32_bf16 v[120:123], a[228:231], a[84:87], v[120:123]
    buffer_load_dwordx4 a[176:179], v24, s[24:27], s53 offen offset:0 sc1
    v_mfma_f32_16x16x32_bf16 v[120:123], a[236:239], a[88:91], v[120:123]
    ds_read_b128 a[124:127], v2 offset:12288
    v_cvt_pk_bf16_f32 v212, v212, v213
    v_mfma_f32_16x16x32_bf16 v[120:123], a[244:247], a[92:95], v[120:123]
    ds_read_b128 a[128:131], v24 offset:15360
    v_cvt_pk_bf16_f32 v213, v214, v215
    v_mfma_f32_16x16x32_bf16 v[116:119], a[248:251], a[96:99], v[116:119]
    v_cvt_pk_bf16_f32 v214, v216, v217
    v_cvt_pk_bf16_f32 v215, v218, v219
    v_mfma_f32_16x16x32_bf16 v[116:119], v[10:13], a[100:103], v[116:119]
    ds_read_b128 a[132:135], v24 offset:33792
    v_min3_f32 v29, v29, v36, v38
    v_mfma_f32_16x16x32_bf16 v[116:119], a[0:3], a[104:107], v[116:119]
    buffer_load_dwordx4 a[184:187], v24, s[24:27], s53 offen offset:1024 sc1
    v_mfma_f32_16x16x32_bf16 v[40:43], a[180:183], v[212:215], v[40:43]
    ds_write_b128 v251, v[212:215] offset:0
    v_pk_add_f32 v[220:221], v[220:221], v[52:53]
    v_pk_add_f32 v[222:223], v[222:223], v[54:55]
    v_pk_add_f32 v[224:225], v[224:225], v[56:57]
    v_pk_add_f32 v[226:227], v[226:227], v[58:59]
    v_pk_mul_f32 v[220:221], v[220:221], v[38:39]
    v_pk_mul_f32 v[222:223], v[222:223], v[38:39]
    v_pk_mul_f32 v[224:225], v[224:225], v[38:39]
    v_pk_mul_f32 v[226:227], v[226:227], v[38:39]
    v_mfma_f32_16x16x32_bf16 v[116:119], a[8:11], a[108:111], v[116:119]
    ds_read_b128 a[136:139], v2 offset:3072
    v_cvt_pk_bf16_f32 v220, v220, v221
    v_mfma_f32_16x16x32_bf16 v[120:123], a[252:255], a[96:99], v[120:123]
    ds_read_b128 a[140:143], v2 offset:21504
    v_cvt_pk_bf16_f32 v221, v222, v223
    v_mfma_f32_16x16x32_bf16 v[120:123], v[14:17], a[100:103], v[120:123]
    v_cvt_pk_bf16_f32 v222, v224, v225
    v_cvt_pk_bf16_f32 v223, v226, v227
    v_mfma_f32_16x16x32_bf16 v[120:123], a[4:7], a[104:107], v[120:123]
    s_add_u32 s53, s98, 122880
    v_mfma_f32_16x16x32_bf16 v[120:123], a[12:15], a[108:111], v[120:123]
    buffer_load_dwordx4 a[188:191], v24, s[24:27], s53 offen offset:0 sc1
    v_mfma_f32_16x16x32_bf16 v[132:135], a[216:219], a[112:115], 0
    ds_read_b128 a[80:83], v24 offset:7168
    v_mfma_f32_16x16x32_bf16 v[40:43], a[180:183], v[220:223], v[40:43]
    s_waitcnt lgkmcnt(1)
    ds_write_b128 v251, v[220:223] offset:18432
    v_pk_mul_f32 v[180:181], v[180:181], v[36:37]
    v_pk_mul_f32 v[182:183], v[182:183], v[36:37]
    v_pk_mul_f32 v[184:185], v[184:185], v[36:37]
    v_pk_mul_f32 v[186:187], v[186:187], v[36:37]
    v_mfma_f32_16x16x32_bf16 v[132:135], a[224:227], a[116:119], v[132:135]
    ds_read_b128 a[84:87], v24 offset:25600
    v_cvt_pk_bf16_f32 v180, v180, v181
    v_mfma_f32_16x16x32_bf16 v[132:135], a[232:235], a[120:123], v[132:135]
    ds_read_b128 a[88:91], v24 offset:44032
    v_cvt_pk_bf16_f32 v181, v182, v183
    v_mfma_f32_16x16x32_bf16 v[132:135], a[240:243], a[124:127], v[132:135]
    v_cvt_pk_bf16_f32 v182, v184, v185
    v_cvt_pk_bf16_f32 v183, v186, v187
    v_mfma_f32_16x16x32_bf16 v[136:139], a[220:223], a[112:115], 0
    buffer_load_dwordx4 a[192:195], v24, s[24:27], s53 offen offset:1024 sc1
    v_mfma_f32_16x16x32_bf16 v[136:139], a[228:231], a[116:119], v[136:139]
    ds_read_b128 a[92:95], v2 offset:13312
    s_add_u32 s53, s98, 163840
    v_mfma_f32_16x16x32_bf16 v[136:139], a[236:239], a[120:123], v[136:139]
    v_cmp_nle_f32 vcc, v28, s82
    s_or_b64 s[54:55], s[54:55], vcc
    v_mfma_f32_16x16x32_bf16 v[40:43], a[180:183], v[180:183], v[40:43]
    ds_write_b128 v250, v[180:183] offset:1024
    v_pk_mul_f32 v[188:189], v[188:189], v[36:37]
    v_pk_mul_f32 v[190:191], v[190:191], v[36:37]
    v_pk_mul_f32 v[192:193], v[192:193], v[36:37]
    v_pk_mul_f32 v[194:195], v[194:195], v[36:37]
    v_mfma_f32_16x16x32_bf16 v[136:139], a[244:247], a[124:127], v[136:139]
    ds_read_b128 a[96:99], v24 offset:16384
    v_cvt_pk_bf16_f32 v188, v188, v189
    v_mfma_f32_16x16x32_bf16 v[132:135], a[248:251], a[128:131], v[132:135]
    ds_read_b128 a[100:103], v24 offset:34816
    v_cvt_pk_bf16_f32 v189, v190, v191
    v_mfma_f32_16x16x32_bf16 v[132:135], v[10:13], a[132:135], v[132:135]
    buffer_load_dwordx4 a[196:199], v24, s[24:27], s53 offen offset:0 sc1
    v_mfma_f32_16x16x32_bf16 v[132:135], a[0:3], a[136:139], v[132:135]
    v_cvt_pk_bf16_f32 v190, v192, v193
    v_cvt_pk_bf16_f32 v191, v194, v195
    v_mfma_f32_16x16x32_bf16 v[132:135], a[8:11], a[140:143], v[132:135]
    ds_read_b128 a[104:107], v2 offset:4096
    v_mfma_f32_16x16x32_bf16 v[136:139], a[252:255], a[128:131], v[136:139]
    buffer_load_dwordx4 a[200:203], v24, s[24:27], s53 offen offset:1024 sc1
    v_mfma_f32_16x16x32_bf16 v[40:43], a[180:183], v[188:191], v[40:43]
    ds_write_b128 v250, v[188:191] offset:19456
    v_pk_mul_f32 v[196:197], v[196:197], v[36:37]
    v_pk_mul_f32 v[198:199], v[198:199], v[36:37]
    v_pk_mul_f32 v[200:201], v[200:201], v[36:37]
    v_pk_mul_f32 v[202:203], v[202:203], v[36:37]
    v_mfma_f32_16x16x32_bf16 v[136:139], v[14:17], a[132:135], v[136:139]
    ds_read_b128 a[108:111], v2 offset:22528
    v_cvt_pk_bf16_f32 v196, v196, v197
    v_mfma_f32_16x16x32_bf16 v[136:139], a[4:7], a[136:139], v[136:139]
    ds_read_b128 a[112:115], v24 offset:8192
    v_cvt_pk_bf16_f32 v197, v198, v199
    v_mfma_f32_16x16x32_bf16 v[136:139], a[12:15], a[140:143], v[136:139]
    s_waitcnt lgkmcnt(2)
    v_cvt_pk_bf16_f32 v198, v200, v201
    v_cvt_pk_bf16_f32 v199, v202, v203
    v_mfma_f32_16x16x32_bf16 v[140:143], a[216:219], a[80:83], 0
    s_add_u32 s53, s98, 204800
    v_mfma_f32_16x16x32_bf16 v[140:143], a[224:227], a[84:87], v[140:143]
    ds_read_b128 a[116:119], v24 offset:26624
    v_mfma_f32_16x16x32_bf16 v[40:43], a[180:183], v[196:199], v[40:43]
    ds_write_b128 v250, v[196:199] offset:37888
    v_pk_mul_f32 v[204:205], v[204:205], v[36:37]
    v_pk_mul_f32 v[206:207], v[206:207], v[36:37]
    v_pk_mul_f32 v[208:209], v[208:209], v[36:37]
    v_pk_mul_f32 v[210:211], v[210:211], v[36:37]
    v_mfma_f32_16x16x32_bf16 v[140:143], a[232:235], a[88:91], v[140:143]
    ds_read_b128 a[120:123], v24 offset:45056
    v_cvt_pk_bf16_f32 v204, v204, v205
    v_mfma_f32_16x16x32_bf16 v[140:143], a[240:243], a[92:95], v[140:143]
    buffer_load_dwordx4 a[204:207], v24, s[24:27], s53 offen offset:0 sc1
    v_mfma_f32_16x16x32_bf16 v[144:147], a[220:223], a[80:83], 0
    ds_read_b128 a[124:127], v2 offset:14336
    v_cvt_pk_bf16_f32 v205, v206, v207
    v_mfma_f32_16x16x32_bf16 v[144:147], a[228:231], a[84:87], v[144:147]
    v_cvt_pk_bf16_f32 v206, v208, v209
    v_cvt_pk_bf16_f32 v207, v210, v211
    v_mfma_f32_16x16x32_bf16 v[144:147], a[236:239], a[88:91], v[144:147]
    buffer_load_dwordx4 a[144:147], v24, s[24:27], s53 offen offset:1024 sc1
    v_mfma_f32_16x16x32_bf16 v[144:147], a[244:247], a[92:95], v[144:147]
    ds_read_b128 a[128:131], v24 offset:17408
    s_add_u32 s53, s98, 245760
    v_mfma_f32_16x16x32_bf16 v[40:43], a[180:183], v[204:207], v[40:43]
    ds_write_b128 v250, v[204:207] offset:56320
    v_mfma_f32_16x16x32_bf16 v[140:143], a[248:251], a[96:99], v[140:143]
    ds_read_b128 a[132:135], v24 offset:35840
    v_mfma_f32_16x16x32_bf16 v[140:143], v[10:13], a[100:103], v[140:143]
    v_cmp_nge_f32 vcc, v29, s81
    s_or_b64 s[54:55], s[54:55], vcc
    v_mfma_f32_16x16x32_bf16 v[140:143], a[0:3], a[104:107], v[140:143]
    s_waitcnt lgkmcnt(3)
    ds_read_b128 a[136:139], v2 offset:5120
    v_bfe_u32 v245, v24, 4, 2
    v_mfma_f32_16x16x32_bf16 v[140:143], a[8:11], a[108:111], v[140:143]
    v_lshlrev_b32 v245, 12, v245
    v_add_u32 v245, 147456, v245
    v_mfma_f32_16x16x32_bf16 v[144:147], a[252:255], a[96:99], v[144:147]
    s_movk_i32 s45, 0x207
    ds_read_b128 a[140:143], v2 offset:23552
    v_mfma_f32_16x16x32_bf16 v[144:147], v[14:17], a[100:103], v[144:147]
    v_cmp_class_f32 vcc, v40, s45
    s_or_b64 s[54:55], s[54:55], vcc
    s_or_b32 s40, s54, s55
    v_mov_b32 v244, s40
    v_mfma_f32_16x16x32_bf16 v[144:147], a[4:7], a[104:107], v[144:147]
    ds_write_b32 v76, v244 offset:0
    v_mfma_f32_16x16x32_bf16 v[144:147], a[12:15], a[108:111], v[144:147]
    buffer_load_dwordx4 a[148:151], v24, s[24:27], s53 offen offset:0 sc1
    v_mfma_f32_16x16x32_bf16 v[124:127], a[216:219], a[112:115], 0
    v_mfma_f32_16x16x32_bf16 v[124:127], a[224:227], a[116:119], v[124:127]
    v_mfma_f32_16x16x32_bf16 v[124:127], a[232:235], a[120:123], v[124:127]
    buffer_load_dwordx4 a[152:155], v24, s[24:27], s53 offen offset:1024 sc1
    v_mfma_f32_16x16x32_bf16 v[124:127], a[240:243], a[124:127], v[124:127]
    s_waitcnt vmcnt(14) lgkmcnt(0)
    s_barrier
    ds_read_b32 v246, v245 offset:0
    v_mfma_f32_16x16x32_bf16 v[128:131], a[220:223], a[112:115], 0
    ds_read_b128 v[148:151], v2 offset:24576
    s_add_u32 s53, s98, 286720
    v_mfma_f32_16x16x32_bf16 v[128:131], a[228:231], a[116:119], v[128:131]
    ds_read_b128 v[152:155], v2 offset:43008
    v_mfma_f32_16x16x32_bf16 v[128:131], a[236:239], a[120:123], v[128:131]
    ds_read_b128 v[156:159], v3 offset:12288
    v_mfma_f32_16x16x32_bf16 v[128:131], a[244:247], a[124:127], v[128:131]
    buffer_load_dwordx4 a[156:159], v24, s[24:27], s53 offen offset:0 sc1
    v_mfma_f32_16x16x32_bf16 v[124:127], a[248:251], a[128:131], v[124:127]
    ds_read_b128 v[160:163], v3 offset:30720
    v_mfma_f32_16x16x32_bf16 v[124:127], v[10:13], a[132:135], v[124:127]
    ds_read_b128 v[76:79], v2 offset:33792
    v_mfma_f32_16x16x32_bf16 v[124:127], a[0:3], a[136:139], v[124:127]
    ds_read_b128 v[80:83], v3 offset:3072
    v_mfma_f32_16x16x32_bf16 v[124:127], a[8:11], a[140:143], v[124:127]
    ds_read_b128 v[84:87], v3 offset:21504
    v_mfma_f32_16x16x32_bf16 v[128:131], a[252:255], a[128:131], v[128:131]
    ds_read_b128 v[88:91], v3 offset:39936
    v_mfma_f32_16x16x32_bf16 v[128:131], v[14:17], a[132:135], v[128:131]
    v_mfma_f32_16x16x32_bf16 v[128:131], a[4:7], a[136:139], v[128:131]
    ds_read_b128 v[28:31], v2 offset:25600
    v_mfma_f32_16x16x32_bf16 v[128:131], a[12:15], a[140:143], v[128:131]
    s_waitcnt lgkmcnt(6)
    v_mfma_f32_16x16x32_bf16 v[60:63], a[16:19], v[148:151], v[60:63]
    ds_read_b128 v[32:35], v2 offset:44032
    v_mfma_f32_16x16x32_bf16 v[60:63], a[24:27], v[152:155], v[60:63]
    v_cmp_ne_u32 vcc, 0, v246
    s_cmp_lg_u64 vcc, 0
    s_cbranch_scc1 gqa_kernel_fb
    v_mfma_f32_16x16x32_bf16 v[60:63], a[32:35], v[156:159], v[60:63]
    s_waitcnt lgkmcnt(2)
    ds_read_b128 v[36:39], v3 offset:13312
    v_add_u32 v1, s4, v24
    v_mfma_f32_16x16x32_bf16 v[60:63], a[40:43], v[160:163], v[60:63]
    buffer_load_dwordx4 a[80:83], v24, s[24:27], s53 offen offset:1024 sc1
    v_mfma_f32_16x16x32_bf16 v[64:67], a[20:23], v[148:151], v[64:67]
    ds_read_b128 v[40:43], v3 offset:31744
    s_mov_b32 s4, s5
    v_mfma_f32_16x16x32_bf16 v[64:67], a[28:31], v[152:155], v[64:67]
    s_add_u32 s53, s98, 327680
    s_mov_b32 s5, s6
    v_mfma_f32_16x16x32_bf16 v[64:67], a[36:39], v[156:159], v[64:67]
    ds_read_b128 v[44:47], v2 offset:34816
    s_mov_b32 s6, s7
    v_mfma_f32_16x16x32_bf16 v[64:67], a[44:47], v[160:163], v[64:67]
    buffer_load_dwordx4 a[84:87], v24, s[24:27], s53 offen offset:0 sc1
    v_mfma_f32_16x16x32_bf16 v[60:63], a[48:51], v[76:79], v[60:63]
    ds_read_b128 v[48:51], v3 offset:4096
    s_mov_b32 s7, s74
    v_mfma_f32_16x16x32_bf16 v[60:63], a[56:59], v[80:83], v[60:63]
    v_mov_b32 v25, 0x40000000
    v_bfe_u32 v4, v24, 4, 3
    v_mfma_f32_16x16x32_bf16 v[60:63], a[64:67], v[84:87], v[60:63]
    ds_read_b128 v[52:55], v3 offset:22528
    v_lshlrev_b32 v4, 3, v4
    v_mfma_f32_16x16x32_bf16 v[60:63], a[72:75], v[88:91], v[60:63]
    buffer_load_dwordx4 a[88:91], v24, s[24:27], s53 offen offset:1024 sc1
    v_mfma_f32_16x16x32_bf16 v[64:67], a[52:55], v[76:79], v[64:67]
    ds_read_b128 v[56:59], v3 offset:40960
    s_add_u32 s53, s98, 368640
    v_mfma_f32_16x16x32_bf16 v[64:67], a[60:63], v[80:83], v[64:67]
    v_bfe_u32 v244, v24, 4, 4
    s_movk_i32 s40, 1280
    v_mfma_f32_16x16x32_bf16 v[64:67], a[68:71], v[84:87], v[64:67]
    ds_read_b128 v[148:151], v2 offset:26624
    v_mul_lo_u32 v5, v244, s40
    v_mfma_f32_16x16x32_bf16 v[64:67], a[76:79], v[88:91], v[64:67]
    buffer_load_dwordx4 a[92:95], v24, s[24:27], s53 offen offset:0 sc1
    s_waitcnt lgkmcnt(2)
    v_mfma_f32_16x16x32_bf16 v[68:71], a[16:19], v[28:31], v[68:71]
    ds_read_b128 v[152:155], v2 offset:45056
    v_lshrrev_b32 v245, 8, v24
    v_mfma_f32_16x16x32_bf16 v[68:71], a[24:27], v[32:35], v[68:71]
    v_lshl_add_u32 v5, v245, 4, v5
    v_lshrrev_b32 v246, 2, v244
    v_mfma_f32_16x16x32_bf16 v[68:71], a[32:35], v[36:39], v[68:71]
    v_cvt_pk_bf16_f32 v60, v60, v61
    v_cvt_pk_bf16_f32 v61, v62, v63
    v_mfma_f32_16x16x32_bf16 v[68:71], a[40:43], v[40:43], v[68:71]
    v_cvt_pk_bf16_f32 v62, v64, v65
    v_cvt_pk_bf16_f32 v63, v66, v67
    v_mfma_f32_16x16x32_bf16 v[72:75], a[20:23], v[28:31], v[72:75]
    ds_read_b128 v[156:159], v3 offset:14336
    v_xor_b32 v246, v246, v245
    v_mfma_f32_16x16x32_bf16 v[72:75], a[28:31], v[32:35], v[72:75]
    ds_read_b128 v[160:163], v3 offset:32768
    v_lshl_add_u32 v246, v244, 2, v246
    v_mfma_f32_16x16x32_bf16 v[72:75], a[36:39], v[36:39], v[72:75]
    buffer_load_dwordx4 a[96:99], v24, s[24:27], s53 offen offset:1024 sc1
    v_mfma_f32_16x16x32_bf16 v[72:75], a[44:47], v[40:43], v[72:75]
    ds_read_b128 v[76:79], v2 offset:35840
    s_add_u32 s53, s98, 409600
    v_mfma_f32_16x16x32_bf16 v[68:71], a[48:51], v[44:47], v[68:71]
    ds_read_b128 v[80:83], v3 offset:5120
    s_lshl_b32 s41, s3, 12
    v_mfma_f32_16x16x32_bf16 v[68:71], a[56:59], v[48:51], v[68:71]
    buffer_load_dwordx4 a[100:103], v24, s[24:27], s53 offen offset:0 sc1
    v_mfma_f32_16x16x32_bf16 v[68:71], a[64:67], v[52:55], v[68:71]
    ds_read_b128 v[84:87], v3 offset:23552
    s_add_u32 s41, s41, 147456
    s_waitcnt lgkmcnt(3)
    v_mfma_f32_16x16x32_bf16 v[68:71], a[72:75], v[56:59], v[68:71]
    v_lshl_add_u32 v237, v246, 4, s41
    v_add_u32 v238, s41, v24
    v_mfma_f32_16x16x32_bf16 v[72:75], a[52:55], v[44:47], v[72:75]
    buffer_load_dwordx4 a[104:107], v24, s[24:27], s53 offen offset:1024 sc1
    v_mfma_f32_16x16x32_bf16 v[72:75], a[60:63], v[48:51], v[72:75]
    ds_read_b128 v[88:91], v3 offset:41984
    s_add_u32 s53, s98, 450560
    v_mfma_f32_16x16x32_bf16 v[72:75], a[68:71], v[52:55], v[72:75]
    ds_read_b128 v[28:31], v2 offset:27648
    v_lshrrev_b32 v246, 6, v24
    v_mfma_f32_16x16x32_bf16 v[72:75], a[76:79], v[56:59], v[72:75]
    buffer_load_dwordx4 a[108:111], v24, s[24:27], s53 offen offset:0 sc1
    v_mfma_f32_16x16x32_bf16 v[92:95], a[16:19], v[148:151], v[92:95]
    ds_read_b128 v[32:35], v2 offset:46080
    v_mul_lo_u32 v5, v246, s40
    v_mfma_f32_16x16x32_bf16 v[92:95], a[24:27], v[152:155], v[92:95]
    v_and_b32 v246, 3, v244
    v_xor_b32 v246, v246, v245
    v_mfma_f32_16x16x32_bf16 v[92:95], a[32:35], v[156:159], v[92:95]
    buffer_load_dwordx4 a[112:115], v24, s[24:27], s53 offen offset:1024 sc1
    v_mfma_f32_16x16x32_bf16 v[92:95], a[40:43], v[160:163], v[92:95]
    v_cvt_pk_bf16_f32 v68, v68, v69
    v_cvt_pk_bf16_f32 v69, v70, v71
    v_cvt_pk_bf16_f32 v70, v72, v73
    v_cvt_pk_bf16_f32 v71, v74, v75
    v_mfma_f32_16x16x32_bf16 v[96:99], a[20:23], v[148:151], v[96:99]
    ds_read_b128 v[36:39], v3 offset:15360
    s_add_u32 s53, s98, 491520
    v_mfma_f32_16x16x32_bf16 v[96:99], a[28:31], v[152:155], v[96:99]
    buffer_load_dwordx4 a[116:119], v24, s[24:27], s53 offen offset:0 sc1
    v_mfma_f32_16x16x32_bf16 v[96:99], a[36:39], v[156:159], v[96:99]
    ds_read_b128 v[40:43], v3 offset:33792
    v_lshl_add_u32 v5, v246, 4, v5
    v_mfma_f32_16x16x32_bf16 v[96:99], a[44:47], v[160:163], v[96:99]
    s_waitcnt lgkmcnt(2)
    ds_read_b128 v[44:47], v2 offset:36864
    v_mov_b32 v8, s48
    v_mfma_f32_16x16x32_bf16 v[92:95], a[48:51], v[76:79], v[92:95]
    buffer_load_dwordx4 a[120:123], v24, s[24:27], s53 offen offset:1024 sc1
    v_mfma_f32_16x16x32_bf16 v[92:95], a[56:59], v[80:83], v[92:95]
    ds_read_b128 v[48:51], v3 offset:6144
    s_add_u32 s53, s98, 532480
    v_mfma_f32_16x16x32_bf16 v[92:95], a[64:67], v[84:87], v[92:95]
    ds_read_b128 v[52:55], v3 offset:24576
    v_mov_b32 v9, s49
    v_mfma_f32_16x16x32_bf16 v[92:95], a[72:75], v[88:91], v[92:95]
    buffer_load_dwordx4 a[124:127], v24, s[24:27], s53 offen offset:0 sc1
    v_mfma_f32_16x16x32_bf16 v[96:99], a[52:55], v[76:79], v[96:99]
    ds_read_b128 v[56:59], v3 offset:43008
    v_and_b32 v246, 1, v244
    v_mfma_f32_16x16x32_bf16 v[96:99], a[60:63], v[80:83], v[96:99]
    v_lshlrev_b32 v246, 4, v246
    s_movk_i32 s40, 0x3f80
    v_mfma_f32_16x16x32_bf16 v[96:99], a[68:71], v[84:87], v[96:99]
    buffer_load_dwordx4 a[128:131], v24, s[24:27], s53 offen offset:1024 sc1
    v_mfma_f32_16x16x32_bf16 v[96:99], a[76:79], v[88:91], v[96:99]
    ds_read_b128 v[148:151], v2 offset:28672
    s_add_u32 s53, s98, 573440
    v_mfma_f32_16x16x32_bf16 v[100:103], a[16:19], v[28:31], v[100:103]
    ds_read_b128 v[152:155], v2 offset:47104
    v_lshlrev_b32 v246, v246, s40
    v_mfma_f32_16x16x32_bf16 v[100:103], a[24:27], v[32:35], v[100:103]
    buffer_load_dwordx4 a[132:135], v24, s[24:27], s53 offen offset:0 sc1
    s_waitcnt lgkmcnt(2)
    v_mfma_f32_16x16x32_bf16 v[100:103], a[32:35], v[36:39], v[100:103]
    v_cvt_pk_bf16_f32 v92, v92, v93
    v_cvt_pk_bf16_f32 v93, v94, v95
    v_mfma_f32_16x16x32_bf16 v[100:103], a[40:43], v[40:43], v[100:103]
    v_cvt_pk_bf16_f32 v94, v96, v97
    v_cvt_pk_bf16_f32 v95, v98, v99
    v_mfma_f32_16x16x32_bf16 v[104:107], a[20:23], v[28:31], v[104:107]
    ds_read_b128 v[156:159], v3 offset:16384
    v_lshrrev_b32 v244, 1, v244
    v_mfma_f32_16x16x32_bf16 v[104:107], a[28:31], v[32:35], v[104:107]
    buffer_load_dwordx4 a[136:139], v24, s[24:27], s53 offen offset:1024 sc1
    v_mfma_f32_16x16x32_bf16 v[104:107], a[36:39], v[36:39], v[104:107]
    ds_read_b128 v[160:163], v3 offset:34816
    s_add_u32 s53, s98, 614400
    v_mfma_f32_16x16x32_bf16 v[104:107], a[44:47], v[40:43], v[104:107]
    ds_read_b128 v[76:79], v2 offset:37888
    v_lshlrev_b32 v245, 1, v245
    v_mfma_f32_16x16x32_bf16 v[100:103], a[48:51], v[44:47], v[100:103]
    buffer_store_dwordx4 v[60:63], v1, s[24:27], s62 offen offset:0 sc1
    v_mfma_f32_16x16x32_bf16 v[100:103], a[56:59], v[48:51], v[100:103]
    ds_read_b128 v[80:83], v3 offset:7168
    v_sub_u32 v244, v244, v245
    v_mfma_f32_16x16x32_bf16 v[100:103], a[64:67], v[52:55], v[100:103]
    ds_read_b128 v[84:87], v3 offset:25600
    v_mfma_f32_16x16x32_bf16 v[100:103], a[72:75], v[56:59], v[100:103]
    buffer_load_dwordx4 a[140:143], v24, s[24:27], s53 offen offset:0 sc1
    v_mfma_f32_16x16x32_bf16 v[104:107], a[52:55], v[44:47], v[104:107]
    ds_read_b128 v[88:91], v3 offset:44032
    v_mfma_f32_16x16x32_bf16 v[104:107], a[60:63], v[48:51], v[104:107]
    v_cmp_eq_u32 vcc, 0, v244
    v_mov_b32 v18, 0
    v_mov_b32 v22, 0
    v_cndmask_b32 v20, 0, v246, vcc
    v_mfma_f32_16x16x32_bf16 v[104:107], a[68:71], v[52:55], v[104:107]
    buffer_load_dwordx4 a[180:183], v24, s[24:27], s53 offen offset:1024 sc1
    v_mfma_f32_16x16x32_bf16 v[104:107], a[76:79], v[56:59], v[104:107]
    s_waitcnt lgkmcnt(1)
    ds_read_b128 v[28:31], v2 offset:29696
    v_mfma_f32_16x16x32_bf16 v[108:111], a[16:19], v[148:151], v[108:111]
    ds_read_b128 v[32:35], v2 offset:48128
    v_mfma_f32_16x16x32_bf16 v[108:111], a[24:27], v[152:155], v[108:111]
    buffer_store_dwordx4 v[68:71], v1, s[24:27], s63 offen offset:0 sc1
    v_mfma_f32_16x16x32_bf16 v[108:111], a[32:35], v[156:159], v[108:111]
    v_cvt_pk_bf16_f32 v100, v100, v101
    v_cvt_pk_bf16_f32 v101, v102, v103
    v_mfma_f32_16x16x32_bf16 v[108:111], a[40:43], v[160:163], v[108:111]
    v_cvt_pk_bf16_f32 v102, v104, v105
    v_cvt_pk_bf16_f32 v103, v106, v107
    v_mfma_f32_16x16x32_bf16 v[112:115], a[20:23], v[148:151], v[112:115]
    ds_read_b128 v[36:39], v3 offset:17408
    v_mfma_f32_16x16x32_bf16 v[112:115], a[28:31], v[152:155], v[112:115]
    ds_read_b128 v[40:43], v3 offset:35840
    v_mfma_f32_16x16x32_bf16 v[112:115], a[36:39], v[156:159], v[112:115]
    ds_read_b128 v[44:47], v2 offset:38912
    v_mfma_f32_16x16x32_bf16 v[112:115], a[44:47], v[160:163], v[112:115]
    v_cmp_eq_u32 vcc, 1, v244
    v_mov_b32 v19, 0
    v_mov_b32 v23, 0
    v_cndmask_b32 v21, 0, v246, vcc
    v_mfma_f32_16x16x32_bf16 v[108:111], a[48:51], v[76:79], v[108:111]
    buffer_store_dwordx4 v[92:95], v1, s[24:27], s64 offen offset:0 sc1
    v_mfma_f32_16x16x32_bf16 v[108:111], a[56:59], v[80:83], v[108:111]
    ds_read_b128 v[48:51], v3 offset:8192
    v_mfma_f32_16x16x32_bf16 v[108:111], a[64:67], v[84:87], v[108:111]
    s_waitcnt lgkmcnt(2)
    ds_read_b128 v[52:55], v3 offset:26624
    v_mfma_f32_16x16x32_bf16 v[108:111], a[72:75], v[88:91], v[108:111]
    v_mfma_f32_16x16x32_bf16 v[112:115], a[52:55], v[76:79], v[112:115]
    ds_read_b128 v[56:59], v3 offset:45056
    v_mfma_f32_16x16x32_bf16 v[112:115], a[60:63], v[80:83], v[112:115]
    v_mfma_f32_16x16x32_bf16 v[112:115], a[68:71], v[84:87], v[112:115]
    ds_read_b128 v[148:151], v2 offset:30720
    v_mfma_f32_16x16x32_bf16 v[112:115], a[76:79], v[88:91], v[112:115]
    v_mfma_f32_16x16x32_bf16 v[116:119], a[16:19], v[28:31], v[116:119]
    buffer_store_dwordx4 v[100:103], v1, s[24:27], s65 offen offset:0 sc1
    v_mfma_f32_16x16x32_bf16 v[116:119], a[24:27], v[32:35], v[116:119]
    ds_read_b128 v[152:155], v3 offset:0
    v_mfma_f32_16x16x32_bf16 v[116:119], a[32:35], v[36:39], v[116:119]
    v_cvt_pk_bf16_f32 v108, v108, v109
    v_cvt_pk_bf16_f32 v109, v110, v111
    v_mfma_f32_16x16x32_bf16 v[116:119], a[40:43], v[40:43], v[116:119]
    v_cvt_pk_bf16_f32 v110, v112, v113
    v_cvt_pk_bf16_f32 v111, v114, v115
    v_mfma_f32_16x16x32_bf16 v[120:123], a[20:23], v[28:31], v[120:123]
    ds_read_b128 v[156:159], v3 offset:18432
    v_mfma_f32_16x16x32_bf16 v[120:123], a[28:31], v[32:35], v[120:123]
    ds_read_b128 v[160:163], v3 offset:36864
    v_mfma_f32_16x16x32_bf16 v[120:123], a[36:39], v[36:39], v[120:123]
    ds_read_b128 v[76:79], v2 offset:39936
    v_mfma_f32_16x16x32_bf16 v[120:123], a[44:47], v[40:43], v[120:123]
    s_waitcnt lgkmcnt(3)
    v_mfma_f32_16x16x32_bf16 v[116:119], a[48:51], v[44:47], v[116:119]
    buffer_store_dwordx4 v[108:111], v1, s[24:27], s66 offen offset:0 sc1
    v_mfma_f32_16x16x32_bf16 v[116:119], a[56:59], v[48:51], v[116:119]
    ds_read_b128 v[80:83], v3 offset:9216
    v_mfma_f32_16x16x32_bf16 v[116:119], a[64:67], v[52:55], v[116:119]
    ds_read_b128 v[84:87], v3 offset:27648
    v_mfma_f32_16x16x32_bf16 v[116:119], a[72:75], v[56:59], v[116:119]
    v_mfma_f32_16x16x32_bf16 v[120:123], a[52:55], v[44:47], v[120:123]
    ds_read_b128 v[88:91], v3 offset:46080
    v_mfma_f32_16x16x32_bf16 v[120:123], a[60:63], v[48:51], v[120:123]
    v_mfma_f32_16x16x32_bf16 v[120:123], a[68:71], v[52:55], v[120:123]
    ds_read_b128 v[28:31], v2 offset:31744
    v_mfma_f32_16x16x32_bf16 v[120:123], a[76:79], v[56:59], v[120:123]
    v_mfma_f32_16x16x32_bf16 v[132:135], a[16:19], v[148:151], v[132:135]
    ds_read_b128 v[32:35], v3 offset:1024
    v_mfma_f32_16x16x32_bf16 v[132:135], a[24:27], v[152:155], v[132:135]
    s_waitcnt lgkmcnt(5)
    v_mfma_f32_16x16x32_bf16 v[132:135], a[32:35], v[156:159], v[132:135]
    v_cvt_pk_bf16_f32 v116, v116, v117
    v_cvt_pk_bf16_f32 v117, v118, v119
    v_mfma_f32_16x16x32_bf16 v[132:135], a[40:43], v[160:163], v[132:135]
    v_cvt_pk_bf16_f32 v118, v120, v121
    v_cvt_pk_bf16_f32 v119, v122, v123
    v_mfma_f32_16x16x32_bf16 v[136:139], a[20:23], v[148:151], v[136:139]
    buffer_store_dwordx4 v[116:119], v1, s[24:27], s67 offen offset:0 sc1
    ds_read_b128 v[36:39], v3 offset:19456
    v_mfma_f32_16x16x32_bf16 v[136:139], a[28:31], v[152:155], v[136:139]
    ds_read_b128 v[40:43], v3 offset:37888
    v_mfma_f32_16x16x32_bf16 v[136:139], a[36:39], v[156:159], v[136:139]
    ds_read_b128 v[44:47], v2 offset:40960
    v_mfma_f32_16x16x32_bf16 v[136:139], a[44:47], v[160:163], v[136:139]
    v_mfma_f32_16x16x32_bf16 v[132:135], a[48:51], v[76:79], v[132:135]
    s_waitcnt lgkmcnt(3)
    ds_read_b128 v[48:51], v3 offset:10240
    v_mfma_f32_16x16x32_bf16 v[132:135], a[56:59], v[80:83], v[132:135]
    v_mfma_f32_16x16x32_bf16 v[132:135], a[64:67], v[84:87], v[132:135]
    ds_read_b128 v[52:55], v3 offset:28672
    v_mfma_f32_16x16x32_bf16 v[132:135], a[72:75], v[88:91], v[132:135]
    v_mfma_f32_16x16x32_bf16 v[136:139], a[52:55], v[76:79], v[136:139]
    ds_read_b128 v[56:59], v3 offset:47104
    v_mfma_f32_16x16x32_bf16 v[136:139], a[60:63], v[80:83], v[136:139]
    v_mfma_f32_16x16x32_bf16 v[136:139], a[68:71], v[84:87], v[136:139]
    ds_read_b128 v[148:151], v2 offset:32768
    v_mfma_f32_16x16x32_bf16 v[136:139], a[76:79], v[88:91], v[136:139]
    v_mfma_f32_16x16x32_bf16 v[140:143], a[16:19], v[28:31], v[140:143]
    ds_read_b128 v[152:155], v3 offset:2048
    v_mfma_f32_16x16x32_bf16 v[140:143], a[24:27], v[32:35], v[140:143]
    s_waitcnt lgkmcnt(4)
    v_mfma_f32_16x16x32_bf16 v[140:143], a[32:35], v[36:39], v[140:143]
    v_cvt_pk_bf16_f32 v132, v132, v133
    v_cvt_pk_bf16_f32 v133, v134, v135
    v_mfma_f32_16x16x32_bf16 v[140:143], a[40:43], v[40:43], v[140:143]
    v_cvt_pk_bf16_f32 v134, v136, v137
    v_cvt_pk_bf16_f32 v135, v138, v139
    v_mfma_f32_16x16x32_bf16 v[144:147], a[20:23], v[28:31], v[144:147]
    buffer_store_dwordx4 v[132:135], v1, s[24:27], s68 offen offset:0 sc1
    ds_read_b128 v[156:159], v3 offset:20480
    v_mfma_f32_16x16x32_bf16 v[144:147], a[28:31], v[32:35], v[144:147]
    ds_read_b128 v[160:163], v3 offset:38912
    v_mfma_f32_16x16x32_bf16 v[144:147], a[36:39], v[36:39], v[144:147]
    ds_read_b128 v[76:79], v2 offset:41984
    v_mfma_f32_16x16x32_bf16 v[144:147], a[44:47], v[40:43], v[144:147]
    v_mfma_f32_16x16x32_bf16 v[140:143], a[48:51], v[44:47], v[140:143]
    ds_read_b128 v[80:83], v3 offset:11264
    v_mfma_f32_16x16x32_bf16 v[140:143], a[56:59], v[48:51], v[140:143]
    s_waitcnt lgkmcnt(4)
    v_mfma_f32_16x16x32_bf16 v[140:143], a[64:67], v[52:55], v[140:143]
    ds_read_b128 v[84:87], v3 offset:29696
    v_mfma_f32_16x16x32_bf16 v[140:143], a[72:75], v[56:59], v[140:143]
    v_mfma_f32_16x16x32_bf16 v[144:147], a[52:55], v[44:47], v[144:147]
    ds_read_b128 v[88:91], v3 offset:48128
    v_mfma_f32_16x16x32_bf16 v[144:147], a[60:63], v[48:51], v[144:147]
    v_mfma_f32_16x16x32_bf16 v[144:147], a[68:71], v[52:55], v[144:147]
    ds_read_b128 v[28:31], v24 offset:0
    v_mfma_f32_16x16x32_bf16 v[144:147], a[76:79], v[56:59], v[144:147]
    v_mfma_f32_16x16x32_bf16 v[124:127], a[16:19], v[148:151], v[124:127]
    ds_read_b128 v[32:35], v24 offset:18432
    v_mfma_f32_16x16x32_bf16 v[124:127], a[24:27], v[152:155], v[124:127]
    s_waitcnt lgkmcnt(4)
    v_mfma_f32_16x16x32_bf16 v[124:127], a[32:35], v[156:159], v[124:127]
    v_cvt_pk_bf16_f32 v140, v140, v141
    v_cvt_pk_bf16_f32 v141, v142, v143
    v_mfma_f32_16x16x32_bf16 v[124:127], a[40:43], v[160:163], v[124:127]
    v_cvt_pk_bf16_f32 v142, v144, v145
    v_cvt_pk_bf16_f32 v143, v146, v147
    v_mfma_f32_16x16x32_bf16 v[128:131], a[20:23], v[148:151], v[128:131]
    buffer_store_dwordx4 v[140:143], v1, s[24:27], s69 offen offset:0 sc1
    ds_read_b128 v[36:39], v24 offset:36864
    v_mfma_f32_16x16x32_bf16 v[128:131], a[28:31], v[152:155], v[128:131]
    ds_read_b128 v[40:43], v2 offset:6144
    s_mov_b32 s76, s98
    v_mfma_f32_16x16x32_bf16 v[128:131], a[36:39], v[156:159], v[128:131]
    ds_read_b128 v[44:47], v24 offset:9216
    s_add_u32 s73, s73, 128
    v_mfma_f32_16x16x32_bf16 v[128:131], a[44:47], v[160:163], v[128:131]
    s_add_u32 s72, s72, 128
    s_add_u32 s71, s71, 1
    v_mfma_f32_16x16x32_bf16 v[124:127], a[48:51], v[76:79], v[124:127]
    ds_read_b128 v[48:51], v24 offset:27648
    v_mfma_f32_16x16x32_bf16 v[124:127], a[56:59], v[80:83], v[124:127]
    s_waitcnt lgkmcnt(4)
    v_mfma_f32_16x16x32_bf16 v[124:127], a[64:67], v[84:87], v[124:127]
    ds_read_b128 v[52:55], v24 offset:46080
    v_mfma_f32_16x16x32_bf16 v[124:127], a[72:75], v[88:91], v[124:127]
    v_mfma_f32_16x16x32_bf16 v[128:131], a[52:55], v[76:79], v[128:131]
    ds_read_b128 v[56:59], v2 offset:15360
    v_mfma_f32_16x16x32_bf16 v[128:131], a[60:63], v[80:83], v[128:131]
    v_mfma_f32_16x16x32_bf16 v[128:131], a[68:71], v[84:87], v[128:131]
    v_mfma_f32_16x16x32_bf16 v[128:131], a[76:79], v[88:91], v[128:131]
    s_branch gqa_kernel_pass1
gqa_kernel_pass0:
    s_waitcnt vmcnt(35)
    s_waitcnt lgkmcnt(3)
    v_mfma_f32_16x16x32_bf16 v[92:95], a[216:219], v[28:31], 0
    s_add_u32 s76, s76, 8192
    s_sub_u32 s45, s101, 40960
    s_cmp_eq_u32 s76, s101
    s_cselect_b32 s76, s45, s76
    ds_read_b128 v[60:63], v2 offset:24576
    v_mfma_f32_16x16x32_bf16 v[92:95], a[224:227], v[32:35], v[92:95]
    s_cmp_eq_u32 s71, 4
    s_cselect_b32 s76, 0x40000000, s76
    v_mfma_f32_16x16x32_bf16 v[92:95], a[232:235], v[36:39], v[92:95]
    ds_read_b128 v[64:67], v2 offset:43008
    v_mfma_f32_16x16x32_bf16 v[92:95], a[240:243], v[40:43], v[92:95]
    ds_read_b128 v[68:71], v3 offset:12288
    v_cvt_pk_bf16_f32 v124, v124, v125
    v_mfma_f32_16x16x32_bf16 v[96:99], a[244:247], v[40:43], 0
    s_add_u32 s53, s76, 0
    ds_read_b128 v[72:75], v3 offset:30720
    v_mfma_f32_16x16x32_bf16 v[96:99], a[236:239], v[36:39], v[96:99]
    buffer_load_dwordx4 a[160:163], v24, s[24:27], s53 offen offset:0 sc1
    v_mfma_f32_16x16x32_bf16 v[96:99], a[228:231], v[32:35], v[96:99]
    ds_read_b128 v[76:79], v2 offset:33792
    v_cvt_pk_bf16_f32 v125, v126, v127
    v_mfma_f32_16x16x32_bf16 v[96:99], a[220:223], v[28:31], v[96:99]
    v_cvt_pk_bf16_f32 v126, v128, v129
    v_cvt_pk_bf16_f32 v127, v130, v131
    v_mfma_f32_16x16x32_bf16 v[96:99], a[252:255], v[44:47], v[96:99]
    s_waitcnt lgkmcnt(2)
    ds_read_b128 v[80:83], v3 offset:3072
    v_mfma_f32_16x16x32_bf16 v[96:99], v[14:17], v[48:51], v[96:99]
    buffer_store_dwordx4 v[124:127], v1, s[24:27], s70 offen offset:0 sc1
    v_mfma_f32_16x16x32_bf16 v[96:99], a[4:7], v[52:55], v[96:99]
    ds_read_b128 v[84:87], v3 offset:21504
    v_add_u32 v1, s4, v24
    v_mfma_f32_16x16x32_bf16 v[96:99], a[12:15], v[56:59], v[96:99]
    s_mov_b32 s4, s5
    s_mov_b32 s5, s6
    v_mfma_f32_16x16x32_bf16 v[92:95], a[8:11], v[56:59], v[92:95]
    ds_read_b128 v[88:91], v3 offset:39936
    s_mov_b32 s6, s7
    v_mfma_f32_16x16x32_bf16 v[92:95], a[0:3], v[52:55], v[92:95]
    buffer_load_dwordx4 a[164:167], v24, s[24:27], s53 offen offset:1024 sc1
    v_mfma_f32_16x16x32_bf16 v[92:95], v[10:13], v[48:51], v[92:95]
    ds_read_b128 v[28:31], v24 offset:1024
    s_mov_b32 s7, s74
    v_mfma_f32_16x16x32_bf16 v[92:95], a[248:251], v[44:47], v[92:95]
    s_waitcnt vmcnt(28)
    v_mfma_f32_16x16x32_bf16 v[92:95], a[16:19], v[60:63], v[92:95]
    s_add_u32 s53, s76, 40960
    ds_read_b128 v[32:35], v24 offset:19456
    v_mfma_f32_16x16x32_bf16 v[92:95], a[24:27], v[64:67], v[92:95]
    buffer_load_dwordx4 a[168:171], v24, s[24:27], s53 offen offset:0 sc1
    v_mfma_f32_16x16x32_bf16 v[92:95], a[32:35], v[68:71], v[92:95]
    s_waitcnt lgkmcnt(2)
    ds_read_b128 v[36:39], v24 offset:37888
    v_mfma_f32_16x16x32_bf16 v[92:95], a[40:43], v[72:75], v[92:95]
    v_mfma_f32_16x16x32_bf16 v[96:99], a[44:47], v[72:75], v[96:99]
    ds_read_b128 v[40:43], v2 offset:7168
    v_mfma_f32_16x16x32_bf16 v[96:99], a[36:39], v[68:71], v[96:99]
    v_mfma_f32_16x16x32_bf16 v[96:99], a[28:31], v[64:67], v[96:99]
    buffer_load_dwordx4 a[172:175], v24, s[24:27], s53 offen offset:1024 sc1
    v_mfma_f32_16x16x32_bf16 v[96:99], a[20:23], v[60:63], v[96:99]
    s_waitcnt vmcnt(20)
    ds_read_b128 v[44:47], v24 offset:10240
    v_mfma_f32_16x16x32_bf16 v[96:99], a[52:55], v[76:79], v[96:99]
    ds_read_b128 v[48:51], v24 offset:28672
    v_mfma_f32_16x16x32_bf16 v[96:99], a[60:63], v[80:83], v[96:99]
    v_mfma_f32_16x16x32_bf16 v[96:99], a[68:71], v[84:87], v[96:99]
    ds_read_b128 v[52:55], v24 offset:47104
    v_mfma_f32_16x16x32_bf16 v[96:99], a[76:79], v[88:91], v[96:99]
    v_mfma_f32_16x16x32_bf16 v[92:95], a[72:75], v[88:91], v[92:95]
    s_add_u32 s53, s76, 81920
    ds_read_b128 v[56:59], v2 offset:16384
    v_mfma_f32_16x16x32_bf16 v[92:95], a[64:67], v[84:87], v[92:95]
    buffer_load_dwordx4 a[176:179], v24, s[24:27], s53 offen offset:0 sc1
    v_mfma_f32_16x16x32_bf16 v[92:95], a[56:59], v[80:83], v[92:95]
    ds_read_b128 v[60:63], v2 offset:25600
    v_mfma_f32_16x16x32_bf16 v[92:95], a[48:51], v[76:79], v[92:95]
    s_waitcnt lgkmcnt(4)
    v_mfma_f32_16x16x32_bf16 v[100:103], a[216:219], v[28:31], 0
    ds_read_b128 v[64:67], v2 offset:44032
    v_mfma_f32_16x16x32_bf16 v[100:103], a[224:227], v[32:35], v[100:103]
    v_mfma_f32_16x16x32_bf16 v[100:103], a[232:235], v[36:39], v[100:103]
    buffer_load_dwordx4 a[184:187], v24, s[24:27], s53 offen offset:1024 sc1
    v_mfma_f32_16x16x32_bf16 v[100:103], a[240:243], v[40:43], v[100:103]
    ds_read_b128 v[68:71], v3 offset:13312
    v_cvt_pk_bf16_f32 v92, v92, v93
    v_mfma_f32_16x16x32_bf16 v[104:107], a[244:247], v[40:43], 0
    ds_read_b128 v[72:75], v3 offset:31744
    v_cvt_pk_bf16_f32 v93, v94, v95
    v_mfma_f32_16x16x32_bf16 v[104:107], a[236:239], v[36:39], v[104:107]
    v_cvt_pk_bf16_f32 v94, v96, v97
    v_cvt_pk_bf16_f32 v95, v98, v99
    v_mfma_f32_16x16x32_bf16 v[104:107], a[228:231], v[32:35], v[104:107]
    buffer_store_dwordx4 v[92:95], v1, s[24:27], s62 offen offset:0 sc1
    v_mfma_f32_16x16x32_bf16 v[104:107], a[220:223], v[28:31], v[104:107]
    ds_read_b128 v[76:79], v2 offset:34816
    v_mfma_f32_16x16x32_bf16 v[104:107], a[252:255], v[44:47], v[104:107]
    s_add_u32 s53, s76, 122880
    ds_read_b128 v[80:83], v3 offset:4096
    s_waitcnt lgkmcnt(3)
    v_mfma_f32_16x16x32_bf16 v[104:107], v[14:17], v[48:51], v[104:107]
    v_mfma_f32_16x16x32_bf16 v[104:107], a[4:7], v[52:55], v[104:107]
    buffer_load_dwordx4 a[188:191], v24, s[24:27], s53 offen offset:0 sc1
    v_mfma_f32_16x16x32_bf16 v[104:107], a[12:15], v[56:59], v[104:107]
    ds_read_b128 v[84:87], v3 offset:22528
    v_mfma_f32_16x16x32_bf16 v[100:103], a[8:11], v[56:59], v[100:103]
    ds_read_b128 v[88:91], v3 offset:40960
    v_mfma_f32_16x16x32_bf16 v[100:103], a[0:3], v[52:55], v[100:103]
    v_mfma_f32_16x16x32_bf16 v[100:103], v[10:13], v[48:51], v[100:103]
    buffer_load_dwordx4 a[192:195], v24, s[24:27], s53 offen offset:1024 sc1
    v_mfma_f32_16x16x32_bf16 v[100:103], a[248:251], v[44:47], v[100:103]
    ds_read_b128 v[28:31], v24 offset:2048
    v_mfma_f32_16x16x32_bf16 v[100:103], a[16:19], v[60:63], v[100:103]
    ds_read_b128 v[32:35], v24 offset:20480
    v_mfma_f32_16x16x32_bf16 v[100:103], a[24:27], v[64:67], v[100:103]
    v_mfma_f32_16x16x32_bf16 v[100:103], a[32:35], v[68:71], v[100:103]
    s_waitcnt lgkmcnt(4)
    ds_read_b128 v[36:39], v24 offset:38912
    v_mfma_f32_16x16x32_bf16 v[100:103], a[40:43], v[72:75], v[100:103]
    v_mfma_f32_16x16x32_bf16 v[104:107], a[44:47], v[72:75], v[104:107]
    s_add_u32 s53, s76, 163840
    ds_read_b128 v[40:43], v2 offset:8192
    v_mfma_f32_16x16x32_bf16 v[104:107], a[36:39], v[68:71], v[104:107]
    buffer_load_dwordx4 a[196:199], v24, s[24:27], s53 offen offset:0 sc1
    v_mfma_f32_16x16x32_bf16 v[104:107], a[28:31], v[64:67], v[104:107]
    ds_read_b128 v[44:47], v24 offset:11264
    v_mfma_f32_16x16x32_bf16 v[104:107], a[20:23], v[60:63], v[104:107]
    s_waitcnt vmcnt(9)
    s_mov_b64 exec, 1
    buffer_store_dwordx2 v[8:9], v24, s[24:27], s72 offen offset:0 sc1
    s_mov_b64 exec, -1
    v_mfma_f32_16x16x32_bf16 v[104:107], a[52:55], v[76:79], v[104:107]
    ds_read_b128 v[48:51], v24 offset:29696
    v_mfma_f32_16x16x32_bf16 v[104:107], a[60:63], v[80:83], v[104:107]
    s_waitcnt lgkmcnt(3)
    v_mfma_f32_16x16x32_bf16 v[104:107], a[68:71], v[84:87], v[104:107]
    buffer_load_dwordx4 a[200:203], v24, s[24:27], s53 offen offset:1024 sc1
    v_mfma_f32_16x16x32_bf16 v[104:107], a[76:79], v[88:91], v[104:107]
    ds_read_b128 v[52:55], v24 offset:48128
    v_mfma_f32_16x16x32_bf16 v[100:103], a[72:75], v[88:91], v[100:103]
    ds_read_b128 v[56:59], v2 offset:17408
    v_mfma_f32_16x16x32_bf16 v[100:103], a[64:67], v[84:87], v[100:103]
    v_mfma_f32_16x16x32_bf16 v[100:103], a[56:59], v[80:83], v[100:103]
    ds_read_b128 v[60:63], v2 offset:26624
    v_mfma_f32_16x16x32_bf16 v[100:103], a[48:51], v[76:79], v[100:103]
    v_mfma_f32_16x16x32_bf16 v[108:111], a[216:219], v[28:31], 0
    s_add_u32 s53, s76, 204800
    ds_read_b128 v[64:67], v2 offset:45056
    v_mfma_f32_16x16x32_bf16 v[108:111], a[224:227], v[32:35], v[108:111]
    buffer_load_dwordx4 a[204:207], v24, s[24:27], s53 offen offset:0 sc1
    v_mfma_f32_16x16x32_bf16 v[108:111], a[232:235], v[36:39], v[108:111]
    s_waitcnt lgkmcnt(3)
    ds_read_b128 v[68:71], v3 offset:14336
    v_mfma_f32_16x16x32_bf16 v[108:111], a[240:243], v[40:43], v[108:111]
    v_cvt_pk_bf16_f32 v100, v100, v101
    v_cvt_pk_bf16_f32 v101, v102, v103
    v_mfma_f32_16x16x32_bf16 v[112:115], a[244:247], v[40:43], 0
    ds_read_b128 v[72:75], v3 offset:32768
    v_cvt_pk_bf16_f32 v102, v104, v105
    v_mfma_f32_16x16x32_bf16 v[112:115], a[236:239], v[36:39], v[112:115]
    v_cvt_pk_bf16_f32 v103, v106, v107
    v_mfma_f32_16x16x32_bf16 v[112:115], a[228:231], v[32:35], v[112:115]
    buffer_store_dwordx4 v[100:103], v1, s[24:27], s63 offen offset:0 sc1
    v_mfma_f32_16x16x32_bf16 v[112:115], a[220:223], v[28:31], v[112:115]
    ds_read_b128 v[76:79], v2 offset:35840
    v_mfma_f32_16x16x32_bf16 v[112:115], a[252:255], v[44:47], v[112:115]
    ds_read_b128 v[80:83], v3 offset:5120
    v_mfma_f32_16x16x32_bf16 v[112:115], v[14:17], v[48:51], v[112:115]
    v_mfma_f32_16x16x32_bf16 v[112:115], a[4:7], v[52:55], v[112:115]
    buffer_load_dwordx4 a[144:147], v24, s[24:27], s53 offen offset:1024 sc1
    s_waitcnt lgkmcnt(3)
    v_mfma_f32_16x16x32_bf16 v[112:115], a[12:15], v[56:59], v[112:115]
    ds_read_b128 v[84:87], v3 offset:23552
    v_mfma_f32_16x16x32_bf16 v[108:111], a[8:11], v[56:59], v[108:111]
    s_add_u32 s53, s76, 245760
    ds_read_b128 v[88:91], v3 offset:41984
    v_mfma_f32_16x16x32_bf16 v[108:111], a[0:3], v[52:55], v[108:111]
    v_mfma_f32_16x16x32_bf16 v[108:111], v[10:13], v[48:51], v[108:111]
    buffer_load_dwordx4 a[148:151], v24, s[24:27], s53 offen offset:0 sc1
    v_mfma_f32_16x16x32_bf16 v[108:111], a[248:251], v[44:47], v[108:111]
    ds_read_b128 v[28:31], v24 offset:3072
    v_mfma_f32_16x16x32_bf16 v[108:111], a[16:19], v[60:63], v[108:111]
    ds_read_b128 v[32:35], v24 offset:21504
    v_mfma_f32_16x16x32_bf16 v[108:111], a[24:27], v[64:67], v[108:111]
    v_mfma_f32_16x16x32_bf16 v[108:111], a[32:35], v[68:71], v[108:111]
    buffer_load_dwordx4 a[152:155], v24, s[24:27], s53 offen offset:1024 sc1
    s_waitcnt lgkmcnt(3)
    v_mfma_f32_16x16x32_bf16 v[108:111], a[40:43], v[72:75], v[108:111]
    ds_read_b128 v[36:39], v24 offset:39936
    v_mfma_f32_16x16x32_bf16 v[112:115], a[44:47], v[72:75], v[112:115]
    ds_read_b128 v[40:43], v2 offset:9216
    v_mfma_f32_16x16x32_bf16 v[112:115], a[36:39], v[68:71], v[112:115]
    v_mfma_f32_16x16x32_bf16 v[112:115], a[28:31], v[64:67], v[112:115]
    ds_read_b128 v[44:47], v24 offset:12288
    v_mfma_f32_16x16x32_bf16 v[112:115], a[20:23], v[60:63], v[112:115]
    v_mfma_f32_16x16x32_bf16 v[112:115], a[52:55], v[76:79], v[112:115]
    s_add_u32 s53, s76, 286720
    ds_read_b128 v[48:51], v24 offset:30720
    v_mfma_f32_16x16x32_bf16 v[112:115], a[60:63], v[80:83], v[112:115]
    buffer_load_dwordx4 a[156:159], v24, s[24:27], s53 offen offset:0 sc1
    v_mfma_f32_16x16x32_bf16 v[112:115], a[68:71], v[84:87], v[112:115]
    s_waitcnt lgkmcnt(3)
    ds_read_b128 v[52:55], v2 offset:0
    v_mfma_f32_16x16x32_bf16 v[112:115], a[76:79], v[88:91], v[112:115]
    v_mfma_f32_16x16x32_bf16 v[108:111], a[72:75], v[88:91], v[108:111]
    ds_read_b128 v[56:59], v2 offset:18432
    v_mfma_f32_16x16x32_bf16 v[108:111], a[64:67], v[84:87], v[108:111]
    v_mfma_f32_16x16x32_bf16 v[108:111], a[56:59], v[80:83], v[108:111]
    buffer_load_dwordx4 a[80:83], v24, s[24:27], s53 offen offset:1024 sc1
    v_mfma_f32_16x16x32_bf16 v[108:111], a[48:51], v[76:79], v[108:111]
    ds_read_b128 v[60:63], v2 offset:27648
    v_mfma_f32_16x16x32_bf16 v[116:119], a[216:219], v[28:31], 0
    ds_read_b128 v[64:67], v2 offset:46080
    v_mfma_f32_16x16x32_bf16 v[116:119], a[224:227], v[32:35], v[116:119]
    v_mfma_f32_16x16x32_bf16 v[116:119], a[232:235], v[36:39], v[116:119]
    s_waitcnt lgkmcnt(3)
    ds_read_b128 v[68:71], v3 offset:15360
    v_mfma_f32_16x16x32_bf16 v[116:119], a[240:243], v[40:43], v[116:119]
    v_cvt_pk_bf16_f32 v108, v108, v109
    v_cvt_pk_bf16_f32 v109, v110, v111
    v_mfma_f32_16x16x32_bf16 v[120:123], a[244:247], v[40:43], 0
    s_add_u32 s53, s76, 327680
    ds_read_b128 v[72:75], v3 offset:33792
    v_mfma_f32_16x16x32_bf16 v[120:123], a[236:239], v[36:39], v[120:123]
    buffer_load_dwordx4 a[84:87], v24, s[24:27], s53 offen offset:0 sc1
    v_mfma_f32_16x16x32_bf16 v[120:123], a[228:231], v[32:35], v[120:123]
    ds_read_b128 v[76:79], v2 offset:36864
    v_cvt_pk_bf16_f32 v110, v112, v113
    v_mfma_f32_16x16x32_bf16 v[120:123], a[220:223], v[28:31], v[120:123]
    v_cvt_pk_bf16_f32 v111, v114, v115
    v_mfma_f32_16x16x32_bf16 v[120:123], a[252:255], v[44:47], v[120:123]
    ds_read_b128 v[80:83], v3 offset:6144
    v_mfma_f32_16x16x32_bf16 v[120:123], v[14:17], v[48:51], v[120:123]
    buffer_store_dwordx4 v[108:111], v1, s[24:27], s64 offen offset:0 sc1
    v_mfma_f32_16x16x32_bf16 v[120:123], a[4:7], v[52:55], v[120:123]
    s_waitcnt lgkmcnt(2)
    ds_read_b128 v[84:87], v3 offset:24576
    v_mfma_f32_16x16x32_bf16 v[120:123], a[12:15], v[56:59], v[120:123]
    s_cmp_eq_u32 s71, 4
    s_cselect_b32 s67, 0x40000000, s67
    s_cselect_b32 s68, 0x40000000, s68
    s_cselect_b32 s69, 0x40000000, s69
    s_cselect_b32 s98, s73, 0x40000000
    v_mfma_f32_16x16x32_bf16 v[116:119], a[8:11], v[56:59], v[116:119]
    ds_read_b128 v[88:91], v3 offset:43008
    v_mfma_f32_16x16x32_bf16 v[116:119], a[0:3], v[52:55], v[116:119]
    buffer_load_dwordx4 a[88:91], v24, s[24:27], s53 offen offset:1024 sc1
    v_mfma_f32_16x16x32_bf16 v[116:119], v[10:13], v[48:51], v[116:119]
    ds_read_b128 v[28:31], v24 offset:4096
    v_mfma_f32_16x16x32_bf16 v[116:119], a[248:251], v[44:47], v[116:119]
    v_mfma_f32_16x16x32_bf16 v[116:119], a[16:19], v[60:63], v[116:119]
    s_add_u32 s53, s76, 368640
    ds_read_b128 v[32:35], v24 offset:22528
    v_mfma_f32_16x16x32_bf16 v[116:119], a[24:27], v[64:67], v[116:119]
    buffer_load_dwordx4 a[92:95], v24, s[24:27], s53 offen offset:0 sc1
    v_mfma_f32_16x16x32_bf16 v[116:119], a[32:35], v[68:71], v[116:119]
    ds_read_b128 v[36:39], v24 offset:40960
    v_mfma_f32_16x16x32_bf16 v[116:119], a[40:43], v[72:75], v[116:119]
    v_mfma_f32_16x16x32_bf16 v[120:123], a[44:47], v[72:75], v[120:123]
    ds_read_b128 v[40:43], v2 offset:10240
    v_mfma_f32_16x16x32_bf16 v[120:123], a[36:39], v[68:71], v[120:123]
    v_mfma_f32_16x16x32_bf16 v[120:123], a[28:31], v[64:67], v[120:123]
    buffer_load_dwordx4 a[96:99], v24, s[24:27], s53 offen offset:1024 sc1
    v_mfma_f32_16x16x32_bf16 v[120:123], a[20:23], v[60:63], v[120:123]
    s_waitcnt lgkmcnt(3)
    ds_read_b128 v[44:47], v24 offset:13312
    v_mfma_f32_16x16x32_bf16 v[120:123], a[52:55], v[76:79], v[120:123]
    ds_read_b128 v[48:51], v24 offset:31744
    v_mfma_f32_16x16x32_bf16 v[120:123], a[60:63], v[80:83], v[120:123]
    v_mfma_f32_16x16x32_bf16 v[120:123], a[68:71], v[84:87], v[120:123]
    ds_read_b128 v[52:55], v2 offset:1024
    v_mfma_f32_16x16x32_bf16 v[120:123], a[76:79], v[88:91], v[120:123]
    v_mfma_f32_16x16x32_bf16 v[116:119], a[72:75], v[88:91], v[116:119]
    s_add_u32 s53, s76, 409600
    ds_read_b128 v[56:59], v2 offset:19456
    v_mfma_f32_16x16x32_bf16 v[116:119], a[64:67], v[84:87], v[116:119]
    buffer_load_dwordx4 a[100:103], v24, s[24:27], s53 offen offset:0 sc1
    v_mfma_f32_16x16x32_bf16 v[116:119], a[56:59], v[80:83], v[116:119]
    ds_read_b128 v[60:63], v2 offset:28672
    v_mfma_f32_16x16x32_bf16 v[116:119], a[48:51], v[76:79], v[116:119]
    v_mfma_f32_16x16x32_bf16 v[92:95], a[216:219], v[28:31], 0
    s_waitcnt lgkmcnt(3)
    ds_read_b128 v[64:67], v2 offset:47104
    v_mfma_f32_16x16x32_bf16 v[92:95], a[224:227], v[32:35], v[92:95]
    v_mfma_f32_16x16x32_bf16 v[92:95], a[232:235], v[36:39], v[92:95]
    buffer_load_dwordx4 a[104:107], v24, s[24:27], s53 offen offset:1024 sc1
    v_mfma_f32_16x16x32_bf16 v[92:95], a[240:243], v[40:43], v[92:95]
    ds_read_b128 v[68:71], v3 offset:16384
    v_cvt_pk_bf16_f32 v116, v116, v117
    v_mfma_f32_16x16x32_bf16 v[96:99], a[244:247], v[40:43], 0
    ds_read_b128 v[72:75], v3 offset:34816
    v_cvt_pk_bf16_f32 v117, v118, v119
    v_mfma_f32_16x16x32_bf16 v[96:99], a[236:239], v[36:39], v[96:99]
    v_cvt_pk_bf16_f32 v118, v120, v121
    v_cvt_pk_bf16_f32 v119, v122, v123
    v_mfma_f32_16x16x32_bf16 v[96:99], a[228:231], v[32:35], v[96:99]
    buffer_store_dwordx4 v[116:119], v1, s[24:27], s65 offen offset:0 sc1
    v_mfma_f32_16x16x32_bf16 v[96:99], a[220:223], v[28:31], v[96:99]
    ds_read_b128 v[76:79], v2 offset:37888
    v_mfma_f32_16x16x32_bf16 v[96:99], a[252:255], v[44:47], v[96:99]
    s_add_u32 s53, s76, 450560
    ds_read_b128 v[80:83], v3 offset:7168
    v_mfma_f32_16x16x32_bf16 v[96:99], v[14:17], v[48:51], v[96:99]
    s_waitcnt lgkmcnt(3)
    v_mfma_f32_16x16x32_bf16 v[96:99], a[4:7], v[52:55], v[96:99]
    buffer_load_dwordx4 a[108:111], v24, s[24:27], s53 offen offset:0 sc1
    v_mfma_f32_16x16x32_bf16 v[96:99], a[12:15], v[56:59], v[96:99]
    ds_read_b128 v[84:87], v3 offset:25600
    v_mfma_f32_16x16x32_bf16 v[92:95], a[8:11], v[56:59], v[92:95]
    ds_read_b128 v[88:91], v3 offset:44032
    v_mfma_f32_16x16x32_bf16 v[92:95], a[0:3], v[52:55], v[92:95]
    v_mfma_f32_16x16x32_bf16 v[92:95], v[10:13], v[48:51], v[92:95]
    buffer_load_dwordx4 a[112:115], v24, s[24:27], s53 offen offset:1024 sc1
    v_mfma_f32_16x16x32_bf16 v[92:95], a[248:251], v[44:47], v[92:95]
    ds_read_b128 v[28:31], v24 offset:5120
    v_mfma_f32_16x16x32_bf16 v[92:95], a[16:19], v[60:63], v[92:95]
    ds_read_b128 v[32:35], v24 offset:23552
    v_mfma_f32_16x16x32_bf16 v[92:95], a[24:27], v[64:67], v[92:95]
    buffer_load_dwordx2 v[6:7], v4, s[24:27], s73 offen offset:0 sc1
    v_mfma_f32_16x16x32_bf16 v[92:95], a[32:35], v[68:71], v[92:95]
    s_waitcnt lgkmcnt(3)
    ds_read_b128 v[36:39], v24 offset:41984
    v_mfma_f32_16x16x32_bf16 v[92:95], a[40:43], v[72:75], v[92:95]
    v_mfma_f32_16x16x32_bf16 v[96:99], a[44:47], v[72:75], v[96:99]
    s_add_u32 s53, s76, 491520
    ds_read_b128 v[40:43], v2 offset:11264
    v_mfma_f32_16x16x32_bf16 v[96:99], a[36:39], v[68:71], v[96:99]
    buffer_load_dwordx4 a[116:119], v24, s[24:27], s53 offen offset:0 sc1
    v_mfma_f32_16x16x32_bf16 v[96:99], a[28:31], v[64:67], v[96:99]
    ds_read_b128 v[44:47], v24 offset:14336
    v_mfma_f32_16x16x32_bf16 v[96:99], a[20:23], v[60:63], v[96:99]
    v_mfma_f32_16x16x32_bf16 v[96:99], a[52:55], v[76:79], v[96:99]
    ds_read_b128 v[48:51], v24 offset:32768
    v_mfma_f32_16x16x32_bf16 v[96:99], a[60:63], v[80:83], v[96:99]
    v_mfma_f32_16x16x32_bf16 v[96:99], a[68:71], v[84:87], v[96:99]
    buffer_load_dwordx4 a[120:123], v24, s[24:27], s53 offen offset:1024 sc1
    s_waitcnt lgkmcnt(3)
    v_mfma_f32_16x16x32_bf16 v[96:99], a[76:79], v[88:91], v[96:99]
    ds_read_b128 v[52:55], v2 offset:2048
    v_mfma_f32_16x16x32_bf16 v[92:95], a[72:75], v[88:91], v[92:95]
    ds_read_b128 v[56:59], v2 offset:20480
    v_mfma_f32_16x16x32_bf16 v[92:95], a[64:67], v[84:87], v[92:95]
    v_mfma_f32_16x16x32_bf16 v[92:95], a[56:59], v[80:83], v[92:95]
    ds_read_b128 v[60:63], v2 offset:29696
    v_mfma_f32_16x16x32_bf16 v[92:95], a[48:51], v[76:79], v[92:95]
    v_mfma_f32_16x16x32_bf16 v[100:103], a[216:219], v[28:31], 0
    s_add_u32 s53, s76, 532480
    ds_read_b128 v[64:67], v2 offset:48128
    v_mfma_f32_16x16x32_bf16 v[100:103], a[224:227], v[32:35], v[100:103]
    buffer_load_dwordx4 a[124:127], v24, s[24:27], s53 offen offset:0 sc1
    v_mfma_f32_16x16x32_bf16 v[100:103], a[232:235], v[36:39], v[100:103]
    s_waitcnt lgkmcnt(3)
    ds_read_b128 v[68:71], v3 offset:17408
    v_mfma_f32_16x16x32_bf16 v[100:103], a[240:243], v[40:43], v[100:103]
    v_cvt_pk_bf16_f32 v92, v92, v93
    v_cvt_pk_bf16_f32 v93, v94, v95
    v_mfma_f32_16x16x32_bf16 v[104:107], a[244:247], v[40:43], 0
    ds_read_b128 v[72:75], v3 offset:35840
    v_cvt_pk_bf16_f32 v94, v96, v97
    v_mfma_f32_16x16x32_bf16 v[104:107], a[236:239], v[36:39], v[104:107]
    v_cvt_pk_bf16_f32 v95, v98, v99
    v_mfma_f32_16x16x32_bf16 v[104:107], a[228:231], v[32:35], v[104:107]
    buffer_store_dwordx4 v[92:95], v1, s[24:27], s66 offen offset:0 sc1
    v_mfma_f32_16x16x32_bf16 v[104:107], a[220:223], v[28:31], v[104:107]
    ds_read_b128 v[76:79], v2 offset:38912
    v_mfma_f32_16x16x32_bf16 v[104:107], a[252:255], v[44:47], v[104:107]
    ds_read_b128 v[80:83], v3 offset:8192
    v_mfma_f32_16x16x32_bf16 v[104:107], v[14:17], v[48:51], v[104:107]
    v_mfma_f32_16x16x32_bf16 v[104:107], a[4:7], v[52:55], v[104:107]
    buffer_load_dwordx4 a[128:131], v24, s[24:27], s53 offen offset:1024 sc1
    s_waitcnt lgkmcnt(3)
    v_mfma_f32_16x16x32_bf16 v[104:107], a[12:15], v[56:59], v[104:107]
    ds_read_b128 v[84:87], v3 offset:26624
    v_mfma_f32_16x16x32_bf16 v[100:103], a[8:11], v[56:59], v[100:103]
    s_add_u32 s53, s76, 573440
    ds_read_b128 v[88:91], v3 offset:45056
    v_mfma_f32_16x16x32_bf16 v[100:103], a[0:3], v[52:55], v[100:103]
    v_mfma_f32_16x16x32_bf16 v[100:103], v[10:13], v[48:51], v[100:103]
    buffer_load_dwordx4 a[132:135], v24, s[24:27], s53 offen offset:0 sc1
    v_mfma_f32_16x16x32_bf16 v[100:103], a[248:251], v[44:47], v[100:103]
    ds_read_b128 v[28:31], v24 offset:6144
    v_mfma_f32_16x16x32_bf16 v[100:103], a[16:19], v[60:63], v[100:103]
    ds_read_b128 v[32:35], v24 offset:24576
    v_mfma_f32_16x16x32_bf16 v[100:103], a[24:27], v[64:67], v[100:103]
    v_mfma_f32_16x16x32_bf16 v[100:103], a[32:35], v[68:71], v[100:103]
    buffer_load_dwordx4 a[136:139], v24, s[24:27], s53 offen offset:1024 sc1
    s_waitcnt lgkmcnt(3)
    v_mfma_f32_16x16x32_bf16 v[100:103], a[40:43], v[72:75], v[100:103]
    ds_read_b128 v[36:39], v24 offset:43008
    v_mfma_f32_16x16x32_bf16 v[104:107], a[44:47], v[72:75], v[104:107]
    ds_read_b128 v[40:43], v2 offset:12288
    v_mfma_f32_16x16x32_bf16 v[104:107], a[36:39], v[68:71], v[104:107]
    v_mfma_f32_16x16x32_bf16 v[104:107], a[28:31], v[64:67], v[104:107]
    ds_read_b128 v[44:47], v24 offset:15360
    v_mfma_f32_16x16x32_bf16 v[104:107], a[20:23], v[60:63], v[104:107]
    v_mfma_f32_16x16x32_bf16 v[104:107], a[52:55], v[76:79], v[104:107]
    s_add_u32 s53, s76, 614400
    ds_read_b128 v[48:51], v24 offset:33792
    v_mfma_f32_16x16x32_bf16 v[104:107], a[60:63], v[80:83], v[104:107]
    buffer_load_dwordx4 a[140:143], v24, s[24:27], s53 offen offset:0 sc1
    v_mfma_f32_16x16x32_bf16 v[104:107], a[68:71], v[84:87], v[104:107]
    s_waitcnt lgkmcnt(3)
    ds_read_b128 v[52:55], v2 offset:3072
    v_mfma_f32_16x16x32_bf16 v[104:107], a[76:79], v[88:91], v[104:107]
    v_mfma_f32_16x16x32_bf16 v[100:103], a[72:75], v[88:91], v[100:103]
    ds_read_b128 v[56:59], v2 offset:21504
    v_mfma_f32_16x16x32_bf16 v[100:103], a[64:67], v[84:87], v[100:103]
    v_mfma_f32_16x16x32_bf16 v[100:103], a[56:59], v[80:83], v[100:103]
    buffer_load_dwordx4 a[180:183], v24, s[24:27], s53 offen offset:1024 sc1
    v_mfma_f32_16x16x32_bf16 v[100:103], a[48:51], v[76:79], v[100:103]
    ds_read_b128 v[60:63], v2 offset:30720
    v_mfma_f32_16x16x32_bf16 v[108:111], a[216:219], v[28:31], 0
    ds_read_b128 v[64:67], v3 offset:0
    v_mfma_f32_16x16x32_bf16 v[108:111], a[224:227], v[32:35], v[108:111]
    v_mfma_f32_16x16x32_bf16 v[108:111], a[232:235], v[36:39], v[108:111]
    s_waitcnt lgkmcnt(3)
    ds_read_b128 v[68:71], v3 offset:18432
    v_mfma_f32_16x16x32_bf16 v[108:111], a[240:243], v[40:43], v[108:111]
    v_cvt_pk_bf16_f32 v136, v100, v101
    v_cvt_pk_bf16_f32 v137, v102, v103
    v_mfma_f32_16x16x32_bf16 v[112:115], a[244:247], v[40:43], 0
    ds_read_b128 v[72:75], v3 offset:36864
    v_cvt_pk_bf16_f32 v138, v104, v105
    v_mfma_f32_16x16x32_bf16 v[112:115], a[236:239], v[36:39], v[112:115]
    v_cvt_pk_bf16_f32 v139, v106, v107
    v_mfma_f32_16x16x32_bf16 v[112:115], a[228:231], v[32:35], v[112:115]
    buffer_store_dwordx4 v[136:139], v1, s[24:27], s67 offen offset:0 sc1
    v_mfma_f32_16x16x32_bf16 v[112:115], a[220:223], v[28:31], v[112:115]
    ds_read_b128 v[76:79], v2 offset:39936
    v_mfma_f32_16x16x32_bf16 v[112:115], a[252:255], v[44:47], v[112:115]
    ds_read_b128 v[80:83], v3 offset:9216
    v_mfma_f32_16x16x32_bf16 v[112:115], v[14:17], v[48:51], v[112:115]
    v_mfma_f32_16x16x32_bf16 v[112:115], a[4:7], v[52:55], v[112:115]
    s_waitcnt lgkmcnt(3)
    ds_read_b128 v[84:87], v3 offset:27648
    v_mfma_f32_16x16x32_bf16 v[112:115], a[12:15], v[56:59], v[112:115]
    v_mfma_f32_16x16x32_bf16 v[108:111], a[8:11], v[56:59], v[108:111]
    ds_read_b128 v[88:91], v3 offset:46080
    v_mfma_f32_16x16x32_bf16 v[108:111], a[0:3], v[52:55], v[108:111]
    s_cmp_lt_u32 s71, 2
    s_cbranch_scc1 gqa_kernel_nojob0
    s_cmp_eq_u32 s71, 2
    s_cbranch_scc1 gqa_kernel_pp0
    s_waitcnt vmcnt(6)
    s_mov_b64 exec, 1
    buffer_store_dwordx2 v[8:9], v24, s[24:27], s72 offen offset:128 sc1
    s_mov_b64 exec, -1
gqa_kernel_pp0:
    s_waitcnt vmcnt(10)
    v_cmp_ne_u32 vcc, s48, v6
    v_cmp_ne_u32 s[86:87], s49, v7
    s_or_b64 vcc, vcc, s[86:87]
    s_cbranch_scc0 gqa_kernel_pp0_ok
    s_sub_u32 s50, s50, 1
    s_cbranch_scc1 gqa_kernel_pp0_ok
    s_sleep 2
    buffer_load_dwordx2 v[6:7], v4, s[24:27], s73 offen offset:0 sc1
    s_waitcnt vmcnt(0)
    s_branch gqa_kernel_pp0
gqa_kernel_pp0_ok:
    v_mov_b32 v25, v24
    s_cmp_eq_u32 s71, 2
    s_cbranch_scc1 gqa_kernel_nojob0
    v_add_u32 v25, 737280, v24
    v_mfma_f32_16x16x32_bf16 v[140:143], v[20:23], v[188:191], v[140:143]
    v_mfma_f32_16x16x32_bf16 v[140:143], v[20:23], v[192:195], v[140:143]
    v_mfma_f32_16x16x32_bf16 v[144:147], v[18:21], v[188:191], v[144:147]
    v_mfma_f32_16x16x32_bf16 v[144:147], v[18:21], v[192:195], v[144:147]
    v_mfma_f32_16x16x32_bf16 v[148:151], v[20:23], v[196:199], v[148:151]
    v_mfma_f32_16x16x32_bf16 v[148:151], v[20:23], v[200:203], v[148:151]
    v_mfma_f32_16x16x32_bf16 v[152:155], v[18:21], v[196:199], v[152:155]
    v_mfma_f32_16x16x32_bf16 v[152:155], v[18:21], v[200:203], v[152:155]
    v_mfma_f32_16x16x32_bf16 v[156:159], v[20:23], v[204:207], v[156:159]
    v_mfma_f32_16x16x32_bf16 v[156:159], v[20:23], v[208:211], v[156:159]
    v_mfma_f32_16x16x32_bf16 v[160:163], v[18:21], v[204:207], v[160:163]
    v_mfma_f32_16x16x32_bf16 v[160:163], v[18:21], v[208:211], v[160:163]
    v_mfma_f32_16x16x32_bf16 v[164:167], v[20:23], v[212:215], v[164:167]
    v_mfma_f32_16x16x32_bf16 v[164:167], v[20:23], v[216:219], v[164:167]
    v_mfma_f32_16x16x32_bf16 v[168:171], v[18:21], v[212:215], v[168:171]
    v_mfma_f32_16x16x32_bf16 v[168:171], v[18:21], v[216:219], v[168:171]
    v_mfma_f32_16x16x32_bf16 v[172:175], v[20:23], v[220:223], v[172:175]
    v_mfma_f32_16x16x32_bf16 v[172:175], v[20:23], v[224:227], v[172:175]
    v_mfma_f32_16x16x32_bf16 v[176:179], v[18:21], v[220:223], v[176:179]
    v_mfma_f32_16x16x32_bf16 v[176:179], v[18:21], v[224:227], v[176:179]
    v_mfma_f32_16x16x32_bf16 v[180:183], v[20:23], v[228:231], v[180:183]
    v_mfma_f32_16x16x32_bf16 v[180:183], v[20:23], v[232:235], v[180:183]
    v_mfma_f32_16x16x32_bf16 v[184:187], v[18:21], v[228:231], v[184:187]
    v_mfma_f32_16x16x32_bf16 v[184:187], v[18:21], v[232:235], v[184:187]
gqa_kernel_nojob0:
    v_mfma_f32_16x16x32_bf16 v[108:111], v[10:13], v[48:51], v[108:111]
    buffer_load_dwordx4 v[188:191], v25, s[24:27], s77 offen offset:0 sc1
    v_mfma_f32_16x16x32_bf16 v[108:111], a[248:251], v[44:47], v[108:111]
    ds_read_b128 v[28:31], v24 offset:7168
    v_mfma_f32_16x16x32_bf16 v[108:111], a[16:19], v[60:63], v[108:111]
    ds_read_b128 v[32:35], v24 offset:25600
    v_mfma_f32_16x16x32_bf16 v[108:111], a[24:27], v[64:67], v[108:111]
    v_mfma_f32_16x16x32_bf16 v[108:111], a[32:35], v[68:71], v[108:111]
    s_waitcnt lgkmcnt(2)
    ds_read_b128 v[36:39], v24 offset:44032
    v_mfma_f32_16x16x32_bf16 v[108:111], a[40:43], v[72:75], v[108:111]
    buffer_load_dwordx4 v[192:195], v25, s[24:27], s77 offen offset:1024 sc1
    v_mfma_f32_16x16x32_bf16 v[112:115], a[44:47], v[72:75], v[112:115]
    ds_read_b128 v[40:43], v2 offset:13312
    v_mfma_f32_16x16x32_bf16 v[112:115], a[36:39], v[68:71], v[112:115]
    v_mfma_f32_16x16x32_bf16 v[112:115], a[28:31], v[64:67], v[112:115]
    ds_read_b128 v[44:47], v24 offset:16384
    v_mfma_f32_16x16x32_bf16 v[112:115], a[20:23], v[60:63], v[112:115]
    v_mfma_f32_16x16x32_bf16 v[112:115], a[52:55], v[76:79], v[112:115]
    s_add_u32 s41, s77, 81920
    ds_read_b128 v[48:51], v24 offset:34816
    v_mfma_f32_16x16x32_bf16 v[112:115], a[60:63], v[80:83], v[112:115]
    buffer_load_dwordx4 v[196:199], v25, s[24:27], s41 offen offset:0 sc1
    v_mfma_f32_16x16x32_bf16 v[112:115], a[68:71], v[84:87], v[112:115]
    ds_read_b128 v[52:55], v2 offset:4096
    v_mfma_f32_16x16x32_bf16 v[112:115], a[76:79], v[88:91], v[112:115]
    v_mfma_f32_16x16x32_bf16 v[108:111], a[72:75], v[88:91], v[108:111]
    ds_read_b128 v[56:59], v2 offset:22528
    v_mfma_f32_16x16x32_bf16 v[108:111], a[64:67], v[84:87], v[108:111]
    buffer_load_dwordx4 v[200:203], v25, s[24:27], s41 offen offset:1024 sc1
    v_mfma_f32_16x16x32_bf16 v[108:111], a[56:59], v[80:83], v[108:111]
    ds_read_b128 v[60:63], v2 offset:31744
    v_mfma_f32_16x16x32_bf16 v[108:111], a[48:51], v[76:79], v[108:111]
    s_waitcnt lgkmcnt(4)
    v_mfma_f32_16x16x32_bf16 v[116:119], a[216:219], v[28:31], 0
    ds_read_b128 v[64:67], v3 offset:1024
    v_mfma_f32_16x16x32_bf16 v[116:119], a[224:227], v[32:35], v[116:119]
    v_mfma_f32_16x16x32_bf16 v[116:119], a[232:235], v[36:39], v[116:119]
    s_add_u32 s41, s77, 163840
    ds_read_b128 v[68:71], v3 offset:19456
    v_mfma_f32_16x16x32_bf16 v[116:119], a[240:243], v[40:43], v[116:119]
    buffer_load_dwordx4 v[204:207], v25, s[24:27], s41 offen offset:0 sc1
    v_mfma_f32_16x16x32_bf16 v[120:123], a[244:247], v[40:43], 0
    ds_read_b128 v[72:75], v3 offset:37888
    v_cvt_pk_bf16_f32 v132, v108, v109
    v_mfma_f32_16x16x32_bf16 v[120:123], a[236:239], v[36:39], v[120:123]
    v_cvt_pk_bf16_f32 v133, v110, v111
    v_cvt_pk_bf16_f32 v134, v112, v113
    v_mfma_f32_16x16x32_bf16 v[120:123], a[228:231], v[32:35], v[120:123]
    ds_read_b128 v[76:79], v2 offset:40960
    v_cvt_pk_bf16_f32 v135, v114, v115
    v_mfma_f32_16x16x32_bf16 v[120:123], a[220:223], v[28:31], v[120:123]
    buffer_store_dwordx4 v[132:135], v1, s[24:27], s68 offen offset:0 sc1
    v_mfma_f32_16x16x32_bf16 v[120:123], a[252:255], v[44:47], v[120:123]
    s_waitcnt lgkmcnt(2)
    ds_read_b128 v[80:83], v3 offset:10240
    v_mfma_f32_16x16x32_bf16 v[120:123], v[14:17], v[48:51], v[120:123]
    v_mfma_f32_16x16x32_bf16 v[120:123], a[4:7], v[52:55], v[120:123]
    ds_read_b128 v[84:87], v3 offset:28672
    v_mfma_f32_16x16x32_bf16 v[120:123], a[12:15], v[56:59], v[120:123]
    buffer_load_dwordx4 v[208:211], v25, s[24:27], s41 offen offset:1024 sc1
    v_mfma_f32_16x16x32_bf16 v[116:119], a[8:11], v[56:59], v[116:119]
    s_add_u32 s41, s77, 245760
    ds_read_b128 v[88:91], v3 offset:47104
    v_mfma_f32_16x16x32_bf16 v[116:119], a[0:3], v[52:55], v[116:119]
    v_mfma_f32_16x16x32_bf16 v[116:119], v[10:13], v[48:51], v[116:119]
    ds_read_b128 v[28:31], v24 offset:8192
    v_mfma_f32_16x16x32_bf16 v[116:119], a[248:251], v[44:47], v[116:119]
    buffer_load_dwordx4 v[212:215], v25, s[24:27], s41 offen offset:0 sc1
    v_mfma_f32_16x16x32_bf16 v[116:119], a[16:19], v[60:63], v[116:119]
    ds_read_b128 v[32:35], v24 offset:26624
    v_mfma_f32_16x16x32_bf16 v[116:119], a[24:27], v[64:67], v[116:119]
    v_mfma_f32_16x16x32_bf16 v[116:119], a[32:35], v[68:71], v[116:119]
    s_waitcnt lgkmcnt(3)
    ds_read_b128 v[36:39], v24 offset:45056
    v_mfma_f32_16x16x32_bf16 v[116:119], a[40:43], v[72:75], v[116:119]
    buffer_load_dwordx4 v[216:219], v25, s[24:27], s41 offen offset:1024 sc1
    v_mfma_f32_16x16x32_bf16 v[120:123], a[44:47], v[72:75], v[120:123]
    ds_read_b128 v[40:43], v2 offset:14336
    v_mfma_f32_16x16x32_bf16 v[120:123], a[36:39], v[68:71], v[120:123]
    v_mfma_f32_16x16x32_bf16 v[120:123], a[28:31], v[64:67], v[120:123]
    ds_read_b128 v[44:47], v24 offset:17408
    v_mfma_f32_16x16x32_bf16 v[120:123], a[20:23], v[60:63], v[120:123]
    buffer_load_dwordx2 v[26:27], v4, s[24:27], s98 offen offset:128 sc1
    v_mfma_f32_16x16x32_bf16 v[120:123], a[52:55], v[76:79], v[120:123]
    ds_read_b128 v[48:51], v24 offset:35840
    v_mfma_f32_16x16x32_bf16 v[120:123], a[60:63], v[80:83], v[120:123]
    v_mfma_f32_16x16x32_bf16 v[120:123], a[68:71], v[84:87], v[120:123]
    s_waitcnt lgkmcnt(3)
    ds_read_b128 v[52:55], v2 offset:5120
    v_mfma_f32_16x16x32_bf16 v[120:123], a[76:79], v[88:91], v[120:123]
    buffer_load_dwordx4 v[220:223], v25, s[24:27], s79 offen offset:0 sc1
    v_mfma_f32_16x16x32_bf16 v[116:119], a[72:75], v[88:91], v[116:119]
    ds_read_b128 v[56:59], v2 offset:23552
    v_mfma_f32_16x16x32_bf16 v[116:119], a[64:67], v[84:87], v[116:119]
    v_mfma_f32_16x16x32_bf16 v[116:119], a[56:59], v[80:83], v[116:119]
    ds_read_b128 v[60:63], v2 offset:32768
    v_mfma_f32_16x16x32_bf16 v[116:119], a[48:51], v[76:79], v[116:119]
    buffer_load_dwordx4 v[224:227], v25, s[24:27], s79 offen offset:1024 sc1
    v_mfma_f32_16x16x32_bf16 v[124:127], a[216:219], v[28:31], 0
    ds_read_b128 v[64:67], v3 offset:2048
    v_mfma_f32_16x16x32_bf16 v[124:127], a[224:227], v[32:35], v[124:127]
    v_mfma_f32_16x16x32_bf16 v[124:127], a[232:235], v[36:39], v[124:127]
    s_waitcnt lgkmcnt(3)
    ds_read_b128 v[68:71], v3 offset:20480
    v_mfma_f32_16x16x32_bf16 v[124:127], a[240:243], v[40:43], v[124:127]
    buffer_load_dwordx4 v[228:231], v25, s[24:27], s80 offen offset:0 sc1
    v_mfma_f32_16x16x32_bf16 v[128:131], a[244:247], v[40:43], 0
    ds_read_b128 v[72:75], v3 offset:38912
    v_cvt_pk_bf16_f32 v136, v116, v117
    v_mfma_f32_16x16x32_bf16 v[128:131], a[236:239], v[36:39], v[128:131]
    v_cvt_pk_bf16_f32 v137, v118, v119
    v_cvt_pk_bf16_f32 v138, v120, v121
    v_mfma_f32_16x16x32_bf16 v[128:131], a[228:231], v[32:35], v[128:131]
    ds_read_b128 v[76:79], v2 offset:41984
    v_cvt_pk_bf16_f32 v139, v122, v123
    v_mfma_f32_16x16x32_bf16 v[128:131], a[220:223], v[28:31], v[128:131]
    buffer_store_dwordx4 v[136:139], v1, s[24:27], s69 offen offset:0 sc1
    v_mfma_f32_16x16x32_bf16 v[128:131], a[252:255], v[44:47], v[128:131]
    ds_read_b128 v[80:83], v3 offset:11264
    v_mfma_f32_16x16x32_bf16 v[128:131], v[14:17], v[48:51], v[128:131]
    v_mfma_f32_16x16x32_bf16 v[128:131], a[4:7], v[52:55], v[128:131]
    s_waitcnt lgkmcnt(2)
    ds_read_b128 v[84:87], v3 offset:29696
    v_mfma_f32_16x16x32_bf16 v[128:131], a[12:15], v[56:59], v[128:131]
    buffer_load_dwordx4 v[232:235], v25, s[24:27], s80 offen offset:1024 sc1
    v_mfma_f32_16x16x32_bf16 v[124:127], a[8:11], v[56:59], v[124:127]
    ds_read_b128 v[88:91], v3 offset:48128
    v_mfma_f32_16x16x32_bf16 v[124:127], a[0:3], v[52:55], v[124:127]
    v_mfma_f32_16x16x32_bf16 v[124:127], v[10:13], v[48:51], v[124:127]
    ds_read_b128 v[28:31], v24 offset:0
    v_mfma_f32_16x16x32_bf16 v[124:127], a[248:251], v[44:47], v[124:127]
    v_mfma_f32_16x16x32_bf16 v[124:127], a[16:19], v[60:63], v[124:127]
    ds_read_b128 v[32:35], v24 offset:18432
    s_add_u32 s72, s72, 128
    v_mfma_f32_16x16x32_bf16 v[124:127], a[24:27], v[64:67], v[124:127]
    s_add_u32 s71, s71, 1
    v_mfma_f32_16x16x32_bf16 v[124:127], a[32:35], v[68:71], v[124:127]
    ds_read_b128 v[36:39], v24 offset:36864
    v_mfma_f32_16x16x32_bf16 v[124:127], a[40:43], v[72:75], v[124:127]
    v_mfma_f32_16x16x32_bf16 v[128:131], a[44:47], v[72:75], v[128:131]
    ds_read_b128 v[40:43], v2 offset:6144
    v_mfma_f32_16x16x32_bf16 v[128:131], a[36:39], v[68:71], v[128:131]
    v_mfma_f32_16x16x32_bf16 v[128:131], a[28:31], v[64:67], v[128:131]
    ds_read_b128 v[44:47], v24 offset:9216
    v_mfma_f32_16x16x32_bf16 v[128:131], a[20:23], v[60:63], v[128:131]
    s_waitcnt lgkmcnt(4)
    v_mfma_f32_16x16x32_bf16 v[128:131], a[52:55], v[76:79], v[128:131]
    ds_read_b128 v[48:51], v24 offset:27648
    v_mfma_f32_16x16x32_bf16 v[128:131], a[60:63], v[80:83], v[128:131]
    v_mfma_f32_16x16x32_bf16 v[128:131], a[68:71], v[84:87], v[128:131]
    ds_read_b128 v[52:55], v24 offset:46080
    v_mfma_f32_16x16x32_bf16 v[128:131], a[76:79], v[88:91], v[128:131]
    v_mfma_f32_16x16x32_bf16 v[124:127], a[72:75], v[88:91], v[124:127]
    ds_read_b128 v[56:59], v2 offset:15360
    v_mfma_f32_16x16x32_bf16 v[124:127], a[64:67], v[84:87], v[124:127]
    v_mfma_f32_16x16x32_bf16 v[124:127], a[56:59], v[80:83], v[124:127]
    v_mfma_f32_16x16x32_bf16 v[124:127], a[48:51], v[76:79], v[124:127]
    s_cmp_eq_u32 s71, 5
    s_cbranch_scc1 gqa_kernel_ptail
    s_add_u32 s73, s73, 128
    s_cmp_eq_u32 s71, 1
    s_cbranch_scc1 gqa_kernel_fbw
gqa_kernel_pass1:
    s_waitcnt vmcnt(24)
    v_mfma_f32_16x16x32_bf16 v[92:95], a[160:163], v[28:31], 0
    s_add_u32 s76, s76, 8192
    s_sub_u32 s45, s101, 40960
    s_cmp_eq_u32 s76, s101
    s_cselect_b32 s76, s45, s76
    ds_read_b128 v[60:63], v2 offset:24576
    s_waitcnt lgkmcnt(1)
    v_mfma_f32_16x16x32_bf16 v[92:95], a[168:171], v[32:35], v[92:95]
    s_waitcnt lgkmcnt(1)
    ds_read_b128 v[64:67], v2 offset:43008
    v_mfma_f32_16x16x32_bf16 v[92:95], a[176:179], v[36:39], v[92:95]
    ds_read_b128 v[68:71], v3 offset:12288
    v_mfma_f32_16x16x32_bf16 v[92:95], a[188:191], v[40:43], v[92:95]
    v_cvt_pk_bf16_f32 v124, v124, v125
    v_cvt_pk_bf16_f32 v125, v126, v127
    v_mfma_f32_16x16x32_bf16 v[96:99], a[192:195], v[40:43], 0
    s_add_u32 s53, s76, 0
    ds_read_b128 v[72:75], v3 offset:30720
    v_mfma_f32_16x16x32_bf16 v[96:99], a[184:187], v[36:39], v[96:99]
    buffer_load_dwordx4 a[216:219], v24, s[24:27], s53 offen offset:0 sc1
    v_mfma_f32_16x16x32_bf16 v[96:99], a[172:175], v[32:35], v[96:99]
    ds_read_b128 v[76:79], v2 offset:33792
    v_cvt_pk_bf16_f32 v126, v128, v129
    v_mfma_f32_16x16x32_bf16 v[96:99], a[164:167], v[28:31], v[96:99]
    v_cvt_pk_bf16_f32 v127, v130, v131
    v_mfma_f32_16x16x32_bf16 v[96:99], a[200:203], v[44:47], v[96:99]
    ds_read_b128 v[80:83], v3 offset:3072
    v_mfma_f32_16x16x32_bf16 v[96:99], a[144:147], v[48:51], v[96:99]
    buffer_store_dwordx4 v[124:127], v1, s[24:27], s70 offen offset:0 sc1
    v_mfma_f32_16x16x32_bf16 v[96:99], a[152:155], v[52:55], v[96:99]
    ds_read_b128 v[84:87], v3 offset:21504
    v_add_u32 v1, s4, v24
    v_mfma_f32_16x16x32_bf16 v[96:99], a[80:83], v[56:59], v[96:99]
    s_mov_b32 s4, s5
    s_mov_b32 s5, s6
    v_mfma_f32_16x16x32_bf16 v[92:95], a[156:159], v[56:59], v[92:95]
    ds_read_b128 v[88:91], v3 offset:39936
    s_mov_b32 s6, s7
    v_mfma_f32_16x16x32_bf16 v[92:95], a[148:151], v[52:55], v[92:95]
    buffer_load_dwordx4 a[220:223], v24, s[24:27], s53 offen offset:1024 sc1
    v_mfma_f32_16x16x32_bf16 v[92:95], a[204:207], v[48:51], v[92:95]
    ds_read_b128 v[28:31], v24 offset:1024
    s_mov_b32 s7, s74
    v_mfma_f32_16x16x32_bf16 v[92:95], a[196:199], v[44:47], v[92:95]
    s_waitcnt vmcnt(19)
    s_waitcnt lgkmcnt(2)
    v_mfma_f32_16x16x32_bf16 v[92:95], a[84:87], v[60:63], v[92:95]
    s_add_u32 s53, s76, 40960
    ds_read_b128 v[32:35], v24 offset:19456
    v_mfma_f32_16x16x32_bf16 v[92:95], a[92:95], v[64:67], v[92:95]
    buffer_load_dwordx4 a[224:227], v24, s[24:27], s53 offen offset:0 sc1
    v_mfma_f32_16x16x32_bf16 v[92:95], a[100:103], v[68:71], v[92:95]
    ds_read_b128 v[36:39], v24 offset:37888
    v_mfma_f32_16x16x32_bf16 v[92:95], a[108:111], v[72:75], v[92:95]
    v_mfma_f32_16x16x32_bf16 v[96:99], a[112:115], v[72:75], v[96:99]
    ds_read_b128 v[40:43], v2 offset:7168
    v_mfma_f32_16x16x32_bf16 v[96:99], a[104:107], v[68:71], v[96:99]
    v_mfma_f32_16x16x32_bf16 v[96:99], a[96:99], v[64:67], v[96:99]
    buffer_load_dwordx4 a[228:231], v24, s[24:27], s53 offen offset:1024 sc1
    v_mfma_f32_16x16x32_bf16 v[96:99], a[88:91], v[60:63], v[96:99]
    s_waitcnt vmcnt(12)
    ds_read_b128 v[44:47], v24 offset:10240
    v_mfma_f32_16x16x32_bf16 v[96:99], a[120:123], v[76:79], v[96:99]
    ds_read_b128 v[48:51], v24 offset:28672
    v_mfma_f32_16x16x32_bf16 v[96:99], a[128:131], v[80:83], v[96:99]
    v_mfma_f32_16x16x32_bf16 v[96:99], a[136:139], v[84:87], v[96:99]
    s_waitcnt lgkmcnt(3)
    ds_read_b128 v[52:55], v24 offset:47104
    v_mfma_f32_16x16x32_bf16 v[96:99], a[180:183], v[88:91], v[96:99]
    v_mfma_f32_16x16x32_bf16 v[92:95], a[140:143], v[88:91], v[92:95]
    s_add_u32 s53, s76, 81920
    ds_read_b128 v[56:59], v2 offset:16384
    v_mfma_f32_16x16x32_bf16 v[92:95], a[132:135], v[84:87], v[92:95]
    buffer_load_dwordx4 a[232:235], v24, s[24:27], s53 offen offset:0 sc1
    v_mfma_f32_16x16x32_bf16 v[92:95], a[124:127], v[80:83], v[92:95]
    ds_read_b128 v[60:63], v2 offset:25600
    v_mfma_f32_16x16x32_bf16 v[92:95], a[116:119], v[76:79], v[92:95]
    v_mfma_f32_16x16x32_bf16 v[100:103], a[160:163], v[28:31], 0
    ds_read_b128 v[64:67], v2 offset:44032
    v_mfma_f32_16x16x32_bf16 v[100:103], a[168:171], v[32:35], v[100:103]
    v_mfma_f32_16x16x32_bf16 v[100:103], a[176:179], v[36:39], v[100:103]
    buffer_load_dwordx4 a[236:239], v24, s[24:27], s53 offen offset:1024 sc1
    s_waitcnt lgkmcnt(3)
    v_mfma_f32_16x16x32_bf16 v[100:103], a[188:191], v[40:43], v[100:103]
    ds_read_b128 v[68:71], v3 offset:13312
    v_cvt_pk_bf16_f32 v92, v92, v93
    v_mfma_f32_16x16x32_bf16 v[104:107], a[192:195], v[40:43], 0
    ds_read_b128 v[72:75], v3 offset:31744
    v_cvt_pk_bf16_f32 v93, v94, v95
    v_mfma_f32_16x16x32_bf16 v[104:107], a[184:187], v[36:39], v[104:107]
    v_cvt_pk_bf16_f32 v94, v96, v97
    v_cvt_pk_bf16_f32 v95, v98, v99
    v_mfma_f32_16x16x32_bf16 v[104:107], a[172:175], v[32:35], v[104:107]
    buffer_store_dwordx4 v[92:95], v1, s[24:27], s62 offen offset:0 sc1
    v_mfma_f32_16x16x32_bf16 v[104:107], a[164:167], v[28:31], v[104:107]
    ds_read_b128 v[76:79], v2 offset:34816
    v_mfma_f32_16x16x32_bf16 v[104:107], a[200:203], v[44:47], v[104:107]
    s_add_u32 s53, s76, 122880
    ds_read_b128 v[80:83], v3 offset:4096
    v_mfma_f32_16x16x32_bf16 v[104:107], a[144:147], v[48:51], v[104:107]
    v_mfma_f32_16x16x32_bf16 v[104:107], a[152:155], v[52:55], v[104:107]
    buffer_load_dwordx4 a[240:243], v24, s[24:27], s53 offen offset:0 sc1
    s_waitcnt lgkmcnt(2)
    v_mfma_f32_16x16x32_bf16 v[104:107], a[80:83], v[56:59], v[104:107]
    ds_read_b128 v[84:87], v3 offset:22528
    v_mfma_f32_16x16x32_bf16 v[100:103], a[156:159], v[56:59], v[100:103]
    ds_read_b128 v[88:91], v3 offset:40960
    v_mfma_f32_16x16x32_bf16 v[100:103], a[148:151], v[52:55], v[100:103]
    v_mfma_f32_16x16x32_bf16 v[100:103], a[204:207], v[48:51], v[100:103]
    buffer_load_dwordx4 a[244:247], v24, s[24:27], s53 offen offset:1024 sc1
    v_mfma_f32_16x16x32_bf16 v[100:103], a[196:199], v[44:47], v[100:103]
    ds_read_b128 v[28:31], v24 offset:2048
    v_mfma_f32_16x16x32_bf16 v[100:103], a[84:87], v[60:63], v[100:103]
    ds_read_b128 v[32:35], v24 offset:20480
    v_mfma_f32_16x16x32_bf16 v[100:103], a[92:95], v[64:67], v[100:103]
    v_mfma_f32_16x16x32_bf16 v[100:103], a[100:103], v[68:71], v[100:103]
    ds_read_b128 v[36:39], v24 offset:38912
    v_mfma_f32_16x16x32_bf16 v[100:103], a[108:111], v[72:75], v[100:103]
    v_mfma_f32_16x16x32_bf16 v[104:107], a[112:115], v[72:75], v[104:107]
    s_add_u32 s53, s76, 163840
    ds_read_b128 v[40:43], v2 offset:8192
    v_mfma_f32_16x16x32_bf16 v[104:107], a[104:107], v[68:71], v[104:107]
    buffer_load_dwordx4 a[248:251], v24, s[24:27], s53 offen offset:0 sc1
    v_mfma_f32_16x16x32_bf16 v[104:107], a[96:99], v[64:67], v[104:107]
    ds_read_b128 v[44:47], v24 offset:11264
    v_mfma_f32_16x16x32_bf16 v[104:107], a[88:91], v[60:63], v[104:107]
    s_waitcnt vmcnt(9)
    s_mov_b64 exec, 1
    buffer_store_dwordx2 v[8:9], v24, s[24:27], s72 offen offset:0 sc1
    s_mov_b64 exec, -1
    s_waitcnt lgkmcnt(2)
    v_mfma_f32_16x16x32_bf16 v[104:107], a[120:123], v[76:79], v[104:107]
    ds_read_b128 v[48:51], v24 offset:29696
    v_mfma_f32_16x16x32_bf16 v[104:107], a[128:131], v[80:83], v[104:107]
    v_mfma_f32_16x16x32_bf16 v[104:107], a[136:139], v[84:87], v[104:107]
    buffer_load_dwordx4 a[252:255], v24, s[24:27], s53 offen offset:1024 sc1
    v_mfma_f32_16x16x32_bf16 v[104:107], a[180:183], v[88:91], v[104:107]
    ds_read_b128 v[52:55], v24 offset:48128
    v_mfma_f32_16x16x32_bf16 v[100:103], a[140:143], v[88:91], v[100:103]
    ds_read_b128 v[56:59], v2 offset:17408
    v_mfma_f32_16x16x32_bf16 v[100:103], a[132:135], v[84:87], v[100:103]
    v_mfma_f32_16x16x32_bf16 v[100:103], a[124:127], v[80:83], v[100:103]
    ds_read_b128 v[60:63], v2 offset:26624
    v_mfma_f32_16x16x32_bf16 v[100:103], a[116:119], v[76:79], v[100:103]
    v_mfma_f32_16x16x32_bf16 v[108:111], a[160:163], v[28:31], 0
    s_add_u32 s53, s76, 204800
    ds_read_b128 v[64:67], v2 offset:45056
    v_mfma_f32_16x16x32_bf16 v[108:111], a[168:171], v[32:35], v[108:111]
    buffer_load_dwordx4 v[10:13], v24, s[24:27], s53 offen offset:0 sc1
    v_mfma_f32_16x16x32_bf16 v[108:111], a[176:179], v[36:39], v[108:111]
    s_waitcnt lgkmcnt(3)
    ds_read_b128 v[68:71], v3 offset:14336
    v_mfma_f32_16x16x32_bf16 v[108:111], a[188:191], v[40:43], v[108:111]
    v_cvt_pk_bf16_f32 v100, v100, v101
    v_cvt_pk_bf16_f32 v101, v102, v103
    v_mfma_f32_16x16x32_bf16 v[112:115], a[192:195], v[40:43], 0
    ds_read_b128 v[72:75], v3 offset:32768
    v_cvt_pk_bf16_f32 v102, v104, v105
    v_mfma_f32_16x16x32_bf16 v[112:115], a[184:187], v[36:39], v[112:115]
    v_cvt_pk_bf16_f32 v103, v106, v107
    v_mfma_f32_16x16x32_bf16 v[112:115], a[172:175], v[32:35], v[112:115]
    buffer_store_dwordx4 v[100:103], v1, s[24:27], s63 offen offset:0 sc1
    v_mfma_f32_16x16x32_bf16 v[112:115], a[164:167], v[28:31], v[112:115]
    ds_read_b128 v[76:79], v2 offset:35840
    v_mfma_f32_16x16x32_bf16 v[112:115], a[200:203], v[44:47], v[112:115]
    ds_read_b128 v[80:83], v3 offset:5120
    v_mfma_f32_16x16x32_bf16 v[112:115], a[144:147], v[48:51], v[112:115]
    v_mfma_f32_16x16x32_bf16 v[112:115], a[152:155], v[52:55], v[112:115]
    buffer_load_dwordx4 v[14:17], v24, s[24:27], s53 offen offset:1024 sc1
    s_waitcnt lgkmcnt(3)
    v_mfma_f32_16x16x32_bf16 v[112:115], a[80:83], v[56:59], v[112:115]
    ds_read_b128 v[84:87], v3 offset:23552
    v_mfma_f32_16x16x32_bf16 v[108:111], a[156:159], v[56:59], v[108:111]
    s_add_u32 s53, s76, 245760
    ds_read_b128 v[88:91], v3 offset:41984
    v_mfma_f32_16x16x32_bf16 v[108:111], a[148:151], v[52:55], v[108:111]
    v_mfma_f32_16x16x32_bf16 v[108:111], a[204:207], v[48:51], v[108:111]
    buffer_load_dwordx4 a[0:3], v24, s[24:27], s53 offen offset:0 sc1
    v_mfma_f32_16x16x32_bf16 v[108:111], a[196:199], v[44:47], v[108:111]
    ds_read_b128 v[28:31], v24 offset:3072
    v_mfma_f32_16x16x32_bf16 v[108:111], a[84:87], v[60:63], v[108:111]
    ds_read_b128 v[32:35], v24 offset:21504
    v_mfma_f32_16x16x32_bf16 v[108:111], a[92:95], v[64:67], v[108:111]
    v_mfma_f32_16x16x32_bf16 v[108:111], a[100:103], v[68:71], v[108:111]
    buffer_load_dwordx4 a[4:7], v24, s[24:27], s53 offen offset:1024 sc1
    s_waitcnt lgkmcnt(3)
    v_mfma_f32_16x16x32_bf16 v[108:111], a[108:111], v[72:75], v[108:111]
    ds_read_b128 v[36:39], v24 offset:39936
    v_mfma_f32_16x16x32_bf16 v[112:115], a[112:115], v[72:75], v[112:115]
    ds_read_b128 v[40:43], v2 offset:9216
    v_mfma_f32_16x16x32_bf16 v[112:115], a[104:107], v[68:71], v[112:115]
    v_mfma_f32_16x16x32_bf16 v[112:115], a[96:99], v[64:67], v[112:115]
    ds_read_b128 v[44:47], v24 offset:12288
    v_mfma_f32_16x16x32_bf16 v[112:115], a[88:91], v[60:63], v[112:115]
    v_mfma_f32_16x16x32_bf16 v[112:115], a[120:123], v[76:79], v[112:115]
    s_add_u32 s53, s76, 286720
    ds_read_b128 v[48:51], v24 offset:30720
    v_mfma_f32_16x16x32_bf16 v[112:115], a[128:131], v[80:83], v[112:115]
    buffer_load_dwordx4 a[8:11], v24, s[24:27], s53 offen offset:0 sc1
    v_mfma_f32_16x16x32_bf16 v[112:115], a[136:139], v[84:87], v[112:115]
    s_waitcnt lgkmcnt(3)
    ds_read_b128 v[52:55], v2 offset:0
    v_mfma_f32_16x16x32_bf16 v[112:115], a[180:183], v[88:91], v[112:115]
    v_mfma_f32_16x16x32_bf16 v[108:111], a[140:143], v[88:91], v[108:111]
    ds_read_b128 v[56:59], v2 offset:18432
    v_mfma_f32_16x16x32_bf16 v[108:111], a[132:135], v[84:87], v[108:111]
    v_mfma_f32_16x16x32_bf16 v[108:111], a[124:127], v[80:83], v[108:111]
    buffer_load_dwordx4 a[12:15], v24, s[24:27], s53 offen offset:1024 sc1
    v_mfma_f32_16x16x32_bf16 v[108:111], a[116:119], v[76:79], v[108:111]
    ds_read_b128 v[60:63], v2 offset:27648
    v_mfma_f32_16x16x32_bf16 v[116:119], a[160:163], v[28:31], 0
    ds_read_b128 v[64:67], v2 offset:46080
    v_mfma_f32_16x16x32_bf16 v[116:119], a[168:171], v[32:35], v[116:119]
    v_mfma_f32_16x16x32_bf16 v[116:119], a[176:179], v[36:39], v[116:119]
    s_waitcnt lgkmcnt(3)
    ds_read_b128 v[68:71], v3 offset:15360
    v_mfma_f32_16x16x32_bf16 v[116:119], a[188:191], v[40:43], v[116:119]
    v_cvt_pk_bf16_f32 v108, v108, v109
    v_cvt_pk_bf16_f32 v109, v110, v111
    v_mfma_f32_16x16x32_bf16 v[120:123], a[192:195], v[40:43], 0
    s_add_u32 s53, s76, 327680
    ds_read_b128 v[72:75], v3 offset:33792
    v_mfma_f32_16x16x32_bf16 v[120:123], a[184:187], v[36:39], v[120:123]
    buffer_load_dwordx4 a[16:19], v24, s[24:27], s53 offen offset:0 sc1
    v_mfma_f32_16x16x32_bf16 v[120:123], a[172:175], v[32:35], v[120:123]
    ds_read_b128 v[76:79], v2 offset:36864
    v_cvt_pk_bf16_f32 v110, v112, v113
    v_mfma_f32_16x16x32_bf16 v[120:123], a[164:167], v[28:31], v[120:123]
    v_cvt_pk_bf16_f32 v111, v114, v115
    v_mfma_f32_16x16x32_bf16 v[120:123], a[200:203], v[44:47], v[120:123]
    ds_read_b128 v[80:83], v3 offset:6144
    v_mfma_f32_16x16x32_bf16 v[120:123], a[144:147], v[48:51], v[120:123]
    buffer_store_dwordx4 v[108:111], v1, s[24:27], s64 offen offset:0 sc1
    v_mfma_f32_16x16x32_bf16 v[120:123], a[152:155], v[52:55], v[120:123]
    s_waitcnt lgkmcnt(2)
    ds_read_b128 v[84:87], v3 offset:24576
    v_mfma_f32_16x16x32_bf16 v[120:123], a[80:83], v[56:59], v[120:123]
    v_mfma_f32_16x16x32_bf16 v[116:119], a[156:159], v[56:59], v[116:119]
    ds_read_b128 v[88:91], v3 offset:43008
    v_mfma_f32_16x16x32_bf16 v[116:119], a[148:151], v[52:55], v[116:119]
    buffer_load_dwordx4 a[20:23], v24, s[24:27], s53 offen offset:1024 sc1
    v_mfma_f32_16x16x32_bf16 v[116:119], a[204:207], v[48:51], v[116:119]
    ds_read_b128 v[28:31], v24 offset:4096
    v_mfma_f32_16x16x32_bf16 v[116:119], a[196:199], v[44:47], v[116:119]
    v_mfma_f32_16x16x32_bf16 v[116:119], a[84:87], v[60:63], v[116:119]
    s_add_u32 s53, s76, 368640
    ds_read_b128 v[32:35], v24 offset:22528
    v_mfma_f32_16x16x32_bf16 v[116:119], a[92:95], v[64:67], v[116:119]
    buffer_load_dwordx4 a[24:27], v24, s[24:27], s53 offen offset:0 sc1
    v_mfma_f32_16x16x32_bf16 v[116:119], a[100:103], v[68:71], v[116:119]
    ds_read_b128 v[36:39], v24 offset:40960
    v_mfma_f32_16x16x32_bf16 v[116:119], a[108:111], v[72:75], v[116:119]
    v_mfma_f32_16x16x32_bf16 v[120:123], a[112:115], v[72:75], v[120:123]
    ds_read_b128 v[40:43], v2 offset:10240
    v_mfma_f32_16x16x32_bf16 v[120:123], a[104:107], v[68:71], v[120:123]
    v_mfma_f32_16x16x32_bf16 v[120:123], a[96:99], v[64:67], v[120:123]
    buffer_load_dwordx4 a[28:31], v24, s[24:27], s53 offen offset:1024 sc1
    v_mfma_f32_16x16x32_bf16 v[120:123], a[88:91], v[60:63], v[120:123]
    s_waitcnt lgkmcnt(3)
    ds_read_b128 v[44:47], v24 offset:13312
    v_mfma_f32_16x16x32_bf16 v[120:123], a[120:123], v[76:79], v[120:123]
    ds_read_b128 v[48:51], v24 offset:31744
    v_mfma_f32_16x16x32_bf16 v[120:123], a[128:131], v[80:83], v[120:123]
    v_mfma_f32_16x16x32_bf16 v[120:123], a[136:139], v[84:87], v[120:123]
    ds_read_b128 v[52:55], v2 offset:1024
    v_mfma_f32_16x16x32_bf16 v[120:123], a[180:183], v[88:91], v[120:123]
    v_mfma_f32_16x16x32_bf16 v[116:119], a[140:143], v[88:91], v[116:119]
    s_add_u32 s53, s76, 409600
    ds_read_b128 v[56:59], v2 offset:19456
    v_mfma_f32_16x16x32_bf16 v[116:119], a[132:135], v[84:87], v[116:119]
    buffer_load_dwordx4 a[32:35], v24, s[24:27], s53 offen offset:0 sc1
    v_mfma_f32_16x16x32_bf16 v[116:119], a[124:127], v[80:83], v[116:119]
    ds_read_b128 v[60:63], v2 offset:28672
    v_mfma_f32_16x16x32_bf16 v[116:119], a[116:119], v[76:79], v[116:119]
    v_mfma_f32_16x16x32_bf16 v[92:95], a[160:163], v[28:31], 0
    s_waitcnt lgkmcnt(3)
    ds_read_b128 v[64:67], v2 offset:47104
    v_mfma_f32_16x16x32_bf16 v[92:95], a[168:171], v[32:35], v[92:95]
    v_mfma_f32_16x16x32_bf16 v[92:95], a[176:179], v[36:39], v[92:95]
    buffer_load_dwordx4 a[36:39], v24, s[24:27], s53 offen offset:1024 sc1
    v_mfma_f32_16x16x32_bf16 v[92:95], a[188:191], v[40:43], v[92:95]
    ds_read_b128 v[68:71], v3 offset:16384
    v_cvt_pk_bf16_f32 v116, v116, v117
    v_mfma_f32_16x16x32_bf16 v[96:99], a[192:195], v[40:43], 0
    ds_read_b128 v[72:75], v3 offset:34816
    v_cvt_pk_bf16_f32 v117, v118, v119
    v_mfma_f32_16x16x32_bf16 v[96:99], a[184:187], v[36:39], v[96:99]
    v_cvt_pk_bf16_f32 v118, v120, v121
    v_cvt_pk_bf16_f32 v119, v122, v123
    v_mfma_f32_16x16x32_bf16 v[96:99], a[172:175], v[32:35], v[96:99]
    buffer_store_dwordx4 v[116:119], v1, s[24:27], s65 offen offset:0 sc1
    v_mfma_f32_16x16x32_bf16 v[96:99], a[164:167], v[28:31], v[96:99]
    ds_read_b128 v[76:79], v2 offset:37888
    v_mfma_f32_16x16x32_bf16 v[96:99], a[200:203], v[44:47], v[96:99]
    s_add_u32 s53, s76, 450560
    ds_read_b128 v[80:83], v3 offset:7168
    v_mfma_f32_16x16x32_bf16 v[96:99], a[144:147], v[48:51], v[96:99]
    s_waitcnt lgkmcnt(3)
    v_mfma_f32_16x16x32_bf16 v[96:99], a[152:155], v[52:55], v[96:99]
    buffer_load_dwordx4 a[40:43], v24, s[24:27], s53 offen offset:0 sc1
    v_mfma_f32_16x16x32_bf16 v[96:99], a[80:83], v[56:59], v[96:99]
    ds_read_b128 v[84:87], v3 offset:25600
    v_mfma_f32_16x16x32_bf16 v[92:95], a[156:159], v[56:59], v[92:95]
    ds_read_b128 v[88:91], v3 offset:44032
    v_mfma_f32_16x16x32_bf16 v[92:95], a[148:151], v[52:55], v[92:95]
    v_mfma_f32_16x16x32_bf16 v[92:95], a[204:207], v[48:51], v[92:95]
    buffer_load_dwordx4 a[44:47], v24, s[24:27], s53 offen offset:1024 sc1
    v_mfma_f32_16x16x32_bf16 v[92:95], a[196:199], v[44:47], v[92:95]
    ds_read_b128 v[28:31], v24 offset:5120
    v_mfma_f32_16x16x32_bf16 v[92:95], a[84:87], v[60:63], v[92:95]
    ds_read_b128 v[32:35], v24 offset:23552
    v_mfma_f32_16x16x32_bf16 v[92:95], a[92:95], v[64:67], v[92:95]
    buffer_load_dwordx2 v[6:7], v4, s[24:27], s73 offen offset:0 sc1
    v_mfma_f32_16x16x32_bf16 v[92:95], a[100:103], v[68:71], v[92:95]
    s_waitcnt lgkmcnt(3)
    ds_read_b128 v[36:39], v24 offset:41984
    v_mfma_f32_16x16x32_bf16 v[92:95], a[108:111], v[72:75], v[92:95]
    v_mfma_f32_16x16x32_bf16 v[96:99], a[112:115], v[72:75], v[96:99]
    s_add_u32 s53, s76, 491520
    ds_read_b128 v[40:43], v2 offset:11264
    v_mfma_f32_16x16x32_bf16 v[96:99], a[104:107], v[68:71], v[96:99]
    buffer_load_dwordx4 a[48:51], v24, s[24:27], s53 offen offset:0 sc1
    v_mfma_f32_16x16x32_bf16 v[96:99], a[96:99], v[64:67], v[96:99]
    ds_read_b128 v[44:47], v24 offset:14336
    v_mfma_f32_16x16x32_bf16 v[96:99], a[88:91], v[60:63], v[96:99]
    v_mfma_f32_16x16x32_bf16 v[96:99], a[120:123], v[76:79], v[96:99]
    ds_read_b128 v[48:51], v24 offset:32768
    v_mfma_f32_16x16x32_bf16 v[96:99], a[128:131], v[80:83], v[96:99]
    v_mfma_f32_16x16x32_bf16 v[96:99], a[136:139], v[84:87], v[96:99]
    buffer_load_dwordx4 a[52:55], v24, s[24:27], s53 offen offset:1024 sc1
    s_waitcnt lgkmcnt(3)
    v_mfma_f32_16x16x32_bf16 v[96:99], a[180:183], v[88:91], v[96:99]
    ds_read_b128 v[52:55], v2 offset:2048
    v_mfma_f32_16x16x32_bf16 v[92:95], a[140:143], v[88:91], v[92:95]
    ds_read_b128 v[56:59], v2 offset:20480
    v_mfma_f32_16x16x32_bf16 v[92:95], a[132:135], v[84:87], v[92:95]
    v_mfma_f32_16x16x32_bf16 v[92:95], a[124:127], v[80:83], v[92:95]
    ds_read_b128 v[60:63], v2 offset:29696
    v_mfma_f32_16x16x32_bf16 v[92:95], a[116:119], v[76:79], v[92:95]
    v_mfma_f32_16x16x32_bf16 v[100:103], a[160:163], v[28:31], 0
    s_add_u32 s53, s76, 532480
    ds_read_b128 v[64:67], v2 offset:48128
    v_mfma_f32_16x16x32_bf16 v[100:103], a[168:171], v[32:35], v[100:103]
    buffer_load_dwordx4 a[56:59], v24, s[24:27], s53 offen offset:0 sc1
    v_mfma_f32_16x16x32_bf16 v[100:103], a[176:179], v[36:39], v[100:103]
    s_waitcnt lgkmcnt(3)
    ds_read_b128 v[68:71], v3 offset:17408
    v_mfma_f32_16x16x32_bf16 v[100:103], a[188:191], v[40:43], v[100:103]
    v_cvt_pk_bf16_f32 v92, v92, v93
    v_cvt_pk_bf16_f32 v93, v94, v95
    v_mfma_f32_16x16x32_bf16 v[104:107], a[192:195], v[40:43], 0
    ds_read_b128 v[72:75], v3 offset:35840
    v_cvt_pk_bf16_f32 v94, v96, v97
    v_mfma_f32_16x16x32_bf16 v[104:107], a[184:187], v[36:39], v[104:107]
    v_cvt_pk_bf16_f32 v95, v98, v99
    v_mfma_f32_16x16x32_bf16 v[104:107], a[172:175], v[32:35], v[104:107]
    buffer_store_dwordx4 v[92:95], v1, s[24:27], s66 offen offset:0 sc1
    v_mfma_f32_16x16x32_bf16 v[104:107], a[164:167], v[28:31], v[104:107]
    ds_read_b128 v[76:79], v2 offset:38912
    v_mfma_f32_16x16x32_bf16 v[104:107], a[200:203], v[44:47], v[104:107]
    ds_read_b128 v[80:83], v3 offset:8192
    v_mfma_f32_16x16x32_bf16 v[104:107], a[144:147], v[48:51], v[104:107]
    v_mfma_f32_16x16x32_bf16 v[104:107], a[152:155], v[52:55], v[104:107]
    buffer_load_dwordx4 a[60:63], v24, s[24:27], s53 offen offset:1024 sc1
    s_waitcnt lgkmcnt(3)
    v_mfma_f32_16x16x32_bf16 v[104:107], a[80:83], v[56:59], v[104:107]
    ds_read_b128 v[84:87], v3 offset:26624
    v_mfma_f32_16x16x32_bf16 v[100:103], a[156:159], v[56:59], v[100:103]
    s_add_u32 s53, s76, 573440
    ds_read_b128 v[88:91], v3 offset:45056
    v_mfma_f32_16x16x32_bf16 v[100:103], a[148:151], v[52:55], v[100:103]
    v_mfma_f32_16x16x32_bf16 v[100:103], a[204:207], v[48:51], v[100:103]
    buffer_load_dwordx4 a[64:67], v24, s[24:27], s53 offen offset:0 sc1
    v_mfma_f32_16x16x32_bf16 v[100:103], a[196:199], v[44:47], v[100:103]
    ds_read_b128 v[28:31], v24 offset:6144
    v_mfma_f32_16x16x32_bf16 v[100:103], a[84:87], v[60:63], v[100:103]
    ds_read_b128 v[32:35], v24 offset:24576
    v_mfma_f32_16x16x32_bf16 v[100:103], a[92:95], v[64:67], v[100:103]
    v_mfma_f32_16x16x32_bf16 v[100:103], a[100:103], v[68:71], v[100:103]
    buffer_load_dwordx4 a[68:71], v24, s[24:27], s53 offen offset:1024 sc1
    s_waitcnt lgkmcnt(3)
    v_mfma_f32_16x16x32_bf16 v[100:103], a[108:111], v[72:75], v[100:103]
    ds_read_b128 v[36:39], v24 offset:43008
    v_mfma_f32_16x16x32_bf16 v[104:107], a[112:115], v[72:75], v[104:107]
    ds_read_b128 v[40:43], v2 offset:12288
    v_mfma_f32_16x16x32_bf16 v[104:107], a[104:107], v[68:71], v[104:107]
    v_mfma_f32_16x16x32_bf16 v[104:107], a[96:99], v[64:67], v[104:107]
    ds_read_b128 v[44:47], v24 offset:15360
    v_mfma_f32_16x16x32_bf16 v[104:107], a[88:91], v[60:63], v[104:107]
    v_mfma_f32_16x16x32_bf16 v[104:107], a[120:123], v[76:79], v[104:107]
    s_add_u32 s53, s76, 614400
    ds_read_b128 v[48:51], v24 offset:33792
    v_mfma_f32_16x16x32_bf16 v[104:107], a[128:131], v[80:83], v[104:107]
    buffer_load_dwordx4 a[72:75], v24, s[24:27], s53 offen offset:0 sc1
    v_mfma_f32_16x16x32_bf16 v[104:107], a[136:139], v[84:87], v[104:107]
    s_waitcnt lgkmcnt(3)
    ds_read_b128 v[52:55], v2 offset:3072
    v_mfma_f32_16x16x32_bf16 v[104:107], a[180:183], v[88:91], v[104:107]
    v_mfma_f32_16x16x32_bf16 v[100:103], a[140:143], v[88:91], v[100:103]
    ds_read_b128 v[56:59], v2 offset:21504
    v_mfma_f32_16x16x32_bf16 v[100:103], a[132:135], v[84:87], v[100:103]
    v_mfma_f32_16x16x32_bf16 v[100:103], a[124:127], v[80:83], v[100:103]
    buffer_load_dwordx4 a[76:79], v24, s[24:27], s53 offen offset:1024 sc1
    v_mfma_f32_16x16x32_bf16 v[100:103], a[116:119], v[76:79], v[100:103]
    ds_read_b128 v[60:63], v2 offset:30720
    v_mfma_f32_16x16x32_bf16 v[108:111], a[160:163], v[28:31], 0
    ds_read_b128 v[64:67], v3 offset:0
    v_mfma_f32_16x16x32_bf16 v[108:111], a[168:171], v[32:35], v[108:111]
    v_mfma_f32_16x16x32_bf16 v[108:111], a[176:179], v[36:39], v[108:111]
    s_waitcnt lgkmcnt(3)
    ds_read_b128 v[68:71], v3 offset:18432
    v_mfma_f32_16x16x32_bf16 v[108:111], a[188:191], v[40:43], v[108:111]
    v_cvt_pk_bf16_f32 v100, v100, v101
    v_cvt_pk_bf16_f32 v101, v102, v103
    v_mfma_f32_16x16x32_bf16 v[112:115], a[192:195], v[40:43], 0
    ds_read_b128 v[72:75], v3 offset:36864
    v_cvt_pk_bf16_f32 v102, v104, v105
    v_mfma_f32_16x16x32_bf16 v[112:115], a[184:187], v[36:39], v[112:115]
    v_cvt_pk_bf16_f32 v103, v106, v107
    v_mfma_f32_16x16x32_bf16 v[112:115], a[172:175], v[32:35], v[112:115]
    buffer_store_dwordx4 v[100:103], v1, s[24:27], s67 offen offset:0 sc1
    v_mfma_f32_16x16x32_bf16 v[112:115], a[164:167], v[28:31], v[112:115]
    ds_read_b128 v[76:79], v2 offset:39936
    v_mfma_f32_16x16x32_bf16 v[112:115], a[200:203], v[44:47], v[112:115]
    ds_read_b128 v[80:83], v3 offset:9216
    v_mfma_f32_16x16x32_bf16 v[112:115], a[144:147], v[48:51], v[112:115]
    v_mfma_f32_16x16x32_bf16 v[112:115], a[152:155], v[52:55], v[112:115]
    s_waitcnt lgkmcnt(3)
    ds_read_b128 v[84:87], v3 offset:27648
    v_mfma_f32_16x16x32_bf16 v[112:115], a[80:83], v[56:59], v[112:115]
    v_mfma_f32_16x16x32_bf16 v[108:111], a[156:159], v[56:59], v[108:111]
    ds_read_b128 v[88:91], v3 offset:46080
    v_mfma_f32_16x16x32_bf16 v[108:111], a[148:151], v[52:55], v[108:111]
    s_cmp_lt_u32 s71, 2
    s_cbranch_scc1 gqa_kernel_nojob1
gqa_kernel_pp1:
    s_waitcnt vmcnt(10)
    v_cmp_ne_u32 vcc, s48, v6
    v_cmp_ne_u32 s[86:87], s49, v7
    s_or_b64 vcc, vcc, s[86:87]
    s_cbranch_scc0 gqa_kernel_pp1_ok
    s_sub_u32 s50, s50, 1
    s_cbranch_scc1 gqa_kernel_pp1_ok
    s_sleep 2
    buffer_load_dwordx2 v[6:7], v4, s[24:27], s73 offen offset:0 sc1
    s_waitcnt vmcnt(0)
    s_branch gqa_kernel_pp1
gqa_kernel_pp1_ok:
    v_add_u32 v25, 40960, v24
    v_mfma_f32_16x16x32_bf16 v[140:143], v[20:23], v[188:191], 0
    v_mfma_f32_16x16x32_bf16 v[140:143], v[20:23], v[192:195], v[140:143]
    v_mfma_f32_16x16x32_bf16 v[144:147], v[18:21], v[188:191], 0
    v_mfma_f32_16x16x32_bf16 v[144:147], v[18:21], v[192:195], v[144:147]
    v_mfma_f32_16x16x32_bf16 v[148:151], v[20:23], v[196:199], 0
    v_mfma_f32_16x16x32_bf16 v[148:151], v[20:23], v[200:203], v[148:151]
    v_mfma_f32_16x16x32_bf16 v[152:155], v[18:21], v[196:199], 0
    v_mfma_f32_16x16x32_bf16 v[152:155], v[18:21], v[200:203], v[152:155]
    v_mfma_f32_16x16x32_bf16 v[156:159], v[20:23], v[204:207], 0
    v_mfma_f32_16x16x32_bf16 v[156:159], v[20:23], v[208:211], v[156:159]
    v_mfma_f32_16x16x32_bf16 v[160:163], v[18:21], v[204:207], 0
    v_mfma_f32_16x16x32_bf16 v[160:163], v[18:21], v[208:211], v[160:163]
    v_mfma_f32_16x16x32_bf16 v[164:167], v[20:23], v[212:215], 0
    v_mfma_f32_16x16x32_bf16 v[164:167], v[20:23], v[216:219], v[164:167]
    v_mfma_f32_16x16x32_bf16 v[168:171], v[18:21], v[212:215], 0
    v_mfma_f32_16x16x32_bf16 v[168:171], v[18:21], v[216:219], v[168:171]
    v_mfma_f32_16x16x32_bf16 v[172:175], v[20:23], v[220:223], 0
    v_mfma_f32_16x16x32_bf16 v[172:175], v[20:23], v[224:227], v[172:175]
    v_mfma_f32_16x16x32_bf16 v[176:179], v[18:21], v[220:223], 0
    v_mfma_f32_16x16x32_bf16 v[176:179], v[18:21], v[224:227], v[176:179]
    v_mfma_f32_16x16x32_bf16 v[180:183], v[20:23], v[228:231], 0
    v_mfma_f32_16x16x32_bf16 v[180:183], v[20:23], v[232:235], v[180:183]
    v_mfma_f32_16x16x32_bf16 v[184:187], v[18:21], v[228:231], 0
    v_mfma_f32_16x16x32_bf16 v[184:187], v[18:21], v[232:235], v[184:187]
gqa_kernel_nojob1:
    v_mfma_f32_16x16x32_bf16 v[108:111], a[204:207], v[48:51], v[108:111]
    buffer_load_dwordx4 v[188:191], v25, s[24:27], s77 offen offset:0 sc1
    v_mfma_f32_16x16x32_bf16 v[108:111], a[196:199], v[44:47], v[108:111]
    ds_read_b128 v[28:31], v24 offset:7168
    v_mfma_f32_16x16x32_bf16 v[108:111], a[84:87], v[60:63], v[108:111]
    ds_read_b128 v[32:35], v24 offset:25600
    v_mfma_f32_16x16x32_bf16 v[108:111], a[92:95], v[64:67], v[108:111]
    v_mfma_f32_16x16x32_bf16 v[108:111], a[100:103], v[68:71], v[108:111]
    s_waitcnt lgkmcnt(2)
    ds_read_b128 v[36:39], v24 offset:44032
    v_mfma_f32_16x16x32_bf16 v[108:111], a[108:111], v[72:75], v[108:111]
    buffer_load_dwordx4 v[192:195], v25, s[24:27], s77 offen offset:1024 sc1
    v_mfma_f32_16x16x32_bf16 v[112:115], a[112:115], v[72:75], v[112:115]
    ds_read_b128 v[40:43], v2 offset:13312
    v_mfma_f32_16x16x32_bf16 v[112:115], a[104:107], v[68:71], v[112:115]
    v_mfma_f32_16x16x32_bf16 v[112:115], a[96:99], v[64:67], v[112:115]
    ds_read_b128 v[44:47], v24 offset:16384
    v_mfma_f32_16x16x32_bf16 v[112:115], a[88:91], v[60:63], v[112:115]
    v_mfma_f32_16x16x32_bf16 v[112:115], a[120:123], v[76:79], v[112:115]
    s_add_u32 s41, s77, 81920
    ds_read_b128 v[48:51], v24 offset:34816
    v_mfma_f32_16x16x32_bf16 v[112:115], a[128:131], v[80:83], v[112:115]
    buffer_load_dwordx4 v[196:199], v25, s[24:27], s41 offen offset:0 sc1
    v_mfma_f32_16x16x32_bf16 v[112:115], a[136:139], v[84:87], v[112:115]
    s_waitcnt lgkmcnt(3)
    ds_read_b128 v[52:55], v2 offset:4096
    v_mfma_f32_16x16x32_bf16 v[112:115], a[180:183], v[88:91], v[112:115]
    v_mfma_f32_16x16x32_bf16 v[108:111], a[140:143], v[88:91], v[108:111]
    ds_read_b128 v[56:59], v2 offset:22528
    v_mfma_f32_16x16x32_bf16 v[108:111], a[132:135], v[84:87], v[108:111]
    buffer_load_dwordx4 v[200:203], v25, s[24:27], s41 offen offset:1024 sc1
    v_mfma_f32_16x16x32_bf16 v[108:111], a[124:127], v[80:83], v[108:111]
    ds_read_b128 v[60:63], v2 offset:31744
    v_mfma_f32_16x16x32_bf16 v[108:111], a[116:119], v[76:79], v[108:111]
    v_mfma_f32_16x16x32_bf16 v[116:119], a[160:163], v[28:31], 0
    ds_read_b128 v[64:67], v3 offset:1024
    v_mfma_f32_16x16x32_bf16 v[116:119], a[168:171], v[32:35], v[116:119]
    v_mfma_f32_16x16x32_bf16 v[116:119], a[176:179], v[36:39], v[116:119]
    s_add_u32 s41, s77, 163840
    ds_read_b128 v[68:71], v3 offset:19456
    s_waitcnt lgkmcnt(4)
    v_mfma_f32_16x16x32_bf16 v[116:119], a[188:191], v[40:43], v[116:119]
    buffer_load_dwordx4 v[204:207], v25, s[24:27], s41 offen offset:0 sc1
    v_mfma_f32_16x16x32_bf16 v[120:123], a[192:195], v[40:43], 0
    ds_read_b128 v[72:75], v3 offset:37888
    v_cvt_pk_bf16_f32 v108, v108, v109
    v_mfma_f32_16x16x32_bf16 v[120:123], a[184:187], v[36:39], v[120:123]
    v_cvt_pk_bf16_f32 v109, v110, v111
    v_cvt_pk_bf16_f32 v110, v112, v113
    v_mfma_f32_16x16x32_bf16 v[120:123], a[172:175], v[32:35], v[120:123]
    ds_read_b128 v[76:79], v2 offset:40960
    v_cvt_pk_bf16_f32 v111, v114, v115
    v_mfma_f32_16x16x32_bf16 v[120:123], a[164:167], v[28:31], v[120:123]
    buffer_store_dwordx4 v[108:111], v1, s[24:27], s68 offen offset:0 sc1
    v_mfma_f32_16x16x32_bf16 v[120:123], a[200:203], v[44:47], v[120:123]
    ds_read_b128 v[80:83], v3 offset:10240
    v_mfma_f32_16x16x32_bf16 v[120:123], a[144:147], v[48:51], v[120:123]
    v_mfma_f32_16x16x32_bf16 v[120:123], a[152:155], v[52:55], v[120:123]
    s_waitcnt lgkmcnt(2)
    ds_read_b128 v[84:87], v3 offset:28672
    v_mfma_f32_16x16x32_bf16 v[120:123], a[80:83], v[56:59], v[120:123]
    buffer_load_dwordx4 v[208:211], v25, s[24:27], s41 offen offset:1024 sc1
    v_mfma_f32_16x16x32_bf16 v[116:119], a[156:159], v[56:59], v[116:119]
    s_add_u32 s41, s77, 245760
    ds_read_b128 v[88:91], v3 offset:47104
    v_mfma_f32_16x16x32_bf16 v[116:119], a[148:151], v[52:55], v[116:119]
    v_mfma_f32_16x16x32_bf16 v[116:119], a[204:207], v[48:51], v[116:119]
    ds_read_b128 v[28:31], v24 offset:8192
    v_mfma_f32_16x16x32_bf16 v[116:119], a[196:199], v[44:47], v[116:119]
    buffer_load_dwordx4 v[212:215], v25, s[24:27], s41 offen offset:0 sc1
    v_mfma_f32_16x16x32_bf16 v[116:119], a[84:87], v[60:63], v[116:119]
    ds_read_b128 v[32:35], v24 offset:26624
    v_mfma_f32_16x16x32_bf16 v[116:119], a[92:95], v[64:67], v[116:119]
    v_mfma_f32_16x16x32_bf16 v[116:119], a[100:103], v[68:71], v[116:119]
    ds_read_b128 v[36:39], v24 offset:45056
    v_mfma_f32_16x16x32_bf16 v[116:119], a[108:111], v[72:75], v[116:119]
    buffer_load_dwordx4 v[216:219], v25, s[24:27], s41 offen offset:1024 sc1
    v_mfma_f32_16x16x32_bf16 v[120:123], a[112:115], v[72:75], v[120:123]
    ds_read_b128 v[40:43], v2 offset:14336
    v_mfma_f32_16x16x32_bf16 v[120:123], a[104:107], v[68:71], v[120:123]
    v_mfma_f32_16x16x32_bf16 v[120:123], a[96:99], v[64:67], v[120:123]
    ds_read_b128 v[44:47], v24 offset:17408
    v_mfma_f32_16x16x32_bf16 v[120:123], a[88:91], v[60:63], v[120:123]
    buffer_load_dwordx4 v[220:223], v25, s[24:27], s79 offen offset:0 sc1
    s_waitcnt lgkmcnt(4)
    v_mfma_f32_16x16x32_bf16 v[120:123], a[120:123], v[76:79], v[120:123]
    ds_read_b128 v[48:51], v24 offset:35840
    v_mfma_f32_16x16x32_bf16 v[120:123], a[128:131], v[80:83], v[120:123]
    v_mfma_f32_16x16x32_bf16 v[120:123], a[136:139], v[84:87], v[120:123]
    ds_read_b128 v[52:55], v2 offset:5120
    v_mfma_f32_16x16x32_bf16 v[120:123], a[180:183], v[88:91], v[120:123]
    buffer_load_dwordx4 v[224:227], v25, s[24:27], s79 offen offset:1024 sc1
    v_mfma_f32_16x16x32_bf16 v[116:119], a[140:143], v[88:91], v[116:119]
    ds_read_b128 v[56:59], v2 offset:23552
    v_mfma_f32_16x16x32_bf16 v[116:119], a[132:135], v[84:87], v[116:119]
    v_mfma_f32_16x16x32_bf16 v[116:119], a[124:127], v[80:83], v[116:119]
    ds_read_b128 v[60:63], v2 offset:32768
    v_mfma_f32_16x16x32_bf16 v[116:119], a[116:119], v[76:79], v[116:119]
    v_mfma_f32_16x16x32_bf16 v[124:127], a[160:163], v[28:31], 0
    buffer_load_dwordx4 v[228:231], v25, s[24:27], s80 offen offset:0 sc1
    s_waitcnt lgkmcnt(3)
    v_mfma_f32_16x16x32_bf16 v[124:127], a[168:171], v[32:35], v[124:127]
    ds_read_b128 v[64:67], v3 offset:2048
    v_mfma_f32_16x16x32_bf16 v[124:127], a[176:179], v[36:39], v[124:127]
    ds_read_b128 v[68:71], v3 offset:20480
    v_mfma_f32_16x16x32_bf16 v[124:127], a[188:191], v[40:43], v[124:127]
    v_cvt_pk_bf16_f32 v116, v116, v117
    v_cvt_pk_bf16_f32 v117, v118, v119
    v_mfma_f32_16x16x32_bf16 v[128:131], a[192:195], v[40:43], 0
    ds_read_b128 v[72:75], v3 offset:38912
    v_cvt_pk_bf16_f32 v118, v120, v121
    v_mfma_f32_16x16x32_bf16 v[128:131], a[184:187], v[36:39], v[128:131]
    buffer_load_dwordx4 v[232:235], v25, s[24:27], s80 offen offset:1024 sc1
    v_mfma_f32_16x16x32_bf16 v[128:131], a[172:175], v[32:35], v[128:131]
    ds_read_b128 v[76:79], v2 offset:41984
    v_cvt_pk_bf16_f32 v119, v122, v123
    v_mfma_f32_16x16x32_bf16 v[128:131], a[164:167], v[28:31], v[128:131]
    v_mfma_f32_16x16x32_bf16 v[128:131], a[200:203], v[44:47], v[128:131]
    ds_read_b128 v[80:83], v3 offset:11264
    v_mfma_f32_16x16x32_bf16 v[128:131], a[144:147], v[48:51], v[128:131]
    buffer_store_dwordx4 v[116:119], v1, s[24:27], s69 offen offset:0 sc1
    s_waitcnt lgkmcnt(3)
    v_mfma_f32_16x16x32_bf16 v[128:131], a[152:155], v[52:55], v[128:131]
    ds_read_b128 v[84:87], v3 offset:29696
    v_mfma_f32_16x16x32_bf16 v[128:131], a[80:83], v[56:59], v[128:131]
    v_mfma_f32_16x16x32_bf16 v[124:127], a[156:159], v[56:59], v[124:127]
    ds_read_b128 v[88:91], v3 offset:48128
    v_mfma_f32_16x16x32_bf16 v[124:127], a[148:151], v[52:55], v[124:127]
    v_mfma_f32_16x16x32_bf16 v[124:127], a[204:207], v[48:51], v[124:127]
    ds_read_b128 v[28:31], v24 offset:0
    v_mfma_f32_16x16x32_bf16 v[124:127], a[196:199], v[44:47], v[124:127]
    v_mfma_f32_16x16x32_bf16 v[124:127], a[84:87], v[60:63], v[124:127]
    ds_read_b128 v[32:35], v24 offset:18432
    s_add_u32 s72, s72, 128
    v_mfma_f32_16x16x32_bf16 v[124:127], a[92:95], v[64:67], v[124:127]
    s_add_u32 s71, s71, 1
    s_bitset0_b32 s72, 30
    v_mfma_f32_16x16x32_bf16 v[124:127], a[100:103], v[68:71], v[124:127]
    ds_read_b128 v[36:39], v24 offset:36864
    s_bitset0_b32 s73, 30
    s_waitcnt lgkmcnt(3)
    v_mfma_f32_16x16x32_bf16 v[124:127], a[108:111], v[72:75], v[124:127]
    v_mfma_f32_16x16x32_bf16 v[128:131], a[112:115], v[72:75], v[128:131]
    ds_read_b128 v[40:43], v2 offset:6144
    v_mfma_f32_16x16x32_bf16 v[128:131], a[104:107], v[68:71], v[128:131]
    v_mfma_f32_16x16x32_bf16 v[128:131], a[96:99], v[64:67], v[128:131]
    ds_read_b128 v[44:47], v24 offset:9216
    v_mfma_f32_16x16x32_bf16 v[128:131], a[88:91], v[60:63], v[128:131]
    v_mfma_f32_16x16x32_bf16 v[128:131], a[120:123], v[76:79], v[128:131]
    ds_read_b128 v[48:51], v24 offset:27648
    v_mfma_f32_16x16x32_bf16 v[128:131], a[128:131], v[80:83], v[128:131]
    v_mfma_f32_16x16x32_bf16 v[128:131], a[136:139], v[84:87], v[128:131]
    ds_read_b128 v[52:55], v24 offset:46080
    v_mfma_f32_16x16x32_bf16 v[128:131], a[180:183], v[88:91], v[128:131]
    v_mfma_f32_16x16x32_bf16 v[124:127], a[140:143], v[88:91], v[124:127]
    ds_read_b128 v[56:59], v2 offset:15360
    v_mfma_f32_16x16x32_bf16 v[124:127], a[132:135], v[84:87], v[124:127]
    v_mfma_f32_16x16x32_bf16 v[124:127], a[124:127], v[80:83], v[124:127]
    v_mfma_f32_16x16x32_bf16 v[124:127], a[116:119], v[76:79], v[124:127]
    s_add_u32 s73, s73, 128
    s_branch gqa_kernel_pass0
gqa_kernel_ptail:
    v_add_u32 v25, 778240, v24
gqa_kernel_pp4:
    s_waitcnt vmcnt(5)
    v_cmp_ne_u32 vcc, s48, v26
    v_cmp_ne_u32 s[86:87], s49, v27
    s_or_b64 vcc, vcc, s[86:87]
    s_cbranch_scc0 gqa_kernel_pp4_ok
    s_sub_u32 s50, s50, 1
    s_cbranch_scc1 gqa_kernel_pp4_ok
    buffer_load_dwordx2 v[26:27], v4, s[24:27], s73 offen offset:128 sc1
    s_waitcnt vmcnt(0)
    s_branch gqa_kernel_pp4
gqa_kernel_pp4_ok:
    buffer_load_dwordx4 v[60:63], v25, s[24:27], s83 offen offset:0 sc1
    s_add_u32 s41, s83, 81920
    buffer_load_dwordx4 v[64:67], v25, s[24:27], s41 offen offset:0 sc1
    s_add_u32 s41, s83, 163840
    buffer_load_dwordx4 v[68:71], v25, s[24:27], s41 offen offset:0 sc1
    s_add_u32 s41, s83, 245760
    buffer_load_dwordx4 v[72:75], v25, s[24:27], s41 offen offset:0 sc1
    buffer_load_dwordx4 v[76:79], v25, s[24:27], s79 offen offset:0 sc1
    buffer_load_dwordx4 v[80:83], v25, s[24:27], s79 offen offset:1024 sc1
    buffer_load_dwordx4 v[84:87], v25, s[24:27], s80 offen offset:0 sc1
    buffer_load_dwordx4 v[88:91], v25, s[24:27], s80 offen offset:1024 sc1
    s_waitcnt vmcnt(12)
    v_mfma_f32_16x16x32_bf16 v[172:175], v[20:23], v[220:223], v[172:175]
    s_waitcnt vmcnt(11)
    v_mfma_f32_16x16x32_bf16 v[172:175], v[20:23], v[224:227], v[172:175]
    v_mfma_f32_16x16x32_bf16 v[176:179], v[18:21], v[220:223], v[176:179]
    v_mfma_f32_16x16x32_bf16 v[176:179], v[18:21], v[224:227], v[176:179]
    s_waitcnt vmcnt(10)
    v_mfma_f32_16x16x32_bf16 v[180:183], v[20:23], v[228:231], v[180:183]
    s_waitcnt vmcnt(8)
    v_mfma_f32_16x16x32_bf16 v[180:183], v[20:23], v[232:235], v[180:183]
    v_mfma_f32_16x16x32_bf16 v[184:187], v[18:21], v[228:231], v[184:187]
    v_mfma_f32_16x16x32_bf16 v[184:187], v[18:21], v[232:235], v[184:187]
    v_add_f32 v140, v140, v100
    v_add_f32 v141, v141, v101
    v_add_f32 v142, v142, v102
    v_add_f32 v143, v143, v103
    v_add_f32 v144, v144, v104
    v_add_f32 v145, v145, v105
    v_add_f32 v146, v146, v106
    v_add_f32 v147, v147, v107
    v_mfma_f32_16x16x32_bf16 v[140:143], v[20:23], v[188:191], v[140:143]
    v_mfma_f32_16x16x32_bf16 v[140:143], v[20:23], v[192:195], v[140:143]
    v_mfma_f32_16x16x32_bf16 v[144:147], v[18:21], v[188:191], v[144:147]
    v_mfma_f32_16x16x32_bf16 v[144:147], v[18:21], v[192:195], v[144:147]
    v_add_f32 v148, v148, v108
    v_add_f32 v149, v149, v109
    v_add_f32 v150, v150, v110
    v_add_f32 v151, v151, v111
    v_add_f32 v152, v152, v112
    v_add_f32 v153, v153, v113
    v_add_f32 v154, v154, v114
    v_add_f32 v155, v155, v115
    v_mfma_f32_16x16x32_bf16 v[148:151], v[20:23], v[196:199], v[148:151]
    v_mfma_f32_16x16x32_bf16 v[148:151], v[20:23], v[200:203], v[148:151]
    v_mfma_f32_16x16x32_bf16 v[152:155], v[18:21], v[196:199], v[152:155]
    v_mfma_f32_16x16x32_bf16 v[152:155], v[18:21], v[200:203], v[152:155]
    v_add_f32 v156, v156, v116
    v_add_f32 v157, v157, v117
    v_add_f32 v158, v158, v118
    v_add_f32 v159, v159, v119
    v_add_f32 v160, v160, v120
    v_add_f32 v161, v161, v121
    v_add_f32 v162, v162, v122
    v_add_f32 v163, v163, v123
    v_mfma_f32_16x16x32_bf16 v[156:159], v[20:23], v[204:207], v[156:159]
    v_mfma_f32_16x16x32_bf16 v[156:159], v[20:23], v[208:211], v[156:159]
    v_mfma_f32_16x16x32_bf16 v[160:163], v[18:21], v[204:207], v[160:163]
    v_mfma_f32_16x16x32_bf16 v[160:163], v[18:21], v[208:211], v[160:163]
    v_add_f32 v164, v164, v124
    v_add_f32 v165, v165, v125
    v_add_f32 v166, v166, v126
    v_add_f32 v167, v167, v127
    v_add_f32 v168, v168, v128
    v_add_f32 v169, v169, v129
    v_add_f32 v170, v170, v130
    v_add_f32 v171, v171, v131
    v_mfma_f32_16x16x32_bf16 v[164:167], v[20:23], v[212:215], v[164:167]
    v_mfma_f32_16x16x32_bf16 v[164:167], v[20:23], v[216:219], v[164:167]
    v_mfma_f32_16x16x32_bf16 v[168:171], v[18:21], v[212:215], v[168:171]
    v_mfma_f32_16x16x32_bf16 v[168:171], v[18:21], v[216:219], v[168:171]
    s_waitcnt vmcnt(7)
    v_mfma_f32_16x16x32_bf16 v[140:143], v[20:23], v[60:63], v[140:143]
    v_mfma_f32_16x16x32_bf16 v[144:147], v[18:21], v[60:63], v[144:147]
    s_waitcnt vmcnt(6)
    v_mfma_f32_16x16x32_bf16 v[148:151], v[20:23], v[64:67], v[148:151]
    v_mfma_f32_16x16x32_bf16 v[152:155], v[18:21], v[64:67], v[152:155]
    s_nop 3
    v_cvt_pk_bf16_f32 v140, v140, v141
    v_cvt_pk_bf16_f32 v141, v142, v143
    v_cvt_pk_bf16_f32 v142, v144, v145
    v_cvt_pk_bf16_f32 v143, v146, v147
    ds_write_b128 v237, v[140:143] offset:1024
    ds_read_b128 v[144:147], v238 offset:1024
    s_waitcnt vmcnt(5)
    v_mfma_f32_16x16x32_bf16 v[156:159], v[20:23], v[68:71], v[156:159]
    v_mfma_f32_16x16x32_bf16 v[160:163], v[18:21], v[68:71], v[160:163]
    v_cvt_pk_bf16_f32 v148, v148, v149
    v_cvt_pk_bf16_f32 v149, v150, v151
    v_cvt_pk_bf16_f32 v150, v152, v153
    v_cvt_pk_bf16_f32 v151, v154, v155
    ds_write_b128 v237, v[148:151] offset:2048
    ds_read_b128 v[152:155], v238 offset:2048
    s_waitcnt lgkmcnt(2)
    buffer_store_dwordx4 v[144:147], v5, s[32:35], s52 offen offset:0 sc1
    s_waitcnt vmcnt(5)
    v_mfma_f32_16x16x32_bf16 v[164:167], v[20:23], v[72:75], v[164:167]
    v_mfma_f32_16x16x32_bf16 v[168:171], v[18:21], v[72:75], v[168:171]
    v_cvt_pk_bf16_f32 v156, v156, v157
    v_cvt_pk_bf16_f32 v157, v158, v159
    v_cvt_pk_bf16_f32 v158, v160, v161
    v_cvt_pk_bf16_f32 v159, v162, v163
    ds_write_b128 v237, v[156:159] offset:3072
    ds_read_b128 v[160:163], v238 offset:3072
    s_add_u32 s52, s52, 20480
    s_waitcnt lgkmcnt(2)
    buffer_store_dwordx4 v[152:155], v5, s[32:35], s52 offen offset:0 sc1
    s_waitcnt vmcnt(5)
    v_mfma_f32_16x16x32_bf16 v[172:175], v[20:23], v[76:79], v[172:175]
    s_waitcnt vmcnt(4)
    v_mfma_f32_16x16x32_bf16 v[172:175], v[20:23], v[80:83], v[172:175]
    v_mfma_f32_16x16x32_bf16 v[176:179], v[18:21], v[76:79], v[176:179]
    v_mfma_f32_16x16x32_bf16 v[176:179], v[18:21], v[80:83], v[176:179]
    v_cvt_pk_bf16_f32 v164, v164, v165
    v_cvt_pk_bf16_f32 v165, v166, v167
    v_cvt_pk_bf16_f32 v166, v168, v169
    v_cvt_pk_bf16_f32 v167, v170, v171
    ds_write_b128 v237, v[164:167] offset:1024
    ds_read_b128 v[168:171], v238 offset:1024
    s_add_u32 s52, s52, 20480
    s_waitcnt lgkmcnt(2)
    buffer_store_dwordx4 v[160:163], v5, s[32:35], s52 offen offset:0 sc1
    s_waitcnt vmcnt(4)
    v_mfma_f32_16x16x32_bf16 v[180:183], v[20:23], v[84:87], v[180:183]
    s_waitcnt vmcnt(3)
    v_mfma_f32_16x16x32_bf16 v[180:183], v[20:23], v[88:91], v[180:183]
    v_mfma_f32_16x16x32_bf16 v[184:187], v[18:21], v[84:87], v[184:187]
    v_mfma_f32_16x16x32_bf16 v[184:187], v[18:21], v[88:91], v[184:187]
    v_cvt_pk_bf16_f32 v172, v172, v173
    v_cvt_pk_bf16_f32 v173, v174, v175
    v_cvt_pk_bf16_f32 v174, v176, v177
    v_cvt_pk_bf16_f32 v175, v178, v179
    ds_write_b128 v237, v[172:175] offset:2048
    ds_read_b128 v[176:179], v238 offset:2048
    s_add_u32 s52, s52, 20480
    s_waitcnt lgkmcnt(2)
    buffer_store_dwordx4 v[168:171], v5, s[32:35], s52 offen offset:0 sc1
    v_cvt_pk_bf16_f32 v180, v180, v181
    v_cvt_pk_bf16_f32 v181, v182, v183
    v_cvt_pk_bf16_f32 v182, v184, v185
    v_cvt_pk_bf16_f32 v183, v186, v187
    ds_write_b128 v237, v[180:183] offset:3072
    ds_read_b128 v[184:187], v238 offset:3072
    s_waitcnt lgkmcnt(2)
    buffer_store_dwordx4 v[176:179], v5, s[32:35], s61 offen offset:0 sc1
    s_waitcnt lgkmcnt(0)
    buffer_store_dwordx4 v[184:187], v5, s[32:35], s100 offen offset:0 sc1
gqa_kernel_end:
    s_endpgm
gqa_kernel_fb:
    s_waitcnt vmcnt(0) lgkmcnt(0)
    s_cmp_lg_u64 s[54:55], 0
    s_cbranch_scc1 gqa_kernel_slow
gqa_kernel_P2:
    s_waitcnt vmcnt(0) lgkmcnt(0)
    s_barrier
    ds_read_b128 v[28:31], v24 offset:0
    ds_read_b128 v[32:35], v24 offset:18432
    ds_read_b128 v[36:39], v24 offset:36864
    ds_read_b128 v[40:43], v2 offset:6144
    ds_read_b128 v[44:47], v24 offset:9216
    ds_read_b128 v[48:51], v24 offset:27648
    ds_read_b128 v[52:55], v24 offset:46080
    ds_read_b128 v[56:59], v2 offset:15360
    v_mov_b32 v1, 0x40000000
    v_mov_b32 v25, 0x40000000
    v_bfe_u32 v4, v24, 4, 3
    v_lshlrev_b32 v4, 3, v4
    v_bfe_u32 v244, v24, 4, 4
    s_movk_i32 s40, 1280
    v_mul_lo_u32 v5, v244, s40
    v_lshrrev_b32 v245, 8, v24
    v_lshl_add_u32 v5, v245, 4, v5
    v_lshrrev_b32 v246, 2, v244
    v_xor_b32 v246, v246, v245
    v_lshl_add_u32 v246, v244, 2, v246
    s_lshl_b32 s41, s3, 12
    s_add_u32 s41, s41, 147456
    v_lshl_add_u32 v237, v246, 4, s41
    v_add_u32 v238, s41, v24
    v_lshrrev_b32 v246, 6, v24
    v_mul_lo_u32 v5, v246, s40
    v_and_b32 v246, 3, v244
    v_xor_b32 v246, v246, v245
    v_lshl_add_u32 v5, v246, 4, v5
    v_mov_b32 v8, s48
    v_mov_b32 v9, s49
    v_and_b32 v246, 1, v244
    v_lshlrev_b32 v246, 4, v246
    s_movk_i32 s40, 0x3f80
    v_lshlrev_b32 v246, v246, s40
    v_lshrrev_b32 v244, 1, v244
    v_lshlrev_b32 v245, 1, v245
    v_sub_u32 v244, v244, v245
    v_cmp_eq_u32 vcc, 0, v244
    v_mov_b32 v18, 0
    v_mov_b32 v22, 0
    v_cndmask_b32 v20, 0, v246, vcc
    v_cmp_eq_u32 vcc, 1, v244
    v_mov_b32 v19, 0
    v_mov_b32 v23, 0
    v_cndmask_b32 v21, 0, v246, vcc
    s_waitcnt lgkmcnt(0)
    s_branch gqa_kernel_pass0
gqa_kernel_fbw:
    s_waitcnt vmcnt(0) lgkmcnt(0)
    s_branch gqa_kernel_pass1
gqa_kernel_slow:
    s_waitcnt vmcnt(0) lgkmcnt(0)
    v_bfe_u32 v40, v24, 4, 4
    v_lshrrev_b32 v41, 8, v24
    v_lshlrev_b32 v28, 16, v41
    v_lshl_add_u32 v28, v40, 1, v28
    v_add_u32 v29, 8192, v28
    v_add_u32 v30, 16384, v28
    v_add_u32 v31, 24576, v28
    v_add_u32 v32, 32768, v28
    v_add_u32 v33, 40960, v28
    v_add_u32 v34, 49152, v28
    v_add_u32 v35, 57344, v28
    s_movk_i32 s40, 1280
    v_mul_lo_u32 v36, v40, s40
    v_lshl_add_u32 v36, v41, 4, v36
    v_lshlrev_b32 v37, 8, v40
    v_lshl_add_u32 v37, v41, 3, v37
    v_lshlrev_b32 v38, 10, v41
    v_lshl_add_u32 v38, v40, 1, v38
    s_mov_b32 s56, 0
gqa_kernel_sl_it:
    s_cmp_ge_u32 s56, 5
    s_cselect_b32 s40, 2, 0
    s_cselect_b32 s41, 5, 0
    s_cselect_b32 s89, 73728, 0
    s_sub_u32 s41, s56, s41
    s_add_u32 s40, s40, s44
    s_mul_i32 s45, s44, 9216
    s_add_u32 s89, s89, s45
    s_lshl_b32 s45, s43, 2
    s_add_u32 s40, s40, s45
    s_lshl_b32 s59, s40, 8
    s_lshl_b32 s45, s42, 5
    s_add_u32 s40, s40, s45
    s_lshl_b32 s88, s40, 17
    s_lshl_b32 s40, s95, 2
    s_add_u32 s40, s40, s41
    s_cmp_lt_u32 s43, 5
    s_cselect_b32 s45, 4, 0
    s_xor_b32 s45, s45, s40
    s_add_u32 s45, s45, 1
    s_cmp_eq_u32 s41, 4
    s_cselect_b32 s40, 8, s40
    s_cselect_b32 s45, 0, s45
    s_lshl_b32 s45, s45, 10
    s_add_u32 s89, s89, s45
    v_add_u32 v39, s89, v24
    s_mul_i32 s45, s42, 9
    s_add_u32 s40, s40, s45
    s_mul_i32 s58, s40, 20480
    v_mov_b32 v84, 0
    v_mov_b32 v85, 0
    v_mov_b32 v86, 0
    v_mov_b32 v87, 0
    v_mov_b32 v88, 0
    v_mov_b32 v89, 0
    v_mov_b32 v90, 0
    v_mov_b32 v91, 0
    v_mov_b32 v92, 0
    v_mov_b32 v93, 0
    v_mov_b32 v94, 0
    v_mov_b32 v95, 0
    v_mov_b32 v96, 0
    v_mov_b32 v97, 0
    v_mov_b32 v98, 0
    v_mov_b32 v99, 0
    v_mov_b32 v100, 0
    v_mov_b32 v101, 0
    v_mov_b32 v102, 0
    v_mov_b32 v103, 0
    v_mov_b32 v104, 0
    v_mov_b32 v105, 0
    v_mov_b32 v106, 0
    v_mov_b32 v107, 0
    v_mov_b32 v108, 0
    v_mov_b32 v109, 0
    v_mov_b32 v110, 0
    v_mov_b32 v111, 0
    v_mov_b32 v112, 0
    v_mov_b32 v113, 0
    v_mov_b32 v114, 0
    v_mov_b32 v115, 0
    s_mov_b32 s57, 0
gqa_kernel_sl_q:
    buffer_load_dwordx4 v[76:79], v36, s[8:11], s58 offen offset:0
    buffer_load_ushort v116, v28, s[20:23], s59 offen offset:0
    buffer_load_ushort v117, v29, s[20:23], s59 offen offset:0
    buffer_load_ushort v118, v30, s[20:23], s59 offen offset:0
    buffer_load_ushort v119, v31, s[20:23], s59 offen offset:0
    buffer_load_ushort v120, v32, s[20:23], s59 offen offset:0
    buffer_load_ushort v121, v33, s[20:23], s59 offen offset:0
    buffer_load_ushort v122, v34, s[20:23], s59 offen offset:0
    buffer_load_ushort v123, v35, s[20:23], s59 offen offset:0
    buffer_load_ushort v124, v28, s[20:23], s59 offen offset:32
    buffer_load_ushort v125, v29, s[20:23], s59 offen offset:32
    buffer_load_ushort v126, v30, s[20:23], s59 offen offset:32
    buffer_load_ushort v127, v31, s[20:23], s59 offen offset:32
    buffer_load_ushort v128, v32, s[20:23], s59 offen offset:32
    buffer_load_ushort v129, v33, s[20:23], s59 offen offset:32
    buffer_load_ushort v130, v34, s[20:23], s59 offen offset:32
    buffer_load_ushort v131, v35, s[20:23], s59 offen offset:32
    buffer_load_ushort v132, v28, s[20:23], s59 offen offset:64
    buffer_load_ushort v133, v29, s[20:23], s59 offen offset:64
    buffer_load_ushort v134, v30, s[20:23], s59 offen offset:64
    buffer_load_ushort v135, v31, s[20:23], s59 offen offset:64
    buffer_load_ushort v136, v32, s[20:23], s59 offen offset:64
    buffer_load_ushort v137, v33, s[20:23], s59 offen offset:64
    buffer_load_ushort v138, v34, s[20:23], s59 offen offset:64
    buffer_load_ushort v139, v35, s[20:23], s59 offen offset:64
    buffer_load_ushort v140, v28, s[20:23], s59 offen offset:96
    buffer_load_ushort v141, v29, s[20:23], s59 offen offset:96
    buffer_load_ushort v142, v30, s[20:23], s59 offen offset:96
    buffer_load_ushort v143, v31, s[20:23], s59 offen offset:96
    buffer_load_ushort v144, v32, s[20:23], s59 offen offset:96
    buffer_load_ushort v145, v33, s[20:23], s59 offen offset:96
    buffer_load_ushort v146, v34, s[20:23], s59 offen offset:96
    buffer_load_ushort v147, v35, s[20:23], s59 offen offset:96
    s_waitcnt vmcnt(0) lgkmcnt(0)
    buffer_load_ushort v148, v28, s[20:23], s59 offen offset:128
    buffer_load_ushort v149, v29, s[20:23], s59 offen offset:128
    buffer_load_ushort v150, v30, s[20:23], s59 offen offset:128
    buffer_load_ushort v151, v31, s[20:23], s59 offen offset:128
    buffer_load_ushort v152, v32, s[20:23], s59 offen offset:128
    buffer_load_ushort v153, v33, s[20:23], s59 offen offset:128
    buffer_load_ushort v154, v34, s[20:23], s59 offen offset:128
    buffer_load_ushort v155, v35, s[20:23], s59 offen offset:128
    buffer_load_ushort v156, v28, s[20:23], s59 offen offset:160
    buffer_load_ushort v157, v29, s[20:23], s59 offen offset:160
    buffer_load_ushort v158, v30, s[20:23], s59 offen offset:160
    buffer_load_ushort v159, v31, s[20:23], s59 offen offset:160
    buffer_load_ushort v160, v32, s[20:23], s59 offen offset:160
    buffer_load_ushort v161, v33, s[20:23], s59 offen offset:160
    buffer_load_ushort v162, v34, s[20:23], s59 offen offset:160
    buffer_load_ushort v163, v35, s[20:23], s59 offen offset:160
    buffer_load_ushort v164, v28, s[20:23], s59 offen offset:192
    buffer_load_ushort v165, v29, s[20:23], s59 offen offset:192
    buffer_load_ushort v166, v30, s[20:23], s59 offen offset:192
    buffer_load_ushort v167, v31, s[20:23], s59 offen offset:192
    buffer_load_ushort v168, v32, s[20:23], s59 offen offset:192
    buffer_load_ushort v169, v33, s[20:23], s59 offen offset:192
    buffer_load_ushort v170, v34, s[20:23], s59 offen offset:192
    buffer_load_ushort v171, v35, s[20:23], s59 offen offset:192
    buffer_load_ushort v172, v28, s[20:23], s59 offen offset:224
    buffer_load_ushort v173, v29, s[20:23], s59 offen offset:224
    buffer_load_ushort v174, v30, s[20:23], s59 offen offset:224
    buffer_load_ushort v175, v31, s[20:23], s59 offen offset:224
    buffer_load_ushort v176, v32, s[20:23], s59 offen offset:224
    buffer_load_ushort v177, v33, s[20:23], s59 offen offset:224
    buffer_load_ushort v178, v34, s[20:23], s59 offen offset:224
    buffer_load_ushort v179, v35, s[20:23], s59 offen offset:224
    s_waitcnt vmcnt(0) lgkmcnt(0)
    v_lshl_or_b32 v180, v117, 16, v116
    v_lshl_or_b32 v181, v119, 16, v118
    v_lshl_or_b32 v182, v121, 16, v120
    v_lshl_or_b32 v183, v123, 16, v122
    v_lshl_or_b32 v184, v125, 16, v124
    v_lshl_or_b32 v185, v127, 16, v126
    v_lshl_or_b32 v186, v129, 16, v128
    v_lshl_or_b32 v187, v131, 16, v130
    v_lshl_or_b32 v188, v133, 16, v132
    v_lshl_or_b32 v189, v135, 16, v134
    v_lshl_or_b32 v190, v137, 16, v136
    v_lshl_or_b32 v191, v139, 16, v138
    v_lshl_or_b32 v192, v141, 16, v140
    v_lshl_or_b32 v193, v143, 16, v142
    v_lshl_or_b32 v194, v145, 16, v144
    v_lshl_or_b32 v195, v147, 16, v146
    v_lshl_or_b32 v196, v149, 16, v148
    v_lshl_or_b32 v197, v151, 16, v150
    v_lshl_or_b32 v198, v153, 16, v152
    v_lshl_or_b32 v199, v155, 16, v154
    v_lshl_or_b32 v200, v157, 16, v156
    v_lshl_or_b32 v201, v159, 16, v158
    v_lshl_or_b32 v202, v161, 16, v160
    v_lshl_or_b32 v203, v163, 16, v162
    v_lshl_or_b32 v204, v165, 16, v164
    v_lshl_or_b32 v205, v167, 16, v166
    v_lshl_or_b32 v206, v169, 16, v168
    v_lshl_or_b32 v207, v171, 16, v170
    v_lshl_or_b32 v208, v173, 16, v172
    v_lshl_or_b32 v209, v175, 16, v174
    v_lshl_or_b32 v210, v177, 16, v176
    v_lshl_or_b32 v211, v179, 16, v178
    v_mfma_f32_16x16x32_bf16 v[84:87], v[180:183], v[76:79], v[84:87]
    v_mfma_f32_16x16x32_bf16 v[88:91], v[184:187], v[76:79], v[88:91]
    v_mfma_f32_16x16x32_bf16 v[92:95], v[188:191], v[76:79], v[92:95]
    v_mfma_f32_16x16x32_bf16 v[96:99], v[192:195], v[76:79], v[96:99]
    v_mfma_f32_16x16x32_bf16 v[100:103], v[196:199], v[76:79], v[100:103]
    v_mfma_f32_16x16x32_bf16 v[104:107], v[200:203], v[76:79], v[104:107]
    v_mfma_f32_16x16x32_bf16 v[108:111], v[204:207], v[76:79], v[108:111]
    v_mfma_f32_16x16x32_bf16 v[112:115], v[208:211], v[76:79], v[112:115]
    s_add_u32 s58, s58, 64
    s_add_u32 s59, s59, 262144
    s_add_u32 s57, s57, 1
    s_cmp_lt_u32 s57, 20
    s_cbranch_scc1 gqa_kernel_sl_q
    v_mul_f32 v84, s46, v84
    v_mul_f32 v85, s46, v85
    v_mul_f32 v86, s46, v86
    v_mul_f32 v87, s46, v87
    v_mul_f32 v88, s46, v88
    v_mul_f32 v89, s46, v89
    v_mul_f32 v90, s46, v90
    v_mul_f32 v91, s46, v91
    v_mul_f32 v92, s46, v92
    v_mul_f32 v93, s46, v93
    v_mul_f32 v94, s46, v94
    v_mul_f32 v95, s46, v95
    v_mul_f32 v96, s46, v96
    v_mul_f32 v97, s46, v97
    v_mul_f32 v98, s46, v98
    v_mul_f32 v99, s46, v99
    v_mul_f32 v100, s46, v100
    v_mul_f32 v101, s46, v101
    v_mul_f32 v102, s46, v102
    v_mul_f32 v103, s46, v103
    v_mul_f32 v104, s46, v104
    v_mul_f32 v105, s46, v105
    v_mul_f32 v106, s46, v106
    v_mul_f32 v107, s46, v107
    v_mul_f32 v108, s46, v108
    v_mul_f32 v109, s46, v109
    v_mul_f32 v110, s46, v110
    v_mul_f32 v111, s46, v111
    v_mul_f32 v112, s46, v112
    v_mul_f32 v113, s46, v113
    v_mul_f32 v114, s46, v114
    v_mul_f32 v115, s46, v115
    v_cvt_pk_bf16_f32 v52, v84, v85
    v_cvt_pk_bf16_f32 v53, v86, v87
    v_cvt_pk_bf16_f32 v54, v88, v89
    v_cvt_pk_bf16_f32 v55, v90, v91
    v_cvt_pk_bf16_f32 v56, v92, v93
    v_cvt_pk_bf16_f32 v57, v94, v95
    v_cvt_pk_bf16_f32 v58, v96, v97
    v_cvt_pk_bf16_f32 v59, v98, v99
    v_cvt_pk_bf16_f32 v60, v100, v101
    v_cvt_pk_bf16_f32 v61, v102, v103
    v_cvt_pk_bf16_f32 v62, v104, v105
    v_cvt_pk_bf16_f32 v63, v106, v107
    v_cvt_pk_bf16_f32 v64, v108, v109
    v_cvt_pk_bf16_f32 v65, v110, v111
    v_cvt_pk_bf16_f32 v66, v112, v113
    v_cvt_pk_bf16_f32 v67, v114, v115
    v_mov_b32 v84, 0
    v_mov_b32 v85, 0
    v_mov_b32 v86, 0
    v_mov_b32 v87, 0
    v_mov_b32 v88, 0
    v_mov_b32 v89, 0
    v_mov_b32 v90, 0
    v_mov_b32 v91, 0
    v_mov_b32 v92, 0
    v_mov_b32 v93, 0
    v_mov_b32 v94, 0
    v_mov_b32 v95, 0
    v_mov_b32 v96, 0
    v_mov_b32 v97, 0
    v_mov_b32 v98, 0
    v_mov_b32 v99, 0
    v_mov_b32 v100, 0
    v_mov_b32 v101, 0
    v_mov_b32 v102, 0
    v_mov_b32 v103, 0
    v_mov_b32 v104, 0
    v_mov_b32 v105, 0
    v_mov_b32 v106, 0
    v_mov_b32 v107, 0
    v_mov_b32 v108, 0
    v_mov_b32 v109, 0
    v_mov_b32 v110, 0
    v_mov_b32 v111, 0
    v_mov_b32 v112, 0
    v_mov_b32 v113, 0
    v_mov_b32 v114, 0
    v_mov_b32 v115, 0
    v_mov_b32 v48, 0
    v_mov_b32 v49, 0
    v_mov_b32 v50, 0
    v_mov_b32 v51, 0
    v_mov_b32 v40, 0xff800000
    s_mov_b32 s90, s88
    s_mov_b32 s57, 0
gqa_kernel_sl_m:
    buffer_load_dwordx2 v[180:181], v37, s[12:15], s90 offen offset:0
    buffer_load_dwordx2 v[182:183], v37, s[12:15], s90 offen offset:32
    buffer_load_dwordx2 v[184:185], v37, s[12:15], s90 offen offset:64
    buffer_load_dwordx2 v[186:187], v37, s[12:15], s90 offen offset:96
    buffer_load_dwordx2 v[188:189], v37, s[12:15], s90 offen offset:128
    buffer_load_dwordx2 v[190:191], v37, s[12:15], s90 offen offset:160
    buffer_load_dwordx2 v[192:193], v37, s[12:15], s90 offen offset:192
    buffer_load_dwordx2 v[194:195], v37, s[12:15], s90 offen offset:224
    s_waitcnt vmcnt(0) lgkmcnt(0)
    v_mfma_f32_16x16x32_bf16 v[68:71], v[180:183], v[52:55], 0
    v_mfma_f32_16x16x32_bf16 v[68:71], v[184:187], v[56:59], v[68:71]
    v_mfma_f32_16x16x32_bf16 v[68:71], v[188:191], v[60:63], v[68:71]
    v_mfma_f32_16x16x32_bf16 v[68:71], v[192:195], v[64:67], v[68:71]
    s_nop 7
    v_max3_f32 v40, v40, v68, v69
    v_max3_f32 v40, v40, v70, v71
    s_add_u32 s90, s90, 4096
    s_add_u32 s57, s57, 1
    s_cmp_lt_u32 s57, 32
    s_cbranch_scc1 gqa_kernel_sl_m
    v_mov_b32 v41, v40
    s_nop 1
    v_permlane32_swap_b32 v40, v41
    v_max_f32 v40, v40, v41
    v_mov_b32 v41, v40
    s_nop 1
    v_permlane16_swap_b32 v40, v41
    v_max_f32 v40, v40, v41
    v_sub_f32 v44, 0, v40
    v_sub_f32 v45, 0, v40
    v_sub_f32 v46, 0, v40
    v_sub_f32 v47, 0, v40
    s_mov_b32 s57, 0
gqa_kernel_sl_a:
    s_add_u32 s90, s88, 4096
    buffer_load_dwordx2 v[180:181], v37, s[12:15], s88 offen offset:0
    buffer_load_dwordx2 v[182:183], v37, s[12:15], s88 offen offset:32
    buffer_load_dwordx2 v[184:185], v37, s[12:15], s88 offen offset:64
    buffer_load_dwordx2 v[186:187], v37, s[12:15], s88 offen offset:96
    buffer_load_dwordx2 v[188:189], v37, s[12:15], s88 offen offset:128
    buffer_load_dwordx2 v[190:191], v37, s[12:15], s88 offen offset:160
    buffer_load_dwordx2 v[192:193], v37, s[12:15], s88 offen offset:192
    buffer_load_dwordx2 v[194:195], v37, s[12:15], s88 offen offset:224
    buffer_load_dwordx2 v[196:197], v37, s[12:15], s90 offen offset:0
    buffer_load_dwordx2 v[198:199], v37, s[12:15], s90 offen offset:32
    buffer_load_dwordx2 v[200:201], v37, s[12:15], s90 offen offset:64
    buffer_load_dwordx2 v[202:203], v37, s[12:15], s90 offen offset:96
    buffer_load_dwordx2 v[204:205], v37, s[12:15], s90 offen offset:128
    buffer_load_dwordx2 v[206:207], v37, s[12:15], s90 offen offset:160
    buffer_load_dwordx2 v[208:209], v37, s[12:15], s90 offen offset:192
    buffer_load_dwordx2 v[210:211], v37, s[12:15], s90 offen offset:224
    s_waitcnt vmcnt(0) lgkmcnt(0)
    buffer_load_ushort v116, v38, s[16:19], s88 offen offset:0
    buffer_load_ushort v117, v38, s[16:19], s88 offen offset:256
    buffer_load_ushort v118, v38, s[16:19], s88 offen offset:512
    buffer_load_ushort v119, v38, s[16:19], s88 offen offset:768
    buffer_load_ushort v120, v38, s[16:19], s90 offen offset:0
    buffer_load_ushort v121, v38, s[16:19], s90 offen offset:256
    buffer_load_ushort v122, v38, s[16:19], s90 offen offset:512
    buffer_load_ushort v123, v38, s[16:19], s90 offen offset:768
    buffer_load_ushort v124, v38, s[16:19], s88 offen offset:32
    buffer_load_ushort v125, v38, s[16:19], s88 offen offset:288
    buffer_load_ushort v126, v38, s[16:19], s88 offen offset:544
    buffer_load_ushort v127, v38, s[16:19], s88 offen offset:800
    buffer_load_ushort v128, v38, s[16:19], s90 offen offset:32
    buffer_load_ushort v129, v38, s[16:19], s90 offen offset:288
    buffer_load_ushort v130, v38, s[16:19], s90 offen offset:544
    buffer_load_ushort v131, v38, s[16:19], s90 offen offset:800
    buffer_load_ushort v132, v38, s[16:19], s88 offen offset:64
    buffer_load_ushort v133, v38, s[16:19], s88 offen offset:320
    buffer_load_ushort v134, v38, s[16:19], s88 offen offset:576
    buffer_load_ushort v135, v38, s[16:19], s88 offen offset:832
    buffer_load_ushort v136, v38, s[16:19], s90 offen offset:64
    buffer_load_ushort v137, v38, s[16:19], s90 offen offset:320
    buffer_load_ushort v138, v38, s[16:19], s90 offen offset:576
    buffer_load_ushort v139, v38, s[16:19], s90 offen offset:832
    buffer_load_ushort v140, v38, s[16:19], s88 offen offset:96
    buffer_load_ushort v141, v38, s[16:19], s88 offen offset:352
    buffer_load_ushort v142, v38, s[16:19], s88 offen offset:608
    buffer_load_ushort v143, v38, s[16:19], s88 offen offset:864
    buffer_load_ushort v144, v38, s[16:19], s90 offen offset:96
    buffer_load_ushort v145, v38, s[16:19], s90 offen offset:352
    buffer_load_ushort v146, v38, s[16:19], s90 offen offset:608
    buffer_load_ushort v147, v38, s[16:19], s90 offen offset:864
    s_waitcnt vmcnt(0) lgkmcnt(0)
    buffer_load_ushort v148, v38, s[16:19], s88 offen offset:128
    buffer_load_ushort v149, v38, s[16:19], s88 offen offset:384
    buffer_load_ushort v150, v38, s[16:19], s88 offen offset:640
    buffer_load_ushort v151, v38, s[16:19], s88 offen offset:896
    buffer_load_ushort v152, v38, s[16:19], s90 offen offset:128
    buffer_load_ushort v153, v38, s[16:19], s90 offen offset:384
    buffer_load_ushort v154, v38, s[16:19], s90 offen offset:640
    buffer_load_ushort v155, v38, s[16:19], s90 offen offset:896
    buffer_load_ushort v156, v38, s[16:19], s88 offen offset:160
    buffer_load_ushort v157, v38, s[16:19], s88 offen offset:416
    buffer_load_ushort v158, v38, s[16:19], s88 offen offset:672
    buffer_load_ushort v159, v38, s[16:19], s88 offen offset:928
    buffer_load_ushort v160, v38, s[16:19], s90 offen offset:160
    buffer_load_ushort v161, v38, s[16:19], s90 offen offset:416
    buffer_load_ushort v162, v38, s[16:19], s90 offen offset:672
    buffer_load_ushort v163, v38, s[16:19], s90 offen offset:928
    buffer_load_ushort v164, v38, s[16:19], s88 offen offset:192
    buffer_load_ushort v165, v38, s[16:19], s88 offen offset:448
    buffer_load_ushort v166, v38, s[16:19], s88 offen offset:704
    buffer_load_ushort v167, v38, s[16:19], s88 offen offset:960
    buffer_load_ushort v168, v38, s[16:19], s90 offen offset:192
    buffer_load_ushort v169, v38, s[16:19], s90 offen offset:448
    buffer_load_ushort v170, v38, s[16:19], s90 offen offset:704
    buffer_load_ushort v171, v38, s[16:19], s90 offen offset:960
    buffer_load_ushort v172, v38, s[16:19], s88 offen offset:224
    buffer_load_ushort v173, v38, s[16:19], s88 offen offset:480
    buffer_load_ushort v174, v38, s[16:19], s88 offen offset:736
    buffer_load_ushort v175, v38, s[16:19], s88 offen offset:992
    buffer_load_ushort v176, v38, s[16:19], s90 offen offset:224
    buffer_load_ushort v177, v38, s[16:19], s90 offen offset:480
    buffer_load_ushort v178, v38, s[16:19], s90 offen offset:736
    buffer_load_ushort v179, v38, s[16:19], s90 offen offset:992
    v_mfma_f32_16x16x32_bf16 v[68:71], v[180:183], v[52:55], v[44:47]
    v_mfma_f32_16x16x32_bf16 v[68:71], v[184:187], v[56:59], v[68:71]
    v_mfma_f32_16x16x32_bf16 v[68:71], v[188:191], v[60:63], v[68:71]
    v_mfma_f32_16x16x32_bf16 v[68:71], v[192:195], v[64:67], v[68:71]
    v_mfma_f32_16x16x32_bf16 v[72:75], v[196:199], v[52:55], v[44:47]
    v_mfma_f32_16x16x32_bf16 v[72:75], v[200:203], v[56:59], v[72:75]
    v_mfma_f32_16x16x32_bf16 v[72:75], v[204:207], v[60:63], v[72:75]
    v_mfma_f32_16x16x32_bf16 v[72:75], v[208:211], v[64:67], v[72:75]
    s_nop 3
    v_exp_f32 v68, v68
    v_exp_f32 v69, v69
    v_exp_f32 v70, v70
    v_exp_f32 v71, v71
    v_exp_f32 v72, v72
    v_exp_f32 v73, v73
    v_exp_f32 v74, v74
    v_exp_f32 v75, v75
    v_cvt_pk_bf16_f32 v76, v68, v69
    v_cvt_pk_bf16_f32 v77, v70, v71
    v_cvt_pk_bf16_f32 v78, v72, v73
    v_cvt_pk_bf16_f32 v79, v74, v75
    s_waitcnt vmcnt(0) lgkmcnt(0)
    v_lshl_or_b32 v180, v117, 16, v116
    v_lshl_or_b32 v181, v119, 16, v118
    v_lshl_or_b32 v182, v121, 16, v120
    v_lshl_or_b32 v183, v123, 16, v122
    v_lshl_or_b32 v184, v125, 16, v124
    v_lshl_or_b32 v185, v127, 16, v126
    v_lshl_or_b32 v186, v129, 16, v128
    v_lshl_or_b32 v187, v131, 16, v130
    v_lshl_or_b32 v188, v133, 16, v132
    v_lshl_or_b32 v189, v135, 16, v134
    v_lshl_or_b32 v190, v137, 16, v136
    v_lshl_or_b32 v191, v139, 16, v138
    v_lshl_or_b32 v192, v141, 16, v140
    v_lshl_or_b32 v193, v143, 16, v142
    v_lshl_or_b32 v194, v145, 16, v144
    v_lshl_or_b32 v195, v147, 16, v146
    v_lshl_or_b32 v196, v149, 16, v148
    v_lshl_or_b32 v197, v151, 16, v150
    v_lshl_or_b32 v198, v153, 16, v152
    v_lshl_or_b32 v199, v155, 16, v154
    v_lshl_or_b32 v200, v157, 16, v156
    v_lshl_or_b32 v201, v159, 16, v158
    v_lshl_or_b32 v202, v161, 16, v160
    v_lshl_or_b32 v203, v163, 16, v162
    v_lshl_or_b32 v204, v165, 16, v164
    v_lshl_or_b32 v205, v167, 16, v166
    v_lshl_or_b32 v206, v169, 16, v168
    v_lshl_or_b32 v207, v171, 16, v170
    v_lshl_or_b32 v208, v173, 16, v172
    v_lshl_or_b32 v209, v175, 16, v174
    v_lshl_or_b32 v210, v177, 16, v176
    v_lshl_or_b32 v211, v179, 16, v178
    v_mfma_f32_16x16x32_bf16 v[48:51], a[180:183], v[76:79], v[48:51]
    v_mfma_f32_16x16x32_bf16 v[84:87], v[180:183], v[76:79], v[84:87]
    v_mfma_f32_16x16x32_bf16 v[88:91], v[184:187], v[76:79], v[88:91]
    v_mfma_f32_16x16x32_bf16 v[92:95], v[188:191], v[76:79], v[92:95]
    v_mfma_f32_16x16x32_bf16 v[96:99], v[192:195], v[76:79], v[96:99]
    v_mfma_f32_16x16x32_bf16 v[100:103], v[196:199], v[76:79], v[100:103]
    v_mfma_f32_16x16x32_bf16 v[104:107], v[200:203], v[76:79], v[104:107]
    v_mfma_f32_16x16x32_bf16 v[108:111], v[204:207], v[76:79], v[108:111]
    v_mfma_f32_16x16x32_bf16 v[112:115], v[208:211], v[76:79], v[112:115]
    s_add_u32 s88, s88, 8192
    s_add_u32 s57, s57, 1
    s_cmp_lt_u32 s57, 16
    s_cbranch_scc1 gqa_kernel_sl_a
    v_rcp_f32 v48, v48
    s_nop 0
    v_mul_f32 v84, v84, v48
    v_mul_f32 v85, v85, v48
    v_mul_f32 v86, v86, v48
    v_mul_f32 v87, v87, v48
    v_mul_f32 v88, v88, v48
    v_mul_f32 v89, v89, v48
    v_mul_f32 v90, v90, v48
    v_mul_f32 v91, v91, v48
    v_mul_f32 v92, v92, v48
    v_mul_f32 v93, v93, v48
    v_mul_f32 v94, v94, v48
    v_mul_f32 v95, v95, v48
    v_mul_f32 v96, v96, v48
    v_mul_f32 v97, v97, v48
    v_mul_f32 v98, v98, v48
    v_mul_f32 v99, v99, v48
    v_mul_f32 v100, v100, v48
    v_mul_f32 v101, v101, v48
    v_mul_f32 v102, v102, v48
    v_mul_f32 v103, v103, v48
    v_mul_f32 v104, v104, v48
    v_mul_f32 v105, v105, v48
    v_mul_f32 v106, v106, v48
    v_mul_f32 v107, v107, v48
    v_mul_f32 v108, v108, v48
    v_mul_f32 v109, v109, v48
    v_mul_f32 v110, v110, v48
    v_mul_f32 v111, v111, v48
    v_mul_f32 v112, v112, v48
    v_mul_f32 v113, v113, v48
    v_mul_f32 v114, v114, v48
    v_mul_f32 v115, v115, v48
    v_cvt_pk_bf16_f32 v52, v84, v85
    v_cvt_pk_bf16_f32 v53, v86, v87
    v_cvt_pk_bf16_f32 v54, v88, v89
    v_cvt_pk_bf16_f32 v55, v90, v91
    v_cvt_pk_bf16_f32 v56, v92, v93
    v_cvt_pk_bf16_f32 v57, v94, v95
    v_cvt_pk_bf16_f32 v58, v96, v97
    v_cvt_pk_bf16_f32 v59, v98, v99
    v_cvt_pk_bf16_f32 v60, v100, v101
    v_cvt_pk_bf16_f32 v61, v102, v103
    v_cvt_pk_bf16_f32 v62, v104, v105
    v_cvt_pk_bf16_f32 v63, v106, v107
    v_cvt_pk_bf16_f32 v64, v108, v109
    v_cvt_pk_bf16_f32 v65, v110, v111
    v_cvt_pk_bf16_f32 v66, v112, v113
    v_cvt_pk_bf16_f32 v67, v114, v115
    s_cmp_eq_u32 s95, 0
    s_cselect_b32 s40, 0, s41
    s_cmp_eq_u32 s40, 4
    s_cbranch_scc1 gqa_kernel_sl_s0
    ds_write_b128 v39, v[52:55] offset:0
    ds_write_b128 v39, v[56:59] offset:18432
gqa_kernel_sl_s0:
    s_cmp_eq_u32 s95, 1
    s_cselect_b32 s40, 0, s41
    s_cmp_eq_u32 s40, 4
    s_cbranch_scc1 gqa_kernel_sl_s1
    ds_write_b128 v39, v[60:63] offset:36864
    ds_write_b128 v39, v[64:67] offset:55296
gqa_kernel_sl_s1:
    s_waitcnt vmcnt(0) lgkmcnt(0)
    s_add_u32 s56, s56, 1
    s_cmp_lt_u32 s56, 10
    s_cbranch_scc1 gqa_kernel_sl_it
    s_branch gqa_kernel_P2
gqa_kernel_last:
.if gqa_kernel_last-gqa_kernel_pc < 68608
.fill (68608-(gqa_kernel_last-gqa_kernel_pc))/4, 4, 0xbf810000
.endif
.if gqa_kernel_end-gqa_kernel_pc > 68608
.warning "code range"
.endif
.section .rodata,"a"
.p2align 6
.amdhsa_kernel standalone__gqa_block_cached__near_ridge_kernel
  .amdhsa_next_free_vgpr 512
  .amdhsa_next_free_sgpr 102
  .amdhsa_accum_offset 256
  .amdhsa_group_segment_fixed_size 0
  .amdhsa_kernarg_size 64
  .amdhsa_user_sgpr_count 2
  .amdhsa_user_sgpr_kernarg_segment_ptr 1
  .amdhsa_system_sgpr_workgroup_id_x 1
.end_amdhsa_kernel
```
